```python
import torch

def _softmax(x, axis=-1):
    return torch.softmax(x, dim=axis)
def _gelu(x):
    return torch.nn.functional.gelu(x, approximate="tanh")
def _silu(x):
    return torch.nn.functional.silu(x)
def _sigmoid(x):
    return torch.sigmoid(x)
def _layernorm(x, axis=-1, eps=1e-5):
    m = x.mean(dim=axis, keepdim=True)
    v = x.var(dim=axis, keepdim=True, unbiased=False)
    return (x - m) / torch.sqrt(v + eps)
def _scatter_add(tgt, idx, src, axis=0):
    return tgt.clone().index_add_(axis, idx, src)
def _segment_sum(src, seg, n):
    out = torch.zeros((n,) + src.shape[1:], dtype=src.dtype)
    return out.index_add_(0, seg, src)
def _pad(x, pw):
    flat = tuple(v for pair in reversed(pw) for v in pair)
    return torch.nn.functional.pad(x, flat)

kernel_name = 'interleave_layers__ssm_conv_h3__mixer_s_mlp__prompt'

def setup_inputs():

    _w = (lambda a: (lambda t: t.to(torch.bfloat16) if t.is_floating_point() else t)(torch.as_tensor(a)))
    def _A_setup():
        B, S, D = 1, 2048, 512
        ks = 4
        return {
            "q": _w((lambda *s: torch.randn(*s, dtype=torch.bfloat16) * 0.05)(B, S, D)),
            "k": _w((lambda *s: torch.randn(*s, dtype=torch.bfloat16) * 0.8)(B, S, D)),
            "v": _w((lambda *s: torch.randn(*s, dtype=torch.bfloat16) * 0.8)(B, S, D)),
            "shift_k": _w((lambda *s: torch.randn(*s, dtype=torch.bfloat16) * 0.8)(D, ks) * 0.5),
            "ssm_k": _w((lambda *s: torch.randn(*s, dtype=torch.bfloat16) * 0.8)(D, S) * (1.0 / S ** 0.5)),
            "ssm_D": _w((lambda *s: torch.randn(*s, dtype=torch.bfloat16) * 0.8)(D)),
        }
    _A_in = _A_setup()

    def _B_setup():
        B, S, D, F = 1, 2048, 512, 1792
        return {
            "x":  _w((lambda *s: torch.randn(*s, dtype=torch.bfloat16) * 0.05)(B, S, D)),
            "w1": _w((lambda *s: torch.randn(*s, dtype=torch.bfloat16) * 3.2)(D, D) * (D ** -0.5)),
            "w2": _w((lambda *s: torch.randn(*s, dtype=torch.bfloat16) * 3.2)(D, D) * (D ** -0.5)),
            "w3": _w((lambda *s: torch.randn(*s, dtype=torch.bfloat16) * 3.2)(D, F) * (D ** -0.5)),
            "w4": _w((lambda *s: torch.randn(*s, dtype=torch.bfloat16) * 3.2)(F, D) * (F ** -0.5)),
        }
    _B_in = _B_setup()

    return {
        "A_q": _A_in["q"],
        "A_k": _A_in["k"],
        "A_v": _A_in["v"],
        "A_shift_k": _A_in["shift_k"],
        "A_ssm_k": _A_in["ssm_k"],
        "A_ssm_D": _A_in["ssm_D"],
        "B_x": _B_in["x"],
        "B_w1": _B_in["w1"],
        "B_w2": _B_in["w2"],
        "B_w3": _B_in["w3"],
        "B_w4": _B_in["w4"],
    }

def reference(A_q, A_k, A_v, A_shift_k, A_ssm_k, A_ssm_D, B_x, B_w1, B_w2, B_w3, B_w4):
    def _A_ref(q, k, v, shift_k, ssm_k, ssm_D):
        B, S, D = q.shape
        ks = shift_k.shape[-1]
        k_pad = _pad(k, ((0, 0), (ks - 1, 0), (0, 0)))
        k_shift = torch.zeros_like(k)
        for t in range(ks):
            k_shift = k_shift + k_pad[:, t:t + S, :] * shift_k[:, ks - 1 - t][None, None, :]
        kv = k_shift * v
        L = 2 * S
        kv_pad = _pad(kv, ((0, 0), (0, S), (0, 0)))
        kf_pad = _pad(ssm_k, ((0, 0), (0, S)))
        kv_f = (lambda x, axes=(-2,-1): torch.fft.rfft2(x.float(), dim=axes))(kv_pad[:, None, :, :], axes=(1, 2))
        kf_f = (lambda x, axes=(-2,-1): torch.fft.rfft2(x.float(), dim=axes))(kf_pad[:, None, :], axes=(1, 2))
        kf_f = (lambda x, *d: x.permute(*d))(kf_f, 1, 2, 0)
        y_f = kv_f * kf_f[None, :, :, :]
        y = (lambda x, s, axes=(-2,-1): torch.fft.irfft2(x, s=s, dim=axes).to(torch.bfloat16))(y_f, (1, L), axes=(1, 2))[:, 0, :S, :]
        y = y + kv * ssm_D[None, None, :]
        return q * y

    def _B_ref(x, w1, w2, w3, w4):
        B, S, D = x.shape
        h = _gelu(_layernorm(x, axis=-1) @ w1)
        c = D // 4
        g0 = _pad(h[:, :, 0*c:1*c], ((0, 0), (1, 0), (0, 0)))[:, :S, :]
        g1 = _pad(h[:, :, 1*c:2*c], ((0, 0), (0, 1), (0, 0)))[:, 1:, :]
        g2 = _pad(h[:, :, 2*c:3*c], ((0, 0), (2, 0), (0, 0)))[:, :S, :]
        g3 = _pad(h[:, :, 3*c:   ], ((0, 0), (0, 2), (0, 0)))[:, 2:, :]
        hs = torch.concatenate([g0, g1, g2, g3], axis=-1) @ w2
        x1 = x + hs
        h2 = _gelu(_layernorm(x1, axis=-1) @ w3) @ w4
        return x1 + h2

    x = A_q
    x = x + _A_ref(_layernorm(x, axis=-1), A_k, A_v, A_shift_k, A_ssm_k, A_ssm_D)
    x = x + _B_ref(_layernorm(x, axis=-1), B_w1, B_w2, B_w3, B_w4)
    x = x + _A_ref(_layernorm(x, axis=-1), A_k, A_v, A_shift_k, A_ssm_k, A_ssm_D)
    x = x + _B_ref(_layernorm(x, axis=-1), B_w1, B_w2, B_w3, B_w4)
    return x
```

```asm
; @launch grid=(256,1,1) block=(256,1,1) lds=163840
.amdgcn_target "amdgcn-amd-amdhsa--gfx950"
.text
.globl interleave_layers__ssm_conv_h3__mixer_s_mlp__prompt_kernel
.p2align 8
.type interleave_layers__ssm_conv_h3__mixer_s_mlp__prompt_kernel,@function
interleave_layers__ssm_conv_h3__mixer_s_mlp__prompt_kernel:
    s_cmp_ge_u32 s2, 256
    s_nop 0
    s_cbranch_scc1 L_end
    s_load_dwordx16 s[48:63], s[0:1], 0
    s_load_dwordx2 s[8:9], s[0:1], 104
    s_load_dwordx2 s[12:13], s[0:1], 88
    s_load_dwordx8 s[76:83], s[0:1], 56
    s_getpc_b64 s[96:97]
L_pc:
    s_and_b32 s86, s2, 7
    s_lshr_b32 s87, s2, 3
    v_lshlrev_b32 v64, 4, v0
    s_lshl_b32 s89, s87, 12
    v_add_u32 v65, s89, v64
    v_min_u32 v65, L_codeend-L_pc-4, v65
    global_load_dword v62, v65, s[96:97]
    s_getreg_b32 s88, hwreg(HW_REG_XCC_ID, 0, 4)
    s_lshl_b32 s67, s86, 21
    v_mov_b32 v15, v0
    v_lshrrev_b32 v16, 6, v0
    v_and_b32 v0, 63, v0
    v_readfirstlane_b32 s44, v16
    v_lshlrev_b32 v1, 4, v0
    s_mov_b32 s10, 0x10000000
    s_mov_b32 s11, 0x20000
    s_mov_b32 s18, 0x200000
    s_mov_b32 s19, 0x20000
    s_mov_b32 s22, 0x200000
    s_mov_b32 s23, 0x20000
    s_mov_b32 s26, 0x1000
    s_mov_b32 s27, 0x20000
    s_mov_b32 s30, 0x200000
    s_mov_b32 s31, 0x20000
    s_mov_b32 s42, 0x200000
    s_mov_b32 s43, 0x20000
    s_mov_b32 s14, 0x200000
    s_mov_b32 s15, 0x20000
    s_mov_b32 s38, 0x1c0000
    s_mov_b32 s39, 0x20000
    v_and_b32 v65, 31, v0
    v_and_b32 v66, 7, v0
    v_lshrrev_b32 v73, 3, v0
    v_lshrrev_b32 v77, 3, v15
    s_lshl_b32 s94, s86, 5
    v_add_u32 v67, s94, v77
    s_lshl_b32 s89, s87, 16
    s_lshl_b32 s90, s86, 7
    s_add_u32 s89, s89, s90
    v_lshlrev_b32 v72, 10, v73
    v_lshl_add_u32 v72, v66, 4, v72
    v_add_u32 v72, s89, v72
    v_subrev_u32 v74, 8192, v72
    v_lshlrev_b32 v75, 4, v67
    v_subrev_u32 v76, 4, v64
    v_cmp_eq_u32 vcc, 0, v0
    s_nop 1
    v_cndmask_b32 v76, -4, v76, vcc
    s_add_u32 s94, s94, s87
    s_lshl_b32 s91, s94, 13
    s_lshl_b32 s92, s94, 2
    s_mov_b32 s93, 0x1130000
    s_lshr_b32 s90, s87, 3
    s_lshl_b32 s90, s90, 18
    s_add_u32 s90, s90, s67
    s_and_b32 s89, s87, 7
    s_lshl_b32 s7, s89, 12
    s_add_u32 s7, s7, s90
    s_add_u32 s7, s7, 0x10000
    s_lshr_b32 s5, s87, 2
    s_lshl_b32 s5, s5, 17
    s_and_b32 s94, s87, 3
    s_lshl_b32 s94, s94, 12
    s_add_u32 s5, s5, s94
    s_add_u32 s5, s5, s67
    s_add_u32 s5, s5, 0x18000
    s_lshl_b32 s89, s89, 9
    s_add_u32 s89, s89, 0x1c000
    v_bfe_u32 v70, v0, 3, 1
    v_lshl_add_u32 v70, v70, 12, s89
    v_mov_b32 v69, 0x1e000
    v_cmp_gt_u32 vcc, 32, v0
    s_nop 1
    v_cndmask_b32 v70, v69, v70, vcc
    v_bfe_u32 v69, v0, 4, 1
    v_lshl_add_u32 v70, v69, 17, v70
    v_and_b32 v69, 7, v0
    v_lshl_add_u32 v70, v69, 6, v70
    v_lshlrev_b32 v69, 6, v0
    v_cmp_gt_u32 vcc, 192, v15
    s_nop 1
    v_cndmask_b32 v70, v70, v69, vcc
    s_lshl_b32 s89, s44, 17
    s_add_u32 s89, s89, s7
    s_cmp_eq_u32 s44, 2
    s_cselect_b32 s89, s5, s89
    s_cmp_eq_u32 s44, 3
    s_cselect_b32 s90, s90, s89
    s_lshl_b32 s97, s44, 15
    v_xor_b32 v73, 7, v66
    v_mul_u32_u24 v73, 1056, v73
    v_lshl_add_u32 v73, v77, 2, v73
    v_add_u32 v73, 25216, v73
    s_lshl_b32 s89, s87, 3
    s_sub_u32 s89, 248, s89
    v_add_lshl_u32 v66, v66, s89, 4
    s_lshl_b32 s72, s44, 14
    s_add_u32 s73, s72, 8192
    s_mul_i32 s74, s44, 2112
    v_add_u32 v104, 32128, v73
    v_xor_b32 v105, 4080, v66
    v_lshrrev_b32 v116, 2, v77
    v_lshl_add_u32 v67, v116, 17, v66
    v_and_b32 v116, 3, v77
    v_lshl_add_u32 v67, v116, 12, v67
    v_lshrrev_b32 v116, 3, v77
    v_lshl_add_u32 v66, v116, 18, v66
    v_and_b32 v116, 7, v77
    v_lshl_add_u32 v66, v116, 12, v66
    v_add_u32 v118, 131072, v64
    v_lshlrev_b32 v68, 2, v65
    v_min_u32 v71, 9, v0
    v_lshlrev_b32 v71, 21, v71
    v_add_u32 v71, 0x1f0000, v71
    s_waitcnt lgkmcnt(0)
    s_load_dword s69, s[8:9], s93
    s_mov_b64 s[16:17], s[50:51]
    s_mov_b64 s[20:21], s[52:53]
    s_mov_b64 s[24:25], s[54:55]
    s_load_dword s95, s[58:59], s92
    buffer_load_dwordx4 v[100:103], v75, s[24:27], 0 offen
    s_add_u32 m0, s74, 25632
    s_nop 0
    buffer_load_dwordx4 v72, s[16:19], s72 offen lds
    s_add_u32 m0, s74, 26688
    s_nop 0
    buffer_load_dwordx4 v72, s[16:19], s73 offen lds
    s_add_u32 m0, s74, 57344
    s_nop 0
    buffer_load_dwordx4 v72, s[20:23], s72 offen lds
    s_add_u32 m0, s74, 58400
    s_nop 0
    buffer_load_dwordx4 v72, s[20:23], s73 offen lds
    s_mov_b32 m0, 24576
    s_mov_b32 exec_lo, 0
    s_mov_b32 exec_hi, 0xffffff00
    buffer_load_dwordx4 v74, s[16:19], 0 offen lds
    s_mov_b64 exec, -1
    s_add_u32 s92, s91, 4096
    s_mov_b64 s[28:29], s[56:57]
    s_mov_b64 s[40:41], s[48:49]
    s_mov_b64 s[36:37], s[80:81]
    s_add_u32 s22, s67, 0x10000
    s_add_u32 s23, s22, 0x20000
    s_add_u32 s84, s67, 0x18000
    s_add_u32 s85, s7, 0x20000
    s_mov_b64 s[24:25], s[76:77]
    s_mov_b32 s26, 0x80000
    s_lshr_b32 s93, s87, 4
    s_and_b32 s94, s87, 15
    s_mul_i32 s73, s93, 14
    s_add_u32 s73, s73, s94
    s_lshl_b32 s73, s73, 1
    s_and_b32 s89, s44, 1
    s_add_u32 s73, s73, s89
    s_lshl_b32 s93, s93, 1
    s_add_u32 s93, s93, s94
    s_lshl_b32 s93, s93, 2
    s_add_u32 s93, s93, s44
    s_sub_u32 s93, s93, 56
    s_mul_i32 s89, s86, 56
    s_add_u32 s89, s89, s73
    s_lshr_b32 s72, s44, 1
    s_mov_b32 s34, 0x1c0000
    s_mov_b32 s35, 0x20000
    s_mov_b32 s4, 114688
    s_mov_b32 s3, 0x1200000
    s_cmp_ge_u32 s94, 14
    s_cmov_b32 s72, 0
    s_cmov_b32 s73, s93
    s_cmov_b32 s4, 32768
    s_cmov_b32 s3, 0x1080000
    s_cmov_b32 s34, 0x80000
    s_cselect_b64 s[32:33], s[78:79], s[82:83]
    s_lshl_b32 s93, s73, 11
    s_add_u32 s3, s3, s93
    s_mul_i32 s93, s86, s4
    buffer_load_dword v62, v71, s[8:11], 0 offen
    buffer_load_dword v62, v70, s[8:11], s90 offen
    s_lshl_b32 s93, s93, 1
    s_add_u32 s3, s3, s93
    s_lshl_b32 s73, s73, 15
    s_lshl_b32 s93, s86, 7
    s_add_u32 s73, s73, s93
    s_lshr_b32 s93, s89, 4
    s_and_b32 s94, s89, 15
    s_mul_i32 s89, s94, 114688
    s_lshl_b32 s20, s93, 7
    s_add_u32 s89, s89, s20
    s_lshl_b32 s93, s93, 12
    s_lshl_b32 s94, s94, 7
    s_add_u32 s93, s93, s94
    s_add_u32 s93, s93, 0x1100000
    s_movk_i32 s94, 1024
    s_cmp_lg_u32 s72, 0
    s_cmov_b32 s73, s89
    s_cmov_b32 s3, s93
    s_cmovk_i32 s94, 3584
    s_cselect_b64 s[32:33], s[36:37], s[32:33]
    s_lshl_b32 s20, s94, 3
    s_sub_u32 s20, s20, 1024
    v_bfe_u32 v77, v0, 2, 3
    v_lshrrev_b32 v78, 5, v0
    v_and_b32 v79, 48, v1
    v_lshl_add_u32 v78, v78, 6, v79
    v_mad_u32_u24 v60, v77, s94, v78
    v_lshl_add_u32 v61, v77, 10, v78
    v_mul_u32_u24 v79, 3584, v77
    s_add_u32 s19, s67, 0x108000
    s_lshl_b32 s16, s87, 2
    s_add_u32 s16, s16, s19
    s_cmp_eq_u32 s44, 3
    s_cselect_b32 s16, s16, 0x40000000
    s_waitcnt lgkmcnt(0)
    s_and_b32 s69, s69, -16
    s_add_u32 s69, s69, 0x9e3779b0
    s_or_b32 s88, s88, s69
    v_mov_b32 v69, s88
    s_mov_b64 exec, 1
    buffer_store_dword v69, off, s[8:11], s16 sc1
    s_mov_b64 exec, -1
    v_mov_b32 v227, s69
    v_mov_b32 v231, s69
    v_mov_b32 v234, s69
    v_mov_b32 v235, s69
    s_bfe_u32 s96, s87, 0x20002
    s_mul_i32 s96, s96, 7
    s_and_b32 s89, s87, 3
    s_and_b32 s93, s44, 2
    s_lshl_b32 s93, s93, 1
    s_add_u32 s89, s89, s93
    s_add_u32 s96, s96, s89
    s_lshl_b32 s96, s96, 7
    s_cmp_eq_u32 s89, 7
    s_cselect_b32 s89, 0x40000000, 0
    v_add3_u32 v63, v78, v79, s89
    s_and_b32 s89, s44, 1
    s_mul_i32 s89, s89, 917504
    s_add_u32 s96, s96, s89
    s_lshl_b32 s21, s44, 17
    s_and_b32 s89, s87, 7
    s_lshl_b32 s89, s89, 7
    s_add_u32 s21, s21, s89
    s_mov_b32 s45, 400000
    s_mov_b32 s65, 0x3f80
    s_mov_b32 s66, 0x3f800000
    v_mov_b32 v120, 0
    v_mov_b32 v121, 0
    v_mov_b32 v122, 0
    s_bfe_u32 s89, s87, 0x10003
    s_mul_i32 s89, s89, 7
    s_cmp_eq_u32 s89, s86
    s_cselect_b32 s89, 1, 0
    v_mov_b32 v123, s89
    v_and_b32 v116, 0x290, v1
    s_lshl_b32 s89, s87, 10
    s_add_u32 s89, s89, s67
    s_add_u32 s89, s89, 0x100000
    s_cmp_eq_u32 s44, 3
    s_cselect_b32 s89, s89, 0x40000000
    s_mov_b32 exec_lo, 0x303
    s_mov_b32 exec_hi, 0x303
    buffer_store_dwordx4 v[120:123], v116, s[8:11], s89 offen sc1
    s_mov_b64 exec, -1
    v_cmp_gt_u32 vcc, 32, v15
    v_mov_b32 v123, 0
    s_nop 0
    s_and_saveexec_b64 s[74:75], vcc
    ds_write_b128 v118, v[120:123] offset:4096
    ds_write_b128 v118, v[120:123] offset:8704
    s_mov_b64 exec, -1
    v_cmp_gt_u32 vcc, 2, v15
    s_nop 1
    s_and_saveexec_b64 s[74:75], vcc
    ds_write_b128 v118, v[120:123] offset:9216
    ds_write_b128 v118, v[120:123] offset:13376
    ds_write_b128 v118, v[120:123] offset:17536
    ds_write_b128 v118, v[120:123] offset:21696
    s_mov_b64 exec, -1
    s_waitcnt vmcnt(9)
    v_lshlrev_b32 v128, 16, v100
    v_and_b32 v130, 0xffff0000, v100
    v_lshlrev_b32 v132, 16, v101
    v_and_b32 v134, 0xffff0000, v101
    v_lshlrev_b32 v129, 16, v102
    v_and_b32 v131, 0xffff0000, v102
    v_lshlrev_b32 v133, 16, v103
    v_and_b32 v135, 0xffff0000, v103
    s_branch L_wa
.p2align 12
L_wa:
    s_waitcnt vmcnt(4)
    s_barrier
    ds_read2_b32 v[80:81], v73 offset0:0 offset1:32
    ds_read2_b32 v[82:83], v73 offset0:64 offset1:104
    ds_read2_b32 v[84:85], v73 offset0:136 offset1:168
    ds_read2_b32 v[86:87], v73 offset0:200 offset1:232
    ds_read_b32 v88, v73 offset:1056
    ds_read_b32 v89, v73 offset:1184
    ds_read_b32 v90, v73 offset:1312
    ds_read2_b32 v[240:241], v104 offset0:0 offset1:32
    ds_read2_b32 v[242:243], v104 offset0:64 offset1:96
    ds_read2_b32 v[244:245], v104 offset0:128 offset1:160
    ds_read2_b32 v[246:247], v104 offset0:192 offset1:224
    v_cmp_ne_u32 s[74:75], 0, v105
    s_waitcnt lgkmcnt(10)
    s_nop 0
    v_cndmask_b32 v80, 0, v80, s[74:75]
    v_lshlrev_b32 v136, 16, v80
    v_and_b32 v137, 0xffff0000, v80
    v_cndmask_b32 v81, 0, v81, s[74:75]
    v_lshlrev_b32 v138, 16, v81
    v_and_b32 v139, 0xffff0000, v81
    s_waitcnt lgkmcnt(9)
    v_cndmask_b32 v82, 0, v82, s[74:75]
    v_lshlrev_b32 v140, 16, v82
    v_and_b32 v141, 0xffff0000, v82
    v_lshlrev_b32 v142, 16, v83
    v_and_b32 v143, 0xffff0000, v83
    s_waitcnt lgkmcnt(8)
    v_lshlrev_b32 v144, 16, v84
    v_and_b32 v145, 0xffff0000, v84
    v_lshlrev_b32 v146, 16, v85
    v_and_b32 v147, 0xffff0000, v85
    s_waitcnt lgkmcnt(7)
    v_lshlrev_b32 v148, 16, v86
    v_and_b32 v149, 0xffff0000, v86
    v_lshlrev_b32 v150, 16, v87
    v_and_b32 v151, 0xffff0000, v87
    s_waitcnt lgkmcnt(6)
    v_lshlrev_b32 v152, 16, v88
    v_and_b32 v153, 0xffff0000, v88
    s_waitcnt lgkmcnt(5)
    v_lshlrev_b32 v154, 16, v89
    v_and_b32 v155, 0xffff0000, v89
    s_waitcnt lgkmcnt(4)
    v_lshlrev_b32 v156, 16, v90
    v_and_b32 v157, 0xffff0000, v90
    v_pk_mul_f32 v[160:161], v[142:143], v[128:129]
    v_pk_mul_f32 v[162:163], v[144:145], v[128:129]
    v_pk_mul_f32 v[164:165], v[146:147], v[128:129]
    v_pk_mul_f32 v[166:167], v[148:149], v[128:129]
    v_pk_mul_f32 v[168:169], v[150:151], v[128:129]
    v_pk_mul_f32 v[170:171], v[152:153], v[128:129]
    v_pk_mul_f32 v[172:173], v[154:155], v[128:129]
    v_pk_mul_f32 v[174:175], v[156:157], v[128:129]
    v_pk_fma_f32 v[160:161], v[140:141], v[130:131], v[160:161]
    v_pk_fma_f32 v[162:163], v[142:143], v[130:131], v[162:163]
    v_pk_fma_f32 v[164:165], v[144:145], v[130:131], v[164:165]
    v_pk_fma_f32 v[166:167], v[146:147], v[130:131], v[166:167]
    v_pk_fma_f32 v[168:169], v[148:149], v[130:131], v[168:169]
    v_pk_fma_f32 v[170:171], v[150:151], v[130:131], v[170:171]
    v_pk_fma_f32 v[172:173], v[152:153], v[130:131], v[172:173]
    v_pk_fma_f32 v[174:175], v[154:155], v[130:131], v[174:175]
    v_pk_fma_f32 v[160:161], v[138:139], v[132:133], v[160:161]
    v_pk_fma_f32 v[162:163], v[140:141], v[132:133], v[162:163]
    v_pk_fma_f32 v[164:165], v[142:143], v[132:133], v[164:165]
    v_pk_fma_f32 v[166:167], v[144:145], v[132:133], v[166:167]
    v_pk_fma_f32 v[168:169], v[146:147], v[132:133], v[168:169]
    v_pk_fma_f32 v[170:171], v[148:149], v[132:133], v[170:171]
    v_pk_fma_f32 v[172:173], v[150:151], v[132:133], v[172:173]
    v_pk_fma_f32 v[174:175], v[152:153], v[132:133], v[174:175]
    v_pk_fma_f32 v[160:161], v[136:137], v[134:135], v[160:161]
    v_pk_fma_f32 v[162:163], v[138:139], v[134:135], v[162:163]
    v_pk_fma_f32 v[164:165], v[140:141], v[134:135], v[164:165]
    v_pk_fma_f32 v[166:167], v[142:143], v[134:135], v[166:167]
    v_pk_fma_f32 v[168:169], v[144:145], v[134:135], v[168:169]
    v_pk_fma_f32 v[170:171], v[146:147], v[134:135], v[170:171]
    v_pk_fma_f32 v[172:173], v[148:149], v[134:135], v[172:173]
    v_pk_fma_f32 v[174:175], v[150:151], v[134:135], v[174:175]
    s_waitcnt lgkmcnt(3)
    v_lshlrev_b32 v176, 16, v240
    v_and_b32 v177, 0xffff0000, v240
    v_lshlrev_b32 v178, 16, v241
    v_and_b32 v179, 0xffff0000, v241
    s_waitcnt lgkmcnt(2)
    v_lshlrev_b32 v180, 16, v242
    v_and_b32 v181, 0xffff0000, v242
    v_lshlrev_b32 v182, 16, v243
    v_and_b32 v183, 0xffff0000, v243
    s_waitcnt lgkmcnt(1)
    v_lshlrev_b32 v184, 16, v244
    v_and_b32 v185, 0xffff0000, v244
    v_lshlrev_b32 v186, 16, v245
    v_and_b32 v187, 0xffff0000, v245
    s_waitcnt lgkmcnt(0)
    v_lshlrev_b32 v188, 16, v246
    v_and_b32 v189, 0xffff0000, v246
    v_lshlrev_b32 v190, 16, v247
    v_and_b32 v191, 0xffff0000, v247
    v_pk_mul_f32 v[160:161], v[160:161], v[176:177]
    v_pk_mul_f32 v[162:163], v[162:163], v[178:179]
    v_pk_mul_f32 v[164:165], v[164:165], v[180:181]
    v_pk_mul_f32 v[166:167], v[166:167], v[182:183]
    v_pk_mul_f32 v[168:169], v[168:169], v[184:185]
    v_pk_mul_f32 v[170:171], v[170:171], v[186:187]
    v_pk_mul_f32 v[172:173], v[172:173], v[188:189]
    v_pk_mul_f32 v[174:175], v[174:175], v[190:191]
    v_cvt_pk_bf16_f32 v224, v174, v172
    v_cvt_pk_bf16_f32 v225, v170, v168
    v_cvt_pk_bf16_f32 v226, v166, v164
    v_cvt_pk_bf16_f32 v232, v162, v160
    v_cvt_pk_bf16_f32 v228, v175, v173
    v_cvt_pk_bf16_f32 v229, v171, v169
    v_cvt_pk_bf16_f32 v230, v167, v165
    v_cvt_pk_bf16_f32 v233, v163, v161
    buffer_store_dwordx4 v[224:227], v66, s[8:11], s22 offen
    buffer_store_dwordx4 v[228:231], v66, s[8:11], s23 offen
    buffer_store_dwordx4 v[232:235], v67, s[8:11], s84 offen
    s_lshr_b32 s76, s87, 3
    s_lshl_b32 s76, s76, 1
    s_and_b32 s77, s44, 1
    buffer_load_dwordx4 v[192:195], v64, s[28:31], s91 offen
    buffer_load_dwordx4 v[196:199], v64, s[28:31], s92 offen
    buffer_load_dword v200, v76, s[28:31], s91 offen
    buffer_load_dword v201, v76, s[28:31], s92 offen
    s_add_u32 s81, s76, s77
    s_lshl_b32 s82, s81, 17
    s_add_u32 s82, s82, s67
    s_lshl_b32 s80, s44, 13
    s_and_b32 s70, s87, 7
    s_lshl_b32 s70, s70, 1
    s_lshr_b32 s78, s44, 1
    s_add_u32 s70, s70, s78
    s_lshl_b32 s78, s70, 11
    s_add_u32 s46, s78, s82
    s_add_u32 s49, s82, 0x1c000
    s_lshr_b32 s79, s70, 2
    s_lshl_b32 s79, s79, 10
    s_add_u32 s48, s49, s79
    s_and_b32 s79, s70, 3
    s_lshl_b32 s79, s79, 2
    s_add_u32 s48, s48, s79
    s_add_u32 s79, s82, 0x1e000
    s_lshl_b32 s78, s70, 2
    s_add_u32 s62, s79, s78
    s_lshl_b32 s55, s70, 15
    s_add_u32 s55, s55, s80
    s_add_u32 s55, s55, 0x1000000
    s_xor_b32 s56, s55, 32768
    v_and_b32 v236, 15, v0
    v_lshlrev_b32 v8, 2, v236
    v_bfe_u32 v237, v0, 4, 1
    v_lshl_add_u32 v236, v237, 17, v8
    v_xor_b32 v6, s79, v236
    v_and_b32 v114, 15, v0
    v_lshrrev_b32 v115, 4, v0
    s_and_b32 s90, s44, 1
    s_lshr_b32 s92, s44, 1
    s_mul_i32 s93, s90, 4608
    s_lshl_b32 s94, s92, 8
    s_add_u32 s93, s93, s94
    s_add_u32 s93, s93, 131552
    v_lshlrev_b32 v116, 5, v114
    v_sub_u32 v16, s93, v116
    v_lshl_add_u32 v16, v115, 4, v16
    s_mul_i32 s93, s90, 8320
    s_add_u32 s93, s93, s94
    s_add_u32 s93, s93, 144448
    v_add_u32 v116, 2, v114
    v_lshrrev_b32 v116, 1, v116
    v_lshlrev_b32 v116, 2, v116
    v_lshl_add_u32 v116, v115, 4, v116
    v_add_u32 v116, s93, v116
    v_and_b32 v117, 1, v114
    v_mul_u32_u24 v117, 4160, v117
    v_sub_u32 v17, v116, v117
    v_add_u32 v18, 512, v17
    v_add_u32 v19, 1024, v17
    v_add_u32 v20, 1536, v17
    v_add_u32 v21, 2048, v17
    v_add_u32 v22, 2560, v17
    v_add_u32 v23, 3072, v17
    v_add_u32 v24, 3584, v17
    v_lshrrev_b32 v116, 5, v0
    v_lshlrev_b32 v116, 8, v116
    v_bfe_u32 v117, v0, 2, 2
    v_lshl_add_u32 v116, v117, 6, v116
    v_bfe_u32 v117, v0, 4, 1
    v_lshl_add_u32 v116, v117, 5, v116
    v_and_b32 v117, 3, v0
    v_lshl_add_u32 v116, v117, 3, v116
    v_add_u32 v119, s97, v116
    buffer_load_dword v57, v68, s[8:11], s19 offen sc1
    s_lshl_b32 s6, s44, 22
    s_bfe_u32 s93, s87, 0x10003
    s_lshl_b32 s93, s93, 15
    s_add_u32 s6, s6, s93
    s_lshl_b32 s93, s86, 12
    s_add_u32 s6, s6, s93
    s_lshr_b32 s93, s87, 4
    s_lshl_b32 s93, s93, 11
    s_add_u32 s6, s6, s93
    s_and_b32 s94, s87, 7
    s_lshl_b32 s93, s94, 8
    s_add_u32 s6, s6, s93
    v_mov_b32 v124, 0x3f803f80
    v_mov_b32 v125, v124
    v_mov_b32 v126, v124
    v_mov_b32 v127, v124
    s_lshl_b32 s93, s90, 4
    s_lshr_b32 s95, s95, s93
    s_and_b32 s95, s95, 0xffff
    s_cmp_eq_u32 s92, 0
    s_cselect_b32 s95, s95, 0
    v_lshl_add_u32 v116, v115, 3, v114
    v_sub_u32 v116, 15, v116
    v_and_b32 v117, 1, v116
    v_lshlrev_b32 v117, 4, v117
    v_lshlrev_b32 v117, v117, s95
    v_ashrrev_i32 v116, 1, v116
    v_cmp_eq_u32 vcc, 0, v116
    s_nop 1
    v_cndmask_b32 v26, 0, v117, vcc
    v_cmp_eq_u32 vcc, 1, v116
    s_nop 1
    v_cndmask_b32 v27, 0, v117, vcc
    v_cmp_eq_u32 vcc, 2, v116
    s_nop 1
    v_cndmask_b32 v28, 0, v117, vcc
    v_cmp_eq_u32 vcc, 3, v116
    s_nop 1
    v_cndmask_b32 v29, 0, v117, vcc
    v_lshrrev_b32 v117, 5, v0
    v_lshl_add_u32 v111, v117, 11, v68
    v_and_b32 v108, 31, v0
    v_lshlrev_b32 v108, 10, v108
    v_lshrrev_b32 v109, 5, v0
    v_lshl_add_u32 v108, v109, 4, v108
    s_lshr_b32 s76, s67, 3
    s_bfe_u32 s77, s46, 0x30011
    s_lshl_b32 s77, s77, 15
    s_add_u32 s76, s76, s77
    s_lshl_b32 s77, s70, 6
    s_add_u32 s76, s76, s77
    v_bfe_u32 v110, v0, 1, 4
    v_and_b32 v109, 1, v0
    v_lshlrev_b32 v110, 10, v110
    v_lshl_add_u32 v110, v109, 6, v110
    s_and_b32 s77, s76, 64
    s_mul_i32 s77, s77, 255
    s_add_u32 s77, s77, s76
    v_lshlrev_b32 v59, 2, v64
    s_lshl_b32 s79, s87, 14
    s_lshr_b32 s18, s87, 4
    s_mul_i32 s18, s18, 3584
    s_add_u32 s18, s18, s96
    s_lshl_b32 s78, s92, 9
    v_add_u32 v112, s78, v119
    v_xor_b32 v113, 512, v112
    s_lshl_b32 s81, s86, 10
    s_cmp_lt_u32 s87, 8
    s_cselect_b32 s81, s81, 0x44000000
    v_bfe_u32 v116, v0, 1, 2
    v_xor_b32 v116, v116, v115
    v_lshlrev_b32 v96, 6, v114
    v_lshl_add_u32 v96, v116, 4, v96
    v_add_u32 v96, s97, v96
    s_lshl_b32 s78, s44, 11
    s_add_u32 s78, s78, 24576
    v_lshl_add_u32 v116, v0, 3, s78
    v_lshlrev_b32 v97, 4, v115
    v_xor_b32 v97, v97, v116
    v_lshlrev_b32 v98, 4, v114
    v_lshl_add_u32 v98, v115, 17, v98
    v_lshlrev_b32 v123, 1, v68
    v_lshl_add_u32 v123, v117, 9, v123
    s_lshl_b32 s78, s92, 9
    v_lshl_add_u32 v10, v117, 9, v68
    v_xor_b32 v10, s78, v10
    s_add_u32 s78, s78, 159744
    v_lshl_add_u32 v11, v117, 8, v68
    v_add_u32 v11, s78, v11
    s_lshl_b32 s78, s44, 7
    s_add_u32 s78, s78, 159744
    v_add_u32 v10, s78, v10
    v_subrev_u32 v15, s97, v119
    v_mov_b32 v33, s69
    v_mov_b32 v35, s69
    v_mov_b32 v37, s69
    v_mov_b32 v39, s69
    v_mov_b32 v41, s69
    v_mov_b32 v43, s69
    v_mov_b32 v45, s69
    v_mov_b32 v47, s69
    s_add_u32 s78, s48, 0x1000
    s_waitcnt vmcnt(4)
    buffer_load_dwordx4 v[136:139], v64, s[8:11], s7 offen sc1
    buffer_load_dwordx4 v[140:143], v64, s[8:11], s85 offen sc1
    buffer_load_dwordx4 v[144:147], v64, s[8:11], s5 offen sc1
    ds_write_b128 v118, v[192:195] offset:9248
    s_waitcnt vmcnt(5)
    v_mov_b32_dpp v200, v195 wave_shr:1 row_mask:0xf bank_mask:0xf
    v_alignbit_b32 v128, v192, v200, 16
    v_alignbit_b32 v129, v193, v192, 16
    v_alignbit_b32 v130, v194, v193, 16
    v_alignbit_b32 v131, v195, v194, 16
    ds_write_b128 v118, v[128:131] offset:13408
    ds_write_b128 v118, v[196:199] offset:17568
    s_waitcnt vmcnt(4)
    v_mov_b32_dpp v201, v199 wave_shr:1 row_mask:0xf bank_mask:0xf
    v_alignbit_b32 v132, v196, v201, 16
    v_alignbit_b32 v133, v197, v196, 16
    v_alignbit_b32 v134, v198, v197, 16
    v_alignbit_b32 v135, v199, v198, 16
    ds_write_b128 v118, v[132:135] offset:21728
    s_waitcnt vmcnt(3)
    v_xor_b32 v57, s88, v57
L_xc:
    v_cmp_lt_u32 vcc, 15, v57
    s_cbranch_vccnz OOL_1
RET_2:
    v_cmp_ne_u32 vcc, 0, v57
    s_cbranch_vccnz L_slow
    buffer_store_dword v122, v1, s[8:11], s48 offen
    buffer_store_dword v122, v1, s[8:11], s78 offen
    s_waitcnt vmcnt(2)
    v_xor_b32 v116, s69, v139
    v_bitop3_b32 v116, v116, v143, s69 bitop3:0xf6
    v_bitop3_b32 v116, v116, v146, s69 bitop3:0xf6
    v_cmp_ne_u32 vcc, 0, v116
    s_cbranch_vccnz OOL_4
RET_5:
    v_mov_b32 v139, v144
    v_mov_b32 v143, v145
    ds_write_b128 v118, v[136:139] offset:0
    ds_write_b128 v118, v[140:143] offset:4608
    s_add_u32 m0, s97, 6144
    s_lshl_b32 s17, s81, 4
    s_add_u32 s17, s17, s21
    buffer_load_dwordx4 v61, s[24:27], s17 offen lds
    s_add_u32 s17, s17, 7168
    buffer_load_dwordx4 v61, s[24:27], s17 offen offset:1024 lds
    s_add_u32 m0, s97, 2048
    s_nop 0
    buffer_load_dwordx4 v60, s[32:35], s73 offen offset:0 lds
    s_add_u32 s73, s73, s20
    buffer_load_dwordx4 v60, s[32:35], s73 offen offset:1024 lds
    s_add_u32 s73, s73, s20
    buffer_load_dwordx4 v60, s[32:35], s73 offen offset:2048 lds
    s_add_u32 s73, s73, s20
    buffer_load_dwordx4 v60, s[32:35], s73 offen offset:3072 lds
    buffer_load_dword v62, v110, s[40:43], s77 offen
    s_waitcnt lgkmcnt(0)
    s_barrier
    ds_read_b128 a[0:3], v16 offset:3584
    ds_read2_b32 a[32:33], v17 offset0:0 offset1:1
    ds_read2_b32 a[34:35], v17 offset0:2 offset1:3
    ds_read_b128 a[4:7], v16 offset:3072
    ds_read2_b32 a[36:37], v18 offset0:0 offset1:1
    ds_read2_b32 a[38:39], v18 offset0:2 offset1:3
    ds_read_b128 a[8:11], v16 offset:2560
    ds_read2_b32 a[40:41], v19 offset0:0 offset1:1
    ds_read2_b32 a[42:43], v19 offset0:2 offset1:3
    ds_read_b128 a[12:15], v16 offset:2048
    ds_read2_b32 a[44:45], v20 offset0:0 offset1:1
    ds_read2_b32 a[46:47], v20 offset0:2 offset1:3
    ds_read_b128 a[16:19], v16 offset:1536
    ds_read2_b32 a[48:49], v21 offset0:0 offset1:1
    ds_read2_b32 a[50:51], v21 offset0:2 offset1:3
    ds_read_b128 a[20:23], v16 offset:1024
    ds_read2_b32 a[52:53], v22 offset0:0 offset1:1
    ds_read2_b32 a[54:55], v22 offset0:2 offset1:3
    ds_read_b128 a[24:27], v16 offset:512
    ds_read2_b32 a[56:57], v23 offset0:0 offset1:1
    ds_read2_b32 a[58:59], v23 offset0:2 offset1:3
    ds_read_b128 a[28:31], v16 offset:0
    ds_read2_b32 a[60:61], v24 offset0:0 offset1:1
    ds_read2_b32 a[62:63], v24 offset0:2 offset1:3
    s_waitcnt lgkmcnt(15)
    v_mfma_f32_16x16x32_bf16 v[64:67], v[26:29], a[0:3], 0
    v_mfma_f32_16x16x32_bf16 v[68:71], v[26:29], a[4:7], 0
    v_mfma_f32_16x16x32_bf16 v[72:75], v[26:29], a[8:11], 0
    s_waitcnt lgkmcnt(14)
    v_mfma_f32_16x16x32_bf16 v[76:79], v[26:29], a[12:15], 0
    s_waitcnt lgkmcnt(11)
    v_mfma_f32_16x16x32_bf16 v[80:83], v[26:29], a[16:19], 0
    s_waitcnt vmcnt(7)
    v_mov_b32 v30, s69
    v_add_u32 v30, 1, v30
    s_mov_b64 exec, 1
    buffer_store_dword v30, off, s[8:11], s62
    s_mov_b64 exec, -1
    s_waitcnt lgkmcnt(8)
    v_mfma_f32_16x16x32_bf16 v[84:87], v[26:29], a[20:23], 0
    s_waitcnt lgkmcnt(5)
    v_mfma_f32_16x16x32_bf16 v[88:91], v[26:29], a[24:27], 0
    s_waitcnt lgkmcnt(2)
    v_mfma_f32_16x16x32_bf16 v[92:95], v[26:29], a[28:31], 0
    v_mfma_f32_16x16x32_bf16 v[64:67], a[32:35], a[0:3], v[64:67]
    ds_read_b128 a[64:67], v16 offset:3648
    v_mfma_f32_16x16x32_bf16 v[68:71], a[32:35], a[4:7], v[68:71]
    ds_read2_b32 a[96:97], v17 offset0:16 offset1:17
    s_add_u32 m0, s97, 8192
    s_add_u32 s17, s21, 0
    buffer_load_dwordx4 v61, s[24:27], s17 offen lds
    v_mfma_f32_16x16x32_bf16 v[68:71], a[36:39], a[0:3], v[68:71]
    ds_read2_b32 a[98:99], v17 offset0:18 offset1:19
    v_mfma_f32_16x16x32_bf16 v[72:75], a[36:39], a[4:7], v[72:75]
    ds_read_b128 a[68:71], v16 offset:3136
    v_mfma_f32_16x16x32_bf16 v[72:75], a[32:35], a[8:11], v[72:75]
    ds_read2_b32 a[100:101], v18 offset0:16 offset1:17
    v_mfma_f32_16x16x32_bf16 v[76:79], a[36:39], a[8:11], v[76:79]
    ds_read2_b32 a[102:103], v18 offset0:18 offset1:19
    v_mfma_f32_16x16x32_bf16 v[72:75], a[40:43], a[0:3], v[72:75]
    ds_read_b128 a[72:75], v16 offset:2624
    s_add_u32 m0, s97, 9216
    s_add_u32 s17, s21, 8192
    buffer_load_dwordx4 v61, s[24:27], s17 offen lds
    v_mfma_f32_16x16x32_bf16 v[76:79], a[40:43], a[4:7], v[76:79]
    ds_read2_b32 a[104:105], v19 offset0:16 offset1:17
    v_mfma_f32_16x16x32_bf16 v[80:83], a[40:43], a[8:11], v[80:83]
    ds_read2_b32 a[106:107], v19 offset0:18 offset1:19
    v_mfma_f32_16x16x32_bf16 v[76:79], a[32:35], a[12:15], v[76:79]
    ds_read_b128 a[76:79], v16 offset:2112
    v_mfma_f32_16x16x32_bf16 v[80:83], a[36:39], a[12:15], v[80:83]
    ds_read2_b32 a[108:109], v20 offset0:16 offset1:17
    v_mfma_f32_16x16x32_bf16 v[84:87], a[40:43], a[12:15], v[84:87]
    ds_read2_b32 a[110:111], v20 offset0:18 offset1:19
    s_add_u32 m0, s97, 10240
    s_add_u32 s17, s21, 16384
    buffer_load_dwordx4 v61, s[24:27], s17 offen lds
    v_mfma_f32_16x16x32_bf16 v[76:79], a[44:47], a[0:3], v[76:79]
    ds_read_b128 a[80:83], v16 offset:1600
    v_mfma_f32_16x16x32_bf16 v[80:83], a[44:47], a[4:7], v[80:83]
    ds_read2_b32 a[112:113], v21 offset0:16 offset1:17
    v_mfma_f32_16x16x32_bf16 v[84:87], a[44:47], a[8:11], v[84:87]
    ds_read2_b32 a[114:115], v21 offset0:18 offset1:19
    v_mfma_f32_16x16x32_bf16 v[88:91], a[44:47], a[12:15], v[88:91]
    ds_read_b128 a[84:87], v16 offset:1088
    v_mfma_f32_16x16x32_bf16 v[80:83], a[32:35], a[16:19], v[80:83]
    ds_read2_b32 a[116:117], v22 offset0:16 offset1:17
    s_add_u32 m0, s97, 11264
    s_add_u32 s17, s21, 24576
    buffer_load_dwordx4 v61, s[24:27], s17 offen lds
    v_mfma_f32_16x16x32_bf16 v[84:87], a[36:39], a[16:19], v[84:87]
    ds_read2_b32 a[118:119], v22 offset0:18 offset1:19
    v_mfma_f32_16x16x32_bf16 v[88:91], a[40:43], a[16:19], v[88:91]
    ds_read_b128 a[88:91], v16 offset:576
    v_mfma_f32_16x16x32_bf16 v[92:95], a[44:47], a[16:19], v[92:95]
    ds_read2_b32 a[120:121], v23 offset0:16 offset1:17
    v_mfma_f32_16x16x32_bf16 v[80:83], a[48:51], a[0:3], v[80:83]
    ds_read2_b32 a[122:123], v23 offset0:18 offset1:19
    v_mfma_f32_16x16x32_bf16 v[84:87], a[48:51], a[4:7], v[84:87]
    ds_read_b128 a[92:95], v16 offset:64
    s_add_u32 m0, s97, 12288
    s_add_u32 s17, s21, 32768
    buffer_load_dwordx4 v61, s[24:27], s17 offen lds
    v_mfma_f32_16x16x32_bf16 v[88:91], a[48:51], a[8:11], v[88:91]
    ds_read2_b32 a[124:125], v24 offset0:16 offset1:17
    v_mfma_f32_16x16x32_bf16 v[92:95], a[48:51], a[12:15], v[92:95]
    ds_read2_b32 a[126:127], v24 offset0:18 offset1:19
    v_mfma_f32_16x16x32_bf16 v[84:87], a[32:35], a[20:23], v[84:87]
    v_mfma_f32_16x16x32_bf16 v[88:91], a[36:39], a[20:23], v[88:91]
    v_mfma_f32_16x16x32_bf16 v[92:95], a[40:43], a[20:23], v[92:95]
    s_add_u32 m0, s97, 13312
    s_add_u32 s17, s21, 40960
    buffer_load_dwordx4 v61, s[24:27], s17 offen lds
    v_mfma_f32_16x16x32_bf16 v[84:87], a[52:55], a[0:3], v[84:87]
    v_mfma_f32_16x16x32_bf16 v[88:91], a[52:55], a[4:7], v[88:91]
    v_mfma_f32_16x16x32_bf16 v[92:95], a[52:55], a[8:11], v[92:95]
    v_mfma_f32_16x16x32_bf16 v[88:91], a[32:35], a[24:27], v[88:91]
    v_mfma_f32_16x16x32_bf16 v[92:95], a[36:39], a[24:27], v[92:95]
    s_add_u32 m0, s97, 14336
    s_add_u32 s17, s21, 49152
    buffer_load_dwordx4 v61, s[24:27], s17 offen lds
    v_mfma_f32_16x16x32_bf16 v[88:91], a[56:59], a[0:3], v[88:91]
    v_mfma_f32_16x16x32_bf16 v[92:95], a[56:59], a[4:7], v[92:95]
    v_mfma_f32_16x16x32_bf16 v[92:95], a[32:35], a[28:31], v[92:95]
    s_waitcnt lgkmcnt(15)
    v_mfma_f32_16x16x32_bf16 v[92:95], a[60:63], a[0:3], v[92:95]
    v_mfma_f32_16x16x32_bf16 v[64:67], a[96:99], a[64:67], v[64:67]
    s_add_u32 m0, s97, 15360
    s_add_u32 s17, s21, 57344
    buffer_load_dwordx4 v61, s[24:27], s17 offen lds
    v_mfma_f32_16x16x32_bf16 v[68:71], a[96:99], a[68:71], v[68:71]
    v_mfma_f32_16x16x32_bf16 v[68:71], a[100:103], a[64:67], v[68:71]
    v_mfma_f32_16x16x32_bf16 v[72:75], a[100:103], a[68:71], v[72:75]
    v_mfma_f32_16x16x32_bf16 v[72:75], a[96:99], a[72:75], v[72:75]
    v_mfma_f32_16x16x32_bf16 v[76:79], a[100:103], a[72:75], v[76:79]
    s_add_u32 m0, s97, 16384
    s_add_u32 s17, s21, 65536
    buffer_load_dwordx4 v61, s[24:27], s17 offen lds
    v_mfma_f32_16x16x32_bf16 v[72:75], a[104:107], a[64:67], v[72:75]
    v_mfma_f32_16x16x32_bf16 v[76:79], a[104:107], a[68:71], v[76:79]
    v_mfma_f32_16x16x32_bf16 v[80:83], a[104:107], a[72:75], v[80:83]
    ds_read_b128 a[0:3], v16 offset:3712
    s_waitcnt lgkmcnt(15)
    v_mfma_f32_16x16x32_bf16 v[76:79], a[96:99], a[76:79], v[76:79]
    ds_read2_b32 a[32:33], v17 offset0:32 offset1:33
    v_mfma_f32_16x16x32_bf16 v[80:83], a[100:103], a[76:79], v[80:83]
    ds_read2_b32 a[34:35], v17 offset0:34 offset1:35
    s_add_u32 m0, s97, 17408
    s_add_u32 s17, s21, 73728
    buffer_load_dwordx4 v61, s[24:27], s17 offen lds
    v_mfma_f32_16x16x32_bf16 v[84:87], a[104:107], a[76:79], v[84:87]
    ds_read_b128 a[4:7], v16 offset:3200
    s_waitcnt lgkmcnt(15)
    v_mfma_f32_16x16x32_bf16 v[76:79], a[108:111], a[64:67], v[76:79]
    ds_read2_b32 a[36:37], v18 offset0:32 offset1:33
    v_mfma_f32_16x16x32_bf16 v[80:83], a[108:111], a[68:71], v[80:83]
    ds_read2_b32 a[38:39], v18 offset0:34 offset1:35
    v_mfma_f32_16x16x32_bf16 v[84:87], a[108:111], a[72:75], v[84:87]
    ds_read_b128 a[8:11], v16 offset:2688
    v_mfma_f32_16x16x32_bf16 v[88:91], a[108:111], a[76:79], v[88:91]
    ds_read2_b32 a[40:41], v19 offset0:32 offset1:33
    s_add_u32 m0, s97, 18432
    s_add_u32 s17, s21, 81920
    buffer_load_dwordx4 v61, s[24:27], s17 offen lds
    v_mfma_f32_16x16x32_bf16 v[80:83], a[96:99], a[80:83], v[80:83]
    ds_read2_b32 a[42:43], v19 offset0:34 offset1:35
    v_mfma_f32_16x16x32_bf16 v[84:87], a[100:103], a[80:83], v[84:87]
    ds_read_b128 a[12:15], v16 offset:2176
    v_mfma_f32_16x16x32_bf16 v[88:91], a[104:107], a[80:83], v[88:91]
    ds_read2_b32 a[44:45], v20 offset0:32 offset1:33
    v_mfma_f32_16x16x32_bf16 v[92:95], a[108:111], a[80:83], v[92:95]
    ds_read2_b32 a[46:47], v20 offset0:34 offset1:35
    s_waitcnt lgkmcnt(15)
    v_mfma_f32_16x16x32_bf16 v[80:83], a[112:115], a[64:67], v[80:83]
    ds_read_b128 a[16:19], v16 offset:1664
    s_add_u32 m0, s97, 19456
    s_add_u32 s17, s21, 90112
    buffer_load_dwordx4 v61, s[24:27], s17 offen lds
    v_mfma_f32_16x16x32_bf16 v[84:87], a[112:115], a[68:71], v[84:87]
    ds_read2_b32 a[48:49], v21 offset0:32 offset1:33
    v_mfma_f32_16x16x32_bf16 v[88:91], a[112:115], a[72:75], v[88:91]
    ds_read2_b32 a[50:51], v21 offset0:34 offset1:35
    v_mfma_f32_16x16x32_bf16 v[92:95], a[112:115], a[76:79], v[92:95]
    ds_read_b128 a[20:23], v16 offset:1152
    v_mfma_f32_16x16x32_bf16 v[84:87], a[96:99], a[84:87], v[84:87]
    ds_read2_b32 a[52:53], v22 offset0:32 offset1:33
    v_mfma_f32_16x16x32_bf16 v[88:91], a[100:103], a[84:87], v[88:91]
    ds_read2_b32 a[54:55], v22 offset0:34 offset1:35
    s_add_u32 m0, s97, 20480
    s_add_u32 s17, s21, 98304
    buffer_load_dwordx4 v61, s[24:27], s17 offen lds
    v_mfma_f32_16x16x32_bf16 v[92:95], a[104:107], a[84:87], v[92:95]
    ds_read_b128 a[24:27], v16 offset:640
    v_mfma_f32_16x16x32_bf16 v[84:87], a[116:119], a[64:67], v[84:87]
    ds_read2_b32 a[56:57], v23 offset0:32 offset1:33
    v_mfma_f32_16x16x32_bf16 v[88:91], a[116:119], a[68:71], v[88:91]
    ds_read2_b32 a[58:59], v23 offset0:34 offset1:35
    v_mfma_f32_16x16x32_bf16 v[92:95], a[116:119], a[72:75], v[92:95]
    ds_read_b128 a[28:31], v16 offset:128
    v_mfma_f32_16x16x32_bf16 v[88:91], a[96:99], a[88:91], v[88:91]
    ds_read2_b32 a[60:61], v24 offset0:32 offset1:33
    s_add_u32 m0, s97, 21504
    s_add_u32 s17, s21, 106496
    buffer_load_dwordx4 v61, s[24:27], s17 offen lds
    v_mfma_f32_16x16x32_bf16 v[92:95], a[100:103], a[88:91], v[92:95]
    ds_read2_b32 a[62:63], v24 offset0:34 offset1:35
    v_mfma_f32_16x16x32_bf16 v[88:91], a[120:123], a[64:67], v[88:91]
    v_mfma_f32_16x16x32_bf16 v[92:95], a[120:123], a[68:71], v[92:95]
    s_waitcnt lgkmcnt(15)
    v_mfma_f32_16x16x32_bf16 v[92:95], a[96:99], a[92:95], v[92:95]
    v_mfma_f32_16x16x32_bf16 v[92:95], a[124:127], a[64:67], v[92:95]
    s_add_u32 m0, s97, 22528
    s_add_u32 s17, s21, 114688
    buffer_load_dwordx4 v61, s[24:27], s17 offen lds
    v_mfma_f32_16x16x32_bf16 v[64:67], a[32:35], a[0:3], v[64:67]
    v_mfma_f32_16x16x32_bf16 v[68:71], a[32:35], a[4:7], v[68:71]
    v_mfma_f32_16x16x32_bf16 v[68:71], a[36:39], a[0:3], v[68:71]
    v_mfma_f32_16x16x32_bf16 v[72:75], a[36:39], a[4:7], v[72:75]
    v_mfma_f32_16x16x32_bf16 v[72:75], a[32:35], a[8:11], v[72:75]
    s_add_u32 m0, s97, 23552
    s_add_u32 s17, s21, 122880
    buffer_load_dwordx4 v61, s[24:27], s17 offen lds
    v_mfma_f32_16x16x32_bf16 v[76:79], a[36:39], a[8:11], v[76:79]
    v_mfma_f32_16x16x32_bf16 v[72:75], a[40:43], a[0:3], v[72:75]
    v_mfma_f32_16x16x32_bf16 v[76:79], a[40:43], a[4:7], v[76:79]
    v_mfma_f32_16x16x32_bf16 v[80:83], a[40:43], a[8:11], v[80:83]
    ds_read_b128 a[64:67], v16 offset:3776
    s_waitcnt lgkmcnt(15)
    v_mfma_f32_16x16x32_bf16 v[76:79], a[32:35], a[12:15], v[76:79]
    ds_read2_b32 a[96:97], v17 offset0:48 offset1:49
    v_mfma_f32_16x16x32_bf16 v[80:83], a[36:39], a[12:15], v[80:83]
    ds_read2_b32 a[98:99], v17 offset0:50 offset1:51
    v_mfma_f32_16x16x32_bf16 v[84:87], a[40:43], a[12:15], v[84:87]
    ds_read_b128 a[68:71], v16 offset:3264
    s_waitcnt lgkmcnt(15)
    v_mfma_f32_16x16x32_bf16 v[76:79], a[44:47], a[0:3], v[76:79]
    ds_read2_b32 a[100:101], v18 offset0:48 offset1:49
    v_mfma_f32_16x16x32_bf16 v[80:83], a[44:47], a[4:7], v[80:83]
    ds_read2_b32 a[102:103], v18 offset0:50 offset1:51
    v_mfma_f32_16x16x32_bf16 v[84:87], a[44:47], a[8:11], v[84:87]
    ds_read_b128 a[72:75], v16 offset:2752
    s_waitcnt vmcnt(18)
    ds_read_b64_tr_b16 v[176:177], v119 offset:2048
    ds_read_b64_tr_b16 v[178:179], v119 offset:3072
    ds_read_b64_tr_b16 v[180:181], v119 offset:4096
    ds_read_b64_tr_b16 v[182:183], v119 offset:5120
    ds_read_b64_tr_b16 v[184:185], v119 offset:2560
    ds_read_b64_tr_b16 v[186:187], v119 offset:3584
    ds_read_b64_tr_b16 v[188:189], v119 offset:4608
    ds_read_b64_tr_b16 v[190:191], v119 offset:5632
    ds_read_b64_tr_b16 v[128:129], v112 offset:6144
    ds_read_b64_tr_b16 v[130:131], v112 offset:7168
    ds_read_b64_tr_b16 v[132:133], v113 offset:6144
    ds_read_b64_tr_b16 v[134:135], v113 offset:7168
    v_mfma_f32_16x16x32_bf16 v[88:91], a[44:47], a[12:15], v[88:91]
    ds_read2_b32 a[104:105], v19 offset0:48 offset1:49
    v_mfma_f32_16x16x32_bf16 v[80:83], a[32:35], a[16:19], v[80:83]
    ds_read2_b32 a[106:107], v19 offset0:50 offset1:51
    v_mfma_f32_16x16x32_bf16 v[84:87], a[36:39], a[16:19], v[84:87]
    ds_read_b128 a[76:79], v16 offset:2240
    v_mfma_f32_16x16x32_bf16 v[88:91], a[40:43], a[16:19], v[88:91]
    ds_read2_b32 a[108:109], v20 offset0:48 offset1:49
    buffer_load_dwordx4 v[100:103], v108, s[40:43], s76 offen offset:0
    buffer_load_dwordx4 v[104:107], v108, s[40:43], s76 offen offset:32
    v_mfma_f32_16x16x32_bf16 v[92:95], a[44:47], a[16:19], v[92:95]
    ds_read2_b32 a[110:111], v20 offset0:50 offset1:51
    s_waitcnt lgkmcnt(15)
    v_mfma_f32_16x16x32_bf16 v[80:83], a[48:51], a[0:3], v[80:83]
    ds_read_b128 a[80:83], v16 offset:1728
    s_cmp_eq_u32 s72, 0
    s_waitcnt lgkmcnt(12)
    s_waitcnt lgkmcnt(10)
    s_cbranch_scc1 ELSE_6
    v_mfma_f32_32x32x16_bf16 v[144:159], v[124:127], v[176:179], 0
    v_mfma_f32_32x32x16_bf16 v[160:175], v[124:127], v[184:187], 0
    v_mfma_f32_32x32x16_bf16 v[144:159], v[124:127], v[180:183], v[144:159]
    v_mfma_f32_32x32x16_bf16 v[160:175], v[124:127], v[188:191], v[160:175]
    v_cmp_gt_u32 vcc, 32, v0
    s_nop 10
    v_cndmask_b32 v144, v160, v144, vcc
    buffer_store_dword v144, v111, s[8:11], s3 offen sc1
    s_nop 3
    s_branch JOIN_7
ELSE_6:
    s_add_u32 s89, s3, s4
    buffer_store_dwordx4 v[176:179], v1, s[8:11], s3 offen offset:0 sc1
    buffer_store_dwordx4 v[180:183], v1, s[8:11], s3 offen offset:1024 sc1
    buffer_store_dwordx4 v[184:187], v1, s[8:11], s89 offen offset:0 sc1
    buffer_store_dwordx4 v[188:191], v1, s[8:11], s89 offen offset:1024 sc1
JOIN_7:
    s_add_u32 s93, s81, s56
    s_add_u32 s89, s81, s55
    s_waitcnt lgkmcnt(8)
    buffer_store_dwordx4 v[128:131], v1, s[8:11], s89 offen sc1
    s_waitcnt lgkmcnt(6)
    buffer_store_dwordx4 v[132:135], v1, s[8:11], s93 offen sc1
    buffer_load_dword v9, v6, s[8:11], 0 offen offset:0 sc1
    v_mfma_f32_16x16x32_bf16 v[84:87], a[48:51], a[4:7], v[84:87]
    ds_read2_b32 a[112:113], v21 offset0:48 offset1:49
    v_mfma_f32_16x16x32_bf16 v[88:91], a[48:51], a[8:11], v[88:91]
    ds_read2_b32 a[114:115], v21 offset0:50 offset1:51
    v_mfma_f32_16x16x32_bf16 v[92:95], a[48:51], a[12:15], v[92:95]
    ds_read_b128 a[84:87], v16 offset:1216
    v_mfma_f32_16x16x32_bf16 v[84:87], a[32:35], a[20:23], v[84:87]
    ds_read2_b32 a[116:117], v22 offset0:48 offset1:49
    v_mfma_f32_16x16x32_bf16 v[88:91], a[36:39], a[20:23], v[88:91]
    ds_read2_b32 a[118:119], v22 offset0:50 offset1:51
    s_add_u32 m0, s97, 0
    s_add_u32 s17, s96, 0
    buffer_load_dwordx4 v63, s[36:39], s17 offen lds
    v_mfma_f32_16x16x32_bf16 v[92:95], a[40:43], a[20:23], v[92:95]
    ds_read_b128 a[88:91], v16 offset:704
    v_mfma_f32_16x16x32_bf16 v[84:87], a[52:55], a[0:3], v[84:87]
    ds_read2_b32 a[120:121], v23 offset0:48 offset1:49
    v_mfma_f32_16x16x32_bf16 v[88:91], a[52:55], a[4:7], v[88:91]
    ds_read2_b32 a[122:123], v23 offset0:50 offset1:51
    v_mfma_f32_16x16x32_bf16 v[92:95], a[52:55], a[8:11], v[92:95]
    ds_read_b128 a[92:95], v16 offset:192
    v_mfma_f32_16x16x32_bf16 v[88:91], a[32:35], a[24:27], v[88:91]
    ds_read2_b32 a[124:125], v24 offset0:48 offset1:49
    s_add_u32 m0, s97, 1024
    s_add_u32 s17, s96, 28672
    buffer_load_dwordx4 v63, s[36:39], s17 offen lds
    v_mfma_f32_16x16x32_bf16 v[92:95], a[36:39], a[24:27], v[92:95]
    ds_read2_b32 a[126:127], v24 offset0:50 offset1:51
    v_mfma_f32_16x16x32_bf16 v[88:91], a[56:59], a[0:3], v[88:91]
    v_mfma_f32_16x16x32_bf16 v[92:95], a[56:59], a[4:7], v[92:95]
    v_mfma_f32_16x16x32_bf16 v[92:95], a[32:35], a[28:31], v[92:95]
    v_mfma_f32_16x16x32_bf16 v[92:95], a[60:63], a[0:3], v[92:95]
    s_add_u32 m0, s97, 2048
    s_add_u32 s17, s96, 57344
    buffer_load_dwordx4 v63, s[36:39], s17 offen lds
    v_mfma_f32_16x16x32_bf16 v[64:67], a[96:99], a[64:67], v[64:67]
    v_mfma_f32_16x16x32_bf16 v[68:71], a[100:103], a[64:67], v[68:71]
    s_waitcnt lgkmcnt(15)
    v_mfma_f32_16x16x32_bf16 v[72:75], a[104:107], a[64:67], v[72:75]
    v_mfma_f32_16x16x32_bf16 v[68:71], a[96:99], a[68:71], v[68:71]
    v_mfma_f32_16x16x32_bf16 v[72:75], a[100:103], a[68:71], v[72:75]
    s_add_u32 m0, s97, 3072
    s_add_u32 s17, s96, 86016
    buffer_load_dwordx4 v63, s[36:39], s17 offen lds
    s_waitcnt lgkmcnt(12)
    v_mfma_f32_16x16x32_bf16 v[76:79], a[108:111], a[64:67], v[76:79]
    ds_write_b128 v96, v[64:67] offset:24576
    v_mfma_f32_16x16x32_bf16 v[72:75], a[96:99], a[72:75], v[72:75]
    ds_write_b128 v96, v[68:71] offset:25600
    v_mfma_f32_16x16x32_bf16 v[76:79], a[104:107], a[68:71], v[76:79]
    s_waitcnt lgkmcnt(11)
    v_mfma_f32_16x16x32_bf16 v[80:83], a[112:115], a[64:67], v[80:83]
    v_mfma_f32_16x16x32_bf16 v[76:79], a[100:103], a[72:75], v[76:79]
    s_add_u32 m0, s97, 4096
    s_add_u32 s17, s96, 114688
    buffer_load_dwordx4 v63, s[36:39], s17 offen lds
    v_mfma_f32_16x16x32_bf16 v[80:83], a[108:111], a[68:71], v[80:83]
    ds_write_b128 v96, v[72:75] offset:26624
    v_mfma_f32_16x16x32_bf16 v[76:79], a[96:99], a[76:79], v[76:79]
    v_mfma_f32_16x16x32_bf16 v[80:83], a[104:107], a[72:75], v[80:83]
    s_waitcnt lgkmcnt(9)
    v_mfma_f32_16x16x32_bf16 v[84:87], a[116:119], a[64:67], v[84:87]
    v_mfma_f32_16x16x32_bf16 v[80:83], a[100:103], a[76:79], v[80:83]
    s_add_u32 m0, s97, 5120
    s_add_u32 s17, s96, 143360
    buffer_load_dwordx4 v63, s[36:39], s17 offen lds
    v_mfma_f32_16x16x32_bf16 v[84:87], a[112:115], a[68:71], v[84:87]
    ds_write_b128 v96, v[76:79] offset:27648
    v_mfma_f32_16x16x32_bf16 v[80:83], a[96:99], a[80:83], v[80:83]
    v_mfma_f32_16x16x32_bf16 v[84:87], a[108:111], a[72:75], v[84:87]
    s_waitcnt lgkmcnt(7)
    v_mfma_f32_16x16x32_bf16 v[88:91], a[120:123], a[64:67], v[88:91]
    v_mfma_f32_16x16x32_bf16 v[84:87], a[104:107], a[76:79], v[84:87]
    s_add_u32 m0, s97, 6144
    s_add_u32 s17, s96, 172032
    buffer_load_dwordx4 v63, s[36:39], s17 offen lds
    v_mfma_f32_16x16x32_bf16 v[88:91], a[116:119], a[68:71], v[88:91]
    ds_write_b128 v96, v[80:83] offset:28672
    s_waitcnt lgkmcnt(5)
    v_mfma_f32_16x16x32_bf16 v[92:95], a[124:127], a[64:67], v[92:95]
    v_mfma_f32_16x16x32_bf16 v[84:87], a[100:103], a[80:83], v[84:87]
    v_mfma_f32_16x16x32_bf16 v[92:95], a[120:123], a[68:71], v[92:95]
    v_mfma_f32_16x16x32_bf16 v[84:87], a[96:99], a[84:87], v[84:87]
    s_add_u32 m0, s97, 7168
    s_add_u32 s17, s96, 200704
    buffer_load_dwordx4 v63, s[36:39], s17 offen lds
    v_mfma_f32_16x16x32_bf16 v[92:95], a[116:119], a[72:75], v[92:95]
    v_mfma_f32_16x16x32_bf16 v[88:91], a[112:115], a[72:75], v[88:91]
    v_mfma_f32_16x16x32_bf16 v[92:95], a[112:115], a[76:79], v[92:95]
    v_mfma_f32_16x16x32_bf16 v[88:91], a[108:111], a[76:79], v[88:91]
    v_mfma_f32_16x16x32_bf16 v[92:95], a[108:111], a[80:83], v[92:95]
    ds_write_b128 v96, v[84:87] offset:29696
    v_mfma_f32_16x16x32_bf16 v[88:91], a[104:107], a[80:83], v[88:91]
    v_mfma_f32_16x16x32_bf16 v[92:95], a[104:107], a[84:87], v[92:95]
    v_mfma_f32_16x16x32_bf16 v[88:91], a[100:103], a[84:87], v[88:91]
    v_mfma_f32_16x16x32_bf16 v[92:95], a[100:103], a[88:91], v[92:95]
    v_mfma_f32_16x16x32_bf16 v[88:91], a[96:99], a[88:91], v[88:91]
    v_mfma_f32_16x16x32_bf16 v[92:95], a[96:99], a[92:95], v[92:95]
    s_nop 6
    ds_write_b128 v96, v[88:91] offset:30720
    ds_write_b128 v96, v[92:95] offset:31744
    s_waitcnt vmcnt(9) lgkmcnt(0)
    s_barrier
    ds_read2st64_b64 v[64:67], v97 offset0:0 offset1:128
    ds_read2st64_b64 v[68:71], v97 offset0:64 offset1:192
    ds_read2st64_b64 v[72:75], v97 offset0:1 offset1:129
    ds_read2st64_b64 v[76:79], v97 offset0:65 offset1:193
    ds_read2st64_b64 v[80:83], v97 offset0:2 offset1:130
    ds_read2st64_b64 v[84:87], v97 offset0:66 offset1:194
    ds_read2st64_b64 v[88:91], v97 offset0:3 offset1:131
    ds_read2st64_b64 v[92:95], v97 offset0:67 offset1:195
    s_waitcnt lgkmcnt(7)
    v_pk_add_f32 v[64:65], v[64:65], v[66:67]
    s_waitcnt lgkmcnt(6)
    v_pk_add_f32 v[68:69], v[68:69], v[70:71]
    v_cvt_pk_bf16_f32 v32, v64, v68
    v_cvt_pk_bf16_f32 v34, v65, v69
    buffer_store_dwordx4 v[32:35], v98, s[8:11], s6 offen sc1
    s_add_u32 s93, s6, 0x80000
    s_waitcnt lgkmcnt(5)
    v_pk_add_f32 v[72:73], v[72:73], v[74:75]
    s_waitcnt lgkmcnt(4)
    v_pk_add_f32 v[76:77], v[76:77], v[78:79]
    v_cvt_pk_bf16_f32 v36, v72, v76
    v_cvt_pk_bf16_f32 v38, v73, v77
    buffer_store_dwordx4 v[36:39], v98, s[8:11], s93 offen sc1
    s_add_u32 s93, s6, 0x200000
    s_waitcnt lgkmcnt(3)
    v_pk_add_f32 v[80:81], v[80:81], v[82:83]
    s_waitcnt lgkmcnt(2)
    v_pk_add_f32 v[84:85], v[84:85], v[86:87]
    v_cvt_pk_bf16_f32 v40, v80, v84
    v_cvt_pk_bf16_f32 v42, v81, v85
    buffer_store_dwordx4 v[40:43], v98, s[8:11], s93 offen sc1
    s_add_u32 s93, s6, 0x280000
    s_waitcnt lgkmcnt(1)
    v_pk_add_f32 v[88:89], v[88:89], v[90:91]
    s_waitcnt lgkmcnt(0)
    v_pk_add_f32 v[92:93], v[92:93], v[94:95]
    v_cvt_pk_bf16_f32 v44, v88, v92
    v_cvt_pk_bf16_f32 v46, v89, v93
    buffer_store_dwordx4 v[44:47], v98, s[8:11], s93 offen sc1
    v_permlane32_swap_b32 v100, v102
    v_permlane32_swap_b32 v101, v103
    v_permlane32_swap_b32 v104, v106
    v_permlane32_swap_b32 v105, v107
    v_lshlrev_b32 v32, 16, v100
    v_and_b32 v33, 0xffff0000, v100
    v_lshlrev_b32 v34, 16, v101
    v_and_b32 v35, 0xffff0000, v101
    v_lshlrev_b32 v36, 16, v102
    v_and_b32 v37, 0xffff0000, v102
    v_lshlrev_b32 v38, 16, v103
    v_and_b32 v39, 0xffff0000, v103
    v_lshlrev_b32 v40, 16, v104
    v_and_b32 v41, 0xffff0000, v104
    v_lshlrev_b32 v42, 16, v105
    v_and_b32 v43, 0xffff0000, v105
    v_lshlrev_b32 v44, 16, v106
    v_and_b32 v45, 0xffff0000, v106
    v_lshlrev_b32 v46, 16, v107
    v_and_b32 v47, 0xffff0000, v107
    s_add_u32 s77, s48, 0x1000
    s_add_u32 s76, s49, 0x1000
    v_pk_add_f32 v[18:19], v[32:33], v[34:35]
    v_pk_mul_f32 v[20:21], v[32:33], v[32:33]
    v_pk_fma_f32 v[20:21], v[34:35], v[34:35], v[20:21]
    v_pk_add_f32 v[18:19], v[18:19], v[36:37]
    v_pk_fma_f32 v[20:21], v[36:37], v[36:37], v[20:21]
    v_pk_add_f32 v[18:19], v[18:19], v[38:39]
    v_pk_fma_f32 v[20:21], v[38:39], v[38:39], v[20:21]
    v_pk_add_f32 v[18:19], v[18:19], v[40:41]
    v_pk_fma_f32 v[20:21], v[40:41], v[40:41], v[20:21]
    v_pk_add_f32 v[18:19], v[18:19], v[42:43]
    v_pk_fma_f32 v[20:21], v[42:43], v[42:43], v[20:21]
    v_pk_add_f32 v[18:19], v[18:19], v[44:45]
    v_pk_fma_f32 v[20:21], v[44:45], v[44:45], v[20:21]
    v_pk_add_f32 v[18:19], v[18:19], v[46:47]
    v_pk_fma_f32 v[20:21], v[46:47], v[46:47], v[20:21]
    v_add_f32 v18, v18, v19
    v_add_f32 v20, v20, v21
    s_nop 1
    v_permlane32_swap_b32 v18, v20
    v_add_f32 v18, v18, v20
    v_or_b32 v18, 1, v18
    buffer_store_dword v18, v1, s[8:11], s77 offen
    s_waitcnt vmcnt(13)
    v_subrev_u32 v9, s69, v9
    v_subrev_u32 v9, 1, v9
    v_cmp_lt_u32 vcc, 7, v9
    s_cbranch_vccnz OOL_9
RET_10:
    s_waitcnt vmcnt(19)
    ds_read_b64_tr_b16 v[192:193], v112 offset:8192
    ds_read_b64_tr_b16 v[194:195], v112 offset:9216
    ds_read_b64_tr_b16 v[196:197], v113 offset:8192
    ds_read_b64_tr_b16 v[198:199], v113 offset:9216
    ds_read_b64_tr_b16 v[200:201], v112 offset:10240
    ds_read_b64_tr_b16 v[202:203], v112 offset:11264
    ds_read_b64_tr_b16 v[204:205], v113 offset:10240
    ds_read_b64_tr_b16 v[206:207], v113 offset:11264
    ds_read_b64_tr_b16 v[208:209], v112 offset:12288
    ds_read_b64_tr_b16 v[210:211], v112 offset:13312
    ds_read_b64_tr_b16 v[212:213], v113 offset:12288
    ds_read_b64_tr_b16 v[214:215], v113 offset:13312
    ds_read_b64_tr_b16 v[216:217], v112 offset:14336
    ds_read_b64_tr_b16 v[218:219], v112 offset:15360
    ds_read_b64_tr_b16 v[220:221], v113 offset:14336
    ds_read_b64_tr_b16 v[222:223], v113 offset:15360
    ds_read_b64_tr_b16 v[224:225], v112 offset:16384
    ds_read_b64_tr_b16 v[226:227], v112 offset:17408
    ds_read_b64_tr_b16 v[228:229], v113 offset:16384
    ds_read_b64_tr_b16 v[230:231], v113 offset:17408
    ds_read_b64_tr_b16 v[232:233], v112 offset:18432
    ds_read_b64_tr_b16 v[234:235], v112 offset:19456
    ds_read_b64_tr_b16 v[236:237], v113 offset:18432
    ds_read_b64_tr_b16 v[238:239], v113 offset:19456
    ds_read_b64_tr_b16 v[240:241], v112 offset:20480
    ds_read_b64_tr_b16 v[242:243], v112 offset:21504
    ds_read_b64_tr_b16 v[244:245], v113 offset:20480
    ds_read_b64_tr_b16 v[246:247], v113 offset:21504
    ds_read_b64_tr_b16 v[248:249], v112 offset:22528
    ds_read_b64_tr_b16 v[250:251], v112 offset:23552
    ds_read_b64_tr_b16 v[252:253], v113 offset:22528
    ds_read_b64_tr_b16 v[254:255], v113 offset:23552
    s_waitcnt lgkmcnt(0)
    s_add_u32 m0, s97, 8192
    s_add_u32 s17, s96, 229376
    buffer_load_dwordx4 v63, s[36:39], s17 offen lds
    s_add_u32 m0, s97, 9216
    s_add_u32 s17, s96, 258048
    buffer_load_dwordx4 v63, s[36:39], s17 offen lds
    s_add_u32 m0, s97, 10240
    s_add_u32 s17, s96, 286720
    buffer_load_dwordx4 v63, s[36:39], s17 offen lds
    s_add_u32 m0, s97, 11264
    s_add_u32 s17, s96, 315392
    buffer_load_dwordx4 v63, s[36:39], s17 offen lds
    s_add_u32 s78, s46, 0x8000
    buffer_load_dwordx4 v[80:83], v1, s[8:11], s76 offen offset:0 sc1
    buffer_load_dwordx4 v[84:87], v1, s[8:11], s76 offen offset:1024 sc1
    buffer_load_dwordx4 v[88:91], v1, s[8:11], s76 offen offset:2048 sc1
    buffer_load_dwordx4 v[92:95], v1, s[8:11], s76 offen offset:3072 sc1
    s_lshr_b32 s28, s87, 3
    s_lshl_b32 s28, s28, 1
    s_and_b32 s29, s44, 1
    s_add_u32 s4, s28, s29
    s_lshl_b32 s5, s4, 17
    s_add_u32 s5, s5, s67
    s_lshl_b32 s3, s44, 13
    s_add_u32 s47, s46, 0x10000
    s_lshl_b32 s30, s70, 11
    s_add_u32 s54, s30, s67
    s_add_u32 s54, s54, 0x8000
    s_add_u32 s50, s5, s3
    s_xor_b32 s51, s50, 0x20000
    s_mul_i32 s52, s44, 12288
    s_add_u32 s52, s52, s5
    s_add_u32 s52, s52, 0x10000
    s_xor_b32 s53, s52, 0x20000
    s_mul_i32 s3, s44, 28672
    s_add_u32 s3, s3, 0x1200000
    s_mul_i32 s57, s70, 114688
    s_add_u32 s57, s57, s3
    s_xor_b32 s31, s70, 1
    s_mul_i32 s58, s31, 114688
    s_add_u32 s58, s58, s3
    s_lshr_b32 s31, s87, 4
    s_lshl_b32 s31, s31, 2
    s_add_u32 s31, s31, s44
    s_lshl_b32 s31, s31, 17
    s_add_u32 s31, s31, s67
    s_add_u32 s59, s31, 0x10000
    s_and_b32 s30, s87, 15
    s_lshl_b32 s60, s30, 11
    s_add_u32 s60, s60, s31
    s_lshl_b32 s30, s30, 2
    s_add_u32 s31, s31, 0x1e000
    s_add_u32 s63, s31, s30
    s_add_u32 s63, s63, 128
    s_bfe_u32 s71, s87, 0x20002
    s_lshl_b32 s30, s71, 12
    s_add_u32 s61, s60, s30
    s_add_u32 s61, s61, 0x10000
    s_and_b32 s3, s87, 3
    s_cmp_lg_u32 s3, 3
    s_cselect_b32 s61, s61, 0x40000000
    s_mul_i32 s71, s71, 7
    s_add_u32 s71, s71, s3
    s_lshl_b32 s71, s71, 1
    s_add_u32 s71, s71, s29
    s_and_b32 s3, s44, 2
    s_lshl_b32 s3, s3, 2
    s_add_u32 s71, s71, s3
    s_lshl_b32 s71, s71, 11
    s_add_u32 s71, s71, 0x1100000
    v_add_u32 v8, s31, v8
    s_mul_i32 s30, s29, 3
    s_sub_u32 s30, s30, 1
    s_add_u32 s3, s28, s30
    s_cmp_lt_u32 s3, 8
    s_cselect_b32 s3, 0, 1
    s_or_b32 s30, s44, 1
    s_brev_b32 s31, s30
    s_cmp_eq_u32 s29, 0
    s_cselect_b32 s30, s30, s31
    s_mul_i32 s30, s30, s3
    s_mov_b32 vcc_lo, s30
    s_mov_b32 vcc_hi, s30
    s_lshl_b32 s72, s44, 13
    s_add_u32 s72, s72, s67
    s_add_u32 s72, s72, 0x100000
    s_cmp_lg_u32 s3, 0
    s_cselect_b32 s72, s72, 0x40000000
    s_lshl_b32 s3, s4, 17
    s_sub_u32 s3, 0xf8000, s3
    v_and_b32 v128, 0x210, v1
    v_add_u32 v128, s3, v128
    v_cndmask_b32 v5, v1, v128, vcc
    v_mov_b32 v128, 128
    v_cndmask_b32 v14, 0, v128, vcc
    s_lshr_b32 s30, s70, 3
    s_add_u32 s30, s30, 1
    s_sub_u32 s31, 0, s30
    s_bitcmp1_b32 s70, 2
    s_cselect_b32 s30, s31, s30
    s_cselect_b32 s31, -1, 1
    s_lshl_b32 s3, s4, 5
    s_sub_u32 s28, s3, s30
    s_add_u32 s30, s30, s3
    v_and_b32 v128, 31, v0
    v_add_u32 v131, s28, v128
    v_add_u32 v128, s30, v128
    v_and_b32 v129, 0x200, v1
    v_and_b32 v130, 31, v128
    v_lshl_add_u32 v130, v130, 4, v129
    v_lshrrev_b32 v3, 5, v128
    v_lshl_add_u32 v3, v3, 17, v130
    v_and_b32 v130, 0x210, v130
    v_mov_b32 v129, 0x40000000
    v_cmp_gt_u32 vcc, 256, v128
    s_nop 1
    v_cndmask_b32 v3, v129, v3, vcc
    v_cndmask_b32 v4, v130, v129, vcc
    v_cmp_gt_u32 vcc, 256, v131
    s_nop 1
    v_cndmask_b32 v4, v1, v4, vcc
    s_sub_u32 s3, s4, s31
    s_cmp_ge_u32 s3, 8
    s_cselect_b32 s28, 2, 0
    s_add_u32 s3, s4, s31
    s_lshl_b32 s30, s31, 17
    s_add_u32 s31, s86, s31
    s_cmp_lt_u32 s3, 8
    s_cselect_b32 s30, s30, 0
    s_add_u32 s30, s30, s62
    v_mov_b32 v128, s30
    v_cmp_gt_u32 vcc, 32, v0
    s_nop 1
    v_cndmask_b32 v8, v128, v8, vcc
    s_cmp_ge_u32 s3, 8
    s_cselect_b32 s64, 1, 0
    s_cmp_lt_u32 s31, 8
    s_cselect_b32 s64, s64, 0
    s_or_b32 s64, s64, s28
    s_lshl_b32 s68, s31, 21
    s_lshl_b32 s30, s70, 11
    s_add_u32 s68, s68, s30
    s_add_u32 s68, s68, 0x100000
    s_cmp_eq_u32 s64, 1
    s_cselect_b32 s68, s68, 0x40000000
    s_lshl_b32 s30, s44, 11
    s_add_u32 s30, s30, 131072
    v_add_u32 v2, s30, v1
    v_bfe_u32 v128, v0, 3, 2
    v_bfe_u32 v129, v0, 1, 1
    v_lshl_add_u32 v128, v128, 1, v129
    v_lshrrev_b32 v129, 3, v0
    v_xor_b32 v129, v129, v0
    v_and_b32 v129, 4, v129
    v_lshl_add_u32 v128, v129, 1, v128
    v_and_b32 v129, 16, v1
    v_lshlrev_b32 v129, v129, s65
    v_add_u32 v130, 161792, v1
    v_cmp_eq_u32 vcc, 0, v128
    s_nop 1
    v_cndmask_b32 v132, 0, v129, vcc
    v_cmp_eq_u32 vcc, 1, v128
    s_nop 1
    v_cndmask_b32 v133, 0, v129, vcc
    v_cmp_eq_u32 vcc, 2, v128
    s_nop 1
    v_cndmask_b32 v134, 0, v129, vcc
    v_cmp_eq_u32 vcc, 3, v128
    s_nop 1
    v_cndmask_b32 v135, 0, v129, vcc
    v_cmp_eq_u32 vcc, 4, v128
    s_nop 1
    v_cndmask_b32 v136, 0, v129, vcc
    v_cmp_eq_u32 vcc, 5, v128
    s_nop 1
    v_cndmask_b32 v137, 0, v129, vcc
    v_cmp_eq_u32 vcc, 6, v128
    s_nop 1
    v_cndmask_b32 v138, 0, v129, vcc
    v_cmp_eq_u32 vcc, 7, v128
    s_nop 1
    v_cndmask_b32 v139, 0, v129, vcc
    ds_write_b128 v130, v[132:135] offset:0
    ds_write_b128 v130, v[136:139] offset:1024
    s_waitcnt vmcnt(0)
    v_bitop3_b32 v7, v80, v81, v82 bitop3:0x80
    v_bitop3_b32 v7, v7, v83, v84 bitop3:0x80
    v_bitop3_b32 v7, v7, v85, v86 bitop3:0x80
    v_bitop3_b32 v7, v7, v87, v88 bitop3:0x80
    v_bitop3_b32 v7, v7, v89, v90 bitop3:0x80
    v_bitop3_b32 v7, v7, v91, v92 bitop3:0x80
    v_bitop3_b32 v7, v7, v93, v94 bitop3:0x80
    v_bitop3_b32 v7, v7, v95, 1 bitop3:0x2a
    v_cmp_ne_u32 vcc, 0, v7
    s_cbranch_vccnz OOL_12
RET_13:
    buffer_load_dwordx2 v[160:161], v123, s[8:11], s46 offen offset:0 sc1
    buffer_load_dwordx2 v[162:163], v123, s[8:11], s46 offen offset:256 sc1
    buffer_load_dwordx2 v[164:165], v123, s[8:11], s46 offen offset:1024 sc1
    buffer_load_dwordx2 v[166:167], v123, s[8:11], s46 offen offset:1280 sc1
    buffer_load_dwordx2 v[168:169], v123, s[8:11], s78 offen offset:0 sc1
    buffer_load_dwordx2 v[170:171], v123, s[8:11], s78 offen offset:256 sc1
    buffer_load_dwordx2 v[172:173], v123, s[8:11], s78 offen offset:1024 sc1
    buffer_load_dwordx2 v[174:175], v123, s[8:11], s78 offen offset:1280 sc1
    v_pk_add_f32 v[80:81], v[80:81], v[88:89]
    v_pk_add_f32 v[82:83], v[82:83], v[90:91]
    v_pk_add_f32 v[84:85], v[84:85], v[92:93]
    v_pk_add_f32 v[86:87], v[86:87], v[94:95]
    v_pk_add_f32 v[80:81], v[80:81], v[84:85]
    v_pk_add_f32 v[82:83], v[82:83], v[86:87]
    v_pk_add_f32 v[80:81], v[80:81], v[82:83]
    v_add_f32 v80, v80, v81
    v_mov_b32 v81, v80
    s_nop 1
    v_permlane32_swap_b32 v80, v81
    v_mul_f32 v80, 0xbb000000, v80
    v_mul_f32 v81, 0x3b000000, v81
    v_fma_f32 v81, -v80, v80, v81
    v_max_f32 v81, 0, v81
    v_add_f32 v81, 0x3727c5ac, v81
    v_rsq_f32 v82, v81
    s_nop 0
    v_mul_f32 v83, v80, v82
    v_pk_fma_f32 v[96:97], v[32:33], v[82:83], v[82:83] op_sel:[0,0,1] op_sel_hi:[1,0,1]
    v_pk_fma_f32 v[98:99], v[34:35], v[82:83], v[82:83] op_sel:[0,0,1] op_sel_hi:[1,0,1]
    v_pk_fma_f32 v[100:101], v[36:37], v[82:83], v[82:83] op_sel:[0,0,1] op_sel_hi:[1,0,1]
    v_pk_fma_f32 v[102:103], v[38:39], v[82:83], v[82:83] op_sel:[0,0,1] op_sel_hi:[1,0,1]
    v_pk_fma_f32 v[104:105], v[40:41], v[82:83], v[82:83] op_sel:[0,0,1] op_sel_hi:[1,0,1]
    v_pk_fma_f32 v[106:107], v[42:43], v[82:83], v[82:83] op_sel:[0,0,1] op_sel_hi:[1,0,1]
    v_pk_fma_f32 v[108:109], v[44:45], v[82:83], v[82:83] op_sel:[0,0,1] op_sel_hi:[1,0,1]
    v_pk_fma_f32 v[110:111], v[46:47], v[82:83], v[82:83] op_sel:[0,0,1] op_sel_hi:[1,0,1]
    s_waitcnt vmcnt(0)
    v_xor_b32 v7, s69, v161
    v_bitop3_b32 v7, v7, v163, s69 bitop3:0xf6
    v_bitop3_b32 v7, v7, v165, s69 bitop3:0xf6
    v_bitop3_b32 v7, v7, v167, s69 bitop3:0xf6
    v_bitop3_b32 v7, v7, v169, s69 bitop3:0xf6
    v_bitop3_b32 v7, v7, v171, s69 bitop3:0xf6
    v_bitop3_b32 v7, v7, v173, s69 bitop3:0xf6
    v_bitop3_b32 v7, v7, v175, s69 bitop3:0xf6
    v_cmp_ne_u32 vcc, 0, v7
    s_cbranch_vccnz OOL_15
RET_16:
    v_lshlrev_b32 v64, 16, v160
    v_and_b32 v65, 0xffff0000, v160
    v_lshlrev_b32 v66, 16, v162
    v_and_b32 v67, 0xffff0000, v162
    v_lshlrev_b32 v68, 16, v164
    v_and_b32 v69, 0xffff0000, v164
    v_lshlrev_b32 v70, 16, v166
    v_and_b32 v71, 0xffff0000, v166
    v_lshlrev_b32 v72, 16, v168
    v_and_b32 v73, 0xffff0000, v168
    v_lshlrev_b32 v74, 16, v170
    v_and_b32 v75, 0xffff0000, v170
    v_lshlrev_b32 v76, 16, v172
    v_and_b32 v77, 0xffff0000, v172
    v_lshlrev_b32 v78, 16, v174
    v_and_b32 v79, 0xffff0000, v174
    v_pk_fma_f32 v[32:33], v[96:97], v[64:65], v[32:33]
    v_pk_fma_f32 v[34:35], v[98:99], v[66:67], v[34:35]
    v_pk_fma_f32 v[36:37], v[100:101], v[68:69], v[36:37]
    v_pk_fma_f32 v[38:39], v[102:103], v[70:71], v[38:39]
    v_pk_fma_f32 v[40:41], v[104:105], v[72:73], v[40:41]
    v_pk_fma_f32 v[42:43], v[106:107], v[74:75], v[42:43]
    v_pk_fma_f32 v[44:45], v[108:109], v[76:77], v[44:45]
    v_pk_fma_f32 v[46:47], v[110:111], v[78:79], v[46:47]
    v_cvt_pk_bf16_f32 v112, v32, v33
    v_cvt_pk_bf16_f32 v113, v34, v35
    v_cvt_pk_bf16_f32 v114, v36, v37
    v_cvt_pk_bf16_f32 v115, v38, v39
    v_cvt_pk_bf16_f32 v116, v40, v41
    v_cvt_pk_bf16_f32 v117, v42, v43
    v_cvt_pk_bf16_f32 v118, v44, v45
    v_cvt_pk_bf16_f32 v119, v46, v47
    v_or_b32 v115, 1, v115
    v_or_b32 v119, 1, v119
    buffer_store_dwordx4 v[112:115], v1, s[8:11], s47 offen offset:0
    buffer_store_dwordx4 v[116:119], v1, s[8:11], s47 offen offset:1024
    v_pk_add_f32 v[120:121], v[32:33], v[34:35]
    v_pk_mul_f32 v[122:123], v[32:33], v[32:33]
    v_pk_fma_f32 v[122:123], v[34:35], v[34:35], v[122:123]
    v_pk_add_f32 v[120:121], v[120:121], v[36:37]
    v_pk_fma_f32 v[122:123], v[36:37], v[36:37], v[122:123]
    v_pk_add_f32 v[120:121], v[120:121], v[38:39]
    v_pk_fma_f32 v[122:123], v[38:39], v[38:39], v[122:123]
    v_pk_add_f32 v[120:121], v[120:121], v[40:41]
    v_pk_fma_f32 v[122:123], v[40:41], v[40:41], v[122:123]
    v_pk_add_f32 v[120:121], v[120:121], v[42:43]
    v_pk_fma_f32 v[122:123], v[42:43], v[42:43], v[122:123]
    v_pk_add_f32 v[120:121], v[120:121], v[44:45]
    v_pk_fma_f32 v[122:123], v[44:45], v[44:45], v[122:123]
    v_pk_add_f32 v[120:121], v[120:121], v[46:47]
    v_pk_fma_f32 v[122:123], v[46:47], v[46:47], v[122:123]
    v_add_f32 v120, v120, v121
    v_add_f32 v122, v122, v123
    s_nop 1
    v_permlane32_swap_b32 v120, v122
    v_add_f32 v120, v120, v122
    v_or_b32 v120, 1, v120
    buffer_store_dword v120, v1, s[8:11], s48 offen
    v_mov_b32 v48, v160
    v_mov_b32 v49, v162
    v_mov_b32 v50, v164
    v_mov_b32 v51, v166
    v_mov_b32 v52, v168
    v_mov_b32 v53, v170
    v_mov_b32 v54, v172
    v_mov_b32 v55, v174
    s_add_u32 s79, s51, 0x10000
    buffer_load_dwordx4 v[132:135], v1, s[8:11], s79 offen offset:0 sc1
    buffer_load_dwordx4 v[140:143], v1, s[8:11], s79 offen offset:1024 sc1
    buffer_load_dwordx4 v[148:151], v1, s[8:11], s79 offen offset:2048 sc1
    buffer_load_dwordx4 v[156:159], v1, s[8:11], s79 offen offset:3072 sc1
    s_add_u32 s79, s51, 0x11000
    buffer_load_dwordx4 v[164:167], v1, s[8:11], s79 offen offset:0 sc1
    buffer_load_dwordx4 v[172:175], v1, s[8:11], s79 offen offset:1024 sc1
    buffer_load_dwordx4 v[180:183], v1, s[8:11], s79 offen offset:2048 sc1
    buffer_load_dwordx4 v[188:191], v1, s[8:11], s79 offen offset:3072 sc1
    v_mfma_f32_32x32x16_bf16 v[64:79], v[124:127], v[192:195], 0
    v_mfma_f32_32x32x16_bf16 v[96:111], v[124:127], v[196:199], 0
    v_mfma_f32_32x32x16_bf16 v[64:79], v[124:127], v[200:203], v[64:79]
    v_mfma_f32_32x32x16_bf16 v[96:111], v[124:127], v[204:207], v[96:111]
    v_mfma_f32_32x32x16_bf16 v[64:79], v[124:127], v[208:211], v[64:79]
    v_mfma_f32_32x32x16_bf16 v[96:111], v[124:127], v[212:215], v[96:111]
    v_mfma_f32_32x32x16_bf16 v[64:79], v[124:127], v[216:219], v[64:79]
    v_mfma_f32_32x32x16_bf16 v[96:111], v[124:127], v[220:223], v[96:111]
    v_mfma_f32_32x32x16_bf16 v[64:79], v[124:127], v[224:227], v[64:79]
    v_mfma_f32_32x32x16_bf16 v[96:111], v[124:127], v[228:231], v[96:111]
    v_mfma_f32_32x32x16_bf16 v[64:79], v[124:127], v[232:235], v[64:79]
    v_mfma_f32_32x32x16_bf16 v[96:111], v[124:127], v[236:239], v[96:111]
    v_mfma_f32_32x32x16_bf16 v[64:79], v[124:127], v[240:243], v[64:79]
    v_mfma_f32_32x32x16_bf16 v[96:111], v[124:127], v[244:247], v[96:111]
    v_mfma_f32_32x32x16_bf16 v[64:79], v[124:127], v[248:251], v[64:79]
    v_mfma_f32_32x32x16_bf16 v[96:111], v[124:127], v[252:255], v[96:111]
    s_waitcnt vmcnt(6)
    v_bitop3_b32 v7, v135, v143, 1 bitop3:0x2a
    v_cmp_ne_u32 vcc, 0, v7
    s_cbranch_vccnz OOL_19
RET_20:
    v_mfma_f32_32x32x16_bf16 v[112:127], v[196:199], v[132:135], 0
    s_add_u32 s80, s50, 0x10000
    buffer_load_dwordx4 v[128:131], v1, s[8:11], s80 offen offset:0 sc1
    v_mov_b32 v30, s69
    v_add_u32 v30, 2, v30
    v_mfma_f32_32x32x16_bf16 v[80:95], v[192:195], v[132:135], 0
    s_mov_b64 exec, 1
    buffer_store_dword v30, off, s[8:11], s62
    s_mov_b64 exec, -1
    v_mfma_f32_32x32x16_bf16 v[112:127], v[204:207], v[140:143], v[112:127]
    buffer_load_dwordx4 v[136:139], v1, s[8:11], s80 offen offset:1024 sc1
    v_cmp_gt_u32 vcc, 32, v0
    s_nop 1
    v_cndmask_b32 v64, v96, v64, vcc
    ds_write_b32 v10, v64
    s_waitcnt vmcnt(7)
    v_bitop3_b32 v7, v151, v159, 1 bitop3:0x2a
    v_cmp_ne_u32 vcc, 0, v7
    v_mfma_f32_32x32x16_bf16 v[80:95], v[200:203], v[140:143], v[80:95]
    s_cbranch_vccnz OOL_22
RET_23:
    v_mfma_f32_32x32x16_bf16 v[112:127], v[212:215], v[148:151], v[112:127]
    buffer_load_dwordx4 v[144:147], v1, s[8:11], s80 offen offset:2048 sc1
    v_mfma_f32_32x32x16_bf16 v[80:95], v[208:211], v[148:151], v[80:95]
    v_mfma_f32_32x32x16_bf16 v[112:127], v[220:223], v[156:159], v[112:127]
    buffer_load_dwordx4 v[152:155], v1, s[8:11], s80 offen offset:3072 sc1
    s_waitcnt vmcnt(5)
    v_bitop3_b32 v7, v167, v175, v183 bitop3:0x80
    v_bitop3_b32 v7, v7, v191, 1 bitop3:0x2a
    v_cmp_ne_u32 vcc, 0, v7
    v_mfma_f32_32x32x16_bf16 v[80:95], v[216:219], v[156:159], v[80:95]
    s_cbranch_vccnz OOL_25
RET_26:
    v_mfma_f32_32x32x16_bf16 v[112:127], v[228:231], v[164:167], v[112:127]
    s_add_u32 s80, s50, 0x11000
    buffer_load_dwordx4 v[160:163], v1, s[8:11], s80 offen offset:0 sc1
    v_mfma_f32_32x32x16_bf16 v[80:95], v[224:227], v[164:167], v[80:95]
    v_mfma_f32_32x32x16_bf16 v[112:127], v[236:239], v[172:175], v[112:127]
    buffer_load_dwordx4 v[168:171], v1, s[8:11], s80 offen offset:1024 sc1
    v_mfma_f32_32x32x16_bf16 v[80:95], v[232:235], v[172:175], v[80:95]
    v_mfma_f32_32x32x16_bf16 v[112:127], v[244:247], v[180:183], v[112:127]
    buffer_load_dwordx4 v[176:179], v1, s[8:11], s80 offen offset:2048 sc1
    v_mfma_f32_32x32x16_bf16 v[80:95], v[240:243], v[180:183], v[80:95]
    v_mfma_f32_32x32x16_bf16 v[112:127], v[252:255], v[188:191], v[112:127]
    buffer_load_dwordx4 v[184:187], v1, s[8:11], s80 offen offset:3072 sc1
    s_waitcnt vmcnt(4)
    v_bitop3_b32 v7, v131, v139, v147 bitop3:0x80
    v_bitop3_b32 v7, v7, v155, 1 bitop3:0x2a
    v_cmp_ne_u32 vcc, 0, v7
    v_mfma_f32_32x32x16_bf16 v[80:95], v[248:251], v[188:191], v[80:95]
    s_cbranch_vccnz OOL_28
RET_29:
    buffer_load_dwordx4 v[132:135], v1, s[8:11], s49 offen offset:0 sc1
    buffer_load_dwordx4 v[140:143], v1, s[8:11], s49 offen offset:1024 sc1
    v_mfma_f32_32x32x16_bf16 v[96:111], v[196:199], v[128:131], 0
    buffer_load_dwordx4 v[148:151], v1, s[8:11], s49 offen offset:2048 sc1
    buffer_load_dwordx4 v[156:159], v1, s[8:11], s49 offen offset:3072 sc1
    buffer_load_dword v9, v8, s[8:11], 0 offen offset:0 sc1
    v_mfma_f32_32x32x16_bf16 v[96:111], v[204:207], v[136:139], v[96:111]
    s_lshr_b32 s22, s2, 3
    s_lshl_b32 s22, s22, 2
    s_add_u32 s22, s22, s44
    s_lshl_b32 s22, s22, 9
    v_and_b32 v28, 3, v0
    v_lshl_add_u32 v28, v28, 7, s22
    s_getpc_b64 s[22:23]
PC_17:
    v_min_u32 v28, L_codeend-PC_17-4, v28
    global_load_dword v62, v28, s[22:23]
    v_mfma_f32_32x32x16_bf16 v[96:111], v[212:215], v[144:147], v[96:111]
    s_add_u32 m0, s97, 12288
    s_add_u32 s17, s96, 344064
    buffer_load_dwordx4 v63, s[36:39], s17 offen lds
    v_xor_b32 v19, 6144, v2
    v_cvt_pk_bf16_f32 v112, v112, v113
    v_cvt_pk_bf16_f32 v113, v114, v115
    v_mfma_f32_32x32x16_bf16 v[64:79], v[192:195], v[128:131], 0
    s_add_u32 m0, s97, 13312
    s_add_u32 s17, s96, 372736
    buffer_load_dwordx4 v63, s[36:39], s17 offen lds
    v_cvt_pk_bf16_f32 v114, v116, v117
    v_cvt_pk_bf16_f32 v115, v118, v119
    v_cvt_pk_bf16_f32 v116, v120, v121
    v_mfma_f32_32x32x16_bf16 v[96:111], v[220:223], v[152:155], v[96:111]
    s_add_u32 m0, s97, 14336
    s_add_u32 s17, s96, 401408
    buffer_load_dwordx4 v63, s[36:39], s17 offen lds
    s_waitcnt vmcnt(11)
    v_bitop3_b32 v7, v163, v171, 1 bitop3:0x2a
    v_cmp_ne_u32 vcc, 0, v7
    v_mfma_f32_32x32x16_bf16 v[64:79], v[200:203], v[136:139], v[64:79]
    s_cbranch_vccnz OOL_31
RET_32:
    s_add_u32 m0, s97, 15360
    s_add_u32 s17, s96, 430080
    buffer_load_dwordx4 v63, s[36:39], s17 offen lds
    v_mfma_f32_32x32x16_bf16 v[96:111], v[228:231], v[160:163], v[96:111]
    s_add_u32 m0, s97, 16384
    s_add_u32 s17, s96, 458752
    buffer_load_dwordx4 v63, s[36:39], s17 offen lds
    v_cvt_pk_bf16_f32 v117, v122, v123
    v_cvt_pk_bf16_f32 v118, v124, v125
    v_cvt_pk_bf16_f32 v119, v126, v127
    v_mfma_f32_32x32x16_bf16 v[64:79], v[208:211], v[144:147], v[64:79]
    s_add_u32 m0, s97, 17408
    s_add_u32 s17, s96, 487424
    buffer_load_dwordx4 v63, s[36:39], s17 offen lds
    v_xor_b32 v17, 2048, v2
    v_cvt_pk_bf16_f32 v80, v80, v81
    v_cvt_pk_bf16_f32 v81, v82, v83
    v_mfma_f32_32x32x16_bf16 v[96:111], v[236:239], v[168:171], v[96:111]
    s_add_u32 m0, s97, 18432
    s_add_u32 s17, s96, 516096
    buffer_load_dwordx4 v63, s[36:39], s17 offen lds
    s_waitcnt vmcnt(13)
    v_bitop3_b32 v7, v179, v187, 1 bitop3:0x2a
    v_cmp_ne_u32 vcc, 0, v7
    v_mfma_f32_32x32x16_bf16 v[64:79], v[216:219], v[152:155], v[64:79]
    s_cbranch_vccnz OOL_34
RET_35:
    s_add_u32 m0, s97, 19456
    s_add_u32 s17, s96, 544768
    buffer_load_dwordx4 v63, s[36:39], s17 offen lds
    v_mfma_f32_32x32x16_bf16 v[96:111], v[244:247], v[176:179], v[96:111]
    s_add_u32 s89, s56, 0x80000
    buffer_load_dwordx4 v[196:199], v1, s[8:11], s89 offen offset:0 sc1
    ds_write_b128 v19, v[112:115] offset:16384
    v_mfma_f32_32x32x16_bf16 v[64:79], v[224:227], v[160:163], v[64:79]
    buffer_load_dwordx4 v[204:207], v1, s[8:11], s89 offen offset:1024 sc1
    ds_write_b128 v19, v[116:119] offset:17408
    v_cvt_pk_bf16_f32 v82, v84, v85
    v_cvt_pk_bf16_f32 v83, v86, v87
    ds_write_b128 v17, v[80:83] offset:0
    v_cvt_pk_bf16_f32 v84, v88, v89
    v_cvt_pk_bf16_f32 v85, v90, v91
    v_cvt_pk_bf16_f32 v86, v92, v93
    v_cvt_pk_bf16_f32 v87, v94, v95
    ds_write_b128 v17, v[84:87] offset:1024
    v_add_u32 v16, 161792, v1
    s_waitcnt lgkmcnt(0)
    s_barrier
    ds_read_b128 v[120:123], v16 offset:0
    ds_read_b128 v[124:127], v16 offset:1024
    ds_read_b128 v[80:83], v2 offset:0
    ds_read_b128 v[84:87], v2 offset:1024
    ds_read_b128 v[112:115], v2 offset:16384
    ds_read_b128 v[116:119], v2 offset:17408
    v_mfma_f32_32x32x16_bf16 v[96:111], v[252:255], v[184:187], v[96:111]
    buffer_load_dwordx4 v[212:215], v1, s[8:11], s89 offen offset:2048 sc1
    v_mfma_f32_32x32x16_bf16 v[64:79], v[232:235], v[168:171], v[64:79]
    s_add_u32 s88, s55, 0x80000
    buffer_load_dwordx4 v[192:195], v1, s[8:11], s88 offen offset:0 sc1
    v_mfma_f32_32x32x16_bf16 v[64:79], v[240:243], v[176:179], v[64:79]
    buffer_load_dwordx4 v[220:223], v1, s[8:11], s89 offen offset:3072 sc1
    v_xor_b32 v18, 4096, v2
    s_nop 4
    v_cvt_pk_bf16_f32 v96, v96, v97
    v_cvt_pk_bf16_f32 v97, v98, v99
    v_cvt_pk_bf16_f32 v98, v100, v101
    v_mfma_f32_32x32x16_bf16 v[64:79], v[248:251], v[184:187], v[64:79]
    buffer_load_dwordx4 v[200:203], v1, s[8:11], s88 offen offset:1024 sc1
    v_cvt_pk_bf16_f32 v99, v102, v103
    v_cvt_pk_bf16_f32 v100, v104, v105
    v_cvt_pk_bf16_f32 v101, v106, v107
    v_cvt_pk_bf16_f32 v102, v108, v109
    v_cvt_pk_bf16_f32 v103, v110, v111
    s_waitcnt lgkmcnt(3)
    v_mfma_f32_32x32x16_bf16 v[64:79], v[120:123], v[80:83], v[64:79]
    s_add_u32 s89, s56, 0x81000
    buffer_load_dwordx4 v[228:231], v1, s[8:11], s89 offen offset:0 sc1
    ds_write_b128 v18, v[96:99] offset:8192
    s_waitcnt lgkmcnt(3)
    v_mfma_f32_32x32x16_bf16 v[64:79], v[124:127], v[84:87], v[64:79]
    buffer_load_dwordx4 v[208:211], v1, s[8:11], s88 offen offset:2048 sc1
    ds_write_b128 v18, v[100:103] offset:9216
    s_waitcnt lgkmcnt(3)
    v_mfma_f32_32x32x16_bf16 v[64:79], v[120:123], v[112:115], v[64:79]
    buffer_load_dwordx4 v[236:239], v1, s[8:11], s89 offen offset:1024 sc1
    s_waitcnt lgkmcnt(0)
    s_barrier
    ds_read_b128 v[96:99], v2 offset:8192
    ds_read_b128 v[100:103], v2 offset:9216
    v_mfma_f32_32x32x16_bf16 v[64:79], v[124:127], v[116:119], v[64:79]
    buffer_load_dwordx4 v[216:219], v1, s[8:11], s88 offen offset:3072 sc1
    buffer_load_dwordx4 v[244:247], v1, s[8:11], s89 offen offset:2048 sc1
    s_add_u32 s88, s55, 0x81000
    buffer_load_dwordx4 v[224:227], v1, s[8:11], s88 offen offset:0 sc1
    ds_read2_b32 v[18:19], v11 offset0:0 offset1:32
    s_waitcnt vmcnt(22)
    v_bitop3_b32 v7, v132, v133, v134 bitop3:0x80
    v_bitop3_b32 v7, v7, v135, v140 bitop3:0x80
    v_bitop3_b32 v7, v7, v141, v142 bitop3:0x80
    v_bitop3_b32 v7, v7, v143, v148 bitop3:0x80
    v_bitop3_b32 v7, v7, v149, v150 bitop3:0x80
    v_bitop3_b32 v7, v7, v151, v156 bitop3:0x80
    v_bitop3_b32 v7, v7, v157, v158 bitop3:0x80
    v_bitop3_b32 v7, v7, v159, 1 bitop3:0x2a
    v_cmp_ne_u32 vcc, 0, v7
    s_cbranch_vccnz OOL_37
RET_38:
    v_pk_add_f32 v[132:133], v[132:133], v[148:149]
    v_pk_add_f32 v[134:135], v[134:135], v[150:151]
    v_pk_add_f32 v[140:141], v[140:141], v[156:157]
    v_pk_add_f32 v[142:143], v[142:143], v[158:159]
    v_pk_add_f32 v[132:133], v[132:133], v[140:141]
    v_pk_add_f32 v[134:135], v[134:135], v[142:143]
    v_pk_add_f32 v[132:133], v[132:133], v[134:135]
    v_add_f32 v132, v132, v133
    v_mov_b32 v133, v132
    s_nop 1
    v_permlane32_swap_b32 v132, v133
    v_mul_f32 v132, 0xbb000000, v132
    v_mul_f32 v133, 0x3b000000, v133
    v_fma_f32 v133, -v132, v132, v133
    v_max_f32 v133, 0, v133
    v_cvt_pk_bf16_f32 v134, v132, v132
    v_and_b32 v134, 0xffff0000, v134
    v_sub_f32 v135, v132, v134
    v_cvt_pk_bf16_f32 v12, v134, v135
    v_mov_b32 v13, v12
    s_waitcnt lgkmcnt(0)
    v_add_f32 v18, v18, v19
    v_cvt_pk_bf16_f32 v10, v18, v18
    v_and_b32 v11, 0xffff0000, v10
    v_sub_f32 v11, v18, v11
    v_cvt_pk_bf16_f32 v11, v11, v11
    s_nop 1
    v_mfma_f32_32x32x8_bf16 v[64:79], v[10:11], v[12:13], v[64:79]
    s_waitcnt vmcnt(21)
    v_subrev_u32 v9, s69, v9
    v_subrev_u32 v9, 2, v9
    v_cmp_lt_u32 vcc, 7, v9
    v_add_f32 v134, 0x3727c5ac, v133
    v_mov_b32 v140, 0x2edbe6ff
    v_rsq_f32 v56, v134
    v_fmac_f32 v140, 0x3f800054, v133
    v_mul_f32 v57, v132, v56
    v_rsq_f32 v141, v140
    s_nop 0
    v_mul_f32 v60, v140, v141
    v_mul_f32 v59, 0xc0135761, v141
    v_mul_f32 v58, v141, v141
    v_mul_f32 v141, 0xbdd2d3e8, v141
    v_mul_f32 v58, v58, v141
    v_mov_b32 v61, v60
    s_cbranch_vccnz OOL_40
RET_41:
    v_dot2c_f32_bf16 v64, s65, v96
    v_dot2c_f32_bf16 v65, s66, v96
    v_dot2c_f32_bf16 v66, s65, v97
    v_dot2c_f32_bf16 v67, s66, v97
    v_dot2c_f32_bf16 v68, s65, v98
    v_dot2c_f32_bf16 v69, s66, v98
    v_dot2c_f32_bf16 v70, s65, v99
    v_dot2c_f32_bf16 v71, s66, v99
    buffer_load_dwordx4 v[252:255], v1, s[8:11], s89 offen offset:3072 sc1
    v_dot2c_f32_bf16 v72, s65, v100
    v_dot2c_f32_bf16 v73, s66, v100
    v_dot2c_f32_bf16 v74, s65, v101
    v_dot2c_f32_bf16 v75, s66, v101
    v_dot2c_f32_bf16 v76, s65, v102
    v_dot2c_f32_bf16 v77, s66, v102
    v_dot2c_f32_bf16 v78, s65, v103
    v_dot2c_f32_bf16 v79, s66, v103
    buffer_load_dwordx4 v[232:235], v1, s[8:11], s88 offen offset:1024 sc1
    v_pk_mul_f32 v[80:81], v[64:65], v[64:65]
    v_pk_mul_f32 v[82:83], v[66:67], v[66:67]
    v_pk_mul_f32 v[84:85], v[68:69], v[68:69]
    v_pk_mul_f32 v[86:87], v[70:71], v[70:71]
    v_pk_fma_f32 v[80:81], v[80:81], v[58:59], v[58:59] op_sel:[0,0,1] op_sel_hi:[1,0,1]
    v_pk_fma_f32 v[82:83], v[82:83], v[58:59], v[58:59] op_sel:[0,0,1] op_sel_hi:[1,0,1]
    buffer_load_dwordx4 v[240:243], v1, s[8:11], s88 offen offset:2048 sc1
    v_pk_fma_f32 v[84:85], v[84:85], v[58:59], v[58:59] op_sel:[0,0,1] op_sel_hi:[1,0,1]
    v_pk_fma_f32 v[86:87], v[86:87], v[58:59], v[58:59] op_sel:[0,0,1] op_sel_hi:[1,0,1]
    v_pk_mul_f32 v[80:81], v[80:81], v[64:65]
    v_pk_mul_f32 v[82:83], v[82:83], v[66:67]
    v_pk_mul_f32 v[84:85], v[84:85], v[68:69]
    v_pk_mul_f32 v[86:87], v[86:87], v[70:71]
    buffer_load_dwordx4 v[248:251], v1, s[8:11], s88 offen offset:3072 sc1
    v_exp_f32 v80, v80
    v_exp_f32 v81, v81
    v_exp_f32 v82, v82
    v_exp_f32 v83, v83
    v_exp_f32 v84, v84
    v_exp_f32 v85, v85
    v_and_b32 v28, 31, v0
    v_lshlrev_b32 v28, 2, v28
    v_lshrrev_b32 v29, 5, v0
    v_lshl_add_u32 v28, v29, 10, v28
    buffer_load_dword v20, v28, s[8:11], s71 offen offset:0 sc1
    buffer_load_dword v21, v28, s[8:11], s71 offen offset:128 sc1
    buffer_load_dword v22, v28, s[8:11], s71 offen offset:256 sc1
    buffer_load_dword v23, v28, s[8:11], s71 offen offset:384 sc1
    buffer_load_dword v24, v28, s[8:11], s71 offen offset:512 sc1
    buffer_load_dword v25, v28, s[8:11], s71 offen offset:640 sc1
    buffer_load_dword v26, v28, s[8:11], s71 offen offset:768 sc1
    buffer_load_dword v27, v28, s[8:11], s71 offen offset:896 sc1
    v_exp_f32 v86, v86
    v_exp_f32 v87, v87
    v_pk_fma_f32 v[80:81], v[80:81], v[60:61], v[60:61]
    v_pk_fma_f32 v[82:83], v[82:83], v[60:61], v[60:61]
    v_pk_fma_f32 v[84:85], v[84:85], v[60:61], v[60:61]
    v_pk_fma_f32 v[86:87], v[86:87], v[60:61], v[60:61]
    v_rcp_f32 v80, v80
    v_rcp_f32 v81, v81
    v_rcp_f32 v82, v82
    v_rcp_f32 v83, v83
    v_rcp_f32 v84, v84
    v_rcp_f32 v85, v85
    v_rcp_f32 v86, v86
    v_rcp_f32 v87, v87
    v_pk_mul_f32 v[64:65], v[64:65], v[80:81]
    v_pk_mul_f32 v[66:67], v[66:67], v[82:83]
    v_pk_mul_f32 v[68:69], v[68:69], v[84:85]
    v_pk_mul_f32 v[70:71], v[70:71], v[86:87]
    v_pk_mul_f32 v[80:81], v[72:73], v[72:73]
    v_pk_mul_f32 v[82:83], v[74:75], v[74:75]
    v_pk_mul_f32 v[84:85], v[76:77], v[76:77]
    v_pk_mul_f32 v[86:87], v[78:79], v[78:79]
    v_pk_fma_f32 v[80:81], v[80:81], v[58:59], v[58:59] op_sel:[0,0,1] op_sel_hi:[1,0,1]
    v_pk_fma_f32 v[82:83], v[82:83], v[58:59], v[58:59] op_sel:[0,0,1] op_sel_hi:[1,0,1]
    v_pk_fma_f32 v[84:85], v[84:85], v[58:59], v[58:59] op_sel:[0,0,1] op_sel_hi:[1,0,1]
    v_pk_fma_f32 v[86:87], v[86:87], v[58:59], v[58:59] op_sel:[0,0,1] op_sel_hi:[1,0,1]
    v_pk_mul_f32 v[80:81], v[80:81], v[72:73]
    v_pk_mul_f32 v[82:83], v[82:83], v[74:75]
    v_pk_mul_f32 v[84:85], v[84:85], v[76:77]
    v_pk_mul_f32 v[86:87], v[86:87], v[78:79]
    v_exp_f32 v80, v80
    v_exp_f32 v81, v81
    v_exp_f32 v82, v82
    v_exp_f32 v83, v83
    v_exp_f32 v84, v84
    v_exp_f32 v85, v85
    v_exp_f32 v86, v86
    v_exp_f32 v87, v87
    v_pk_fma_f32 v[80:81], v[80:81], v[60:61], v[60:61]
    v_pk_fma_f32 v[82:83], v[82:83], v[60:61], v[60:61]
    v_pk_fma_f32 v[84:85], v[84:85], v[60:61], v[60:61]
    v_pk_fma_f32 v[86:87], v[86:87], v[60:61], v[60:61]
    v_rcp_f32 v80, v80
    v_rcp_f32 v81, v81
    v_rcp_f32 v82, v82
    v_rcp_f32 v83, v83
    v_rcp_f32 v84, v84
    v_rcp_f32 v85, v85
    v_rcp_f32 v86, v86
    v_rcp_f32 v87, v87
    v_pk_mul_f32 v[72:73], v[72:73], v[80:81]
    v_pk_mul_f32 v[74:75], v[74:75], v[82:83]
    v_pk_mul_f32 v[76:77], v[76:77], v[84:85]
    v_pk_mul_f32 v[78:79], v[78:79], v[86:87]
    v_cvt_pk_bf16_f32 v112, v64, v65
    v_cvt_pk_bf16_f32 v113, v66, v67
    v_cvt_pk_bf16_f32 v114, v68, v69
    v_cvt_pk_bf16_f32 v115, v70, v71
    v_cvt_pk_bf16_f32 v116, v72, v73
    v_cvt_pk_bf16_f32 v117, v74, v75
    v_cvt_pk_bf16_f32 v118, v76, v77
    v_cvt_pk_bf16_f32 v119, v78, v79
    v_or_b32 v115, 1, v115
    v_or_b32 v119, 1, v119
    buffer_store_dwordx4 v[112:115], v3, s[8:11], s54 offen offset:0
    buffer_store_dwordx4 v[116:119], v3, s[8:11], s54 offen offset:1024
    buffer_store_dwordx4 v[112:115], v4, s[8:11], s68 offen offset:0 sc1
    buffer_store_dwordx4 v[116:119], v4, s[8:11], s68 offen offset:1024 sc1
    s_cmp_eq_u32 s64, 2
    s_cbranch_scc1 OOL_43
RET_44:
    v_pk_fma_f32 v[64:65], v[32:33], v[56:57], v[56:57] op_sel:[0,0,1] op_sel_hi:[1,0,1]
    v_pk_fma_f32 v[66:67], v[34:35], v[56:57], v[56:57] op_sel:[0,0,1] op_sel_hi:[1,0,1]
    v_pk_fma_f32 v[68:69], v[36:37], v[56:57], v[56:57] op_sel:[0,0,1] op_sel_hi:[1,0,1]
    v_pk_fma_f32 v[70:71], v[38:39], v[56:57], v[56:57] op_sel:[0,0,1] op_sel_hi:[1,0,1]
    v_pk_fma_f32 v[72:73], v[40:41], v[56:57], v[56:57] op_sel:[0,0,1] op_sel_hi:[1,0,1]
    v_pk_fma_f32 v[74:75], v[42:43], v[56:57], v[56:57] op_sel:[0,0,1] op_sel_hi:[1,0,1]
    v_pk_fma_f32 v[76:77], v[44:45], v[56:57], v[56:57] op_sel:[0,0,1] op_sel_hi:[1,0,1]
    v_pk_fma_f32 v[78:79], v[46:47], v[56:57], v[56:57] op_sel:[0,0,1] op_sel_hi:[1,0,1]
    s_add_u32 s79, s51, 0x8000
    buffer_load_dwordx4 v[132:135], v1, s[8:11], s79 offen offset:0 sc1
    buffer_load_dwordx4 v[140:143], v1, s[8:11], s79 offen offset:1024 sc1
    buffer_load_dwordx4 v[148:151], v1, s[8:11], s79 offen offset:2048 sc1
    buffer_load_dwordx4 v[156:159], v1, s[8:11], s79 offen offset:3072 sc1
    s_add_u32 s79, s51, 0x9000
    buffer_load_dwordx4 v[164:167], v1, s[8:11], s79 offen offset:0 sc1
    buffer_load_dwordx4 v[172:175], v1, s[8:11], s79 offen offset:1024 sc1
    buffer_load_dwordx4 v[180:183], v1, s[8:11], s79 offen offset:2048 sc1
    buffer_load_dwordx4 v[188:191], v1, s[8:11], s79 offen offset:3072 sc1
    s_waitcnt vmcnt(6)
    v_bitop3_b32 v7, v135, v143, 1 bitop3:0x2a
    v_cmp_ne_u32 vcc, 0, v7
    s_cbranch_vccnz OOL_46
RET_47:
    v_mfma_f32_32x32x16_bf16 v[112:127], v[196:199], v[132:135], 0
    s_add_u32 s80, s50, 0x8000
    buffer_load_dwordx4 v[128:131], v5, s[8:11], s80 offen offset:0 sc1
    v_add_f32 v20, v20, v24
    v_add_f32 v21, v21, v25
    v_add_f32 v22, v22, v26
    v_add_f32 v23, v23, v27
    v_mfma_f32_32x32x16_bf16 v[80:95], v[192:195], v[132:135], 0
    v_add_f32 v20, v20, v22
    v_add_f32 v21, v21, v23
    v_add_f32 v20, v20, v21
    v_cvt_pk_bf16_f32 v22, v20, v20
    v_and_b32 v23, 0xffff0000, v22
    v_sub_f32 v23, v20, v23
    v_mfma_f32_32x32x16_bf16 v[112:127], v[204:207], v[140:143], v[112:127]
    buffer_load_dwordx4 v[136:139], v5, s[8:11], s80 offen offset:1024 sc1
    s_waitcnt vmcnt(6)
    v_bitop3_b32 v7, v151, v159, 1 bitop3:0x2a
    v_cmp_ne_u32 vcc, 0, v7
    v_cvt_pk_bf16_f32 v23, v23, v23
    v_mfma_f32_32x32x16_bf16 v[80:95], v[200:203], v[140:143], v[80:95]
    s_cbranch_vccnz OOL_49
RET_50:
    s_lshl_b32 s76, s44, 9
    s_add_u32 s76, s76, 131072
    v_lshl_add_u32 v20, v0, 3, s76
    v_mfma_f32_32x32x16_bf16 v[112:127], v[212:215], v[148:151], v[112:127]
    buffer_load_dwordx4 v[144:147], v5, s[8:11], s80 offen offset:2048 sc1
    ds_write_b64 v20, v[22:23] offset:24576
    v_mfma_f32_32x32x16_bf16 v[80:95], v[208:211], v[148:151], v[80:95]
    v_mfma_f32_32x32x16_bf16 v[112:127], v[220:223], v[156:159], v[112:127]
    buffer_load_dwordx4 v[152:155], v5, s[8:11], s80 offen offset:3072 sc1
    s_waitcnt vmcnt(4)
    v_bitop3_b32 v7, v167, v175, v183 bitop3:0x80
    v_bitop3_b32 v7, v7, v191, 1 bitop3:0x2a
    v_cmp_ne_u32 vcc, 0, v7
    v_mfma_f32_32x32x16_bf16 v[80:95], v[216:219], v[156:159], v[80:95]
    s_cbranch_vccnz OOL_52
RET_53:
    v_mfma_f32_32x32x16_bf16 v[112:127], v[228:231], v[164:167], v[112:127]
    s_add_u32 s80, s50, 0x9000
    buffer_load_dwordx4 v[160:163], v5, s[8:11], s80 offen offset:0 sc1
    v_mfma_f32_32x32x16_bf16 v[80:95], v[224:227], v[164:167], v[80:95]
    v_mfma_f32_32x32x16_bf16 v[112:127], v[236:239], v[172:175], v[112:127]
    buffer_load_dwordx4 v[168:171], v5, s[8:11], s80 offen offset:1024 sc1
    v_mfma_f32_32x32x16_bf16 v[80:95], v[232:235], v[172:175], v[80:95]
    v_mfma_f32_32x32x16_bf16 v[112:127], v[244:247], v[180:183], v[112:127]
    buffer_load_dwordx4 v[176:179], v5, s[8:11], s80 offen offset:2048 sc1
    v_mfma_f32_32x32x16_bf16 v[80:95], v[240:243], v[180:183], v[80:95]
    v_mfma_f32_32x32x16_bf16 v[112:127], v[252:255], v[188:191], v[112:127]
    buffer_load_dwordx4 v[184:187], v5, s[8:11], s80 offen offset:3072 sc1
    s_waitcnt vmcnt(4)
    v_bitop3_b32 v7, v131, v139, v147 bitop3:0x80
    v_bitop3_b32 v7, v7, v155, 1 bitop3:0x2a
    v_cmp_ne_u32 vcc, 0, v7
    v_mfma_f32_32x32x16_bf16 v[80:95], v[248:251], v[188:191], v[80:95]
    s_cbranch_vccnz OOL_55
RET_56:
    v_lshlrev_b32 v28, 2, v1
    s_lshl_b32 s90, s70, 10
    s_sub_u32 s90, 0x17800, s90
    v_add_u32 v7, s90, v28
    s_mov_b32 exec_lo, 0
    v_mov_b32 v28, v7
    s_mul_i32 s90, s70, 1792
    s_sub_u32 s90, 0x1cd00, s90
    s_mov_b32 exec_hi, 0xffff0000
    v_add_u32 v28, s90, v1
    s_mov_b64 exec, -1
    buffer_load_dword v62, v28, s[8:11], s46 offen sc1
    v_mfma_f32_32x32x16_bf16 v[96:111], v[196:199], v[128:131], 0
    s_add_u32 m0, s97, 20480
    s_add_u32 s17, s96, 573440
    buffer_load_dwordx4 v63, s[36:39], s17 offen lds
    v_mfma_f32_32x32x16_bf16 v[96:111], v[204:207], v[136:139], v[96:111]
    s_add_u32 m0, s97, 21504
    s_add_u32 s17, s96, 602112
    buffer_load_dwordx4 v63, s[36:39], s17 offen lds
    v_xor_b32 v19, 6144, v2
    v_cvt_pk_bf16_f32 v112, v112, v113
    v_cvt_pk_bf16_f32 v113, v114, v115
    v_mfma_f32_32x32x16_bf16 v[96:111], v[212:215], v[144:147], v[96:111]
    s_add_u32 m0, s97, 22528
    s_add_u32 s17, s96, 630784
    buffer_load_dwordx4 v63, s[36:39], s17 offen lds
    v_cvt_pk_bf16_f32 v114, v116, v117
    v_cvt_pk_bf16_f32 v115, v118, v119
    v_cvt_pk_bf16_f32 v116, v120, v121
    v_mfma_f32_32x32x16_bf16 v[96:111], v[220:223], v[152:155], v[96:111]
    s_add_u32 m0, s97, 23552
    s_add_u32 s17, s96, 659456
    buffer_load_dwordx4 v63, s[36:39], s17 offen lds
    s_waitcnt vmcnt(7)
    v_bitop3_b32 v7, v163, v171, 1 bitop3:0x2a
    v_cmp_ne_u32 vcc, 0, v7
    v_mfma_f32_32x32x16_bf16 v[64:79], v[192:195], v[128:131], v[64:79]
    s_cbranch_vccnz OOL_58
RET_59:
    s_add_u32 m0, s97, 24576
    s_add_u32 s17, s96, 688128
    buffer_load_dwordx4 v63, s[36:39], s17 offen lds
    v_mfma_f32_32x32x16_bf16 v[96:111], v[228:231], v[160:163], v[96:111]
    s_add_u32 m0, s97, 25600
    s_add_u32 s17, s96, 716800
    buffer_load_dwordx4 v63, s[36:39], s17 offen lds
    v_cvt_pk_bf16_f32 v117, v122, v123
    v_cvt_pk_bf16_f32 v118, v124, v125
    v_cvt_pk_bf16_f32 v119, v126, v127
    v_mfma_f32_32x32x16_bf16 v[64:79], v[200:203], v[136:139], v[64:79]
    s_add_u32 m0, s97, 26624
    s_add_u32 s17, s96, 745472
    buffer_load_dwordx4 v63, s[36:39], s17 offen lds
    v_xor_b32 v17, 2048, v2
    v_cvt_pk_bf16_f32 v80, v80, v81
    v_cvt_pk_bf16_f32 v81, v82, v83
    v_mfma_f32_32x32x16_bf16 v[96:111], v[236:239], v[168:171], v[96:111]
    s_add_u32 m0, s97, 27648
    s_add_u32 s17, s96, 774144
    buffer_load_dwordx4 v63, s[36:39], s17 offen lds
    s_waitcnt vmcnt(9)
    v_bitop3_b32 v7, v179, v187, 1 bitop3:0x2a
    v_cmp_ne_u32 vcc, 0, v7
    v_mfma_f32_32x32x16_bf16 v[64:79], v[208:211], v[144:147], v[64:79]
    s_cbranch_vccnz OOL_61
RET_62:
    s_add_u32 m0, s97, 28672
    s_add_u32 s17, s96, 802816
    buffer_load_dwordx4 v63, s[36:39], s17 offen lds
    v_mfma_f32_32x32x16_bf16 v[96:111], v[244:247], v[176:179], v[96:111]
    s_add_u32 m0, s97, 29696
    s_add_u32 s17, s96, 831488
    buffer_load_dwordx4 v63, s[36:39], s17 offen lds
    v_cvt_pk_bf16_f32 v82, v84, v85
    v_cvt_pk_bf16_f32 v83, v86, v87
    v_cvt_pk_bf16_f32 v84, v88, v89
    v_mfma_f32_32x32x16_bf16 v[64:79], v[216:219], v[152:155], v[64:79]
    s_add_u32 m0, s97, 30720
    s_add_u32 s17, s96, 860160
    buffer_load_dwordx4 v63, s[36:39], s17 offen lds
    v_cvt_pk_bf16_f32 v85, v90, v91
    v_cvt_pk_bf16_f32 v86, v92, v93
    v_cvt_pk_bf16_f32 v87, v94, v95
    ds_write_b128 v19, v[112:115] offset:16384
    ds_write_b128 v19, v[116:119] offset:17408
    ds_write_b128 v17, v[80:83] offset:0
    ds_write_b128 v17, v[84:87] offset:1024
    v_add_u32 v16, 161792, v1
    s_waitcnt lgkmcnt(0)
    s_barrier
    ds_read_b128 v[120:123], v16 offset:0
    ds_read_b128 v[124:127], v16 offset:1024
    ds_read_b128 v[80:83], v2 offset:0
    ds_read_b128 v[84:87], v2 offset:1024
    ds_read_b128 v[112:115], v2 offset:16384
    ds_read_b128 v[116:119], v2 offset:17408
    v_mfma_f32_32x32x16_bf16 v[96:111], v[252:255], v[184:187], v[96:111]
    s_add_u32 m0, s97, 31744
    s_add_u32 s17, s96, 888832
    buffer_load_dwordx4 v63, s[36:39], s17 offen lds
    v_mfma_f32_32x32x16_bf16 v[64:79], v[224:227], v[160:163], v[64:79]
    buffer_load_dwordx4 a[0:3], v1, s[8:11], s57 offen offset:0 sc1
    v_mfma_f32_32x32x16_bf16 v[64:79], v[232:235], v[168:171], v[64:79]
    buffer_load_dwordx4 a[4:7], v1, s[8:11], s58 offen offset:0 sc1
    v_xor_b32 v18, 4096, v2
    s_nop 3
    v_cvt_pk_bf16_f32 v96, v96, v97
    v_cvt_pk_bf16_f32 v97, v98, v99
    v_cvt_pk_bf16_f32 v98, v100, v101
    v_mfma_f32_32x32x16_bf16 v[64:79], v[240:243], v[176:179], v[64:79]
    buffer_load_dwordx4 a[8:11], v1, s[8:11], s57 offen offset:1024 sc1
    v_cvt_pk_bf16_f32 v99, v102, v103
    v_cvt_pk_bf16_f32 v100, v104, v105
    v_cvt_pk_bf16_f32 v101, v106, v107
    v_cvt_pk_bf16_f32 v102, v108, v109
    v_cvt_pk_bf16_f32 v103, v110, v111
    v_mfma_f32_32x32x16_bf16 v[64:79], v[248:251], v[184:187], v[64:79]
    buffer_load_dwordx4 a[12:15], v1, s[8:11], s58 offen offset:1024 sc1
    ds_write_b128 v18, v[96:99] offset:8192
    s_waitcnt lgkmcnt(4)
    v_mfma_f32_32x32x16_bf16 v[64:79], v[120:123], v[80:83], v[64:79]
    buffer_load_dwordx4 a[16:19], v1, s[8:11], s57 offen offset:2048 sc1
    ds_write_b128 v18, v[100:103] offset:9216
    s_waitcnt lgkmcnt(4)
    v_mfma_f32_32x32x16_bf16 v[64:79], v[124:127], v[84:87], v[64:79]
    buffer_load_dwordx4 a[20:23], v1, s[8:11], s58 offen offset:2048 sc1
    s_waitcnt lgkmcnt(0)
    s_barrier
    ds_read_b128 v[96:99], v2 offset:8192
    ds_read_b128 v[100:103], v2 offset:9216
    v_mfma_f32_32x32x16_bf16 v[64:79], v[120:123], v[112:115], v[64:79]
    buffer_load_dwordx4 a[24:27], v1, s[8:11], s57 offen offset:3072 sc1
    v_mfma_f32_32x32x16_bf16 v[64:79], v[124:127], v[116:119], v[64:79]
    buffer_load_dwordx4 a[28:31], v1, s[8:11], s58 offen offset:3072 sc1
    s_add_u32 s91, s57, 0x1000
    buffer_load_dwordx4 a[32:35], v1, s[8:11], s91 offen offset:0 sc1
    s_add_u32 s92, s58, 0x1000
    buffer_load_dwordx4 a[36:39], v1, s[8:11], s92 offen offset:0 sc1
    s_waitcnt lgkmcnt(1)
    s_nop 5
    v_dot2c_f32_bf16 v64, s65, v96
    v_dot2c_f32_bf16 v65, s66, v96
    v_dot2c_f32_bf16 v66, s65, v97
    v_dot2c_f32_bf16 v67, s66, v97
    v_dot2c_f32_bf16 v68, s65, v98
    v_dot2c_f32_bf16 v69, s66, v98
    v_dot2c_f32_bf16 v70, s65, v99
    v_dot2c_f32_bf16 v71, s66, v99
    s_waitcnt lgkmcnt(0)
    v_dot2c_f32_bf16 v72, s65, v100
    v_dot2c_f32_bf16 v73, s66, v100
    v_dot2c_f32_bf16 v74, s65, v101
    v_dot2c_f32_bf16 v75, s66, v101
    v_dot2c_f32_bf16 v76, s65, v102
    v_dot2c_f32_bf16 v77, s66, v102
    v_dot2c_f32_bf16 v78, s65, v103
    v_dot2c_f32_bf16 v79, s66, v103
    v_cvt_pk_bf16_f32 v112, v64, v65
    v_cvt_pk_bf16_f32 v113, v66, v67
    v_cvt_pk_bf16_f32 v114, v68, v69
    v_cvt_pk_bf16_f32 v115, v70, v71
    v_cvt_pk_bf16_f32 v116, v72, v73
    v_cvt_pk_bf16_f32 v117, v74, v75
    v_cvt_pk_bf16_f32 v118, v76, v77
    v_cvt_pk_bf16_f32 v119, v78, v79
    v_and_b32 v115, -2, v115
    v_and_b32 v119, -2, v119
    buffer_store_dwordx4 v[112:115], v1, s[8:11], s47 offen offset:0
    buffer_store_dwordx4 v[116:119], v1, s[8:11], s47 offen offset:1024
    v_pk_add_f32 v[120:121], v[64:65], v[66:67]
    v_pk_mul_f32 v[122:123], v[64:65], v[64:65]
    v_pk_fma_f32 v[122:123], v[66:67], v[66:67], v[122:123]
    v_pk_add_f32 v[120:121], v[120:121], v[68:69]
    v_pk_fma_f32 v[122:123], v[68:69], v[68:69], v[122:123]
    v_pk_add_f32 v[120:121], v[120:121], v[70:71]
    v_pk_fma_f32 v[122:123], v[70:71], v[70:71], v[122:123]
    v_pk_add_f32 v[120:121], v[120:121], v[72:73]
    v_pk_fma_f32 v[122:123], v[72:73], v[72:73], v[122:123]
    v_pk_add_f32 v[120:121], v[120:121], v[74:75]
    v_pk_fma_f32 v[122:123], v[74:75], v[74:75], v[122:123]
    v_pk_add_f32 v[120:121], v[120:121], v[76:77]
    v_pk_fma_f32 v[122:123], v[76:77], v[76:77], v[122:123]
    v_pk_add_f32 v[120:121], v[120:121], v[78:79]
    v_pk_fma_f32 v[122:123], v[78:79], v[78:79], v[122:123]
    v_add_f32 v120, v120, v121
    v_add_f32 v122, v122, v123
    s_nop 1
    v_permlane32_swap_b32 v120, v122
    v_add_f32 v120, v120, v122
    v_and_b32 v120, -2, v120
    buffer_store_dword v120, v1, s[8:11], s48 offen
    v_pk_add_f32 v[32:33], v[32:33], v[64:65]
    v_pk_add_f32 v[34:35], v[34:35], v[66:67]
    v_pk_add_f32 v[36:37], v[36:37], v[68:69]
    v_pk_add_f32 v[38:39], v[38:39], v[70:71]
    v_pk_add_f32 v[40:41], v[40:41], v[72:73]
    v_pk_add_f32 v[42:43], v[42:43], v[74:75]
    v_pk_add_f32 v[44:45], v[44:45], v[76:77]
    v_pk_add_f32 v[46:47], v[46:47], v[78:79]
    v_add_u32 v29, 65536, v15
    buffer_load_dwordx4 v[128:131], v1, s[8:11], s59 offen offset:0 sc1
    buffer_load_dwordx4 v[132:135], v1, s[8:11], s59 offen offset:1024 sc1
    buffer_load_dwordx4 v[136:139], v1, s[8:11], s59 offen offset:2048 sc1
    buffer_load_dwordx4 v[140:143], v1, s[8:11], s59 offen offset:3072 sc1
    s_add_u32 s79, s59, 0x1000
    buffer_load_dwordx4 v[144:147], v1, s[8:11], s79 offen offset:0 sc1
    buffer_load_dwordx4 v[148:151], v1, s[8:11], s79 offen offset:1024 sc1
    buffer_load_dwordx4 v[152:155], v1, s[8:11], s79 offen offset:2048 sc1
    buffer_load_dwordx4 v[156:159], v1, s[8:11], s79 offen offset:3072 sc1
    s_add_u32 s79, s59, 0x2000
    buffer_load_dwordx4 v[160:163], v1, s[8:11], s79 offen offset:0 sc1
    buffer_load_dwordx4 v[164:167], v1, s[8:11], s79 offen offset:1024 sc1
    buffer_load_dwordx4 v[168:171], v1, s[8:11], s79 offen offset:2048 sc1
    buffer_load_dwordx4 v[172:175], v1, s[8:11], s79 offen offset:3072 sc1
    v_lshlrev_b32 v30, 3, v0
    v_add_u32 v30, 131072, v30
    s_waitcnt vmcnt(25) lgkmcnt(0)
    s_barrier
    ds_read_b64 a[224:225], v30 offset:24576
    ds_read_b64 a[226:227], v30 offset:25088
    ds_read_b64 a[228:229], v30 offset:25600
    ds_read_b64 a[230:231], v30 offset:26112
    ds_read_b64_tr_b16 a[232:233], v15 offset:0
    ds_read_b64_tr_b16 a[234:235], v15 offset:1024
    ds_read_b64_tr_b16 a[236:237], v15 offset:512
    ds_read_b64_tr_b16 a[238:239], v15 offset:1536
    ds_read_b64_tr_b16 a[240:241], v15 offset:2048
    ds_read_b64_tr_b16 a[242:243], v15 offset:3072
    ds_read_b64_tr_b16 a[244:245], v15 offset:2560
    ds_read_b64_tr_b16 a[246:247], v15 offset:3584
    ds_read_b64_tr_b16 a[248:249], v15 offset:4096
    ds_read_b64_tr_b16 a[250:251], v15 offset:5120
    s_add_u32 s77, s59, 0xc000
    s_waitcnt vmcnt(10)
    v_bitop3_b32 v7, v131, v135, 1 bitop3:0xa8
    v_cmp_ne_u32 vcc, 0, v7
    s_cbranch_vccnz OOL_64
RET_65:
    s_waitcnt lgkmcnt(8)
    v_mfma_f32_32x32x16_bf16 v[64:79], a[232:235], v[128:131], 0
    s_waitcnt lgkmcnt(4)
    ds_read_b64_tr_b16 a[252:253], v15 offset:4608
    ds_read_b64_tr_b16 a[254:255], v15 offset:5632
    s_add_u32 s79, s59, 0x3000
    buffer_load_dwordx4 v[176:179], v1, s[8:11], s79 offen offset:0 sc1
    v_mfma_f32_32x32x16_bf16 v[80:95], a[236:239], v[128:131], 0
    ds_read_b64_tr_b16 a[232:233], v15 offset:6144
    ds_read_b64_tr_b16 a[234:235], v15 offset:7168
    v_mfma_f32_32x32x16_bf16 v[64:79], a[240:243], v[132:135], v[64:79]
    s_waitcnt lgkmcnt(4)
    ds_read_b64_tr_b16 a[236:237], v15 offset:6656
    ds_read_b64_tr_b16 a[238:239], v15 offset:7680
    buffer_load_dwordx4 v[180:183], v1, s[8:11], s79 offen offset:1024 sc1
    s_waitcnt vmcnt(10)
    v_bitop3_b32 v7, v139, v143, 1 bitop3:0xa8
    v_cmp_ne_u32 vcc, 0, v7
    v_mfma_f32_32x32x16_bf16 v[80:95], a[244:247], v[132:135], v[80:95]
    s_cbranch_vccnz OOL_68
RET_69:
    ds_read_b64_tr_b16 a[240:241], v15 offset:8192
    ds_read_b64_tr_b16 a[242:243], v15 offset:9216
    v_mfma_f32_32x32x16_bf16 v[64:79], a[248:251], v[136:139], v[64:79]
    s_waitcnt lgkmcnt(4)
    ds_read_b64_tr_b16 a[244:245], v15 offset:8704
    ds_read_b64_tr_b16 a[246:247], v15 offset:9728
    buffer_load_dwordx4 v[184:187], v1, s[8:11], s79 offen offset:2048 sc1
    v_mfma_f32_32x32x16_bf16 v[80:95], a[252:255], v[136:139], v[80:95]
    ds_read_b64_tr_b16 a[248:249], v15 offset:10240
    ds_read_b64_tr_b16 a[250:251], v15 offset:11264
    v_mfma_f32_32x32x16_bf16 v[64:79], a[232:235], v[140:143], v[64:79]
    s_waitcnt lgkmcnt(4)
    ds_read_b64_tr_b16 a[252:253], v15 offset:10752
    ds_read_b64_tr_b16 a[254:255], v15 offset:11776
    buffer_load_dwordx4 v[188:191], v1, s[8:11], s79 offen offset:3072 sc1
    s_waitcnt vmcnt(8)
    v_bitop3_b32 v7, v147, v151, v155 bitop3:0xfe
    v_bitop3_b32 v7, v7, v159, 1 bitop3:0xa8
    v_cmp_ne_u32 vcc, 0, v7
    v_mfma_f32_32x32x16_bf16 v[80:95], a[236:239], v[140:143], v[80:95]
    s_cbranch_vccnz OOL_71
RET_72:
    ds_read_b64_tr_b16 a[232:233], v15 offset:12288
    ds_read_b64_tr_b16 a[234:235], v15 offset:13312
    v_mfma_f32_32x32x16_bf16 v[64:79], a[240:243], v[144:147], v[64:79]
    s_waitcnt lgkmcnt(4)
    ds_read_b64_tr_b16 a[236:237], v15 offset:12800
    ds_read_b64_tr_b16 a[238:239], v15 offset:13824
    s_add_u32 s79, s59, 0x4000
    buffer_load_dwordx4 v[192:195], v1, s[8:11], s79 offen offset:0 sc1
    v_mfma_f32_32x32x16_bf16 v[80:95], a[244:247], v[144:147], v[80:95]
    ds_read_b64_tr_b16 a[240:241], v15 offset:14336
    ds_read_b64_tr_b16 a[242:243], v15 offset:15360
    v_mfma_f32_32x32x16_bf16 v[64:79], a[248:251], v[148:151], v[64:79]
    s_waitcnt lgkmcnt(4)
    ds_read_b64_tr_b16 a[244:245], v15 offset:14848
    ds_read_b64_tr_b16 a[246:247], v15 offset:15872
    buffer_load_dwordx4 v[196:199], v1, s[8:11], s79 offen offset:1024 sc1
    v_mfma_f32_32x32x16_bf16 v[80:95], a[252:255], v[148:151], v[80:95]
    ds_read_b64_tr_b16 a[248:249], v15 offset:16384
    ds_read_b64_tr_b16 a[250:251], v15 offset:17408
    v_mfma_f32_32x32x16_bf16 v[64:79], a[232:235], v[152:155], v[64:79]
    s_waitcnt lgkmcnt(4)
    ds_read_b64_tr_b16 a[252:253], v15 offset:16896
    ds_read_b64_tr_b16 a[254:255], v15 offset:17920
    buffer_load_dwordx4 v[200:203], v1, s[8:11], s79 offen offset:2048 sc1
    v_mfma_f32_32x32x16_bf16 v[80:95], a[236:239], v[152:155], v[80:95]
    ds_read_b64_tr_b16 a[232:233], v15 offset:18432
    ds_read_b64_tr_b16 a[234:235], v15 offset:19456
    v_mfma_f32_32x32x16_bf16 v[64:79], a[240:243], v[156:159], v[64:79]
    s_waitcnt lgkmcnt(4)
    ds_read_b64_tr_b16 a[236:237], v15 offset:18944
    ds_read_b64_tr_b16 a[238:239], v15 offset:19968
    buffer_load_dwordx4 v[204:207], v1, s[8:11], s79 offen offset:3072 sc1
    s_waitcnt vmcnt(8)
    v_bitop3_b32 v7, v163, v167, v171 bitop3:0xfe
    v_bitop3_b32 v7, v7, v175, 1 bitop3:0xa8
    v_cmp_ne_u32 vcc, 0, v7
    v_mfma_f32_32x32x16_bf16 v[80:95], a[244:247], v[156:159], v[80:95]
    s_cbranch_vccnz OOL_74
RET_75:
    ds_read_b64_tr_b16 a[240:241], v15 offset:20480
    ds_read_b64_tr_b16 a[242:243], v15 offset:21504
    v_mfma_f32_32x32x16_bf16 v[64:79], a[248:251], v[160:163], v[64:79]
    s_waitcnt lgkmcnt(4)
    ds_read_b64_tr_b16 a[244:245], v15 offset:20992
    ds_read_b64_tr_b16 a[246:247], v15 offset:22016
    s_add_u32 s79, s59, 0x5000
    buffer_load_dwordx4 v[208:211], v1, s[8:11], s79 offen offset:0 sc1
    v_mfma_f32_32x32x16_bf16 v[80:95], a[252:255], v[160:163], v[80:95]
    ds_read_b64_tr_b16 a[248:249], v15 offset:22528
    ds_read_b64_tr_b16 a[250:251], v15 offset:23552
    v_mfma_f32_32x32x16_bf16 v[64:79], a[232:235], v[164:167], v[64:79]
    s_waitcnt lgkmcnt(4)
    ds_read_b64_tr_b16 a[252:253], v15 offset:23040
    ds_read_b64_tr_b16 a[254:255], v15 offset:24064
    buffer_load_dwordx4 v[212:215], v1, s[8:11], s79 offen offset:1024 sc1
    v_mfma_f32_32x32x16_bf16 v[80:95], a[236:239], v[164:167], v[80:95]
    ds_read_b64_tr_b16 a[232:233], v15 offset:24576
    ds_read_b64_tr_b16 a[234:235], v15 offset:25600
    v_mfma_f32_32x32x16_bf16 v[64:79], a[240:243], v[168:171], v[64:79]
    s_waitcnt lgkmcnt(4)
    ds_read_b64_tr_b16 a[236:237], v15 offset:25088
    ds_read_b64_tr_b16 a[238:239], v15 offset:26112
    buffer_load_dwordx4 v[216:219], v1, s[8:11], s79 offen offset:2048 sc1
    v_mfma_f32_32x32x16_bf16 v[80:95], a[244:247], v[168:171], v[80:95]
    ds_read_b64_tr_b16 a[240:241], v15 offset:26624
    ds_read_b64_tr_b16 a[242:243], v15 offset:27648
    v_mfma_f32_32x32x16_bf16 v[64:79], a[248:251], v[172:175], v[64:79]
    s_waitcnt lgkmcnt(4)
    ds_read_b64_tr_b16 a[244:245], v15 offset:27136
    ds_read_b64_tr_b16 a[246:247], v15 offset:28160
    buffer_load_dwordx4 v[220:223], v1, s[8:11], s79 offen offset:3072 sc1
    s_waitcnt vmcnt(8)
    v_bitop3_b32 v7, v179, v183, v187 bitop3:0xfe
    v_bitop3_b32 v7, v7, v191, 1 bitop3:0xa8
    v_cmp_ne_u32 vcc, 0, v7
    v_mfma_f32_32x32x16_bf16 v[80:95], a[252:255], v[172:175], v[80:95]
    s_cbranch_vccnz OOL_77
RET_78:
    ds_read_b64_tr_b16 a[248:249], v15 offset:28672
    ds_read_b64_tr_b16 a[250:251], v15 offset:29696
    v_mfma_f32_32x32x16_bf16 v[64:79], a[232:235], v[176:179], v[64:79]
    s_waitcnt lgkmcnt(4)
    ds_read_b64_tr_b16 a[252:253], v15 offset:29184
    ds_read_b64_tr_b16 a[254:255], v15 offset:30208
    s_add_u32 s79, s59, 0x6000
    buffer_load_dwordx4 v[224:227], v1, s[8:11], s79 offen offset:0 sc1
    v_mfma_f32_32x32x16_bf16 v[80:95], a[236:239], v[176:179], v[80:95]
    ds_read_b64_tr_b16 a[232:233], v15 offset:30720
    ds_read_b64_tr_b16 a[234:235], v15 offset:31744
    v_mfma_f32_32x32x16_bf16 v[64:79], a[240:243], v[180:183], v[64:79]
    s_waitcnt lgkmcnt(4)
    ds_read_b64_tr_b16 a[236:237], v15 offset:31232
    ds_read_b64_tr_b16 a[238:239], v15 offset:32256
    buffer_load_dwordx4 v[228:231], v1, s[8:11], s79 offen offset:1024 sc1
    v_mfma_f32_32x32x16_bf16 v[80:95], a[244:247], v[180:183], v[80:95]
    ds_read_b64_tr_b16 a[240:241], v15 offset:32768
    ds_read_b64_tr_b16 a[242:243], v15 offset:33792
    v_mfma_f32_32x32x16_bf16 v[64:79], a[248:251], v[184:187], v[64:79]
    s_waitcnt lgkmcnt(4)
    ds_read_b64_tr_b16 a[244:245], v15 offset:33280
    ds_read_b64_tr_b16 a[246:247], v15 offset:34304
    buffer_load_dwordx4 v[232:235], v1, s[8:11], s79 offen offset:2048 sc1
    v_mfma_f32_32x32x16_bf16 v[80:95], a[252:255], v[184:187], v[80:95]
    ds_read_b64_tr_b16 a[248:249], v15 offset:34816
    ds_read_b64_tr_b16 a[250:251], v15 offset:35840
    v_mfma_f32_32x32x16_bf16 v[64:79], a[232:235], v[188:191], v[64:79]
    s_waitcnt lgkmcnt(4)
    ds_read_b64_tr_b16 a[252:253], v15 offset:35328
    ds_read_b64_tr_b16 a[254:255], v15 offset:36352
    buffer_load_dwordx4 v[236:239], v1, s[8:11], s79 offen offset:3072 sc1
    s_waitcnt vmcnt(8)
    v_bitop3_b32 v7, v195, v199, v203 bitop3:0xfe
    v_bitop3_b32 v7, v7, v207, 1 bitop3:0xa8
    v_cmp_ne_u32 vcc, 0, v7
    v_mfma_f32_32x32x16_bf16 v[80:95], a[236:239], v[188:191], v[80:95]
    s_cbranch_vccnz OOL_80
RET_81:
    ds_read_b64_tr_b16 a[232:233], v15 offset:36864
    ds_read_b64_tr_b16 a[234:235], v15 offset:37888
    v_mfma_f32_32x32x16_bf16 v[64:79], a[240:243], v[192:195], v[64:79]
    s_waitcnt lgkmcnt(4)
    ds_read_b64_tr_b16 a[236:237], v15 offset:37376
    ds_read_b64_tr_b16 a[238:239], v15 offset:38400
    s_add_u32 s79, s59, 0x7000
    buffer_load_dwordx4 v[240:243], v1, s[8:11], s79 offen offset:0 sc1
    v_mfma_f32_32x32x16_bf16 v[80:95], a[244:247], v[192:195], v[80:95]
    ds_read_b64_tr_b16 a[240:241], v15 offset:38912
    ds_read_b64_tr_b16 a[242:243], v15 offset:39936
    v_mfma_f32_32x32x16_bf16 v[64:79], a[248:251], v[196:199], v[64:79]
    s_waitcnt lgkmcnt(4)
    ds_read_b64_tr_b16 a[244:245], v15 offset:39424
    ds_read_b64_tr_b16 a[246:247], v15 offset:40448
    buffer_load_dwordx4 v[244:247], v1, s[8:11], s79 offen offset:1024 sc1
    v_mfma_f32_32x32x16_bf16 v[80:95], a[252:255], v[196:199], v[80:95]
    ds_read_b64_tr_b16 a[248:249], v15 offset:40960
    ds_read_b64_tr_b16 a[250:251], v15 offset:41984
    v_mfma_f32_32x32x16_bf16 v[64:79], a[232:235], v[200:203], v[64:79]
    s_waitcnt lgkmcnt(4)
    ds_read_b64_tr_b16 a[252:253], v15 offset:41472
    ds_read_b64_tr_b16 a[254:255], v15 offset:42496
    buffer_load_dwordx4 v[248:251], v1, s[8:11], s79 offen offset:2048 sc1
    v_mfma_f32_32x32x16_bf16 v[80:95], a[236:239], v[200:203], v[80:95]
    ds_read_b64_tr_b16 a[232:233], v15 offset:43008
    ds_read_b64_tr_b16 a[234:235], v15 offset:44032
    v_mfma_f32_32x32x16_bf16 v[64:79], a[240:243], v[204:207], v[64:79]
    s_waitcnt lgkmcnt(4)
    ds_read_b64_tr_b16 a[236:237], v15 offset:43520
    ds_read_b64_tr_b16 a[238:239], v15 offset:44544
    buffer_load_dwordx4 v[252:255], v1, s[8:11], s79 offen offset:3072 sc1
    s_waitcnt vmcnt(8)
    v_bitop3_b32 v7, v211, v215, v219 bitop3:0xfe
    v_bitop3_b32 v7, v7, v223, 1 bitop3:0xa8
    v_cmp_ne_u32 vcc, 0, v7
    v_mfma_f32_32x32x16_bf16 v[80:95], a[244:247], v[204:207], v[80:95]
    s_cbranch_vccnz OOL_83
RET_84:
    ds_read_b64_tr_b16 a[240:241], v15 offset:45056
    ds_read_b64_tr_b16 a[242:243], v15 offset:46080
    v_mfma_f32_32x32x16_bf16 v[64:79], a[248:251], v[208:211], v[64:79]
    s_waitcnt lgkmcnt(4)
    ds_read_b64_tr_b16 a[244:245], v15 offset:45568
    ds_read_b64_tr_b16 a[246:247], v15 offset:46592
    v_mfma_f32_32x32x16_bf16 v[80:95], a[252:255], v[208:211], v[80:95]
    ds_read_b64_tr_b16 a[248:249], v15 offset:47104
    ds_read_b64_tr_b16 a[250:251], v15 offset:48128
    buffer_load_dwordx4 v[112:115], v1, s[8:11], s77 offen offset:0 sc1
    buffer_load_dwordx4 v[116:119], v1, s[8:11], s77 offen offset:1024 sc1
    buffer_load_dwordx4 v[120:123], v1, s[8:11], s77 offen offset:2048 sc1
    buffer_load_dwordx4 v[124:127], v1, s[8:11], s77 offen offset:3072 sc1
    v_mfma_f32_32x32x16_bf16 v[64:79], a[232:235], v[212:215], v[64:79]
    s_waitcnt lgkmcnt(4)
    ds_read_b64_tr_b16 a[252:253], v15 offset:47616
    ds_read_b64_tr_b16 a[254:255], v15 offset:48640
    v_lshlrev_b32 v28, 2, v1
    s_lshl_b32 s90, s70, 10
    s_sub_u32 s90, 0x17800, s90
    v_add_u32 v7, s90, v28
    s_mov_b32 exec_lo, 0
    v_mov_b32 v28, v7
    s_mul_i32 s90, s70, 1792
    s_sub_u32 s90, 0x1cd00, s90
    s_mov_b32 exec_hi, 0xffff0000
    v_add_u32 v28, s90, v1
    s_mov_b64 exec, -1
    buffer_load_dword v62, v28, s[8:11], s46 offen sc1
    v_mfma_f32_32x32x16_bf16 v[80:95], a[236:239], v[212:215], v[80:95]
    ds_read_b64_tr_b16 a[232:233], v15 offset:49152
    ds_read_b64_tr_b16 a[234:235], v15 offset:50176
    v_mfma_f32_32x32x16_bf16 v[64:79], a[240:243], v[216:219], v[64:79]
    s_waitcnt lgkmcnt(4)
    ds_read_b64_tr_b16 a[236:237], v15 offset:49664
    ds_read_b64_tr_b16 a[238:239], v15 offset:50688
    v_and_b32 v28, 48, v1
    v_bfe_u32 v7, v0, 2, 3
    v_lshlrev_b32 v28, 2, v28
    v_lshl_add_u32 v28, v7, 10, v28
    v_lshrrev_b32 v7, 5, v0
    v_lshl_add_u32 v28, v7, 15, v28
    s_lshr_b32 s90, s2, 6
    s_lshl_b32 s90, s90, 8
    s_add_u32 s90, s90, s55
    s_and_b32 s90, s90, 0xffff7fff
    s_add_u32 s90, s90, 0x80000
    buffer_load_dword v62, v28, s[8:11], s90 offen sc1
    v_mfma_f32_32x32x16_bf16 v[80:95], a[244:247], v[216:219], v[80:95]
    ds_read_b64_tr_b16 a[240:241], v15 offset:51200
    ds_read_b64_tr_b16 a[242:243], v15 offset:52224
    v_mfma_f32_32x32x16_bf16 v[64:79], a[248:251], v[220:223], v[64:79]
    s_waitcnt lgkmcnt(4)
    ds_read_b64_tr_b16 a[244:245], v15 offset:51712
    ds_read_b64_tr_b16 a[246:247], v15 offset:52736
    buffer_load_dwordx4 a[40:43], v1, s[8:11], s91 offen offset:1024 sc1
    s_waitcnt vmcnt(11)
    v_bitop3_b32 v7, v227, v231, v235 bitop3:0xfe
    v_bitop3_b32 v7, v7, v239, 1 bitop3:0xa8
    v_cmp_ne_u32 vcc, 0, v7
    v_mfma_f32_32x32x16_bf16 v[80:95], a[252:255], v[220:223], v[80:95]
    s_cbranch_vccnz OOL_86
RET_87:
    ds_read_b64_tr_b16 a[248:249], v15 offset:53248
    ds_read_b64_tr_b16 a[250:251], v15 offset:54272
    v_mfma_f32_32x32x16_bf16 v[64:79], a[232:235], v[224:227], v[64:79]
    s_waitcnt lgkmcnt(4)
    ds_read_b64_tr_b16 a[252:253], v15 offset:53760
    ds_read_b64_tr_b16 a[254:255], v15 offset:54784
    buffer_load_dwordx4 a[44:47], v1, s[8:11], s92 offen offset:1024 sc1
    v_mfma_f32_32x32x16_bf16 v[80:95], a[236:239], v[224:227], v[80:95]
    ds_read_b64_tr_b16 a[232:233], v15 offset:55296
    ds_read_b64_tr_b16 a[234:235], v15 offset:56320
    v_mfma_f32_32x32x16_bf16 v[64:79], a[240:243], v[228:231], v[64:79]
    s_waitcnt lgkmcnt(4)
    ds_read_b64_tr_b16 a[236:237], v15 offset:55808
    ds_read_b64_tr_b16 a[238:239], v15 offset:56832
    buffer_load_dwordx4 a[48:51], v1, s[8:11], s91 offen offset:2048 sc1
    v_mfma_f32_32x32x16_bf16 v[80:95], a[244:247], v[228:231], v[80:95]
    ds_read_b64_tr_b16 a[240:241], v15 offset:57344
    ds_read_b64_tr_b16 a[242:243], v15 offset:58368
    v_mfma_f32_32x32x16_bf16 v[64:79], a[248:251], v[232:235], v[64:79]
    s_waitcnt lgkmcnt(4)
    ds_read_b64_tr_b16 a[244:245], v15 offset:57856
    ds_read_b64_tr_b16 a[246:247], v15 offset:58880
    buffer_load_dwordx4 a[52:55], v1, s[8:11], s92 offen offset:2048 sc1
    v_mfma_f32_32x32x16_bf16 v[80:95], a[252:255], v[232:235], v[80:95]
    ds_read_b64_tr_b16 a[248:249], v15 offset:59392
    ds_read_b64_tr_b16 a[250:251], v15 offset:60416
    s_waitcnt vmcnt(6)
    v_bitop3_b32 v7, v112, v113, v114 bitop3:0xfe
    v_bitop3_b32 v7, v7, v115, v116 bitop3:0xfe
    v_bitop3_b32 v7, v7, v117, v118 bitop3:0xfe
    v_bitop3_b32 v7, v7, v119, v120 bitop3:0xfe
    v_bitop3_b32 v7, v7, v121, v122 bitop3:0xfe
    v_bitop3_b32 v7, v7, v123, v124 bitop3:0xfe
    v_bitop3_b32 v7, v7, v125, v126 bitop3:0xfe
    v_bitop3_b32 v7, v7, v127, 1 bitop3:0xa8
    v_cmp_ne_u32 vcc, 0, v7
    v_mfma_f32_32x32x16_bf16 v[64:79], a[232:235], v[236:239], v[64:79]
    s_cbranch_vccnz OOL_89
RET_90:
    s_waitcnt lgkmcnt(4)
    ds_read_b64_tr_b16 a[252:253], v15 offset:61440
    ds_read_b64_tr_b16 a[254:255], v15 offset:62464
    buffer_load_dwordx4 a[56:59], v1, s[8:11], s91 offen offset:3072 sc1
    v_bitop3_b32 v7, v243, v247, v251 bitop3:0xfe
    v_bitop3_b32 v7, v7, v255, 1 bitop3:0xa8
    v_cmp_ne_u32 vcc, 0, v7
    v_mfma_f32_32x32x16_bf16 v[80:95], a[236:239], v[236:239], v[80:95]
    s_cbranch_vccnz OOL_92
RET_93:
    ds_read_b64_tr_b16 a[232:233], v15 offset:63488
    ds_read_b64_tr_b16 a[234:235], v15 offset:64512
    v_add_f32 v112, v112, v120
    v_mfma_f32_32x32x16_bf16 v[64:79], a[240:243], v[240:243], v[64:79]
    s_waitcnt lgkmcnt(4)
    ds_read_b64_tr_b16 a[236:237], v15 offset:59904
    ds_read_b64_tr_b16 a[238:239], v15 offset:60928
    buffer_load_dwordx4 a[60:63], v1, s[8:11], s92 offen offset:3072 sc1
    v_add_f32 v113, v113, v121
    v_add_f32 v114, v114, v122
    v_mfma_f32_32x32x16_bf16 v[80:95], a[244:247], v[240:243], v[80:95]
    ds_read_b64_tr_b16 a[240:241], v15 offset:61952
    ds_read_b64_tr_b16 a[242:243], v15 offset:62976
    v_add_f32 v115, v115, v123
    v_add_f32 v116, v116, v124
    v_add_f32 v117, v117, v125
    v_add_f32 v118, v118, v126
    v_add_f32 v119, v119, v127
    v_mfma_f32_32x32x16_bf16 v[64:79], a[248:251], v[244:247], v[64:79]
    s_waitcnt lgkmcnt(4)
    ds_read_b64_tr_b16 a[244:245], v15 offset:64000
    ds_read_b64_tr_b16 a[246:247], v15 offset:65024
    s_add_u32 s91, s57, 0x2000
    buffer_load_dwordx4 a[64:67], v1, s[8:11], s91 offen offset:0 sc1
    v_add_f32 v112, v112, v116
    v_mfma_f32_32x32x16_bf16 v[64:79], a[252:255], v[248:251], v[64:79]
    ds_read_b64_tr_b16 a[248:249], v29 offset:33280
    ds_read_b64_tr_b16 a[250:251], v29 offset:34304
    v_add_f32 v113, v113, v117
    v_add_f32 v114, v114, v118
    v_add_f32 v115, v115, v119
    v_add_f32 v112, v112, v114
    v_add_f32 v113, v113, v115
    v_mfma_f32_32x32x16_bf16 v[64:79], a[232:235], v[252:255], v[64:79]
    s_waitcnt lgkmcnt(4)
    ds_read_b64_tr_b16 a[252:253], v29 offset:32768
    ds_read_b64_tr_b16 a[254:255], v29 offset:33792
    s_add_u32 s92, s58, 0x2000
    buffer_load_dwordx4 a[68:71], v1, s[8:11], s92 offen offset:0 sc1
    v_add_f32 v112, v112, v113
    v_mov_b32 v113, v112
    s_nop 1
    v_permlane32_swap_b32 v112, v113
    v_mul_f32 v112, 0xbb000000, v112
    v_mul_f32 v113, 0x3b000000, v113
    v_fma_f32 v113, -v112, v112, v113
    v_max_f32 v113, 0, v113
    v_cvt_pk_bf16_f32 v114, v112, v112
    v_and_b32 v114, 0xffff0000, v114
    v_sub_f32 v115, v112, v114
    v_cvt_pk_bf16_f32 v12, v114, v115
    v_mov_b32 v13, v12
    v_add_f32 v116, 0x3727c5ac, v113
    v_rsq_f32 v117, v116
    s_nop 0
    v_mul_f32 v60, v116, v117
    v_mul_f32 v59, 0xc0135761, v117
    v_mul_f32 v58, v117, v117
    v_mul_f32 v117, 0xbdd2d3e8, v117
    v_mul_f32 v58, v58, v117
    v_mov_b32 v61, v60
    v_mfma_f32_32x32x8_bf16 v[64:79], a[224:225], v[12:13], v[64:79]
    v_mov_b32 v30, s69
    v_add_u32 v30, 1, v30
    v_mfma_f32_32x32x16_bf16 v[80:95], a[236:239], v[244:247], v[80:95]
    ds_read_b64_tr_b16 a[232:233], v29 offset:35328
    ds_read_b64_tr_b16 a[234:235], v29 offset:36352
    s_mov_b64 exec, 1
    buffer_store_dword v30, off, s[8:11], s63
    s_mov_b64 exec, -1
    v_mfma_f32_32x32x16_bf16 v[80:95], a[240:243], v[248:251], v[80:95]
    s_waitcnt lgkmcnt(4)
    ds_read_b64_tr_b16 a[236:237], v29 offset:34816
    ds_read_b64_tr_b16 a[238:239], v29 offset:35840
    buffer_load_dwordx4 a[72:75], v1, s[8:11], s91 offen offset:1024 sc1
    v_mul_f32 v16, v64, v64
    v_fma_f32 v16, v16, v58, v59
    v_mfma_f32_32x32x16_bf16 v[80:95], a[244:247], v[252:255], v[80:95]
    ds_read_b64_tr_b16 a[240:241], v29 offset:37376
    ds_read_b64_tr_b16 a[242:243], v29 offset:38400
    v_mul_f32 v16, v16, v64
    v_mul_f32 v17, v65, v65
    v_exp_f32 v16, v16
    v_fma_f32 v17, v17, v58, v59
    v_mfma_f32_32x32x8_bf16 v[80:95], a[226:227], v[12:13], v[80:95]
    v_mul_f32 v17, v17, v65
    v_mul_f32 v18, v66, v66
    v_exp_f32 v17, v17
    v_fma_f32 v16, v16, v60, v60
    v_fma_f32 v18, v18, v58, v59
    v_mfma_f32_32x32x8_bf16 v[96:111], a[228:229], v[12:13], 0
    v_rcp_f32 v16, v16
    v_mul_f32 v18, v18, v66
    v_mul_f32 v19, v67, v67
    v_exp_f32 v18, v18
    v_mfma_f32_32x32x8_bf16 v[112:127], a[230:231], v[12:13], 0
    v_fma_f32 v17, v17, v60, v60
    v_fma_f32 v19, v19, v58, v59
    v_rcp_f32 v17, v17
    v_mul_f32 v64, v64, v16
    v_mul_f32 v19, v19, v67
    v_mfma_f32_32x32x16_bf16 v[112:127], a[248:251], v[192:195], v[112:127]
    s_waitcnt lgkmcnt(4)
    ds_read_b64_tr_b16 a[244:245], v29 offset:36864
    ds_read_b64_tr_b16 a[246:247], v29 offset:37888
    buffer_load_dwordx4 a[76:79], v1, s[8:11], s92 offen offset:1024 sc1
    v_mul_f32 v16, v68, v68
    v_fma_f32 v18, v18, v60, v60
    v_mfma_f32_32x32x16_bf16 v[96:111], a[252:255], v[192:195], v[96:111]
    ds_read_b64_tr_b16 a[248:249], v29 offset:39424
    ds_read_b64_tr_b16 a[250:251], v29 offset:40448
    v_exp_f32 v19, v19
    v_fma_f32 v16, v16, v58, v59
    v_rcp_f32 v18, v18
    v_mfma_f32_32x32x16_bf16 v[112:127], a[232:235], v[196:199], v[112:127]
    s_waitcnt lgkmcnt(4)
    ds_read_b64_tr_b16 a[252:253], v29 offset:38912
    ds_read_b64_tr_b16 a[254:255], v29 offset:39936
    buffer_load_dwordx4 a[80:83], v1, s[8:11], s91 offen offset:2048 sc1
    v_mul_f32 v65, v65, v17
    v_mul_f32 v16, v16, v68
    v_mfma_f32_32x32x16_bf16 v[96:111], a[236:239], v[196:199], v[96:111]
    ds_read_b64_tr_b16 a[232:233], v29 offset:41472
    ds_read_b64_tr_b16 a[234:235], v29 offset:42496
    v_mul_f32 v17, v69, v69
    v_cvt_pk_bf16_f32 v20, v64, v65
    v_exp_f32 v16, v16
    v_fma_f32 v19, v19, v60, v60
    v_mfma_f32_32x32x16_bf16 v[112:127], a[240:243], v[200:203], v[112:127]
    s_waitcnt lgkmcnt(4)
    ds_read_b64_tr_b16 a[236:237], v29 offset:40960
    ds_read_b64_tr_b16 a[238:239], v29 offset:41984
    buffer_load_dwordx4 a[84:87], v1, s[8:11], s92 offen offset:2048 sc1
    v_fma_f32 v17, v17, v58, v59
    v_mul_f32 v66, v66, v18
    v_mfma_f32_32x32x16_bf16 v[96:111], a[244:247], v[200:203], v[96:111]
    ds_read_b64_tr_b16 a[240:241], v29 offset:43520
    ds_read_b64_tr_b16 a[242:243], v29 offset:44544
    v_rcp_f32 v19, v19
    v_mul_f32 v17, v17, v69
    v_mul_f32 v18, v70, v70
    v_fma_f32 v16, v16, v60, v60
    v_mfma_f32_32x32x16_bf16 v[112:127], a[248:251], v[204:207], v[112:127]
    s_waitcnt lgkmcnt(4)
    ds_read_b64_tr_b16 a[244:245], v29 offset:43008
    ds_read_b64_tr_b16 a[246:247], v29 offset:44032
    buffer_load_dwordx4 a[88:91], v1, s[8:11], s91 offen offset:3072 sc1
    v_exp_f32 v17, v17
    v_mfma_f32_32x32x16_bf16 v[96:111], a[252:255], v[204:207], v[96:111]
    ds_read_b64_tr_b16 a[248:249], v29 offset:45568
    ds_read_b64_tr_b16 a[250:251], v29 offset:46592
    v_fma_f32 v18, v18, v58, v59
    v_rcp_f32 v16, v16
    v_mul_f32 v67, v67, v19
    v_mul_f32 v18, v18, v70
    v_mfma_f32_32x32x16_bf16 v[112:127], a[232:235], v[208:211], v[112:127]
    s_waitcnt lgkmcnt(4)
    ds_read_b64_tr_b16 a[252:253], v29 offset:45056
    ds_read_b64_tr_b16 a[254:255], v29 offset:46080
    buffer_load_dwordx4 a[92:95], v1, s[8:11], s92 offen offset:3072 sc1
    v_mul_f32 v19, v71, v71
    v_cvt_pk_bf16_f32 v21, v66, v67
    v_mfma_f32_32x32x16_bf16 v[96:111], a[236:239], v[208:211], v[96:111]
    ds_read_b64_tr_b16 a[232:233], v29 offset:47616
    ds_read_b64_tr_b16 a[234:235], v29 offset:48640
    v_exp_f32 v18, v18
    v_fma_f32 v17, v17, v60, v60
    v_fma_f32 v19, v19, v58, v59
    v_mul_f32 v68, v68, v16
    v_mfma_f32_32x32x16_bf16 v[112:127], a[240:243], v[212:215], v[112:127]
    s_waitcnt lgkmcnt(4)
    ds_read_b64_tr_b16 a[236:237], v29 offset:47104
    ds_read_b64_tr_b16 a[238:239], v29 offset:48128
    s_add_u32 s91, s57, 0x3000
    buffer_load_dwordx4 a[96:99], v1, s[8:11], s91 offen offset:0 sc1
    v_mul_f32 v19, v19, v71
    v_mfma_f32_32x32x16_bf16 v[96:111], a[244:247], v[212:215], v[96:111]
    ds_read_b64_tr_b16 a[240:241], v29 offset:49664
    ds_read_b64_tr_b16 a[242:243], v29 offset:50688
    v_rcp_f32 v17, v17
    v_mul_f32 v16, v72, v72
    v_exp_f32 v19, v19
    v_mfma_f32_32x32x16_bf16 v[112:127], a[248:251], v[216:219], v[112:127]
    s_waitcnt lgkmcnt(4)
    ds_read_b64_tr_b16 a[244:245], v29 offset:49152
    ds_read_b64_tr_b16 a[246:247], v29 offset:50176
    s_add_u32 s92, s58, 0x3000
    buffer_load_dwordx4 a[100:103], v1, s[8:11], s92 offen offset:0 sc1
    v_fma_f32 v18, v18, v60, v60
    v_mfma_f32_32x32x16_bf16 v[96:111], a[252:255], v[216:219], v[96:111]
    ds_read_b64_tr_b16 a[248:249], v29 offset:51712
    ds_read_b64_tr_b16 a[250:251], v29 offset:52736
    v_fma_f32 v16, v16, v58, v59
    v_rcp_f32 v18, v18
    v_mul_f32 v69, v69, v17
    v_mul_f32 v16, v16, v72
    v_mfma_f32_32x32x16_bf16 v[112:127], a[232:235], v[220:223], v[112:127]
    s_waitcnt lgkmcnt(4)
    ds_read_b64_tr_b16 a[252:253], v29 offset:51200
    ds_read_b64_tr_b16 a[254:255], v29 offset:52224
    buffer_load_dwordx4 a[104:107], v1, s[8:11], s91 offen offset:1024 sc1
    v_mul_f32 v17, v73, v73
    v_cvt_pk_bf16_f32 v22, v68, v69
    v_mfma_f32_32x32x16_bf16 v[96:111], a[236:239], v[220:223], v[96:111]
    ds_read_b64_tr_b16 a[232:233], v29 offset:53760
    ds_read_b64_tr_b16 a[234:235], v29 offset:54784
    v_exp_f32 v16, v16
    v_fma_f32 v19, v19, v60, v60
    v_fma_f32 v17, v17, v58, v59
    v_mul_f32 v70, v70, v18
    v_mfma_f32_32x32x16_bf16 v[112:127], a[240:243], v[224:227], v[112:127]
    s_waitcnt lgkmcnt(4)
    ds_read_b64_tr_b16 a[236:237], v29 offset:53248
    ds_read_b64_tr_b16 a[238:239], v29 offset:54272
    buffer_load_dwordx4 a[108:111], v1, s[8:11], s92 offen offset:1024 sc1
    v_rcp_f32 v19, v19
    v_mfma_f32_32x32x16_bf16 v[96:111], a[244:247], v[224:227], v[96:111]
    ds_read_b64_tr_b16 a[240:241], v29 offset:55808
    ds_read_b64_tr_b16 a[242:243], v29 offset:56832
    v_mul_f32 v17, v17, v73
    v_mul_f32 v18, v74, v74
    v_exp_f32 v17, v17
    v_fma_f32 v16, v16, v60, v60
    v_mfma_f32_32x32x16_bf16 v[112:127], a[248:251], v[228:231], v[112:127]
    s_waitcnt lgkmcnt(4)
    ds_read_b64_tr_b16 a[244:245], v29 offset:55296
    ds_read_b64_tr_b16 a[246:247], v29 offset:56320
    buffer_load_dwordx4 a[112:115], v1, s[8:11], s91 offen offset:2048 sc1
    v_fma_f32 v18, v18, v58, v59
    v_mul_f32 v71, v71, v19
    v_mfma_f32_32x32x16_bf16 v[96:111], a[252:255], v[228:231], v[96:111]
    ds_read_b64_tr_b16 a[248:249], v29 offset:57856
    ds_read_b64_tr_b16 a[250:251], v29 offset:58880
    v_rcp_f32 v16, v16
    v_mul_f32 v18, v18, v74
    v_mul_f32 v19, v75, v75
    v_cvt_pk_bf16_f32 v23, v70, v71
    v_mfma_f32_32x32x16_bf16 v[112:127], a[232:235], v[232:235], v[112:127]
    s_waitcnt lgkmcnt(4)
    ds_read_b64_tr_b16 a[252:253], v29 offset:57344
    ds_read_b64_tr_b16 a[254:255], v29 offset:58368
    buffer_load_dwordx4 a[116:119], v1, s[8:11], s92 offen offset:2048 sc1
    v_exp_f32 v18, v18
    v_mfma_f32_32x32x16_bf16 v[96:111], a[236:239], v[232:235], v[96:111]
    ds_read_b64_tr_b16 a[232:233], v29 offset:59904
    ds_read_b64_tr_b16 a[234:235], v29 offset:60928
    v_fma_f32 v17, v17, v60, v60
    v_fma_f32 v19, v19, v58, v59
    v_rcp_f32 v17, v17
    v_mul_f32 v72, v72, v16
    v_mfma_f32_32x32x16_bf16 v[112:127], a[240:243], v[236:239], v[112:127]
    s_waitcnt lgkmcnt(4)
    ds_read_b64_tr_b16 a[236:237], v29 offset:59392
    ds_read_b64_tr_b16 a[238:239], v29 offset:60416
    buffer_load_dwordx4 a[120:123], v1, s[8:11], s91 offen offset:3072 sc1
    v_mul_f32 v19, v19, v75
    v_mul_f32 v16, v76, v76
    v_mfma_f32_32x32x16_bf16 v[96:111], a[244:247], v[236:239], v[96:111]
    ds_read_b64_tr_b16 a[240:241], v29 offset:61952
    ds_read_b64_tr_b16 a[242:243], v29 offset:62976
    v_exp_f32 v19, v19
    v_fma_f32 v18, v18, v60, v60
    v_fma_f32 v16, v16, v58, v59
    v_mul_f32 v73, v73, v17
    v_mfma_f32_32x32x16_bf16 v[112:127], a[248:251], v[240:243], v[112:127]
    s_waitcnt lgkmcnt(4)
    ds_read_b64_tr_b16 a[244:245], v29 offset:61440
    ds_read_b64_tr_b16 a[246:247], v29 offset:62464
    buffer_load_dwordx4 a[124:127], v1, s[8:11], s92 offen offset:3072 sc1
    v_rcp_f32 v18, v18
    v_mfma_f32_32x32x16_bf16 v[96:111], a[252:255], v[240:243], v[96:111]
    ds_read_b64_tr_b16 a[248:249], v29 offset:64000
    ds_read_b64_tr_b16 a[250:251], v29 offset:65024
    v_mul_f32 v16, v16, v76
    v_mul_f32 v17, v77, v77
    v_cvt_pk_bf16_f32 v24, v72, v73
    v_or_b32 v23, 1, v23
    v_fma_f32 v19, v19, v60, v60
    v_mfma_f32_32x32x16_bf16 v[112:127], a[232:235], v[244:247], v[112:127]
    s_waitcnt lgkmcnt(4)
    ds_read_b64_tr_b16 a[252:253], v29 offset:63488
    ds_read_b64_tr_b16 a[254:255], v29 offset:64512
    s_add_u32 s91, s57, 0x4000
    buffer_load_dwordx4 a[128:131], v1, s[8:11], s91 offen offset:0 sc1
    v_fma_f32 v17, v17, v58, v59
    v_mfma_f32_32x32x16_bf16 v[96:111], a[236:239], v[244:247], v[96:111]
    ds_read_b64_tr_b16 a[232:233], v29 offset:8704
    ds_read_b64_tr_b16 a[234:235], v29 offset:9728
    v_exp_f32 v16, v16
    v_rcp_f32 v19, v19
    v_mul_f32 v74, v74, v18
    v_mfma_f32_32x32x16_bf16 v[112:127], a[240:243], v[248:251], v[112:127]
    s_waitcnt lgkmcnt(4)
    ds_read_b64_tr_b16 a[236:237], v29 offset:8192
    ds_read_b64_tr_b16 a[238:239], v29 offset:9216
    s_add_u32 s92, s58, 0x4000
    buffer_load_dwordx4 a[132:135], v1, s[8:11], s92 offen offset:0 sc1
    v_mul_f32 v17, v17, v77
    v_mfma_f32_32x32x16_bf16 v[96:111], a[244:247], v[248:251], v[96:111]
    ds_read_b64_tr_b16 a[240:241], v29 offset:10752
    ds_read_b64_tr_b16 a[242:243], v29 offset:11776
    v_mul_f32 v18, v78, v78
    v_exp_f32 v17, v17
    v_fma_f32 v16, v16, v60, v60
    v_fma_f32 v18, v18, v58, v59
    v_mfma_f32_32x32x16_bf16 v[112:127], a[248:251], v[252:255], v[112:127]
    s_waitcnt lgkmcnt(4)
    ds_read_b64_tr_b16 a[244:245], v29 offset:10240
    ds_read_b64_tr_b16 a[246:247], v29 offset:11264
    buffer_load_dwordx4 a[136:139], v1, s[8:11], s91 offen offset:1024 sc1
    v_rcp_f32 v16, v16
    v_mfma_f32_32x32x16_bf16 v[96:111], a[252:255], v[252:255], v[96:111]
    ds_read_b64_tr_b16 a[248:249], v29 offset:12800
    ds_read_b64_tr_b16 a[250:251], v29 offset:13824
    v_mul_f32 v75, v75, v19
    v_mul_f32 v18, v18, v78
    v_mul_f32 v19, v79, v79
    v_cvt_pk_bf16_f32 v25, v74, v75
    v_fma_f32 v17, v17, v60, v60
    v_mfma_f32_32x32x16_bf16 v[112:127], a[232:235], v[144:147], v[112:127]
    s_waitcnt lgkmcnt(4)
    ds_read_b64_tr_b16 a[252:253], v29 offset:12288
    ds_read_b64_tr_b16 a[254:255], v29 offset:13312
    buffer_load_dwordx4 a[140:143], v1, s[8:11], s92 offen offset:1024 sc1
    v_exp_f32 v18, v18
    v_mfma_f32_32x32x16_bf16 v[96:111], a[236:239], v[144:147], v[96:111]
    ds_read_b64_tr_b16 a[232:233], v29 offset:14848
    ds_read_b64_tr_b16 a[234:235], v29 offset:15872
    v_fma_f32 v19, v19, v58, v59
    v_rcp_f32 v17, v17
    v_mul_f32 v76, v76, v16
    v_mul_f32 v19, v19, v79
    v_mfma_f32_32x32x16_bf16 v[112:127], a[240:243], v[148:151], v[112:127]
    s_waitcnt lgkmcnt(4)
    ds_read_b64_tr_b16 a[236:237], v29 offset:14336
    ds_read_b64_tr_b16 a[238:239], v29 offset:15360
    buffer_load_dwordx4 a[144:147], v1, s[8:11], s91 offen offset:2048 sc1
    v_mul_f32 v16, v80, v80
    v_fma_f32 v18, v18, v60, v60
    v_mfma_f32_32x32x16_bf16 v[96:111], a[244:247], v[148:151], v[96:111]
    ds_read_b64_tr_b16 a[240:241], v29 offset:16896
    ds_read_b64_tr_b16 a[242:243], v29 offset:17920
    v_exp_f32 v19, v19
    v_fma_f32 v16, v16, v58, v59
    v_rcp_f32 v18, v18
    v_mfma_f32_32x32x16_bf16 v[112:127], a[248:251], v[152:155], v[112:127]
    s_waitcnt lgkmcnt(4)
    ds_read_b64_tr_b16 a[244:245], v29 offset:16384
    ds_read_b64_tr_b16 a[246:247], v29 offset:17408
    buffer_load_dwordx4 a[148:151], v1, s[8:11], s92 offen offset:2048 sc1
    v_mul_f32 v77, v77, v17
    v_mul_f32 v16, v16, v80
    v_mfma_f32_32x32x16_bf16 v[96:111], a[252:255], v[152:155], v[96:111]
    ds_read_b64_tr_b16 a[248:249], v29 offset:18944
    ds_read_b64_tr_b16 a[250:251], v29 offset:19968
    v_mul_f32 v17, v81, v81
    v_cvt_pk_bf16_f32 v26, v76, v77
    v_exp_f32 v16, v16
    v_fma_f32 v19, v19, v60, v60
    v_mfma_f32_32x32x16_bf16 v[112:127], a[232:235], v[156:159], v[112:127]
    s_waitcnt lgkmcnt(4)
    ds_read_b64_tr_b16 a[252:253], v29 offset:18432
    ds_read_b64_tr_b16 a[254:255], v29 offset:19456
    buffer_load_dwordx4 a[152:155], v1, s[8:11], s91 offen offset:3072 sc1
    v_fma_f32 v17, v17, v58, v59
    v_mul_f32 v78, v78, v18
    v_mfma_f32_32x32x16_bf16 v[96:111], a[236:239], v[156:159], v[96:111]
    ds_read_b64_tr_b16 a[232:233], v29 offset:20992
    ds_read_b64_tr_b16 a[234:235], v29 offset:22016
    v_rcp_f32 v19, v19
    v_mul_f32 v17, v17, v81
    v_mul_f32 v18, v82, v82
    v_fma_f32 v16, v16, v60, v60
    v_mfma_f32_32x32x16_bf16 v[112:127], a[240:243], v[160:163], v[112:127]
    s_waitcnt lgkmcnt(4)
    ds_read_b64_tr_b16 a[236:237], v29 offset:20480
    ds_read_b64_tr_b16 a[238:239], v29 offset:21504
    buffer_load_dwordx4 a[156:159], v1, s[8:11], s92 offen offset:3072 sc1
    v_exp_f32 v17, v17
    v_mfma_f32_32x32x16_bf16 v[96:111], a[244:247], v[160:163], v[96:111]
    ds_read_b64_tr_b16 a[240:241], v29 offset:23040
    ds_read_b64_tr_b16 a[242:243], v29 offset:24064
    v_fma_f32 v18, v18, v58, v59
    v_rcp_f32 v16, v16
    v_mul_f32 v79, v79, v19
    v_mul_f32 v18, v18, v82
    v_mfma_f32_32x32x16_bf16 v[112:127], a[248:251], v[164:167], v[112:127]
    s_waitcnt lgkmcnt(4)
    ds_read_b64_tr_b16 a[244:245], v29 offset:22528
    ds_read_b64_tr_b16 a[246:247], v29 offset:23552
    s_add_u32 s91, s57, 0x5000
    buffer_load_dwordx4 a[160:163], v1, s[8:11], s91 offen offset:0 sc1
    v_mul_f32 v19, v83, v83
    v_mfma_f32_32x32x16_bf16 v[96:111], a[252:255], v[164:167], v[96:111]
    ds_read_b64_tr_b16 a[248:249], v29 offset:25088
    ds_read_b64_tr_b16 a[250:251], v29 offset:26112
    v_cvt_pk_bf16_f32 v27, v78, v79
    v_or_b32 v27, 1, v27
    v_exp_f32 v18, v18
    v_fma_f32 v17, v17, v60, v60
    v_mfma_f32_32x32x16_bf16 v[112:127], a[232:235], v[168:171], v[112:127]
    s_waitcnt lgkmcnt(4)
    ds_read_b64_tr_b16 a[252:253], v29 offset:24576
    ds_read_b64_tr_b16 a[254:255], v29 offset:25600
    s_add_u32 s92, s58, 0x5000
    buffer_load_dwordx4 a[164:167], v1, s[8:11], s92 offen offset:0 sc1
    v_fma_f32 v19, v19, v58, v59
    v_mfma_f32_32x32x16_bf16 v[96:111], a[236:239], v[168:171], v[96:111]
    ds_read_b64_tr_b16 a[232:233], v29 offset:27136
    ds_read_b64_tr_b16 a[234:235], v29 offset:28160
    buffer_store_dwordx4 v[20:23], v1, s[8:11], s60 offen offset:0
    buffer_store_dwordx4 v[24:27], v1, s[8:11], s60 offen offset:1024
    v_mul_f32 v80, v80, v16
    v_mfma_f32_32x32x16_bf16 v[112:127], a[240:243], v[172:175], v[112:127]
    s_waitcnt lgkmcnt(4)
    ds_read_b64_tr_b16 a[236:237], v29 offset:26624
    ds_read_b64_tr_b16 a[238:239], v29 offset:27648
    buffer_load_dwordx4 a[168:171], v1, s[8:11], s91 offen offset:1024 sc1
    v_rcp_f32 v17, v17
    v_mfma_f32_32x32x16_bf16 v[96:111], a[244:247], v[172:175], v[96:111]
    ds_read_b64_tr_b16 a[240:241], v29 offset:29184
    ds_read_b64_tr_b16 a[242:243], v29 offset:30208
    v_mul_f32 v19, v19, v83
    v_mul_f32 v16, v84, v84
    v_exp_f32 v19, v19
    v_fma_f32 v18, v18, v60, v60
    v_mfma_f32_32x32x16_bf16 v[112:127], a[248:251], v[176:179], v[112:127]
    s_waitcnt lgkmcnt(4)
    ds_read_b64_tr_b16 a[244:245], v29 offset:28672
    ds_read_b64_tr_b16 a[246:247], v29 offset:29696
    buffer_load_dwordx4 a[172:175], v1, s[8:11], s92 offen offset:1024 sc1
    v_fma_f32 v16, v16, v58, v59
    v_mul_f32 v81, v81, v17
    v_mfma_f32_32x32x16_bf16 v[96:111], a[252:255], v[176:179], v[96:111]
    ds_read_b64_tr_b16 a[248:249], v29 offset:31232
    ds_read_b64_tr_b16 a[250:251], v29 offset:32256
    v_rcp_f32 v18, v18
    v_mul_f32 v16, v16, v84
    v_mul_f32 v17, v85, v85
    v_cvt_pk_bf16_f32 v20, v80, v81
    v_mfma_f32_32x32x16_bf16 v[112:127], a[232:235], v[180:183], v[112:127]
    s_waitcnt lgkmcnt(4)
    ds_read_b64_tr_b16 a[252:253], v29 offset:30720
    ds_read_b64_tr_b16 a[254:255], v29 offset:31744
    buffer_load_dwordx4 a[176:179], v1, s[8:11], s91 offen offset:2048 sc1
    v_exp_f32 v16, v16
    v_mfma_f32_32x32x16_bf16 v[96:111], a[236:239], v[180:183], v[96:111]
    ds_read_b64_tr_b16 a[232:233], v29 offset:512
    ds_read_b64_tr_b16 a[234:235], v29 offset:1536
    v_fma_f32 v19, v19, v60, v60
    v_fma_f32 v17, v17, v58, v59
    v_rcp_f32 v19, v19
    v_mul_f32 v82, v82, v18
    v_mfma_f32_32x32x16_bf16 v[112:127], a[240:243], v[184:187], v[112:127]
    s_waitcnt lgkmcnt(4)
    ds_read_b64_tr_b16 a[236:237], v29 offset:0
    ds_read_b64_tr_b16 a[238:239], v29 offset:1024
    buffer_load_dwordx4 a[180:183], v1, s[8:11], s92 offen offset:2048 sc1
    v_mul_f32 v17, v17, v85
    v_mul_f32 v18, v86, v86
    v_mfma_f32_32x32x16_bf16 v[96:111], a[244:247], v[184:187], v[96:111]
    ds_read_b64_tr_b16 a[240:241], v29 offset:2560
    ds_read_b64_tr_b16 a[242:243], v29 offset:3584
    v_exp_f32 v17, v17
    v_fma_f32 v16, v16, v60, v60
    v_fma_f32 v18, v18, v58, v59
    v_mul_f32 v83, v83, v19
    v_mfma_f32_32x32x16_bf16 v[112:127], a[248:251], v[188:191], v[112:127]
    s_waitcnt lgkmcnt(4)
    ds_read_b64_tr_b16 a[244:245], v29 offset:2048
    ds_read_b64_tr_b16 a[246:247], v29 offset:3072
    buffer_load_dwordx4 a[184:187], v1, s[8:11], s91 offen offset:3072 sc1
    v_rcp_f32 v16, v16
    v_mfma_f32_32x32x16_bf16 v[96:111], a[252:255], v[188:191], v[96:111]
    ds_read_b64_tr_b16 a[248:249], v29 offset:4608
    ds_read_b64_tr_b16 a[250:251], v29 offset:5632
    buffer_load_dwordx4 v[192:195], v1, s[8:11], s51 offen offset:0 sc1
    v_mul_f32 v18, v18, v86
    v_mul_f32 v19, v87, v87
    v_cvt_pk_bf16_f32 v21, v82, v83
    v_mfma_f32_32x32x16_bf16 v[112:127], a[232:235], v[128:131], v[112:127]
    s_waitcnt lgkmcnt(4)
    ds_read_b64_tr_b16 a[252:253], v29 offset:4096
    ds_read_b64_tr_b16 a[254:255], v29 offset:5120
    buffer_load_dwordx4 v[196:199], v1, s[8:11], s51 offen offset:1024 sc1
    buffer_load_dword v9, v8, s[8:11], 0 offen offset:128 sc1
    v_mfma_f32_32x32x16_bf16 v[96:111], a[236:239], v[128:131], v[96:111]
    ds_read_b64_tr_b16 a[232:233], v29 offset:6656
    ds_read_b64_tr_b16 a[234:235], v29 offset:7680
    buffer_load_dwordx4 v[200:203], v1, s[8:11], s51 offen offset:2048 sc1
    v_exp_f32 v18, v18
    v_fma_f32 v17, v17, v60, v60
    v_mfma_f32_32x32x16_bf16 v[112:127], a[240:243], v[132:135], v[112:127]
    s_waitcnt lgkmcnt(4)
    ds_read_b64_tr_b16 a[236:237], v29 offset:6144
    ds_read_b64_tr_b16 a[238:239], v29 offset:7168
    buffer_load_dwordx4 v[204:207], v1, s[8:11], s51 offen offset:3072 sc1
    v_fma_f32 v19, v19, v58, v59
    v_mul_f32 v84, v84, v16
    v_mfma_f32_32x32x16_bf16 v[96:111], a[244:247], v[132:135], v[96:111]
    s_add_u32 s78, s51, 0x1000
    buffer_load_dwordx4 v[208:211], v1, s[8:11], s78 offen offset:0 sc1
    v_rcp_f32 v17, v17
    v_mul_f32 v19, v19, v87
    v_mul_f32 v16, v88, v88
    v_mfma_f32_32x32x16_bf16 v[112:127], a[248:251], v[136:139], v[112:127]
    s_waitcnt lgkmcnt(2)
    buffer_load_dwordx4 v[212:215], v1, s[8:11], s78 offen offset:1024 sc1
    v_exp_f32 v19, v19
    v_fma_f32 v18, v18, v60, v60
    v_fma_f32 v16, v16, v58, v59
    v_mfma_f32_32x32x16_bf16 v[96:111], a[252:255], v[136:139], v[96:111]
    buffer_load_dwordx4 v[216:219], v1, s[8:11], s78 offen offset:2048 sc1
    v_rcp_f32 v18, v18
    v_mul_f32 v85, v85, v17
    v_mul_f32 v16, v16, v88
    v_mul_f32 v17, v89, v89
    v_mfma_f32_32x32x16_bf16 v[112:127], a[232:235], v[140:143], v[112:127]
    s_waitcnt lgkmcnt(0)
    buffer_load_dwordx4 v[220:223], v1, s[8:11], s78 offen offset:3072 sc1
    v_cvt_pk_bf16_f32 v22, v84, v85
    v_exp_f32 v16, v16
    v_fma_f32 v19, v19, v60, v60
    v_mfma_f32_32x32x16_bf16 v[96:111], a[236:239], v[140:143], v[96:111]
    buffer_load_dwordx4 v[224:227], v1, s[8:11], s50 offen offset:0 sc1
    v_fma_f32 v17, v17, v58, v59
    v_rcp_f32 v19, v19
    v_mul_f32 v86, v86, v18
    v_mul_f32 v17, v17, v89
    v_mul_f32 v18, v90, v90
    v_exp_f32 v17, v17
    v_fma_f32 v16, v16, v60, v60
    v_fma_f32 v18, v18, v58, v59
    v_rcp_f32 v16, v16
    v_mul_f32 v87, v87, v19
    v_mul_f32 v18, v18, v90
    v_mul_f32 v19, v91, v91
    v_cvt_pk_bf16_f32 v23, v86, v87
    v_exp_f32 v18, v18
    v_fma_f32 v17, v17, v60, v60
    v_fma_f32 v19, v19, v58, v59
    v_rcp_f32 v17, v17
    v_mul_f32 v88, v88, v16
    v_mul_f32 v19, v19, v91
    v_mul_f32 v16, v92, v92
    v_exp_f32 v19, v19
    v_fma_f32 v18, v18, v60, v60
    v_fma_f32 v16, v16, v58, v59
    v_rcp_f32 v18, v18
    v_mul_f32 v89, v89, v17
    v_mul_f32 v16, v16, v92
    v_mul_f32 v17, v93, v93
    v_cvt_pk_bf16_f32 v24, v88, v89
    v_and_b32 v23, -2, v23
    v_exp_f32 v16, v16
    v_fma_f32 v19, v19, v60, v60
    v_fma_f32 v17, v17, v58, v59
    v_rcp_f32 v19, v19
    v_mul_f32 v90, v90, v18
    v_mul_f32 v17, v17, v93
    v_mul_f32 v18, v94, v94
    v_exp_f32 v17, v17
    v_fma_f32 v16, v16, v60, v60
    v_fma_f32 v18, v18, v58, v59
    v_rcp_f32 v16, v16
    v_mul_f32 v91, v91, v19
    v_mul_f32 v18, v18, v94
    v_mul_f32 v19, v95, v95
    v_cvt_pk_bf16_f32 v25, v90, v91
    v_exp_f32 v18, v18
    v_fma_f32 v17, v17, v60, v60
    v_fma_f32 v19, v19, v58, v59
    v_rcp_f32 v17, v17
    v_mul_f32 v92, v92, v16
    v_mul_f32 v19, v19, v95
    v_exp_f32 v19, v19
    v_fma_f32 v18, v18, v60, v60
    v_rcp_f32 v18, v18
    v_mul_f32 v93, v93, v17
    v_cvt_pk_bf16_f32 v26, v92, v93
    v_fma_f32 v19, v19, v60, v60
    v_rcp_f32 v19, v19
    v_mul_f32 v94, v94, v18
    v_mul_f32 v95, v95, v19
    v_cvt_pk_bf16_f32 v27, v94, v95
    v_and_b32 v27, -2, v27
    s_add_u32 s76, s60, 32768
    buffer_store_dwordx4 v[20:23], v1, s[8:11], s76 offen offset:0
    buffer_store_dwordx4 v[24:27], v1, s[8:11], s76 offen offset:1024
    s_waitcnt vmcnt(7)
    v_bitop3_b32 v7, v195, v199, v203 bitop3:0x80
    v_bitop3_b32 v7, v7, v207, 1 bitop3:0x2a
    v_cmp_ne_u32 vcc, 0, v7
    s_cbranch_vccnz OOL_95
RET_96:
    v_mfma_f32_32x32x16_bf16 v[80:95], a[4:7], v[192:195], 0
    buffer_load_dwordx4 v[228:231], v1, s[8:11], s50 offen offset:1024 sc1
    v_subrev_u32 v9, s69, v9
    v_subrev_u32 v9, 1, v9
    v_cmp_lt_u32 vcc, 7, v9
    v_mfma_f32_32x32x16_bf16 v[64:79], a[0:3], v[192:195], 0
    s_cbranch_vccnz OOL_98
RET_99:
    buffer_load_dwordx4 v[232:235], v1, s[8:11], s50 offen offset:2048 sc1
    v_mul_f32 v16, v96, v96
    v_fma_f32 v16, v16, v58, v59
    v_mul_f32 v16, v16, v96
    v_mul_f32 v17, v97, v97
    v_fma_f32 v17, v17, v58, v59
    v_mfma_f32_32x32x16_bf16 v[80:95], a[12:15], v[196:199], v[80:95]
    buffer_load_dwordx4 v[236:239], v1, s[8:11], s50 offen offset:3072 sc1
    v_exp_f32 v16, v16
    v_mul_f32 v17, v17, v97
    v_mul_f32 v18, v98, v98
    v_exp_f32 v17, v17
    v_fma_f32 v16, v16, v60, v60
    v_fma_f32 v18, v18, v58, v59
    v_mul_f32 v18, v18, v98
    v_mfma_f32_32x32x16_bf16 v[64:79], a[8:11], v[196:199], v[64:79]
    s_add_u32 s78, s50, 0x1000
    buffer_load_dwordx4 v[240:243], v1, s[8:11], s78 offen offset:0 sc1
    v_rcp_f32 v16, v16
    v_mul_f32 v19, v99, v99
    v_exp_f32 v18, v18
    v_fma_f32 v17, v17, v60, v60
    v_fma_f32 v19, v19, v58, v59
    v_mul_f32 v96, v96, v16
    v_mfma_f32_32x32x16_bf16 v[80:95], a[36:39], v[200:203], v[80:95]
    buffer_load_dwordx4 v[244:247], v1, s[8:11], s78 offen offset:1024 sc1
    v_rcp_f32 v17, v17
    v_mul_f32 v19, v19, v99
    v_mul_f32 v16, v100, v100
    v_exp_f32 v19, v19
    v_fma_f32 v18, v18, v60, v60
    v_fma_f32 v16, v16, v58, v59
    v_mul_f32 v97, v97, v17
    v_mfma_f32_32x32x16_bf16 v[64:79], a[32:35], v[200:203], v[64:79]
    buffer_load_dwordx4 v[248:251], v1, s[8:11], s78 offen offset:2048 sc1
    v_rcp_f32 v18, v18
    v_mul_f32 v16, v16, v100
    v_mul_f32 v17, v101, v101
    v_cvt_pk_bf16_f32 v20, v96, v97
    v_exp_f32 v16, v16
    v_fma_f32 v19, v19, v60, v60
    v_fma_f32 v17, v17, v58, v59
    v_mfma_f32_32x32x16_bf16 v[80:95], a[44:47], v[204:207], v[80:95]
    s_waitcnt vmcnt(9)
    v_bitop3_b32 v7, v211, v215, v219 bitop3:0x80
    v_bitop3_b32 v7, v7, v223, 1 bitop3:0x2a
    v_cmp_ne_u32 vcc, 0, v7
    v_rcp_f32 v19, v19
    v_mul_f32 v98, v98, v18
    v_mul_f32 v17, v17, v101
    v_mul_f32 v18, v102, v102
    v_exp_f32 v17, v17
    v_mfma_f32_32x32x16_bf16 v[64:79], a[40:43], v[204:207], v[64:79]
    s_cbranch_vccnz OOL_101
RET_102:
    buffer_load_dwordx4 v[252:255], v1, s[8:11], s78 offen offset:3072 sc1
    v_fma_f32 v16, v16, v60, v60
    v_fma_f32 v18, v18, v58, v59
    v_rcp_f32 v16, v16
    v_mul_f32 v99, v99, v19
    v_mfma_f32_32x32x16_bf16 v[80:95], a[68:71], v[208:211], v[80:95]
    buffer_load_dwordx4 a[188:191], v1, s[8:11], s92 offen offset:3072 sc1
    v_mul_f32 v18, v18, v102
    v_mul_f32 v19, v103, v103
    v_cvt_pk_bf16_f32 v21, v98, v99
    v_exp_f32 v18, v18
    v_fma_f32 v17, v17, v60, v60
    v_fma_f32 v19, v19, v58, v59
    v_rcp_f32 v17, v17
    v_mfma_f32_32x32x16_bf16 v[64:79], a[64:67], v[208:211], v[64:79]
    s_add_u32 s78, s51, 0x8000
    buffer_load_dwordx4 v[144:147], v1, s[8:11], s78 offen offset:0 sc1
    v_mul_f32 v100, v100, v16
    v_mul_f32 v19, v19, v103
    v_mul_f32 v16, v104, v104
    v_exp_f32 v19, v19
    v_fma_f32 v18, v18, v60, v60
    v_fma_f32 v16, v16, v58, v59
    v_mul_f32 v101, v101, v17
    v_mfma_f32_32x32x16_bf16 v[80:95], a[76:79], v[212:215], v[80:95]
    s_add_u32 s91, s57, 0x6000
    buffer_load_dwordx4 a[192:195], v1, s[8:11], s91 offen offset:0 sc1
    v_rcp_f32 v18, v18
    v_mul_f32 v16, v16, v104
    v_mul_f32 v17, v105, v105
    v_cvt_pk_bf16_f32 v22, v100, v101
    v_exp_f32 v16, v16
    v_fma_f32 v19, v19, v60, v60
    v_mfma_f32_32x32x16_bf16 v[64:79], a[72:75], v[212:215], v[64:79]
    buffer_load_dwordx4 v[148:151], v1, s[8:11], s78 offen offset:1024 sc1
    v_fma_f32 v17, v17, v58, v59
    v_rcp_f32 v19, v19
    v_mul_f32 v102, v102, v18
    v_mul_f32 v17, v17, v105
    v_mul_f32 v18, v106, v106
    v_exp_f32 v17, v17
    v_fma_f32 v16, v16, v60, v60
    v_mfma_f32_32x32x16_bf16 v[80:95], a[100:103], v[216:219], v[80:95]
    s_add_u32 s92, s58, 0x6000
    buffer_load_dwordx4 a[196:199], v1, s[8:11], s92 offen offset:0 sc1
    v_fma_f32 v18, v18, v58, v59
    v_rcp_f32 v16, v16
    v_mul_f32 v103, v103, v19
    v_mul_f32 v18, v18, v106
    v_mul_f32 v19, v107, v107
    v_cvt_pk_bf16_f32 v23, v102, v103
    v_fma_f32 v17, v17, v60, v60
    v_mfma_f32_32x32x16_bf16 v[64:79], a[96:99], v[216:219], v[64:79]
    buffer_load_dwordx4 v[152:155], v1, s[8:11], s78 offen offset:2048 sc1
    v_exp_f32 v18, v18
    v_fma_f32 v19, v19, v58, v59
    v_rcp_f32 v17, v17
    v_mul_f32 v104, v104, v16
    v_mul_f32 v19, v19, v107
    v_mul_f32 v16, v108, v108
    v_fma_f32 v18, v18, v60, v60
    v_mfma_f32_32x32x16_bf16 v[80:95], a[108:111], v[220:223], v[80:95]
    s_waitcnt vmcnt(10)
    v_bitop3_b32 v7, v227, v231, v235 bitop3:0x80
    v_bitop3_b32 v7, v7, v239, 1 bitop3:0x2a
    v_cmp_ne_u32 vcc, 0, v7
    v_exp_f32 v19, v19
    v_fma_f32 v16, v16, v58, v59
    v_rcp_f32 v18, v18
    v_mul_f32 v105, v105, v17
    v_mul_f32 v16, v16, v108
    v_mfma_f32_32x32x16_bf16 v[64:79], a[104:107], v[220:223], v[64:79]
    s_cbranch_vccnz OOL_104
RET_105:
    buffer_load_dwordx4 v[156:159], v1, s[8:11], s78 offen offset:3072 sc1
    v_mul_f32 v17, v109, v109
    v_cvt_pk_bf16_f32 v24, v104, v105
    v_or_b32 v23, 1, v23
    v_exp_f32 v16, v16
    v_mfma_f32_32x32x16_bf16 v[128:143], a[4:7], v[224:227], 0
    buffer_load_dwordx4 a[200:203], v1, s[8:11], s91 offen offset:1024 sc1
    v_fma_f32 v19, v19, v60, v60
    v_fma_f32 v17, v17, v58, v59
    v_rcp_f32 v19, v19
    v_mul_f32 v106, v106, v18
    v_mul_f32 v17, v17, v109
    v_mul_f32 v18, v110, v110
    v_exp_f32 v17, v17
    v_mfma_f32_32x32x16_bf16 v[32:47], a[0:3], v[224:227], v[32:47]
    s_add_u32 s78, s51, 0x9000
    buffer_load_dwordx4 v[160:163], v1, s[8:11], s78 offen offset:0 sc1
    v_fma_f32 v16, v16, v60, v60
    v_fma_f32 v18, v18, v58, v59
    v_rcp_f32 v16, v16
    v_mul_f32 v107, v107, v19
    v_mul_f32 v18, v18, v110
    v_mul_f32 v19, v111, v111
    v_cvt_pk_bf16_f32 v25, v106, v107
    v_mfma_f32_32x32x16_bf16 v[128:143], a[12:15], v[228:231], v[128:143]
    buffer_load_dwordx4 a[204:207], v1, s[8:11], s92 offen offset:1024 sc1
    v_exp_f32 v18, v18
    v_fma_f32 v17, v17, v60, v60
    v_fma_f32 v19, v19, v58, v59
    v_rcp_f32 v17, v17
    v_mul_f32 v108, v108, v16
    v_mul_f32 v19, v19, v111
    v_mul_f32 v16, v112, v112
    v_mfma_f32_32x32x16_bf16 v[32:47], a[8:11], v[228:231], v[32:47]
    buffer_load_dwordx4 v[164:167], v1, s[8:11], s78 offen offset:1024 sc1
    v_exp_f32 v19, v19
    v_fma_f32 v18, v18, v60, v60
    v_fma_f32 v16, v16, v58, v59
    v_rcp_f32 v18, v18
    v_mul_f32 v109, v109, v17
    v_mul_f32 v16, v16, v112
    v_mul_f32 v17, v113, v113
    v_mfma_f32_32x32x16_bf16 v[128:143], a[36:39], v[232:235], v[128:143]
    buffer_load_dwordx4 a[208:211], v1, s[8:11], s91 offen offset:2048 sc1
    v_cvt_pk_bf16_f32 v26, v108, v109
    v_exp_f32 v16, v16
    v_fma_f32 v19, v19, v60, v60
    v_fma_f32 v17, v17, v58, v59
    v_rcp_f32 v19, v19
    v_mul_f32 v110, v110, v18
    v_mul_f32 v17, v17, v113
    v_mfma_f32_32x32x16_bf16 v[32:47], a[32:35], v[232:235], v[32:47]
    buffer_load_dwordx4 v[168:171], v1, s[8:11], s78 offen offset:2048 sc1
    v_mul_f32 v18, v114, v114
    v_exp_f32 v17, v17
    v_fma_f32 v16, v16, v60, v60
    v_fma_f32 v18, v18, v58, v59
    v_rcp_f32 v16, v16
    v_mul_f32 v111, v111, v19
    v_mul_f32 v18, v18, v114
    v_mfma_f32_32x32x16_bf16 v[128:143], a[44:47], v[236:239], v[128:143]
    s_waitcnt vmcnt(13)
    v_bitop3_b32 v7, v243, v247, v251 bitop3:0x80
    v_bitop3_b32 v7, v7, v255, 1 bitop3:0x2a
    v_cmp_ne_u32 vcc, 0, v7
    v_mul_f32 v19, v115, v115
    v_cvt_pk_bf16_f32 v27, v110, v111
    v_or_b32 v27, 1, v27
    v_exp_f32 v18, v18
    v_fma_f32 v17, v17, v60, v60
    v_fma_f32 v19, v19, v58, v59
    v_mfma_f32_32x32x16_bf16 v[32:47], a[40:43], v[236:239], v[32:47]
    s_cbranch_vccnz OOL_107
RET_108:
    buffer_load_dwordx4 v[172:175], v1, s[8:11], s78 offen offset:3072 sc1
    buffer_store_dwordx4 v[20:23], v1, s[8:11], s61 offen offset:0
    buffer_store_dwordx4 v[24:27], v1, s[8:11], s61 offen offset:1024
    v_mul_f32 v112, v112, v16
    v_mfma_f32_32x32x16_bf16 v[128:143], a[68:71], v[240:243], v[128:143]
    buffer_load_dwordx4 a[212:215], v1, s[8:11], s92 offen offset:2048 sc1
    v_rcp_f32 v17, v17
    v_mul_f32 v19, v19, v115
    v_mul_f32 v16, v116, v116
    v_exp_f32 v19, v19
    v_fma_f32 v18, v18, v60, v60
    v_fma_f32 v16, v16, v58, v59
    v_mul_f32 v113, v113, v17
    v_mfma_f32_32x32x16_bf16 v[32:47], a[64:67], v[240:243], v[32:47]
    s_add_u32 s78, s50, 0x8000
    buffer_load_dwordx4 v[176:179], v1, s[8:11], s78 offen offset:0 sc1
    v_rcp_f32 v18, v18
    v_mul_f32 v16, v16, v116
    v_mul_f32 v17, v117, v117
    v_cvt_pk_bf16_f32 v20, v112, v113
    v_exp_f32 v16, v16
    v_fma_f32 v19, v19, v60, v60
    v_mfma_f32_32x32x16_bf16 v[128:143], a[76:79], v[244:247], v[128:143]
    buffer_load_dwordx4 a[216:219], v1, s[8:11], s91 offen offset:3072 sc1
    v_fma_f32 v17, v17, v58, v59
    v_rcp_f32 v19, v19
    v_mul_f32 v114, v114, v18
    v_mul_f32 v17, v17, v117
    v_mul_f32 v18, v118, v118
    v_exp_f32 v17, v17
    v_fma_f32 v16, v16, v60, v60
    v_mfma_f32_32x32x16_bf16 v[32:47], a[72:75], v[244:247], v[32:47]
    buffer_load_dwordx4 v[180:183], v1, s[8:11], s78 offen offset:1024 sc1
    v_fma_f32 v18, v18, v58, v59
    v_rcp_f32 v16, v16
    v_mul_f32 v115, v115, v19
    v_mul_f32 v18, v18, v118
    v_mul_f32 v19, v119, v119
    v_cvt_pk_bf16_f32 v21, v114, v115
    v_exp_f32 v18, v18
    v_mfma_f32_32x32x16_bf16 v[128:143], a[100:103], v[248:251], v[128:143]
    buffer_load_dwordx4 a[220:223], v1, s[8:11], s92 offen offset:3072 sc1
    v_fma_f32 v17, v17, v60, v60
    v_fma_f32 v19, v19, v58, v59
    v_rcp_f32 v17, v17
    v_mul_f32 v116, v116, v16
    v_mul_f32 v19, v19, v119
    v_mul_f32 v16, v120, v120
    v_exp_f32 v19, v19
    v_mfma_f32_32x32x16_bf16 v[32:47], a[96:99], v[248:251], v[32:47]
    buffer_load_dwordx4 v[184:187], v1, s[8:11], s78 offen offset:2048 sc1
    v_fma_f32 v18, v18, v60, v60
    v_fma_f32 v16, v16, v58, v59
    v_rcp_f32 v18, v18
    v_mul_f32 v117, v117, v17
    v_mul_f32 v16, v16, v120
    v_mul_f32 v17, v121, v121
    v_cvt_pk_bf16_f32 v22, v116, v117
    v_fma_f32 v19, v19, v60, v60
    v_mfma_f32_32x32x16_bf16 v[128:143], a[108:111], v[252:255], v[128:143]
    s_waitcnt vmcnt(15)
    v_bitop3_b32 v7, v147, v151, v155 bitop3:0xfe
    v_bitop3_b32 v7, v7, v159, 1 bitop3:0xa8
    v_cmp_ne_u32 vcc, 0, v7
    v_exp_f32 v16, v16
    v_fma_f32 v17, v17, v58, v59
    v_rcp_f32 v19, v19
    v_mul_f32 v118, v118, v18
    v_mul_f32 v17, v17, v121
    v_mfma_f32_32x32x16_bf16 v[32:47], a[104:107], v[252:255], v[32:47]
    s_cbranch_vccnz OOL_110
RET_111:
    buffer_load_dwordx4 v[188:191], v1, s[8:11], s78 offen offset:3072 sc1
    v_mul_f32 v18, v122, v122
    v_exp_f32 v17, v17
    v_fma_f32 v16, v16, v60, v60
    v_fma_f32 v18, v18, v58, v59
    v_mfma_f32_32x32x16_bf16 v[80:95], a[20:23], v[144:147], v[80:95]
    s_lshr_b32 s22, s2, 3
    s_lshl_b32 s22, s22, 2
    s_add_u32 s22, s22, s44
    s_lshl_b32 s22, s22, 9
    v_and_b32 v28, 3, v0
    v_lshl_add_u32 v28, v28, 7, s22
    s_getpc_b64 s[22:23]
PC_66:
    v_min_u32 v28, L_codeend-PC_66-4, v28
    global_load_dword v62, v28, s[22:23]
    v_rcp_f32 v16, v16
    v_mfma_f32_32x32x16_bf16 v[64:79], a[16:19], v[144:147], v[64:79]
    s_add_u32 s78, s50, 0x9000
    buffer_load_dwordx4 v[192:195], v1, s[8:11], s78 offen offset:0 sc1
    v_mul_f32 v119, v119, v19
    v_mul_f32 v18, v18, v122
    v_mul_f32 v19, v123, v123
    v_cvt_pk_bf16_f32 v23, v118, v119
    v_exp_f32 v18, v18
    v_fma_f32 v17, v17, v60, v60
    v_fma_f32 v19, v19, v58, v59
    v_mfma_f32_32x32x16_bf16 v[80:95], a[28:31], v[148:151], v[80:95]
    v_rcp_f32 v17, v17
    v_mul_f32 v120, v120, v16
    v_mul_f32 v19, v19, v123
    v_mul_f32 v16, v124, v124
    v_exp_f32 v19, v19
    v_fma_f32 v18, v18, v60, v60
    v_fma_f32 v16, v16, v58, v59
    v_mul_f32 v121, v121, v17
    v_mfma_f32_32x32x16_bf16 v[64:79], a[24:27], v[148:151], v[64:79]
    buffer_load_dwordx4 v[196:199], v1, s[8:11], s78 offen offset:1024 sc1
    v_rcp_f32 v18, v18
    v_mul_f32 v16, v16, v124
    v_mul_f32 v17, v125, v125
    v_cvt_pk_bf16_f32 v24, v120, v121
    v_or_b32 v23, 1, v23
    v_exp_f32 v16, v16
    v_fma_f32 v19, v19, v60, v60
    v_mfma_f32_32x32x16_bf16 v[80:95], a[52:55], v[152:155], v[80:95]
    v_fma_f32 v17, v17, v58, v59
    v_rcp_f32 v19, v19
    v_mul_f32 v122, v122, v18
    v_mul_f32 v17, v17, v125
    v_mul_f32 v18, v126, v126
    v_exp_f32 v17, v17
    v_fma_f32 v16, v16, v60, v60
    v_fma_f32 v18, v18, v58, v59
    v_mfma_f32_32x32x16_bf16 v[64:79], a[48:51], v[152:155], v[64:79]
    buffer_load_dwordx4 v[200:203], v1, s[8:11], s78 offen offset:2048 sc1
    v_rcp_f32 v16, v16
    v_mul_f32 v123, v123, v19
    v_mul_f32 v18, v18, v126
    v_mul_f32 v19, v127, v127
    v_cvt_pk_bf16_f32 v25, v122, v123
    v_exp_f32 v18, v18
    v_fma_f32 v17, v17, v60, v60
    v_mfma_f32_32x32x16_bf16 v[80:95], a[60:63], v[156:159], v[80:95]
    s_waitcnt vmcnt(13)
    v_bitop3_b32 v7, v163, v167, v171 bitop3:0xfe
    v_bitop3_b32 v7, v7, v175, 1 bitop3:0xa8
    v_cmp_ne_u32 vcc, 0, v7
    v_fma_f32 v19, v19, v58, v59
    v_rcp_f32 v17, v17
    v_mul_f32 v124, v124, v16
    v_mul_f32 v19, v19, v127
    v_exp_f32 v19, v19
    v_mfma_f32_32x32x16_bf16 v[64:79], a[56:59], v[156:159], v[64:79]
    s_cbranch_vccnz OOL_113
RET_114:
    buffer_load_dwordx4 v[204:207], v1, s[8:11], s78 offen offset:3072 sc1
    v_fma_f32 v18, v18, v60, v60
    v_rcp_f32 v18, v18
    v_mul_f32 v125, v125, v17
    v_cvt_pk_bf16_f32 v26, v124, v125
    v_mfma_f32_32x32x16_bf16 v[80:95], a[84:87], v[160:163], v[80:95]
    v_fma_f32 v19, v19, v60, v60
    v_rcp_f32 v19, v19
    v_mul_f32 v126, v126, v18
    v_mul_f32 v127, v127, v19
    v_cvt_pk_bf16_f32 v27, v126, v127
    v_or_b32 v27, 1, v27
    v_mfma_f32_32x32x16_bf16 v[64:79], a[80:83], v[160:163], v[64:79]
    buffer_load_dwordx4 v[208:211], v1, s[8:11], s53 offen offset:0 sc1
    s_add_u32 s76, s61, 6144
    buffer_store_dwordx4 v[20:23], v1, s[8:11], s76 offen offset:0
    buffer_store_dwordx4 v[24:27], v1, s[8:11], s76 offen offset:1024
    v_mfma_f32_32x32x16_bf16 v[80:95], a[92:95], v[164:167], v[80:95]
    v_mfma_f32_32x32x16_bf16 v[64:79], a[88:91], v[164:167], v[64:79]
    buffer_load_dwordx4 v[212:215], v1, s[8:11], s53 offen offset:1024 sc1
    v_mfma_f32_32x32x16_bf16 v[80:95], a[116:119], v[168:171], v[80:95]
    v_mfma_f32_32x32x16_bf16 v[64:79], a[112:115], v[168:171], v[64:79]
    buffer_load_dwordx4 v[216:219], v1, s[8:11], s53 offen offset:2048 sc1
    v_mfma_f32_32x32x16_bf16 v[80:95], a[124:127], v[172:175], v[80:95]
    s_waitcnt vmcnt(10)
    v_bitop3_b32 v7, v179, v183, v187 bitop3:0xfe
    v_bitop3_b32 v7, v7, v191, 1 bitop3:0xa8
    v_cmp_ne_u32 vcc, 0, v7
    v_mfma_f32_32x32x16_bf16 v[64:79], a[120:123], v[172:175], v[64:79]
    s_cbranch_vccnz OOL_116
RET_117:
    buffer_load_dwordx4 v[220:223], v1, s[8:11], s53 offen offset:3072 sc1
    v_mfma_f32_32x32x16_bf16 v[128:143], a[20:23], v[176:179], v[128:143]
    v_mfma_f32_32x32x16_bf16 v[32:47], a[16:19], v[176:179], v[32:47]
    s_add_u32 s78, s53, 0x1000
    buffer_load_dwordx4 v[224:227], v1, s[8:11], s78 offen offset:0 sc1
    v_mfma_f32_32x32x16_bf16 v[128:143], a[28:31], v[180:183], v[128:143]
    v_mfma_f32_32x32x16_bf16 v[32:47], a[24:27], v[180:183], v[32:47]
    buffer_load_dwordx4 v[228:231], v1, s[8:11], s78 offen offset:1024 sc1
    v_mfma_f32_32x32x16_bf16 v[128:143], a[52:55], v[184:187], v[128:143]
    v_mfma_f32_32x32x16_bf16 v[32:47], a[48:51], v[184:187], v[32:47]
    buffer_load_dwordx4 v[232:235], v1, s[8:11], s52 offen offset:0 sc1
    v_mfma_f32_32x32x16_bf16 v[128:143], a[60:63], v[188:191], v[128:143]
    s_waitcnt vmcnt(9)
    v_bitop3_b32 v7, v195, v199, v203 bitop3:0xfe
    v_bitop3_b32 v7, v7, v207, 1 bitop3:0xa8
    v_cmp_ne_u32 vcc, 0, v7
    v_mfma_f32_32x32x16_bf16 v[32:47], a[56:59], v[188:191], v[32:47]
    s_cbranch_vccnz OOL_119
RET_120:
    buffer_load_dwordx4 v[236:239], v1, s[8:11], s52 offen offset:1024 sc1
    v_mfma_f32_32x32x16_bf16 v[128:143], a[84:87], v[192:195], v[128:143]
    v_mfma_f32_32x32x16_bf16 v[32:47], a[80:83], v[192:195], v[32:47]
    buffer_load_dwordx4 v[240:243], v1, s[8:11], s52 offen offset:2048 sc1
    v_mfma_f32_32x32x16_bf16 v[128:143], a[92:95], v[196:199], v[128:143]
    v_mfma_f32_32x32x16_bf16 v[32:47], a[88:91], v[196:199], v[32:47]
    buffer_load_dwordx4 v[244:247], v1, s[8:11], s52 offen offset:3072 sc1
    v_mfma_f32_32x32x16_bf16 v[128:143], a[116:119], v[200:203], v[128:143]
    v_mfma_f32_32x32x16_bf16 v[32:47], a[112:115], v[200:203], v[32:47]
    s_add_u32 s78, s52, 0x1000
    buffer_load_dwordx4 v[248:251], v1, s[8:11], s78 offen offset:0 sc1
    v_mfma_f32_32x32x16_bf16 v[128:143], a[124:127], v[204:207], v[128:143]
    s_waitcnt vmcnt(7)
    v_bitop3_b32 v7, v211, v215, v219 bitop3:0x80
    v_bitop3_b32 v7, v7, v223, 1 bitop3:0x2a
    v_cmp_ne_u32 vcc, 0, v7
    v_mfma_f32_32x32x16_bf16 v[32:47], a[120:123], v[204:207], v[32:47]
    s_cbranch_vccnz OOL_122
RET_123:
    buffer_load_dwordx4 v[252:255], v1, s[8:11], s78 offen offset:1024 sc1
    v_mfma_f32_32x32x16_bf16 v[80:95], a[132:135], v[208:211], v[80:95]
    v_mfma_f32_32x32x16_bf16 v[64:79], a[128:131], v[208:211], v[64:79]
    s_add_u32 s78, s53, 0x1800
    buffer_load_dwordx4 v[144:147], v1, s[8:11], s78 offen offset:0 sc1
    v_mfma_f32_32x32x16_bf16 v[80:95], a[140:143], v[212:215], v[80:95]
    v_mfma_f32_32x32x16_bf16 v[64:79], a[136:139], v[212:215], v[64:79]
    buffer_load_dwordx4 v[148:151], v1, s[8:11], s78 offen offset:1024 sc1
    v_mfma_f32_32x32x16_bf16 v[80:95], a[164:167], v[216:219], v[80:95]
    v_mfma_f32_32x32x16_bf16 v[64:79], a[160:163], v[216:219], v[64:79]
    buffer_load_dwordx4 v[152:155], v1, s[8:11], s78 offen offset:2048 sc1
    v_mfma_f32_32x32x16_bf16 v[80:95], a[172:175], v[220:223], v[80:95]
    s_waitcnt vmcnt(9)
    v_bitop3_b32 v7, v227, v231, 1 bitop3:0x2a
    v_cmp_ne_u32 vcc, 0, v7
    v_mfma_f32_32x32x16_bf16 v[64:79], a[168:171], v[220:223], v[64:79]
    s_cbranch_vccnz OOL_125
RET_126:
    buffer_load_dwordx4 v[156:159], v1, s[8:11], s78 offen offset:3072 sc1
    v_mfma_f32_32x32x16_bf16 v[80:95], a[196:199], v[224:227], v[80:95]
    v_mfma_f32_32x32x16_bf16 v[64:79], a[192:195], v[224:227], v[64:79]
    s_add_u32 s78, s53, 0x2800
    buffer_load_dwordx4 v[160:163], v1, s[8:11], s78 offen offset:0 sc1
    v_mfma_f32_32x32x16_bf16 v[80:95], a[204:207], v[228:231], v[80:95]
    s_waitcnt vmcnt(7)
    v_bitop3_b32 v7, v235, v239, v243 bitop3:0x80
    v_bitop3_b32 v7, v7, v247, 1 bitop3:0x2a
    v_cmp_ne_u32 vcc, 0, v7
    v_mfma_f32_32x32x16_bf16 v[64:79], a[200:203], v[228:231], v[64:79]
    s_cbranch_vccnz OOL_128
RET_129:
    buffer_load_dwordx4 v[164:167], v1, s[8:11], s78 offen offset:1024 sc1
    v_mfma_f32_32x32x16_bf16 v[128:143], a[132:135], v[232:235], v[128:143]
    v_mfma_f32_32x32x16_bf16 v[32:47], a[128:131], v[232:235], v[32:47]
    s_add_u32 s78, s52, 0x1800
    buffer_load_dwordx4 v[168:171], v1, s[8:11], s78 offen offset:0 sc1
    v_mfma_f32_32x32x16_bf16 v[128:143], a[140:143], v[236:239], v[128:143]
    v_mfma_f32_32x32x16_bf16 v[32:47], a[136:139], v[236:239], v[32:47]
    buffer_load_dwordx4 v[172:175], v1, s[8:11], s78 offen offset:1024 sc1
    v_mfma_f32_32x32x16_bf16 v[128:143], a[164:167], v[240:243], v[128:143]
    v_mfma_f32_32x32x16_bf16 v[32:47], a[160:163], v[240:243], v[32:47]
    buffer_load_dwordx4 v[176:179], v1, s[8:11], s78 offen offset:2048 sc1
    v_mfma_f32_32x32x16_bf16 v[128:143], a[172:175], v[244:247], v[128:143]
    s_waitcnt vmcnt(9)
    v_bitop3_b32 v7, v251, v255, 1 bitop3:0x2a
    v_cmp_ne_u32 vcc, 0, v7
    v_mfma_f32_32x32x16_bf16 v[32:47], a[168:171], v[244:247], v[32:47]
    s_cbranch_vccnz OOL_131
RET_132:
    buffer_load_dwordx4 v[180:183], v1, s[8:11], s78 offen offset:3072 sc1
    v_mfma_f32_32x32x16_bf16 v[128:143], a[196:199], v[248:251], v[128:143]
    v_mfma_f32_32x32x16_bf16 v[32:47], a[192:195], v[248:251], v[32:47]
    s_add_u32 s78, s52, 0x2800
    buffer_load_dwordx4 v[184:187], v1, s[8:11], s78 offen offset:0 sc1
    v_mfma_f32_32x32x16_bf16 v[128:143], a[204:207], v[252:255], v[128:143]
    s_waitcnt vmcnt(7)
    v_bitop3_b32 v7, v147, v151, v155 bitop3:0x80
    v_bitop3_b32 v7, v7, v159, 1 bitop3:0x2a
    v_cmp_ne_u32 vcc, 0, v7
    v_mfma_f32_32x32x16_bf16 v[32:47], a[200:203], v[252:255], v[32:47]
    s_cbranch_vccnz OOL_134
RET_135:
    buffer_load_dwordx4 v[188:191], v1, s[8:11], s78 offen offset:1024 sc1
    v_mfma_f32_32x32x16_bf16 v[80:95], a[148:151], v[144:147], v[80:95]
    buffer_load_dwordx4 v[192:195], v1, s[8:11], s55 offen offset:0 sc1
    v_mfma_f32_32x32x16_bf16 v[64:79], a[144:147], v[144:147], v[64:79]
    v_mfma_f32_32x32x16_bf16 v[80:95], a[156:159], v[148:151], v[80:95]
    buffer_load_dwordx4 v[196:199], v1, s[8:11], s56 offen offset:0 sc1
    v_mfma_f32_32x32x16_bf16 v[64:79], a[152:155], v[148:151], v[64:79]
    v_mfma_f32_32x32x16_bf16 v[80:95], a[180:183], v[152:155], v[80:95]
    buffer_load_dwordx4 v[200:203], v1, s[8:11], s55 offen offset:1024 sc1
    v_mfma_f32_32x32x16_bf16 v[64:79], a[176:179], v[152:155], v[64:79]
    v_mfma_f32_32x32x16_bf16 v[80:95], a[188:191], v[156:159], v[80:95]
    s_waitcnt vmcnt(9)
    v_bitop3_b32 v7, v163, v167, 1 bitop3:0x2a
    v_cmp_ne_u32 vcc, 0, v7
    v_mfma_f32_32x32x16_bf16 v[64:79], a[184:187], v[156:159], v[64:79]
    s_cbranch_vccnz OOL_137
RET_138:
    buffer_load_dwordx4 v[204:207], v1, s[8:11], s56 offen offset:1024 sc1
    v_mfma_f32_32x32x16_bf16 v[80:95], a[212:215], v[160:163], v[80:95]
    v_mfma_f32_32x32x16_bf16 v[64:79], a[208:211], v[160:163], v[64:79]
    buffer_load_dwordx4 v[208:211], v1, s[8:11], s55 offen offset:2048 sc1
    v_mfma_f32_32x32x16_bf16 v[80:95], a[220:223], v[164:167], v[80:95]
    s_waitcnt vmcnt(7)
    v_bitop3_b32 v7, v171, v175, v179 bitop3:0x80
    v_bitop3_b32 v7, v7, v183, 1 bitop3:0x2a
    v_cmp_ne_u32 vcc, 0, v7
    v_mfma_f32_32x32x16_bf16 v[64:79], a[216:219], v[164:167], v[64:79]
    s_cbranch_vccnz OOL_140
RET_141:
    buffer_load_dwordx4 v[212:215], v1, s[8:11], s56 offen offset:2048 sc1
    v_mfma_f32_32x32x16_bf16 v[128:143], a[148:151], v[168:171], v[128:143]
    s_lshr_b32 s22, s2, 3
    s_lshl_b32 s22, s22, 2
    s_add_u32 s22, s22, s44
    s_lshl_b32 s22, s22, 9
    v_and_b32 v28, 3, v0
    v_lshl_add_u32 v28, v28, 7, s22
    s_getpc_b64 s[22:23]
PC_142:
    v_min_u32 v28, L_codeend-PC_142-4, v28
    global_load_dword v62, v28, s[22:23]
    v_mfma_f32_32x32x16_bf16 v[128:143], a[156:159], v[172:175], v[128:143]
    buffer_load_dwordx4 v[216:219], v1, s[8:11], s55 offen offset:3072 sc1
    v_xor_b32 v19, 6144, v2
    v_cvt_pk_bf16_f32 v80, v80, v81
    v_cvt_pk_bf16_f32 v81, v82, v83
    v_cvt_pk_bf16_f32 v82, v84, v85
    v_cvt_pk_bf16_f32 v83, v86, v87
    v_mfma_f32_32x32x16_bf16 v[128:143], a[180:183], v[176:179], v[128:143]
    ds_write_b128 v19, v[80:83] offset:16384
    v_cvt_pk_bf16_f32 v84, v88, v89
    v_cvt_pk_bf16_f32 v85, v90, v91
    v_cvt_pk_bf16_f32 v86, v92, v93
    v_mfma_f32_32x32x16_bf16 v[128:143], a[188:191], v[180:183], v[128:143]
    s_waitcnt vmcnt(8)
    v_bitop3_b32 v7, v187, v191, 1 bitop3:0x2a
    v_cmp_ne_u32 vcc, 0, v7
    v_cvt_pk_bf16_f32 v87, v94, v95
    v_xor_b32 v17, 2048, v2
    v_cvt_pk_bf16_f32 v64, v64, v65
    v_cvt_pk_bf16_f32 v65, v66, v67
    v_mfma_f32_32x32x16_bf16 v[32:47], a[144:147], v[168:171], v[32:47]
    s_cbranch_vccnz OOL_144
RET_145:
    buffer_load_dwordx4 v[220:223], v1, s[8:11], s56 offen offset:3072 sc1
    v_cvt_pk_bf16_f32 v66, v68, v69
    v_mfma_f32_32x32x16_bf16 v[128:143], a[212:215], v[184:187], v[128:143]
    ds_write_b128 v19, v[84:87] offset:17408
    v_cvt_pk_bf16_f32 v67, v70, v71
    v_cvt_pk_bf16_f32 v68, v72, v73
    v_cvt_pk_bf16_f32 v69, v74, v75
    v_mfma_f32_32x32x16_bf16 v[32:47], a[152:155], v[172:175], v[32:47]
    s_add_u32 s88, s55, 0x1000
    buffer_load_dwordx4 v[224:227], v1, s[8:11], s88 offen offset:0 sc1
    ds_write_b128 v17, v[64:67] offset:0
    v_mfma_f32_32x32x16_bf16 v[128:143], a[220:223], v[188:191], v[128:143]
    v_cvt_pk_bf16_f32 v70, v76, v77
    v_cvt_pk_bf16_f32 v71, v78, v79
    ds_write_b128 v17, v[68:71] offset:1024
    v_add_u32 v16, 161792, v1
    s_waitcnt lgkmcnt(0)
    s_barrier
    ds_read_b128 v[120:123], v16 offset:0
    ds_read_b128 v[124:127], v16 offset:1024
    ds_read_b128 v[80:83], v2 offset:0
    ds_read_b128 v[84:87], v2 offset:1024
    ds_read_b128 v[112:115], v2 offset:16384
    ds_read_b128 v[116:119], v2 offset:17408
    v_mfma_f32_32x32x16_bf16 v[32:47], a[176:179], v[176:179], v[32:47]
    s_add_u32 s89, s56, 0x1000
    buffer_load_dwordx4 v[228:231], v1, s[8:11], s89 offen offset:0 sc1
    v_mfma_f32_32x32x16_bf16 v[32:47], a[184:187], v[180:183], v[32:47]
    v_xor_b32 v18, 4096, v2
    v_cvt_pk_bf16_f32 v128, v128, v129
    v_cvt_pk_bf16_f32 v129, v130, v131
    v_cvt_pk_bf16_f32 v130, v132, v133
    v_cvt_pk_bf16_f32 v131, v134, v135
    v_cvt_pk_bf16_f32 v132, v136, v137
    v_mfma_f32_32x32x16_bf16 v[32:47], a[208:211], v[184:187], v[32:47]
    buffer_load_dwordx4 v[232:235], v1, s[8:11], s88 offen offset:1024 sc1
    ds_write_b128 v18, v[128:131] offset:8192
    v_cvt_pk_bf16_f32 v133, v138, v139
    v_mfma_f32_32x32x16_bf16 v[32:47], a[216:219], v[188:191], v[32:47]
    v_cvt_pk_bf16_f32 v134, v140, v141
    v_cvt_pk_bf16_f32 v135, v142, v143
    s_waitcnt lgkmcnt(4)
    v_mfma_f32_32x32x16_bf16 v[32:47], v[120:123], v[80:83], v[32:47]
    buffer_load_dwordx4 v[236:239], v1, s[8:11], s89 offen offset:1024 sc1
    ds_write_b128 v18, v[132:135] offset:9216
    s_waitcnt lgkmcnt(4)
    v_mfma_f32_32x32x16_bf16 v[32:47], v[124:127], v[84:87], v[32:47]
    s_waitcnt lgkmcnt(0)
    s_barrier
    ds_read_b128 v[96:99], v2 offset:8192
    ds_read_b128 v[100:103], v2 offset:9216
    v_mfma_f32_32x32x16_bf16 v[32:47], v[120:123], v[112:115], v[32:47]
    buffer_load_dwordx4 v[240:243], v1, s[8:11], s88 offen offset:2048 sc1
    v_mfma_f32_32x32x16_bf16 v[32:47], v[124:127], v[116:119], v[32:47]
    buffer_load_dwordx4 v[244:247], v1, s[8:11], s89 offen offset:2048 sc1
    buffer_load_dwordx4 v[248:251], v1, s[8:11], s88 offen offset:3072 sc1
    s_waitcnt lgkmcnt(1)
    s_nop 8
    v_dot2c_f32_bf16 v32, s65, v96
    v_dot2c_f32_bf16 v33, s66, v96
    v_dot2c_f32_bf16 v34, s65, v97
    v_dot2c_f32_bf16 v35, s66, v97
    buffer_load_dwordx4 v[252:255], v1, s[8:11], s89 offen offset:3072 sc1
    v_dot2c_f32_bf16 v36, s65, v98
    v_dot2c_f32_bf16 v37, s66, v98
    v_dot2c_f32_bf16 v38, s65, v99
    v_dot2c_f32_bf16 v39, s66, v99
    s_waitcnt lgkmcnt(0)
    v_dot2c_f32_bf16 v40, s65, v100
    v_dot2c_f32_bf16 v41, s66, v100
    v_dot2c_f32_bf16 v42, s65, v101
    v_dot2c_f32_bf16 v43, s66, v101
    v_dot2c_f32_bf16 v44, s65, v102
    v_dot2c_f32_bf16 v45, s66, v102
    v_dot2c_f32_bf16 v46, s65, v103
    v_dot2c_f32_bf16 v47, s66, v103
    s_add_u32 s77, s48, 0x1000
    s_add_u32 s76, s49, 0x1000
    v_pk_add_f32 v[18:19], v[32:33], v[34:35]
    v_pk_mul_f32 v[20:21], v[32:33], v[32:33]
    v_pk_fma_f32 v[20:21], v[34:35], v[34:35], v[20:21]
    v_pk_add_f32 v[18:19], v[18:19], v[36:37]
    v_pk_fma_f32 v[20:21], v[36:37], v[36:37], v[20:21]
    v_pk_add_f32 v[18:19], v[18:19], v[38:39]
    v_pk_fma_f32 v[20:21], v[38:39], v[38:39], v[20:21]
    v_pk_add_f32 v[18:19], v[18:19], v[40:41]
    v_pk_fma_f32 v[20:21], v[40:41], v[40:41], v[20:21]
    v_pk_add_f32 v[18:19], v[18:19], v[42:43]
    v_pk_fma_f32 v[20:21], v[42:43], v[42:43], v[20:21]
    v_pk_add_f32 v[18:19], v[18:19], v[44:45]
    v_pk_fma_f32 v[20:21], v[44:45], v[44:45], v[20:21]
    v_pk_add_f32 v[18:19], v[18:19], v[46:47]
    v_pk_fma_f32 v[20:21], v[46:47], v[46:47], v[20:21]
    v_add_f32 v18, v18, v19
    v_add_f32 v20, v20, v21
    s_nop 1
    v_permlane32_swap_b32 v18, v20
    v_add_f32 v18, v18, v20
    v_and_b32 v18, -2, v18
    buffer_store_dword v18, v1, s[8:11], s77 offen
    v_add_u32 v5, v5, v14
    v_lshlrev_b32 v64, 16, v48
    v_and_b32 v65, 0xffff0000, v48
    v_lshlrev_b32 v66, 16, v49
    v_and_b32 v67, 0xffff0000, v49
    v_lshlrev_b32 v68, 16, v50
    v_and_b32 v69, 0xffff0000, v50
    v_lshlrev_b32 v70, 16, v51
    v_and_b32 v71, 0xffff0000, v51
    v_lshlrev_b32 v72, 16, v52
    v_and_b32 v73, 0xffff0000, v52
    v_lshlrev_b32 v74, 16, v53
    v_and_b32 v75, 0xffff0000, v53
    v_lshlrev_b32 v76, 16, v54
    v_and_b32 v77, 0xffff0000, v54
    v_lshlrev_b32 v78, 16, v55
    v_and_b32 v79, 0xffff0000, v55
    s_waitcnt vmcnt(0)
    buffer_load_dwordx4 v[80:83], v1, s[8:11], s76 offen offset:0 sc1
    buffer_load_dwordx4 v[84:87], v1, s[8:11], s76 offen offset:1024 sc1
    buffer_load_dwordx4 v[88:91], v1, s[8:11], s76 offen offset:2048 sc1
    buffer_load_dwordx4 v[92:95], v1, s[8:11], s76 offen offset:3072 sc1
    s_waitcnt vmcnt(0)
    v_bitop3_b32 v7, v80, v81, v82 bitop3:0xfe
    v_bitop3_b32 v7, v7, v83, v84 bitop3:0xfe
    v_bitop3_b32 v7, v7, v85, v86 bitop3:0xfe
    v_bitop3_b32 v7, v7, v87, v88 bitop3:0xfe
    v_bitop3_b32 v7, v7, v89, v90 bitop3:0xfe
    v_bitop3_b32 v7, v7, v91, v92 bitop3:0xfe
    v_bitop3_b32 v7, v7, v93, v94 bitop3:0xfe
    v_bitop3_b32 v7, v7, v95, 1 bitop3:0xa8
    v_cmp_ne_u32 vcc, 0, v7
    s_cbranch_vccnz OOL_147
RET_148:
    v_pk_add_f32 v[80:81], v[80:81], v[88:89]
    v_pk_add_f32 v[82:83], v[82:83], v[90:91]
    v_pk_add_f32 v[84:85], v[84:85], v[92:93]
    v_pk_add_f32 v[86:87], v[86:87], v[94:95]
    v_pk_add_f32 v[80:81], v[80:81], v[84:85]
    v_pk_add_f32 v[82:83], v[82:83], v[86:87]
    v_pk_add_f32 v[80:81], v[80:81], v[82:83]
    v_add_f32 v80, v80, v81
    v_mov_b32 v81, v80
    s_nop 1
    v_permlane32_swap_b32 v80, v81
    v_mul_f32 v80, 0xbb000000, v80
    v_mul_f32 v81, 0x3b000000, v81
    v_fma_f32 v81, -v80, v80, v81
    v_max_f32 v81, 0, v81
    v_add_f32 v81, 0x3727c5ac, v81
    v_rsq_f32 v82, v81
    s_nop 0
    v_mul_f32 v83, v80, v82
    v_pk_fma_f32 v[96:97], v[32:33], v[82:83], v[82:83] op_sel:[0,0,1] op_sel_hi:[1,0,1]
    v_pk_fma_f32 v[98:99], v[34:35], v[82:83], v[82:83] op_sel:[0,0,1] op_sel_hi:[1,0,1]
    v_pk_fma_f32 v[100:101], v[36:37], v[82:83], v[82:83] op_sel:[0,0,1] op_sel_hi:[1,0,1]
    v_pk_fma_f32 v[102:103], v[38:39], v[82:83], v[82:83] op_sel:[0,0,1] op_sel_hi:[1,0,1]
    v_pk_fma_f32 v[104:105], v[40:41], v[82:83], v[82:83] op_sel:[0,0,1] op_sel_hi:[1,0,1]
    v_pk_fma_f32 v[106:107], v[42:43], v[82:83], v[82:83] op_sel:[0,0,1] op_sel_hi:[1,0,1]
    v_pk_fma_f32 v[108:109], v[44:45], v[82:83], v[82:83] op_sel:[0,0,1] op_sel_hi:[1,0,1]
    v_pk_fma_f32 v[110:111], v[46:47], v[82:83], v[82:83] op_sel:[0,0,1] op_sel_hi:[1,0,1]
    v_pk_fma_f32 v[32:33], v[96:97], v[64:65], v[32:33]
    v_pk_fma_f32 v[34:35], v[98:99], v[66:67], v[34:35]
    v_pk_fma_f32 v[36:37], v[100:101], v[68:69], v[36:37]
    v_pk_fma_f32 v[38:39], v[102:103], v[70:71], v[38:39]
    v_pk_fma_f32 v[40:41], v[104:105], v[72:73], v[40:41]
    v_pk_fma_f32 v[42:43], v[106:107], v[74:75], v[42:43]
    v_pk_fma_f32 v[44:45], v[108:109], v[76:77], v[44:45]
    v_pk_fma_f32 v[46:47], v[110:111], v[78:79], v[46:47]
    v_cvt_pk_bf16_f32 v112, v32, v33
    v_cvt_pk_bf16_f32 v113, v34, v35
    v_cvt_pk_bf16_f32 v114, v36, v37
    v_cvt_pk_bf16_f32 v115, v38, v39
    v_cvt_pk_bf16_f32 v116, v40, v41
    v_cvt_pk_bf16_f32 v117, v42, v43
    v_cvt_pk_bf16_f32 v118, v44, v45
    v_cvt_pk_bf16_f32 v119, v46, v47
    v_and_b32 v115, -2, v115
    v_and_b32 v119, -2, v119
    buffer_store_dwordx4 v[112:115], v1, s[8:11], s47 offen offset:0
    buffer_store_dwordx4 v[116:119], v1, s[8:11], s47 offen offset:1024
    v_pk_add_f32 v[120:121], v[32:33], v[34:35]
    v_pk_mul_f32 v[122:123], v[32:33], v[32:33]
    v_pk_fma_f32 v[122:123], v[34:35], v[34:35], v[122:123]
    v_pk_add_f32 v[120:121], v[120:121], v[36:37]
    v_pk_fma_f32 v[122:123], v[36:37], v[36:37], v[122:123]
    v_pk_add_f32 v[120:121], v[120:121], v[38:39]
    v_pk_fma_f32 v[122:123], v[38:39], v[38:39], v[122:123]
    v_pk_add_f32 v[120:121], v[120:121], v[40:41]
    v_pk_fma_f32 v[122:123], v[40:41], v[40:41], v[122:123]
    v_pk_add_f32 v[120:121], v[120:121], v[42:43]
    v_pk_fma_f32 v[122:123], v[42:43], v[42:43], v[122:123]
    v_pk_add_f32 v[120:121], v[120:121], v[44:45]
    v_pk_fma_f32 v[122:123], v[44:45], v[44:45], v[122:123]
    v_pk_add_f32 v[120:121], v[120:121], v[46:47]
    v_pk_fma_f32 v[122:123], v[46:47], v[46:47], v[122:123]
    v_add_f32 v120, v120, v121
    v_add_f32 v122, v122, v123
    s_nop 1
    v_permlane32_swap_b32 v120, v122
    v_add_f32 v120, v120, v122
    v_or_b32 v120, 1, v120
    buffer_store_dword v120, v1, s[8:11], s48 offen
    s_add_u32 s79, s51, 0x10000
    buffer_load_dwordx4 v[132:135], v1, s[8:11], s79 offen offset:0 sc1
    buffer_load_dwordx4 v[140:143], v1, s[8:11], s79 offen offset:1024 sc1
    buffer_load_dwordx4 v[148:151], v1, s[8:11], s79 offen offset:2048 sc1
    buffer_load_dwordx4 v[156:159], v1, s[8:11], s79 offen offset:3072 sc1
    s_add_u32 s79, s51, 0x11000
    buffer_load_dwordx4 v[164:167], v1, s[8:11], s79 offen offset:0 sc1
    buffer_load_dwordx4 v[172:175], v1, s[8:11], s79 offen offset:1024 sc1
    buffer_load_dwordx4 v[180:183], v1, s[8:11], s79 offen offset:2048 sc1
    buffer_load_dwordx4 v[188:191], v1, s[8:11], s79 offen offset:3072 sc1
    s_waitcnt vmcnt(6)
    v_bitop3_b32 v7, v135, v143, 1 bitop3:0xa8
    v_cmp_ne_u32 vcc, 0, v7
    s_cbranch_vccnz OOL_150
RET_151:
    v_mfma_f32_32x32x16_bf16 v[112:127], v[196:199], v[132:135], 0
    s_add_u32 s80, s50, 0x10000
    buffer_load_dwordx4 v[128:131], v1, s[8:11], s80 offen offset:0 sc1
    v_mov_b32 v30, s69
    v_add_u32 v30, 3, v30
    v_mfma_f32_32x32x16_bf16 v[80:95], v[192:195], v[132:135], 0
    s_mov_b64 exec, 1
    buffer_store_dword v30, off, s[8:11], s62
    s_mov_b64 exec, -1
    v_mfma_f32_32x32x16_bf16 v[112:127], v[204:207], v[140:143], v[112:127]
    buffer_load_dwordx4 v[136:139], v1, s[8:11], s80 offen offset:1024 sc1
    s_waitcnt vmcnt(7)
    v_bitop3_b32 v7, v151, v159, 1 bitop3:0xa8
    v_cmp_ne_u32 vcc, 0, v7
    v_mfma_f32_32x32x16_bf16 v[80:95], v[200:203], v[140:143], v[80:95]
    s_cbranch_vccnz OOL_153
RET_154:
    v_mfma_f32_32x32x16_bf16 v[112:127], v[212:215], v[148:151], v[112:127]
    buffer_load_dwordx4 v[144:147], v1, s[8:11], s80 offen offset:2048 sc1
    v_mfma_f32_32x32x16_bf16 v[80:95], v[208:211], v[148:151], v[80:95]
    v_mfma_f32_32x32x16_bf16 v[112:127], v[220:223], v[156:159], v[112:127]
    buffer_load_dwordx4 v[152:155], v1, s[8:11], s80 offen offset:3072 sc1
    s_waitcnt vmcnt(5)
    v_bitop3_b32 v7, v167, v175, v183 bitop3:0xfe
    v_bitop3_b32 v7, v7, v191, 1 bitop3:0xa8
    v_cmp_ne_u32 vcc, 0, v7
    v_mfma_f32_32x32x16_bf16 v[80:95], v[216:219], v[156:159], v[80:95]
    s_cbranch_vccnz OOL_156
RET_157:
    v_mfma_f32_32x32x16_bf16 v[112:127], v[228:231], v[164:167], v[112:127]
    s_add_u32 s80, s50, 0x11000
    buffer_load_dwordx4 v[160:163], v1, s[8:11], s80 offen offset:0 sc1
    v_mfma_f32_32x32x16_bf16 v[80:95], v[224:227], v[164:167], v[80:95]
    v_mfma_f32_32x32x16_bf16 v[112:127], v[236:239], v[172:175], v[112:127]
    buffer_load_dwordx4 v[168:171], v1, s[8:11], s80 offen offset:1024 sc1
    v_mfma_f32_32x32x16_bf16 v[80:95], v[232:235], v[172:175], v[80:95]
    v_mfma_f32_32x32x16_bf16 v[112:127], v[244:247], v[180:183], v[112:127]
    buffer_load_dwordx4 v[176:179], v1, s[8:11], s80 offen offset:2048 sc1
    v_mfma_f32_32x32x16_bf16 v[80:95], v[240:243], v[180:183], v[80:95]
    v_mfma_f32_32x32x16_bf16 v[112:127], v[252:255], v[188:191], v[112:127]
    buffer_load_dwordx4 v[184:187], v1, s[8:11], s80 offen offset:3072 sc1
    s_waitcnt vmcnt(4)
    v_bitop3_b32 v7, v131, v139, v147 bitop3:0xfe
    v_bitop3_b32 v7, v7, v155, 1 bitop3:0xa8
    v_cmp_ne_u32 vcc, 0, v7
    v_mfma_f32_32x32x16_bf16 v[80:95], v[248:251], v[188:191], v[80:95]
    s_cbranch_vccnz OOL_159
RET_160:
    buffer_load_dwordx4 v[132:135], v1, s[8:11], s49 offen offset:0 sc1
    buffer_load_dwordx4 v[140:143], v1, s[8:11], s49 offen offset:1024 sc1
    v_mfma_f32_32x32x16_bf16 v[96:111], v[196:199], v[128:131], 0
    buffer_load_dwordx4 v[148:151], v1, s[8:11], s49 offen offset:2048 sc1
    buffer_load_dwordx4 v[156:159], v1, s[8:11], s49 offen offset:3072 sc1
    buffer_load_dword v9, v8, s[8:11], 0 offen offset:0 sc1
    v_mfma_f32_32x32x16_bf16 v[96:111], v[204:207], v[136:139], v[96:111]
    v_xor_b32 v19, 6144, v2
    v_cvt_pk_bf16_f32 v112, v112, v113
    v_cvt_pk_bf16_f32 v113, v114, v115
    v_cvt_pk_bf16_f32 v114, v116, v117
    v_cvt_pk_bf16_f32 v115, v118, v119
    v_cvt_pk_bf16_f32 v116, v120, v121
    v_mfma_f32_32x32x16_bf16 v[96:111], v[212:215], v[144:147], v[96:111]
    ds_write_b128 v19, v[112:115] offset:16384
    v_cvt_pk_bf16_f32 v117, v122, v123
    v_cvt_pk_bf16_f32 v118, v124, v125
    v_cvt_pk_bf16_f32 v119, v126, v127
    v_mfma_f32_32x32x16_bf16 v[64:79], v[192:195], v[128:131], 0
    ds_write_b128 v19, v[116:119] offset:17408
    v_xor_b32 v17, 2048, v2
    v_cvt_pk_bf16_f32 v80, v80, v81
    v_cvt_pk_bf16_f32 v81, v82, v83
    v_mfma_f32_32x32x16_bf16 v[96:111], v[220:223], v[152:155], v[96:111]
    s_waitcnt vmcnt(7)
    v_bitop3_b32 v7, v163, v171, 1 bitop3:0xa8
    v_cmp_ne_u32 vcc, 0, v7
    v_cvt_pk_bf16_f32 v82, v84, v85
    v_cvt_pk_bf16_f32 v83, v86, v87
    v_cvt_pk_bf16_f32 v84, v88, v89
    v_cvt_pk_bf16_f32 v85, v90, v91
    v_mfma_f32_32x32x16_bf16 v[64:79], v[200:203], v[136:139], v[64:79]
    s_cbranch_vccnz OOL_162
RET_163:
    s_add_u32 s89, s56, 0x80000
    buffer_load_dwordx4 v[196:199], v1, s[8:11], s89 offen offset:0 sc1
    v_mfma_f32_32x32x16_bf16 v[96:111], v[228:231], v[160:163], v[96:111]
    buffer_load_dwordx4 v[204:207], v1, s[8:11], s89 offen offset:1024 sc1
    ds_write_b128 v17, v[80:83] offset:0
    v_cvt_pk_bf16_f32 v86, v92, v93
    v_mfma_f32_32x32x16_bf16 v[64:79], v[208:211], v[144:147], v[64:79]
    buffer_load_dwordx4 v[212:215], v1, s[8:11], s89 offen offset:2048 sc1
    v_cvt_pk_bf16_f32 v87, v94, v95
    v_mfma_f32_32x32x16_bf16 v[96:111], v[236:239], v[168:171], v[96:111]
    s_add_u32 s88, s55, 0x80000
    buffer_load_dwordx4 v[192:195], v1, s[8:11], s88 offen offset:0 sc1
    ds_write_b128 v17, v[84:87] offset:1024
    s_waitcnt vmcnt(9)
    v_bitop3_b32 v7, v179, v187, 1 bitop3:0xa8
    v_cmp_ne_u32 vcc, 0, v7
    v_mfma_f32_32x32x16_bf16 v[64:79], v[216:219], v[152:155], v[64:79]
    s_cbranch_vccnz OOL_165
RET_166:
    buffer_load_dwordx4 v[220:223], v1, s[8:11], s89 offen offset:3072 sc1
    v_mfma_f32_32x32x16_bf16 v[96:111], v[244:247], v[176:179], v[96:111]
    buffer_load_dwordx4 v[200:203], v1, s[8:11], s88 offen offset:1024 sc1
    v_mfma_f32_32x32x16_bf16 v[64:79], v[224:227], v[160:163], v[64:79]
    s_add_u32 s89, s56, 0x81000
    buffer_load_dwordx4 v[228:231], v1, s[8:11], s89 offen offset:0 sc1
    v_add_u32 v16, 161792, v1
    s_waitcnt lgkmcnt(0)
    s_barrier
    ds_read_b128 v[120:123], v16 offset:0
    ds_read_b128 v[124:127], v16 offset:1024
    ds_read_b128 v[80:83], v2 offset:0
    ds_read_b128 v[84:87], v2 offset:1024
    ds_read_b128 v[112:115], v2 offset:16384
    ds_read_b128 v[116:119], v2 offset:17408
    v_mfma_f32_32x32x16_bf16 v[96:111], v[252:255], v[184:187], v[96:111]
    buffer_load_dwordx4 v[208:211], v1, s[8:11], s88 offen offset:2048 sc1
    v_mfma_f32_32x32x16_bf16 v[64:79], v[232:235], v[168:171], v[64:79]
    buffer_load_dwordx4 v[236:239], v1, s[8:11], s89 offen offset:1024 sc1
    v_mfma_f32_32x32x16_bf16 v[64:79], v[240:243], v[176:179], v[64:79]
    buffer_load_dwordx4 v[216:219], v1, s[8:11], s88 offen offset:3072 sc1
    v_xor_b32 v18, 4096, v2
    s_nop 5
    v_cvt_pk_bf16_f32 v96, v96, v97
    v_cvt_pk_bf16_f32 v97, v98, v99
    v_cvt_pk_bf16_f32 v98, v100, v101
    v_mfma_f32_32x32x16_bf16 v[64:79], v[248:251], v[184:187], v[64:79]
    buffer_load_dwordx4 v[244:247], v1, s[8:11], s89 offen offset:2048 sc1
    v_cvt_pk_bf16_f32 v99, v102, v103
    v_cvt_pk_bf16_f32 v100, v104, v105
    v_cvt_pk_bf16_f32 v101, v106, v107
    v_cvt_pk_bf16_f32 v102, v108, v109
    v_cvt_pk_bf16_f32 v103, v110, v111
    s_waitcnt lgkmcnt(3)
    v_mfma_f32_32x32x16_bf16 v[64:79], v[120:123], v[80:83], v[64:79]
    s_add_u32 s88, s55, 0x81000
    buffer_load_dwordx4 v[224:227], v1, s[8:11], s88 offen offset:0 sc1
    ds_write_b128 v18, v[96:99] offset:8192
    s_waitcnt lgkmcnt(3)
    v_mfma_f32_32x32x16_bf16 v[64:79], v[124:127], v[84:87], v[64:79]
    buffer_load_dwordx4 v[252:255], v1, s[8:11], s89 offen offset:3072 sc1
    ds_write_b128 v18, v[100:103] offset:9216
    s_waitcnt lgkmcnt(3)
    v_mfma_f32_32x32x16_bf16 v[64:79], v[120:123], v[112:115], v[64:79]
    buffer_load_dwordx4 v[232:235], v1, s[8:11], s88 offen offset:1024 sc1
    s_waitcnt lgkmcnt(0)
    s_barrier
    ds_read_b128 v[96:99], v2 offset:8192
    ds_read_b128 v[100:103], v2 offset:9216
    v_mfma_f32_32x32x16_bf16 v[64:79], v[124:127], v[116:119], v[64:79]
    buffer_load_dwordx4 v[240:243], v1, s[8:11], s88 offen offset:2048 sc1
    buffer_load_dwordx4 v[248:251], v1, s[8:11], s88 offen offset:3072 sc1
    s_waitcnt vmcnt(17)
    v_bitop3_b32 v7, v132, v133, v134 bitop3:0x80
    v_bitop3_b32 v7, v7, v135, v140 bitop3:0x80
    v_bitop3_b32 v7, v7, v141, v142 bitop3:0x80
    v_bitop3_b32 v7, v7, v143, v148 bitop3:0x80
    v_bitop3_b32 v7, v7, v149, v150 bitop3:0x80
    v_bitop3_b32 v7, v7, v151, v156 bitop3:0x80
    v_bitop3_b32 v7, v7, v157, v158 bitop3:0x80
    v_bitop3_b32 v7, v7, v159, 1 bitop3:0x2a
    v_cmp_ne_u32 vcc, 0, v7
    s_cbranch_vccnz OOL_168
RET_169:
    v_pk_add_f32 v[132:133], v[132:133], v[148:149]
    v_pk_add_f32 v[134:135], v[134:135], v[150:151]
    v_pk_add_f32 v[140:141], v[140:141], v[156:157]
    v_pk_add_f32 v[142:143], v[142:143], v[158:159]
    v_pk_add_f32 v[132:133], v[132:133], v[140:141]
    v_pk_add_f32 v[134:135], v[134:135], v[142:143]
    v_pk_add_f32 v[132:133], v[132:133], v[134:135]
    v_add_f32 v132, v132, v133
    v_mov_b32 v133, v132
    s_nop 1
    v_permlane32_swap_b32 v132, v133
    v_mul_f32 v132, 0xbb000000, v132
    v_mul_f32 v133, 0x3b000000, v133
    v_fma_f32 v133, -v132, v132, v133
    v_max_f32 v133, 0, v133
    v_cvt_pk_bf16_f32 v134, v132, v132
    v_and_b32 v134, 0xffff0000, v134
    v_sub_f32 v135, v132, v134
    v_cvt_pk_bf16_f32 v12, v134, v135
    v_mov_b32 v13, v12
    s_nop 1
    v_mfma_f32_32x32x8_bf16 v[64:79], v[10:11], v[12:13], v[64:79]
    s_waitcnt vmcnt(16)
    v_subrev_u32 v9, s69, v9
    v_subrev_u32 v9, 3, v9
    v_cmp_lt_u32 vcc, 7, v9
    v_add_f32 v134, 0x3727c5ac, v133
    v_mov_b32 v140, 0x2edbe6ff
    v_rsq_f32 v56, v134
    v_fmac_f32 v140, 0x3f800054, v133
    v_mul_f32 v57, v132, v56
    v_rsq_f32 v141, v140
    s_nop 0
    v_mul_f32 v60, v140, v141
    v_mul_f32 v59, 0xc0135761, v141
    v_mul_f32 v58, v141, v141
    v_mul_f32 v141, 0xbdd2d3e8, v141
    v_mul_f32 v58, v58, v141
    v_mov_b32 v61, v60
    s_cbranch_vccnz OOL_171
RET_172:
    s_waitcnt lgkmcnt(1)
    v_dot2c_f32_bf16 v64, s65, v96
    v_dot2c_f32_bf16 v65, s66, v96
    v_dot2c_f32_bf16 v66, s65, v97
    v_dot2c_f32_bf16 v67, s66, v97
    v_dot2c_f32_bf16 v68, s65, v98
    v_dot2c_f32_bf16 v69, s66, v98
    v_dot2c_f32_bf16 v70, s65, v99
    v_dot2c_f32_bf16 v71, s66, v99
    s_waitcnt lgkmcnt(0)
    v_dot2c_f32_bf16 v72, s65, v100
    v_dot2c_f32_bf16 v73, s66, v100
    v_dot2c_f32_bf16 v74, s65, v101
    v_dot2c_f32_bf16 v75, s66, v101
    v_dot2c_f32_bf16 v76, s65, v102
    v_dot2c_f32_bf16 v77, s66, v102
    v_dot2c_f32_bf16 v78, s65, v103
    v_dot2c_f32_bf16 v79, s66, v103
    v_pk_mul_f32 v[80:81], v[64:65], v[64:65]
    v_pk_mul_f32 v[82:83], v[66:67], v[66:67]
    v_pk_mul_f32 v[84:85], v[68:69], v[68:69]
    v_pk_mul_f32 v[86:87], v[70:71], v[70:71]
    v_pk_fma_f32 v[80:81], v[80:81], v[58:59], v[58:59] op_sel:[0,0,1] op_sel_hi:[1,0,1]
    v_pk_fma_f32 v[82:83], v[82:83], v[58:59], v[58:59] op_sel:[0,0,1] op_sel_hi:[1,0,1]
    v_pk_fma_f32 v[84:85], v[84:85], v[58:59], v[58:59] op_sel:[0,0,1] op_sel_hi:[1,0,1]
    v_pk_fma_f32 v[86:87], v[86:87], v[58:59], v[58:59] op_sel:[0,0,1] op_sel_hi:[1,0,1]
    v_pk_mul_f32 v[80:81], v[80:81], v[64:65]
    v_pk_mul_f32 v[82:83], v[82:83], v[66:67]
    v_pk_mul_f32 v[84:85], v[84:85], v[68:69]
    v_pk_mul_f32 v[86:87], v[86:87], v[70:71]
    v_exp_f32 v80, v80
    v_exp_f32 v81, v81
    v_exp_f32 v82, v82
    v_exp_f32 v83, v83
    v_exp_f32 v84, v84
    v_exp_f32 v85, v85
    v_exp_f32 v86, v86
    v_exp_f32 v87, v87
    v_pk_fma_f32 v[80:81], v[80:81], v[60:61], v[60:61]
    v_pk_fma_f32 v[82:83], v[82:83], v[60:61], v[60:61]
    v_pk_fma_f32 v[84:85], v[84:85], v[60:61], v[60:61]
    v_pk_fma_f32 v[86:87], v[86:87], v[60:61], v[60:61]
    v_rcp_f32 v80, v80
    v_rcp_f32 v81, v81
    v_rcp_f32 v82, v82
    v_rcp_f32 v83, v83
    v_rcp_f32 v84, v84
    v_rcp_f32 v85, v85
    v_rcp_f32 v86, v86
    v_rcp_f32 v87, v87
    v_pk_mul_f32 v[64:65], v[64:65], v[80:81]
    v_pk_mul_f32 v[66:67], v[66:67], v[82:83]
    v_pk_mul_f32 v[68:69], v[68:69], v[84:85]
    v_pk_mul_f32 v[70:71], v[70:71], v[86:87]
    v_pk_mul_f32 v[80:81], v[72:73], v[72:73]
    v_pk_mul_f32 v[82:83], v[74:75], v[74:75]
    v_pk_mul_f32 v[84:85], v[76:77], v[76:77]
    v_pk_mul_f32 v[86:87], v[78:79], v[78:79]
    v_pk_fma_f32 v[80:81], v[80:81], v[58:59], v[58:59] op_sel:[0,0,1] op_sel_hi:[1,0,1]
    v_pk_fma_f32 v[82:83], v[82:83], v[58:59], v[58:59] op_sel:[0,0,1] op_sel_hi:[1,0,1]
    v_pk_fma_f32 v[84:85], v[84:85], v[58:59], v[58:59] op_sel:[0,0,1] op_sel_hi:[1,0,1]
    v_pk_fma_f32 v[86:87], v[86:87], v[58:59], v[58:59] op_sel:[0,0,1] op_sel_hi:[1,0,1]
    v_pk_mul_f32 v[80:81], v[80:81], v[72:73]
    v_pk_mul_f32 v[82:83], v[82:83], v[74:75]
    v_pk_mul_f32 v[84:85], v[84:85], v[76:77]
    v_pk_mul_f32 v[86:87], v[86:87], v[78:79]
    v_exp_f32 v80, v80
    v_exp_f32 v81, v81
    v_exp_f32 v82, v82
    v_exp_f32 v83, v83
    v_exp_f32 v84, v84
    v_exp_f32 v85, v85
    v_exp_f32 v86, v86
    v_exp_f32 v87, v87
    v_pk_fma_f32 v[80:81], v[80:81], v[60:61], v[60:61]
    v_pk_fma_f32 v[82:83], v[82:83], v[60:61], v[60:61]
    v_pk_fma_f32 v[84:85], v[84:85], v[60:61], v[60:61]
    v_pk_fma_f32 v[86:87], v[86:87], v[60:61], v[60:61]
    v_rcp_f32 v80, v80
    v_rcp_f32 v81, v81
    v_rcp_f32 v82, v82
    v_rcp_f32 v83, v83
    v_rcp_f32 v84, v84
    v_rcp_f32 v85, v85
    v_rcp_f32 v86, v86
    v_rcp_f32 v87, v87
    v_pk_mul_f32 v[72:73], v[72:73], v[80:81]
    v_pk_mul_f32 v[74:75], v[74:75], v[82:83]
    v_pk_mul_f32 v[76:77], v[76:77], v[84:85]
    v_pk_mul_f32 v[78:79], v[78:79], v[86:87]
    v_cvt_pk_bf16_f32 v112, v64, v65
    v_cvt_pk_bf16_f32 v113, v66, v67
    v_cvt_pk_bf16_f32 v114, v68, v69
    v_cvt_pk_bf16_f32 v115, v70, v71
    v_cvt_pk_bf16_f32 v116, v72, v73
    v_cvt_pk_bf16_f32 v117, v74, v75
    v_cvt_pk_bf16_f32 v118, v76, v77
    v_cvt_pk_bf16_f32 v119, v78, v79
    v_or_b32 v115, 1, v115
    v_or_b32 v119, 1, v119
    buffer_store_dwordx4 v[112:115], v3, s[8:11], s54 offen offset:0
    buffer_store_dwordx4 v[116:119], v3, s[8:11], s54 offen offset:1024
    buffer_store_dwordx4 v[112:115], v4, s[8:11], s68 offen offset:128 sc1
    buffer_store_dwordx4 v[116:119], v4, s[8:11], s68 offen offset:1152 sc1
    s_cmp_eq_u32 s64, 2
    s_cbranch_scc1 OOL_174
RET_175:
    v_pk_fma_f32 v[64:65], v[32:33], v[56:57], v[56:57] op_sel:[0,0,1] op_sel_hi:[1,0,1]
    v_pk_fma_f32 v[66:67], v[34:35], v[56:57], v[56:57] op_sel:[0,0,1] op_sel_hi:[1,0,1]
    v_pk_fma_f32 v[68:69], v[36:37], v[56:57], v[56:57] op_sel:[0,0,1] op_sel_hi:[1,0,1]
    v_pk_fma_f32 v[70:71], v[38:39], v[56:57], v[56:57] op_sel:[0,0,1] op_sel_hi:[1,0,1]
    v_pk_fma_f32 v[72:73], v[40:41], v[56:57], v[56:57] op_sel:[0,0,1] op_sel_hi:[1,0,1]
    v_pk_fma_f32 v[74:75], v[42:43], v[56:57], v[56:57] op_sel:[0,0,1] op_sel_hi:[1,0,1]
    v_pk_fma_f32 v[76:77], v[44:45], v[56:57], v[56:57] op_sel:[0,0,1] op_sel_hi:[1,0,1]
    v_pk_fma_f32 v[78:79], v[46:47], v[56:57], v[56:57] op_sel:[0,0,1] op_sel_hi:[1,0,1]
    s_add_u32 s79, s51, 0x8000
    buffer_load_dwordx4 v[132:135], v1, s[8:11], s79 offen offset:0 sc1
    buffer_load_dwordx4 v[140:143], v1, s[8:11], s79 offen offset:1024 sc1
    buffer_load_dwordx4 v[148:151], v1, s[8:11], s79 offen offset:2048 sc1
    buffer_load_dwordx4 v[156:159], v1, s[8:11], s79 offen offset:3072 sc1
    s_add_u32 s79, s51, 0x9000
    buffer_load_dwordx4 v[164:167], v1, s[8:11], s79 offen offset:0 sc1
    buffer_load_dwordx4 v[172:175], v1, s[8:11], s79 offen offset:1024 sc1
    buffer_load_dwordx4 v[180:183], v1, s[8:11], s79 offen offset:2048 sc1
    buffer_load_dwordx4 v[188:191], v1, s[8:11], s79 offen offset:3072 sc1
    s_waitcnt vmcnt(6)
    v_bitop3_b32 v7, v135, v143, 1 bitop3:0x2a
    v_cmp_ne_u32 vcc, 0, v7
    s_cbranch_vccnz OOL_177
RET_178:
    v_mfma_f32_32x32x16_bf16 v[112:127], v[196:199], v[132:135], 0
    s_add_u32 s80, s50, 0x8000
    buffer_load_dwordx4 v[128:131], v5, s[8:11], s80 offen offset:0 sc1
    v_mfma_f32_32x32x16_bf16 v[80:95], v[192:195], v[132:135], 0
    v_mfma_f32_32x32x16_bf16 v[112:127], v[204:207], v[140:143], v[112:127]
    buffer_load_dwordx4 v[136:139], v5, s[8:11], s80 offen offset:1024 sc1
    s_waitcnt vmcnt(6)
    v_bitop3_b32 v7, v151, v159, 1 bitop3:0x2a
    v_cmp_ne_u32 vcc, 0, v7
    v_mfma_f32_32x32x16_bf16 v[80:95], v[200:203], v[140:143], v[80:95]
    s_cbranch_vccnz OOL_180
RET_181:
    v_mfma_f32_32x32x16_bf16 v[112:127], v[212:215], v[148:151], v[112:127]
    buffer_load_dwordx4 v[144:147], v5, s[8:11], s80 offen offset:2048 sc1
    v_mfma_f32_32x32x16_bf16 v[80:95], v[208:211], v[148:151], v[80:95]
    v_mfma_f32_32x32x16_bf16 v[112:127], v[220:223], v[156:159], v[112:127]
    buffer_load_dwordx4 v[152:155], v5, s[8:11], s80 offen offset:3072 sc1
    s_waitcnt vmcnt(6)
    v_bitop3_b32 v7, v167, v175, 1 bitop3:0x2a
    v_cmp_ne_u32 vcc, 0, v7
    v_mfma_f32_32x32x16_bf16 v[80:95], v[216:219], v[156:159], v[80:95]
    s_cbranch_vccnz OOL_183
RET_184:
    v_mfma_f32_32x32x16_bf16 v[112:127], v[228:231], v[164:167], v[112:127]
    s_add_u32 s80, s50, 0x9000
    buffer_load_dwordx4 v[160:163], v5, s[8:11], s80 offen offset:0 sc1
    v_mfma_f32_32x32x16_bf16 v[80:95], v[224:227], v[164:167], v[80:95]
    v_mfma_f32_32x32x16_bf16 v[112:127], v[236:239], v[172:175], v[112:127]
    buffer_load_dwordx4 v[168:171], v5, s[8:11], s80 offen offset:1024 sc1
    s_waitcnt vmcnt(6)
    v_bitop3_b32 v7, v183, v191, 1 bitop3:0x2a
    v_cmp_ne_u32 vcc, 0, v7
    v_mfma_f32_32x32x16_bf16 v[80:95], v[232:235], v[172:175], v[80:95]
    s_cbranch_vccnz OOL_186
RET_187:
    v_mfma_f32_32x32x16_bf16 v[112:127], v[244:247], v[180:183], v[112:127]
    buffer_load_dwordx4 v[176:179], v5, s[8:11], s80 offen offset:2048 sc1
    v_mfma_f32_32x32x16_bf16 v[80:95], v[240:243], v[180:183], v[80:95]
    v_mfma_f32_32x32x16_bf16 v[112:127], v[252:255], v[188:191], v[112:127]
    buffer_load_dwordx4 v[184:187], v5, s[8:11], s80 offen offset:3072 sc1
    s_waitcnt vmcnt(4)
    v_bitop3_b32 v7, v131, v139, v147 bitop3:0x80
    v_bitop3_b32 v7, v7, v155, 1 bitop3:0x2a
    v_cmp_ne_u32 vcc, 0, v7
    v_mfma_f32_32x32x16_bf16 v[80:95], v[248:251], v[188:191], v[80:95]
    s_cbranch_vccnz OOL_189
RET_190:
    v_mfma_f32_32x32x16_bf16 v[96:111], v[196:199], v[128:131], 0
    v_mfma_f32_32x32x16_bf16 v[96:111], v[204:207], v[136:139], v[96:111]
    v_xor_b32 v19, 6144, v2
    s_nop 1
    v_cvt_pk_bf16_f32 v112, v112, v113
    v_cvt_pk_bf16_f32 v113, v114, v115
    v_cvt_pk_bf16_f32 v114, v116, v117
    v_cvt_pk_bf16_f32 v115, v118, v119
    v_mfma_f32_32x32x16_bf16 v[96:111], v[212:215], v[144:147], v[96:111]
    ds_write_b128 v19, v[112:115] offset:16384
    v_cvt_pk_bf16_f32 v116, v120, v121
    v_cvt_pk_bf16_f32 v117, v122, v123
    v_cvt_pk_bf16_f32 v118, v124, v125
    v_mfma_f32_32x32x16_bf16 v[96:111], v[220:223], v[152:155], v[96:111]
    s_waitcnt vmcnt(2)
    v_bitop3_b32 v7, v163, v171, 1 bitop3:0x2a
    v_cmp_ne_u32 vcc, 0, v7
    v_cvt_pk_bf16_f32 v119, v126, v127
    v_xor_b32 v17, 2048, v2
    v_cvt_pk_bf16_f32 v80, v80, v81
    v_cvt_pk_bf16_f32 v81, v82, v83
    v_mfma_f32_32x32x16_bf16 v[64:79], v[192:195], v[128:131], v[64:79]
    s_cbranch_vccnz OOL_192
RET_193:
    v_cvt_pk_bf16_f32 v82, v84, v85
    v_cvt_pk_bf16_f32 v83, v86, v87
    v_cvt_pk_bf16_f32 v84, v88, v89
    v_mfma_f32_32x32x16_bf16 v[96:111], v[228:231], v[160:163], v[96:111]
    ds_write_b128 v19, v[116:119] offset:17408
    v_cvt_pk_bf16_f32 v85, v90, v91
    v_cvt_pk_bf16_f32 v86, v92, v93
    v_cvt_pk_bf16_f32 v87, v94, v95
    v_mfma_f32_32x32x16_bf16 v[64:79], v[200:203], v[136:139], v[64:79]
    ds_write_b128 v17, v[80:83] offset:0
    v_mfma_f32_32x32x16_bf16 v[96:111], v[236:239], v[168:171], v[96:111]
    ds_write_b128 v17, v[84:87] offset:1024
    s_waitcnt vmcnt(0)
    v_bitop3_b32 v7, v179, v187, 1 bitop3:0x2a
    v_cmp_ne_u32 vcc, 0, v7
    v_mfma_f32_32x32x16_bf16 v[64:79], v[208:211], v[144:147], v[64:79]
    s_cbranch_vccnz OOL_195
RET_196:
    v_mfma_f32_32x32x16_bf16 v[96:111], v[244:247], v[176:179], v[96:111]
    v_mfma_f32_32x32x16_bf16 v[64:79], v[216:219], v[152:155], v[64:79]
    v_add_u32 v16, 161792, v1
    s_waitcnt lgkmcnt(0)
    s_barrier
    ds_read_b128 v[120:123], v16 offset:0
    ds_read_b128 v[124:127], v16 offset:1024
    ds_read_b128 v[80:83], v2 offset:0
    ds_read_b128 v[84:87], v2 offset:1024
    ds_read_b128 v[112:115], v2 offset:16384
    ds_read_b128 v[116:119], v2 offset:17408
    v_mfma_f32_32x32x16_bf16 v[96:111], v[252:255], v[184:187], v[96:111]
    v_mfma_f32_32x32x16_bf16 v[64:79], v[224:227], v[160:163], v[64:79]
    v_mfma_f32_32x32x16_bf16 v[64:79], v[232:235], v[168:171], v[64:79]
    v_xor_b32 v18, 4096, v2
    s_nop 8
    v_cvt_pk_bf16_f32 v96, v96, v97
    v_cvt_pk_bf16_f32 v97, v98, v99
    v_cvt_pk_bf16_f32 v98, v100, v101
    v_cvt_pk_bf16_f32 v99, v102, v103
    v_mfma_f32_32x32x16_bf16 v[64:79], v[240:243], v[176:179], v[64:79]
    ds_write_b128 v18, v[96:99] offset:8192
    v_cvt_pk_bf16_f32 v100, v104, v105
    v_cvt_pk_bf16_f32 v101, v106, v107
    v_cvt_pk_bf16_f32 v102, v108, v109
    v_mfma_f32_32x32x16_bf16 v[64:79], v[248:251], v[184:187], v[64:79]
    v_cvt_pk_bf16_f32 v103, v110, v111
    s_waitcnt lgkmcnt(4)
    v_mfma_f32_32x32x16_bf16 v[64:79], v[120:123], v[80:83], v[64:79]
    ds_write_b128 v18, v[100:103] offset:9216
    s_waitcnt lgkmcnt(4)
    v_mfma_f32_32x32x16_bf16 v[64:79], v[124:127], v[84:87], v[64:79]
    s_waitcnt lgkmcnt(0)
    s_barrier
    ds_read_b128 v[96:99], v2 offset:8192
    ds_read_b128 v[100:103], v2 offset:9216
    v_mfma_f32_32x32x16_bf16 v[64:79], v[120:123], v[112:115], v[64:79]
    v_mfma_f32_32x32x16_bf16 v[64:79], v[124:127], v[116:119], v[64:79]
    s_waitcnt lgkmcnt(1)
    s_nop 10
    v_dot2c_f32_bf16 v64, s65, v96
    v_dot2c_f32_bf16 v65, s66, v96
    v_dot2c_f32_bf16 v66, s65, v97
    v_dot2c_f32_bf16 v67, s66, v97
    v_dot2c_f32_bf16 v68, s65, v98
    v_dot2c_f32_bf16 v69, s66, v98
    v_dot2c_f32_bf16 v70, s65, v99
    v_dot2c_f32_bf16 v71, s66, v99
    s_waitcnt lgkmcnt(0)
    v_dot2c_f32_bf16 v72, s65, v100
    v_dot2c_f32_bf16 v73, s66, v100
    v_dot2c_f32_bf16 v74, s65, v101
    v_dot2c_f32_bf16 v75, s66, v101
    v_dot2c_f32_bf16 v76, s65, v102
    v_dot2c_f32_bf16 v77, s66, v102
    v_dot2c_f32_bf16 v78, s65, v103
    v_dot2c_f32_bf16 v79, s66, v103
    v_cvt_pk_bf16_f32 v112, v64, v65
    v_cvt_pk_bf16_f32 v113, v66, v67
    v_cvt_pk_bf16_f32 v114, v68, v69
    v_cvt_pk_bf16_f32 v115, v70, v71
    v_cvt_pk_bf16_f32 v116, v72, v73
    v_cvt_pk_bf16_f32 v117, v74, v75
    v_cvt_pk_bf16_f32 v118, v76, v77
    v_cvt_pk_bf16_f32 v119, v78, v79
    v_or_b32 v115, 1, v115
    v_or_b32 v119, 1, v119
    buffer_store_dwordx4 v[112:115], v1, s[8:11], s47 offen offset:0
    buffer_store_dwordx4 v[116:119], v1, s[8:11], s47 offen offset:1024
    v_pk_add_f32 v[120:121], v[64:65], v[66:67]
    v_pk_mul_f32 v[122:123], v[64:65], v[64:65]
    v_pk_fma_f32 v[122:123], v[66:67], v[66:67], v[122:123]
    v_pk_add_f32 v[120:121], v[120:121], v[68:69]
    v_pk_fma_f32 v[122:123], v[68:69], v[68:69], v[122:123]
    v_pk_add_f32 v[120:121], v[120:121], v[70:71]
    v_pk_fma_f32 v[122:123], v[70:71], v[70:71], v[122:123]
    v_pk_add_f32 v[120:121], v[120:121], v[72:73]
    v_pk_fma_f32 v[122:123], v[72:73], v[72:73], v[122:123]
    v_pk_add_f32 v[120:121], v[120:121], v[74:75]
    v_pk_fma_f32 v[122:123], v[74:75], v[74:75], v[122:123]
    v_pk_add_f32 v[120:121], v[120:121], v[76:77]
    v_pk_fma_f32 v[122:123], v[76:77], v[76:77], v[122:123]
    v_pk_add_f32 v[120:121], v[120:121], v[78:79]
    v_pk_fma_f32 v[122:123], v[78:79], v[78:79], v[122:123]
    v_add_f32 v120, v120, v121
    v_add_f32 v122, v122, v123
    s_nop 1
    v_permlane32_swap_b32 v120, v122
    v_add_f32 v120, v120, v122
    v_and_b32 v120, -2, v120
    buffer_store_dword v120, v1, s[8:11], s48 offen
    v_pk_add_f32 v[32:33], v[32:33], v[64:65]
    v_pk_add_f32 v[34:35], v[34:35], v[66:67]
    v_pk_add_f32 v[36:37], v[36:37], v[68:69]
    v_pk_add_f32 v[38:39], v[38:39], v[70:71]
    v_pk_add_f32 v[40:41], v[40:41], v[72:73]
    v_pk_add_f32 v[42:43], v[42:43], v[74:75]
    v_pk_add_f32 v[44:45], v[44:45], v[76:77]
    v_pk_add_f32 v[46:47], v[46:47], v[78:79]
    v_add_u32 v29, 65536, v15
    buffer_load_dwordx4 v[128:131], v1, s[8:11], s59 offen offset:0 sc1
    buffer_load_dwordx4 v[132:135], v1, s[8:11], s59 offen offset:1024 sc1
    buffer_load_dwordx4 v[136:139], v1, s[8:11], s59 offen offset:2048 sc1
    buffer_load_dwordx4 v[140:143], v1, s[8:11], s59 offen offset:3072 sc1
    s_add_u32 s79, s59, 0x1000
    buffer_load_dwordx4 v[144:147], v1, s[8:11], s79 offen offset:0 sc1
    buffer_load_dwordx4 v[148:151], v1, s[8:11], s79 offen offset:1024 sc1
    buffer_load_dwordx4 v[152:155], v1, s[8:11], s79 offen offset:2048 sc1
    buffer_load_dwordx4 v[156:159], v1, s[8:11], s79 offen offset:3072 sc1
    s_add_u32 s79, s59, 0x2000
    buffer_load_dwordx4 v[160:163], v1, s[8:11], s79 offen offset:0 sc1
    buffer_load_dwordx4 v[164:167], v1, s[8:11], s79 offen offset:1024 sc1
    buffer_load_dwordx4 v[168:171], v1, s[8:11], s79 offen offset:2048 sc1
    buffer_load_dwordx4 v[172:175], v1, s[8:11], s79 offen offset:3072 sc1
    ds_read_b64_tr_b16 a[232:233], v15 offset:0
    ds_read_b64_tr_b16 a[234:235], v15 offset:1024
    ds_read_b64_tr_b16 a[236:237], v15 offset:512
    ds_read_b64_tr_b16 a[238:239], v15 offset:1536
    ds_read_b64_tr_b16 a[240:241], v15 offset:2048
    ds_read_b64_tr_b16 a[242:243], v15 offset:3072
    ds_read_b64_tr_b16 a[244:245], v15 offset:2560
    ds_read_b64_tr_b16 a[246:247], v15 offset:3584
    ds_read_b64_tr_b16 a[248:249], v15 offset:4096
    ds_read_b64_tr_b16 a[250:251], v15 offset:5120
    s_add_u32 s77, s59, 0xc000
    v_and_b32 v52, 4, v0
    v_lshl_add_u32 v52, v52, 8, v1
    s_waitcnt vmcnt(10)
    v_bitop3_b32 v7, v131, v135, 1 bitop3:0x2a
    v_cmp_ne_u32 vcc, 0, v7
    s_cbranch_vccnz OOL_198
RET_199:
    s_waitcnt lgkmcnt(8)
    v_mfma_f32_32x32x16_bf16 v[64:79], a[232:235], v[128:131], 0
    s_waitcnt lgkmcnt(4)
    ds_read_b64_tr_b16 a[252:253], v15 offset:4608
    ds_read_b64_tr_b16 a[254:255], v15 offset:5632
    s_add_u32 s79, s59, 0x3000
    buffer_load_dwordx4 v[176:179], v1, s[8:11], s79 offen offset:0 sc1
    v_mfma_f32_32x32x16_bf16 v[80:95], a[236:239], v[128:131], 0
    ds_read_b64_tr_b16 a[232:233], v15 offset:6144
    ds_read_b64_tr_b16 a[234:235], v15 offset:7168
    v_mfma_f32_32x32x16_bf16 v[64:79], a[240:243], v[132:135], v[64:79]
    s_waitcnt lgkmcnt(4)
    ds_read_b64_tr_b16 a[236:237], v15 offset:6656
    ds_read_b64_tr_b16 a[238:239], v15 offset:7680
    buffer_load_dwordx4 v[180:183], v1, s[8:11], s79 offen offset:1024 sc1
    s_waitcnt vmcnt(10)
    v_bitop3_b32 v7, v139, v143, 1 bitop3:0x2a
    v_cmp_ne_u32 vcc, 0, v7
    v_mfma_f32_32x32x16_bf16 v[80:95], a[244:247], v[132:135], v[80:95]
    s_cbranch_vccnz OOL_201
RET_202:
    ds_read_b64_tr_b16 a[240:241], v15 offset:8192
    ds_read_b64_tr_b16 a[242:243], v15 offset:9216
    v_mfma_f32_32x32x16_bf16 v[64:79], a[248:251], v[136:139], v[64:79]
    s_waitcnt lgkmcnt(4)
    ds_read_b64_tr_b16 a[244:245], v15 offset:8704
    ds_read_b64_tr_b16 a[246:247], v15 offset:9728
    buffer_load_dwordx4 v[184:187], v1, s[8:11], s79 offen offset:2048 sc1
    v_mfma_f32_32x32x16_bf16 v[80:95], a[252:255], v[136:139], v[80:95]
    ds_read_b64_tr_b16 a[248:249], v15 offset:10240
    ds_read_b64_tr_b16 a[250:251], v15 offset:11264
    v_mfma_f32_32x32x16_bf16 v[64:79], a[232:235], v[140:143], v[64:79]
    s_waitcnt lgkmcnt(4)
    ds_read_b64_tr_b16 a[252:253], v15 offset:10752
    ds_read_b64_tr_b16 a[254:255], v15 offset:11776
    buffer_load_dwordx4 v[188:191], v1, s[8:11], s79 offen offset:3072 sc1
    s_waitcnt vmcnt(8)
    v_bitop3_b32 v7, v147, v151, v155 bitop3:0x80
    v_bitop3_b32 v7, v7, v159, 1 bitop3:0x2a
    v_cmp_ne_u32 vcc, 0, v7
    v_mfma_f32_32x32x16_bf16 v[80:95], a[236:239], v[140:143], v[80:95]
    s_cbranch_vccnz OOL_204
RET_205:
    ds_read_b64_tr_b16 a[232:233], v15 offset:12288
    ds_read_b64_tr_b16 a[234:235], v15 offset:13312
    v_mfma_f32_32x32x16_bf16 v[64:79], a[240:243], v[144:147], v[64:79]
    s_waitcnt lgkmcnt(4)
    ds_read_b64_tr_b16 a[236:237], v15 offset:12800
    ds_read_b64_tr_b16 a[238:239], v15 offset:13824
    s_add_u32 s79, s59, 0x4000
    buffer_load_dwordx4 v[192:195], v1, s[8:11], s79 offen offset:0 sc1
    v_mfma_f32_32x32x16_bf16 v[80:95], a[244:247], v[144:147], v[80:95]
    ds_read_b64_tr_b16 a[240:241], v15 offset:14336
    ds_read_b64_tr_b16 a[242:243], v15 offset:15360
    v_mfma_f32_32x32x16_bf16 v[64:79], a[248:251], v[148:151], v[64:79]
    s_waitcnt lgkmcnt(4)
    ds_read_b64_tr_b16 a[244:245], v15 offset:14848
    ds_read_b64_tr_b16 a[246:247], v15 offset:15872
    buffer_load_dwordx4 v[196:199], v1, s[8:11], s79 offen offset:1024 sc1
    v_mfma_f32_32x32x16_bf16 v[80:95], a[252:255], v[148:151], v[80:95]
    ds_read_b64_tr_b16 a[248:249], v15 offset:16384
    ds_read_b64_tr_b16 a[250:251], v15 offset:17408
    v_mfma_f32_32x32x16_bf16 v[64:79], a[232:235], v[152:155], v[64:79]
    s_waitcnt lgkmcnt(4)
    ds_read_b64_tr_b16 a[252:253], v15 offset:16896
    ds_read_b64_tr_b16 a[254:255], v15 offset:17920
    buffer_load_dwordx4 v[200:203], v1, s[8:11], s79 offen offset:2048 sc1
    v_mfma_f32_32x32x16_bf16 v[80:95], a[236:239], v[152:155], v[80:95]
    ds_read_b64_tr_b16 a[232:233], v15 offset:18432
    ds_read_b64_tr_b16 a[234:235], v15 offset:19456
    v_mfma_f32_32x32x16_bf16 v[64:79], a[240:243], v[156:159], v[64:79]
    s_waitcnt lgkmcnt(4)
    ds_read_b64_tr_b16 a[236:237], v15 offset:18944
    ds_read_b64_tr_b16 a[238:239], v15 offset:19968
    buffer_load_dwordx4 v[204:207], v1, s[8:11], s79 offen offset:3072 sc1
    s_waitcnt vmcnt(8)
    v_bitop3_b32 v7, v163, v167, v171 bitop3:0x80
    v_bitop3_b32 v7, v7, v175, 1 bitop3:0x2a
    v_cmp_ne_u32 vcc, 0, v7
    v_mfma_f32_32x32x16_bf16 v[80:95], a[244:247], v[156:159], v[80:95]
    s_cbranch_vccnz OOL_207
RET_208:
    ds_read_b64_tr_b16 a[240:241], v15 offset:20480
    ds_read_b64_tr_b16 a[242:243], v15 offset:21504
    v_mfma_f32_32x32x16_bf16 v[64:79], a[248:251], v[160:163], v[64:79]
    s_waitcnt lgkmcnt(4)
    ds_read_b64_tr_b16 a[244:245], v15 offset:20992
    ds_read_b64_tr_b16 a[246:247], v15 offset:22016
    s_add_u32 s79, s59, 0x5000
    buffer_load_dwordx4 v[208:211], v1, s[8:11], s79 offen offset:0 sc1
    v_mfma_f32_32x32x16_bf16 v[80:95], a[252:255], v[160:163], v[80:95]
    ds_read_b64_tr_b16 a[248:249], v15 offset:22528
    ds_read_b64_tr_b16 a[250:251], v15 offset:23552
    v_mfma_f32_32x32x16_bf16 v[64:79], a[232:235], v[164:167], v[64:79]
    s_waitcnt lgkmcnt(4)
    ds_read_b64_tr_b16 a[252:253], v15 offset:23040
    ds_read_b64_tr_b16 a[254:255], v15 offset:24064
    buffer_load_dwordx4 v[212:215], v1, s[8:11], s79 offen offset:1024 sc1
    v_mfma_f32_32x32x16_bf16 v[80:95], a[236:239], v[164:167], v[80:95]
    ds_read_b64_tr_b16 a[232:233], v15 offset:24576
    ds_read_b64_tr_b16 a[234:235], v15 offset:25600
    v_mfma_f32_32x32x16_bf16 v[64:79], a[240:243], v[168:171], v[64:79]
    s_waitcnt lgkmcnt(4)
    ds_read_b64_tr_b16 a[236:237], v15 offset:25088
    ds_read_b64_tr_b16 a[238:239], v15 offset:26112
    buffer_load_dwordx4 v[216:219], v1, s[8:11], s79 offen offset:2048 sc1
    v_mfma_f32_32x32x16_bf16 v[80:95], a[244:247], v[168:171], v[80:95]
    ds_read_b64_tr_b16 a[240:241], v15 offset:26624
    ds_read_b64_tr_b16 a[242:243], v15 offset:27648
    v_mfma_f32_32x32x16_bf16 v[64:79], a[248:251], v[172:175], v[64:79]
    s_waitcnt lgkmcnt(4)
    ds_read_b64_tr_b16 a[244:245], v15 offset:27136
    ds_read_b64_tr_b16 a[246:247], v15 offset:28160
    buffer_load_dwordx4 v[220:223], v1, s[8:11], s79 offen offset:3072 sc1
    s_waitcnt vmcnt(8)
    v_bitop3_b32 v7, v179, v183, v187 bitop3:0x80
    v_bitop3_b32 v7, v7, v191, 1 bitop3:0x2a
    v_cmp_ne_u32 vcc, 0, v7
    v_mfma_f32_32x32x16_bf16 v[80:95], a[252:255], v[172:175], v[80:95]
    s_cbranch_vccnz OOL_210
RET_211:
    ds_read_b64_tr_b16 a[248:249], v15 offset:28672
    ds_read_b64_tr_b16 a[250:251], v15 offset:29696
    v_mfma_f32_32x32x16_bf16 v[64:79], a[232:235], v[176:179], v[64:79]
    s_waitcnt lgkmcnt(4)
    ds_read_b64_tr_b16 a[252:253], v15 offset:29184
    ds_read_b64_tr_b16 a[254:255], v15 offset:30208
    s_add_u32 s79, s59, 0x6000
    buffer_load_dwordx4 v[224:227], v1, s[8:11], s79 offen offset:0 sc1
    v_mfma_f32_32x32x16_bf16 v[80:95], a[236:239], v[176:179], v[80:95]
    ds_read_b64_tr_b16 a[232:233], v15 offset:30720
    ds_read_b64_tr_b16 a[234:235], v15 offset:31744
    v_mfma_f32_32x32x16_bf16 v[64:79], a[240:243], v[180:183], v[64:79]
    s_waitcnt lgkmcnt(4)
    ds_read_b64_tr_b16 a[236:237], v15 offset:31232
    ds_read_b64_tr_b16 a[238:239], v15 offset:32256
    buffer_load_dwordx4 v[228:231], v1, s[8:11], s79 offen offset:1024 sc1
    v_mfma_f32_32x32x16_bf16 v[80:95], a[244:247], v[180:183], v[80:95]
    ds_read_b64_tr_b16 a[240:241], v15 offset:32768
    ds_read_b64_tr_b16 a[242:243], v15 offset:33792
    v_mfma_f32_32x32x16_bf16 v[64:79], a[248:251], v[184:187], v[64:79]
    s_waitcnt lgkmcnt(4)
    ds_read_b64_tr_b16 a[244:245], v15 offset:33280
    ds_read_b64_tr_b16 a[246:247], v15 offset:34304
    buffer_load_dwordx4 v[232:235], v1, s[8:11], s79 offen offset:2048 sc1
    v_mfma_f32_32x32x16_bf16 v[80:95], a[252:255], v[184:187], v[80:95]
    ds_read_b64_tr_b16 a[248:249], v15 offset:34816
    ds_read_b64_tr_b16 a[250:251], v15 offset:35840
    v_mfma_f32_32x32x16_bf16 v[64:79], a[232:235], v[188:191], v[64:79]
    s_waitcnt lgkmcnt(4)
    ds_read_b64_tr_b16 a[252:253], v15 offset:35328
    ds_read_b64_tr_b16 a[254:255], v15 offset:36352
    buffer_load_dwordx4 v[236:239], v1, s[8:11], s79 offen offset:3072 sc1
    s_waitcnt vmcnt(8)
    v_bitop3_b32 v7, v195, v199, v203 bitop3:0x80
    v_bitop3_b32 v7, v7, v207, 1 bitop3:0x2a
    v_cmp_ne_u32 vcc, 0, v7
    v_mfma_f32_32x32x16_bf16 v[80:95], a[236:239], v[188:191], v[80:95]
    s_cbranch_vccnz OOL_213
RET_214:
    ds_read_b64_tr_b16 a[232:233], v15 offset:36864
    ds_read_b64_tr_b16 a[234:235], v15 offset:37888
    v_mfma_f32_32x32x16_bf16 v[64:79], a[240:243], v[192:195], v[64:79]
    s_waitcnt lgkmcnt(4)
    ds_read_b64_tr_b16 a[236:237], v15 offset:37376
    ds_read_b64_tr_b16 a[238:239], v15 offset:38400
    s_add_u32 s79, s59, 0x7000
    buffer_load_dwordx4 v[240:243], v1, s[8:11], s79 offen offset:0 sc1
    v_mfma_f32_32x32x16_bf16 v[80:95], a[244:247], v[192:195], v[80:95]
    ds_read_b64_tr_b16 a[240:241], v15 offset:38912
    ds_read_b64_tr_b16 a[242:243], v15 offset:39936
    v_mfma_f32_32x32x16_bf16 v[64:79], a[248:251], v[196:199], v[64:79]
    s_waitcnt lgkmcnt(4)
    ds_read_b64_tr_b16 a[244:245], v15 offset:39424
    ds_read_b64_tr_b16 a[246:247], v15 offset:40448
    buffer_load_dwordx4 v[244:247], v1, s[8:11], s79 offen offset:1024 sc1
    v_mfma_f32_32x32x16_bf16 v[80:95], a[252:255], v[196:199], v[80:95]
    ds_read_b64_tr_b16 a[248:249], v15 offset:40960
    ds_read_b64_tr_b16 a[250:251], v15 offset:41984
    v_mfma_f32_32x32x16_bf16 v[64:79], a[232:235], v[200:203], v[64:79]
    s_waitcnt lgkmcnt(4)
    ds_read_b64_tr_b16 a[252:253], v15 offset:41472
    ds_read_b64_tr_b16 a[254:255], v15 offset:42496
    buffer_load_dwordx4 v[248:251], v1, s[8:11], s79 offen offset:2048 sc1
    v_mfma_f32_32x32x16_bf16 v[80:95], a[236:239], v[200:203], v[80:95]
    ds_read_b64_tr_b16 a[232:233], v15 offset:43008
    ds_read_b64_tr_b16 a[234:235], v15 offset:44032
    v_mfma_f32_32x32x16_bf16 v[64:79], a[240:243], v[204:207], v[64:79]
    s_waitcnt lgkmcnt(4)
    ds_read_b64_tr_b16 a[236:237], v15 offset:43520
    ds_read_b64_tr_b16 a[238:239], v15 offset:44544
    buffer_load_dwordx4 v[252:255], v1, s[8:11], s79 offen offset:3072 sc1
    s_waitcnt vmcnt(8)
    v_bitop3_b32 v7, v211, v215, v219 bitop3:0x80
    v_bitop3_b32 v7, v7, v223, 1 bitop3:0x2a
    v_cmp_ne_u32 vcc, 0, v7
    v_mfma_f32_32x32x16_bf16 v[80:95], a[244:247], v[204:207], v[80:95]
    s_cbranch_vccnz OOL_216
RET_217:
    ds_read_b64_tr_b16 a[240:241], v15 offset:45056
    ds_read_b64_tr_b16 a[242:243], v15 offset:46080
    v_mfma_f32_32x32x16_bf16 v[64:79], a[248:251], v[208:211], v[64:79]
    s_waitcnt lgkmcnt(4)
    ds_read_b64_tr_b16 a[244:245], v15 offset:45568
    ds_read_b64_tr_b16 a[246:247], v15 offset:46592
    v_mfma_f32_32x32x16_bf16 v[80:95], a[252:255], v[208:211], v[80:95]
    ds_read_b64_tr_b16 a[248:249], v15 offset:47104
    ds_read_b64_tr_b16 a[250:251], v15 offset:48128
    buffer_load_dwordx4 v[112:115], v1, s[8:11], s77 offen offset:0 sc1
    buffer_load_dwordx4 v[116:119], v1, s[8:11], s77 offen offset:1024 sc1
    buffer_load_dwordx4 v[120:123], v1, s[8:11], s77 offen offset:2048 sc1
    buffer_load_dwordx4 v[124:127], v1, s[8:11], s77 offen offset:3072 sc1
    v_mfma_f32_32x32x16_bf16 v[64:79], a[232:235], v[212:215], v[64:79]
    s_waitcnt lgkmcnt(4)
    ds_read_b64_tr_b16 a[252:253], v15 offset:47616
    ds_read_b64_tr_b16 a[254:255], v15 offset:48640
    v_mfma_f32_32x32x16_bf16 v[80:95], a[236:239], v[212:215], v[80:95]
    ds_read_b64_tr_b16 a[232:233], v15 offset:49152
    ds_read_b64_tr_b16 a[234:235], v15 offset:50176
    v_mfma_f32_32x32x16_bf16 v[64:79], a[240:243], v[216:219], v[64:79]
    s_waitcnt lgkmcnt(4)
    ds_read_b64_tr_b16 a[236:237], v15 offset:49664
    ds_read_b64_tr_b16 a[238:239], v15 offset:50688
    v_mfma_f32_32x32x16_bf16 v[80:95], a[244:247], v[216:219], v[80:95]
    ds_read_b64_tr_b16 a[240:241], v15 offset:51200
    ds_read_b64_tr_b16 a[242:243], v15 offset:52224
    v_mfma_f32_32x32x16_bf16 v[64:79], a[248:251], v[220:223], v[64:79]
    s_waitcnt lgkmcnt(4)
    ds_read_b64_tr_b16 a[244:245], v15 offset:51712
    ds_read_b64_tr_b16 a[246:247], v15 offset:52736
    s_waitcnt vmcnt(8)
    v_bitop3_b32 v7, v227, v231, v235 bitop3:0x80
    v_bitop3_b32 v7, v7, v239, 1 bitop3:0x2a
    v_cmp_ne_u32 vcc, 0, v7
    v_mfma_f32_32x32x16_bf16 v[80:95], a[252:255], v[220:223], v[80:95]
    s_cbranch_vccnz OOL_219
RET_220:
    ds_read_b64_tr_b16 a[248:249], v15 offset:53248
    ds_read_b64_tr_b16 a[250:251], v15 offset:54272
    v_mfma_f32_32x32x16_bf16 v[64:79], a[232:235], v[224:227], v[64:79]
    s_waitcnt lgkmcnt(4)
    ds_read_b64_tr_b16 a[252:253], v15 offset:53760
    ds_read_b64_tr_b16 a[254:255], v15 offset:54784
    v_mfma_f32_32x32x16_bf16 v[80:95], a[236:239], v[224:227], v[80:95]
    ds_read_b64_tr_b16 a[232:233], v15 offset:55296
    ds_read_b64_tr_b16 a[234:235], v15 offset:56320
    v_mfma_f32_32x32x16_bf16 v[64:79], a[240:243], v[228:231], v[64:79]
    s_waitcnt lgkmcnt(4)
    ds_read_b64_tr_b16 a[236:237], v15 offset:55808
    ds_read_b64_tr_b16 a[238:239], v15 offset:56832
    v_mfma_f32_32x32x16_bf16 v[80:95], a[244:247], v[228:231], v[80:95]
    ds_read_b64_tr_b16 a[240:241], v15 offset:57344
    ds_read_b64_tr_b16 a[242:243], v15 offset:58368
    v_mfma_f32_32x32x16_bf16 v[64:79], a[248:251], v[232:235], v[64:79]
    s_waitcnt lgkmcnt(4)
    ds_read_b64_tr_b16 a[244:245], v15 offset:57856
    ds_read_b64_tr_b16 a[246:247], v15 offset:58880
    s_waitcnt vmcnt(0)
    v_bitop3_b32 v7, v112, v113, v114 bitop3:0xfe
    v_bitop3_b32 v7, v7, v115, v116 bitop3:0xfe
    v_bitop3_b32 v7, v7, v117, v118 bitop3:0xfe
    v_bitop3_b32 v7, v7, v119, v120 bitop3:0xfe
    v_bitop3_b32 v7, v7, v121, v122 bitop3:0xfe
    v_bitop3_b32 v7, v7, v123, v124 bitop3:0xfe
    v_bitop3_b32 v7, v7, v125, v126 bitop3:0xfe
    v_bitop3_b32 v7, v7, v127, 1 bitop3:0xa8
    v_cmp_ne_u32 vcc, 0, v7
    v_mfma_f32_32x32x16_bf16 v[80:95], a[252:255], v[232:235], v[80:95]
    s_cbranch_vccnz OOL_222
RET_223:
    ds_read_b64_tr_b16 a[248:249], v15 offset:59392
    ds_read_b64_tr_b16 a[250:251], v15 offset:60416
    v_add_f32 v112, v112, v120
    v_mfma_f32_32x32x16_bf16 v[64:79], a[232:235], v[236:239], v[64:79]
    s_waitcnt lgkmcnt(4)
    ds_read_b64_tr_b16 a[252:253], v15 offset:61440
    ds_read_b64_tr_b16 a[254:255], v15 offset:62464
    v_bitop3_b32 v7, v243, v247, v251 bitop3:0x80
    v_bitop3_b32 v7, v7, v255, 1 bitop3:0x2a
    v_cmp_ne_u32 vcc, 0, v7
    v_add_f32 v113, v113, v121
    v_mfma_f32_32x32x16_bf16 v[80:95], a[236:239], v[236:239], v[80:95]
    s_cbranch_vccnz OOL_225
RET_226:
    ds_read_b64_tr_b16 a[232:233], v15 offset:63488
    ds_read_b64_tr_b16 a[234:235], v15 offset:64512
    v_add_f32 v114, v114, v122
    v_mfma_f32_32x32x16_bf16 v[64:79], a[240:243], v[240:243], v[64:79]
    s_waitcnt lgkmcnt(4)
    ds_read_b64_tr_b16 a[236:237], v15 offset:59904
    ds_read_b64_tr_b16 a[238:239], v15 offset:60928
    v_add_f32 v115, v115, v123
    v_add_f32 v116, v116, v124
    v_add_f32 v117, v117, v125
    v_add_f32 v118, v118, v126
    v_mfma_f32_32x32x16_bf16 v[80:95], a[244:247], v[240:243], v[80:95]
    ds_read_b64_tr_b16 a[240:241], v15 offset:61952
    ds_read_b64_tr_b16 a[242:243], v15 offset:62976
    v_add_f32 v119, v119, v127
    v_add_f32 v112, v112, v116
    v_add_f32 v113, v113, v117
    v_add_f32 v114, v114, v118
    v_add_f32 v115, v115, v119
    v_mfma_f32_32x32x16_bf16 v[64:79], a[248:251], v[244:247], v[64:79]
    s_waitcnt lgkmcnt(4)
    ds_read_b64_tr_b16 a[244:245], v15 offset:64000
    ds_read_b64_tr_b16 a[246:247], v15 offset:65024
    v_add_f32 v112, v112, v114
    v_add_f32 v113, v113, v115
    v_add_f32 v112, v112, v113
    v_mov_b32 v113, v112
    v_mfma_f32_32x32x16_bf16 v[64:79], a[252:255], v[248:251], v[64:79]
    ds_read_b64_tr_b16 a[248:249], v29 offset:33280
    ds_read_b64_tr_b16 a[250:251], v29 offset:34304
    v_permlane32_swap_b32 v112, v113
    v_mul_f32 v112, 0xbb000000, v112
    v_mul_f32 v113, 0x3b000000, v113
    v_fma_f32 v113, -v112, v112, v113
    v_max_f32 v113, 0, v113
    v_mfma_f32_32x32x16_bf16 v[64:79], a[232:235], v[252:255], v[64:79]
    s_waitcnt lgkmcnt(4)
    ds_read_b64_tr_b16 a[252:253], v29 offset:32768
    ds_read_b64_tr_b16 a[254:255], v29 offset:33792
    v_cvt_pk_bf16_f32 v114, v112, v112
    v_and_b32 v114, 0xffff0000, v114
    v_sub_f32 v115, v112, v114
    v_cvt_pk_bf16_f32 v12, v114, v115
    v_mov_b32 v13, v12
    v_add_f32 v116, 0x3727c5ac, v113
    v_rsq_f32 v117, v116
    s_nop 0
    v_mul_f32 v60, v116, v117
    v_mul_f32 v59, 0xc0135761, v117
    v_mul_f32 v58, v117, v117
    v_mul_f32 v117, 0xbdd2d3e8, v117
    v_mul_f32 v58, v58, v117
    v_mov_b32 v61, v60
    v_mfma_f32_32x32x8_bf16 v[64:79], a[224:225], v[12:13], v[64:79]
    v_mov_b32 v30, s69
    v_add_u32 v30, 2, v30
    v_mfma_f32_32x32x16_bf16 v[80:95], a[236:239], v[244:247], v[80:95]
    ds_read_b64_tr_b16 a[232:233], v29 offset:35328
    ds_read_b64_tr_b16 a[234:235], v29 offset:36352
    s_mov_b64 exec, 1
    buffer_store_dword v30, off, s[8:11], s63
    s_mov_b64 exec, -1
    v_mfma_f32_32x32x16_bf16 v[80:95], a[240:243], v[248:251], v[80:95]
    s_waitcnt lgkmcnt(4)
    ds_read_b64_tr_b16 a[236:237], v29 offset:34816
    ds_read_b64_tr_b16 a[238:239], v29 offset:35840
    v_mul_f32 v16, v64, v64
    v_fma_f32 v16, v16, v58, v59
    v_mul_f32 v16, v16, v64
    v_mul_f32 v17, v65, v65
    v_fma_f32 v17, v17, v58, v59
    v_mfma_f32_32x32x16_bf16 v[80:95], a[244:247], v[252:255], v[80:95]
    ds_read_b64_tr_b16 a[240:241], v29 offset:37376
    ds_read_b64_tr_b16 a[242:243], v29 offset:38400
    v_exp_f32 v16, v16
    v_mul_f32 v17, v17, v65
    v_mul_f32 v18, v66, v66
    v_exp_f32 v17, v17
    v_mfma_f32_32x32x8_bf16 v[80:95], a[226:227], v[12:13], v[80:95]
    v_fma_f32 v16, v16, v60, v60
    v_fma_f32 v18, v18, v58, v59
    v_rcp_f32 v16, v16
    v_mul_f32 v18, v18, v66
    v_mul_f32 v19, v67, v67
    v_fma_f32 v17, v17, v60, v60
    v_mfma_f32_32x32x8_bf16 v[96:111], a[228:229], v[12:13], 0
    v_exp_f32 v18, v18
    v_fma_f32 v19, v19, v58, v59
    v_rcp_f32 v17, v17
    v_mul_f32 v64, v64, v16
    v_mul_f32 v19, v19, v67
    v_mfma_f32_32x32x8_bf16 v[112:127], a[230:231], v[12:13], 0
    v_mul_f32 v16, v68, v68
    v_exp_f32 v19, v19
    v_fma_f32 v18, v18, v60, v60
    v_fma_f32 v16, v16, v58, v59
    v_rcp_f32 v18, v18
    v_mfma_f32_32x32x16_bf16 v[112:127], a[248:251], v[192:195], v[112:127]
    s_waitcnt lgkmcnt(4)
    ds_read_b64_tr_b16 a[244:245], v29 offset:36864
    ds_read_b64_tr_b16 a[246:247], v29 offset:37888
    v_mul_f32 v65, v65, v17
    v_mul_f32 v16, v16, v68
    v_mul_f32 v17, v69, v69
    v_cvt_pk_bf16_f32 v20, v64, v65
    v_fma_f32 v19, v19, v60, v60
    v_mfma_f32_32x32x16_bf16 v[96:111], a[252:255], v[192:195], v[96:111]
    ds_read_b64_tr_b16 a[248:249], v29 offset:39424
    ds_read_b64_tr_b16 a[250:251], v29 offset:40448
    v_exp_f32 v16, v16
    v_fma_f32 v17, v17, v58, v59
    v_rcp_f32 v19, v19
    v_mul_f32 v66, v66, v18
    v_mfma_f32_32x32x16_bf16 v[112:127], a[232:235], v[196:199], v[112:127]
    s_waitcnt lgkmcnt(4)
    ds_read_b64_tr_b16 a[252:253], v29 offset:38912
    ds_read_b64_tr_b16 a[254:255], v29 offset:39936
    v_mul_f32 v17, v17, v69
    v_mul_f32 v18, v70, v70
    v_exp_f32 v17, v17
    v_fma_f32 v16, v16, v60, v60
    v_mfma_f32_32x32x16_bf16 v[96:111], a[236:239], v[196:199], v[96:111]
    ds_read_b64_tr_b16 a[232:233], v29 offset:41472
    ds_read_b64_tr_b16 a[234:235], v29 offset:42496
    v_fma_f32 v18, v18, v58, v59
    v_rcp_f32 v16, v16
    v_mul_f32 v67, v67, v19
    v_mul_f32 v18, v18, v70
    v_mul_f32 v19, v71, v71
    v_mfma_f32_32x32x16_bf16 v[112:127], a[240:243], v[200:203], v[112:127]
    s_waitcnt lgkmcnt(4)
    ds_read_b64_tr_b16 a[236:237], v29 offset:40960
    ds_read_b64_tr_b16 a[238:239], v29 offset:41984
    v_cvt_pk_bf16_f32 v21, v66, v67
    v_exp_f32 v18, v18
    v_fma_f32 v17, v17, v60, v60
    v_fma_f32 v19, v19, v58, v59
    v_mfma_f32_32x32x16_bf16 v[96:111], a[244:247], v[200:203], v[96:111]
    ds_read_b64_tr_b16 a[240:241], v29 offset:43520
    ds_read_b64_tr_b16 a[242:243], v29 offset:44544
    v_rcp_f32 v17, v17
    v_mul_f32 v68, v68, v16
    v_mul_f32 v19, v19, v71
    v_mul_f32 v16, v72, v72
    v_fma_f32 v18, v18, v60, v60
    v_mfma_f32_32x32x16_bf16 v[112:127], a[248:251], v[204:207], v[112:127]
    s_waitcnt lgkmcnt(4)
    ds_read_b64_tr_b16 a[244:245], v29 offset:43008
    ds_read_b64_tr_b16 a[246:247], v29 offset:44032
    v_exp_f32 v19, v19
    v_fma_f32 v16, v16, v58, v59
    v_rcp_f32 v18, v18
    v_mfma_f32_32x32x16_bf16 v[96:111], a[252:255], v[204:207], v[96:111]
    ds_read_b64_tr_b16 a[248:249], v29 offset:45568
    ds_read_b64_tr_b16 a[250:251], v29 offset:46592
    v_mul_f32 v69, v69, v17
    v_mul_f32 v16, v16, v72
    v_mul_f32 v17, v73, v73
    v_cvt_pk_bf16_f32 v22, v68, v69
    v_exp_f32 v16, v16
    v_mfma_f32_32x32x16_bf16 v[112:127], a[232:235], v[208:211], v[112:127]
    s_waitcnt lgkmcnt(4)
    ds_read_b64_tr_b16 a[252:253], v29 offset:45056
    ds_read_b64_tr_b16 a[254:255], v29 offset:46080
    v_fma_f32 v19, v19, v60, v60
    v_fma_f32 v17, v17, v58, v59
    v_rcp_f32 v19, v19
    v_mul_f32 v70, v70, v18
    v_mfma_f32_32x32x16_bf16 v[96:111], a[236:239], v[208:211], v[96:111]
    ds_read_b64_tr_b16 a[232:233], v29 offset:47616
    ds_read_b64_tr_b16 a[234:235], v29 offset:48640
    v_mul_f32 v17, v17, v73
    v_mul_f32 v18, v74, v74
    v_exp_f32 v17, v17
    v_fma_f32 v16, v16, v60, v60
    v_fma_f32 v18, v18, v58, v59
    v_mfma_f32_32x32x16_bf16 v[112:127], a[240:243], v[212:215], v[112:127]
    s_waitcnt lgkmcnt(4)
    ds_read_b64_tr_b16 a[236:237], v29 offset:47104
    ds_read_b64_tr_b16 a[238:239], v29 offset:48128
    v_rcp_f32 v16, v16
    v_mul_f32 v71, v71, v19
    v_mul_f32 v18, v18, v74
    v_mul_f32 v19, v75, v75
    v_mfma_f32_32x32x16_bf16 v[96:111], a[244:247], v[212:215], v[96:111]
    ds_read_b64_tr_b16 a[240:241], v29 offset:49664
    ds_read_b64_tr_b16 a[242:243], v29 offset:50688
    v_cvt_pk_bf16_f32 v23, v70, v71
    v_exp_f32 v18, v18
    v_fma_f32 v17, v17, v60, v60
    v_fma_f32 v19, v19, v58, v59
    v_mul_f32 v72, v72, v16
    v_mfma_f32_32x32x16_bf16 v[112:127], a[248:251], v[216:219], v[112:127]
    s_waitcnt lgkmcnt(4)
    ds_read_b64_tr_b16 a[244:245], v29 offset:49152
    ds_read_b64_tr_b16 a[246:247], v29 offset:50176
    v_rcp_f32 v17, v17
    v_mul_f32 v19, v19, v75
    v_mul_f32 v16, v76, v76
    v_fma_f32 v18, v18, v60, v60
    v_mfma_f32_32x32x16_bf16 v[96:111], a[252:255], v[216:219], v[96:111]
    ds_read_b64_tr_b16 a[248:249], v29 offset:51712
    ds_read_b64_tr_b16 a[250:251], v29 offset:52736
    v_exp_f32 v19, v19
    v_fma_f32 v16, v16, v58, v59
    v_rcp_f32 v18, v18
    v_mul_f32 v73, v73, v17
    v_mfma_f32_32x32x16_bf16 v[112:127], a[232:235], v[220:223], v[112:127]
    s_waitcnt lgkmcnt(4)
    ds_read_b64_tr_b16 a[252:253], v29 offset:51200
    ds_read_b64_tr_b16 a[254:255], v29 offset:52224
    v_mul_f32 v16, v16, v76
    v_mul_f32 v17, v77, v77
    v_cvt_pk_bf16_f32 v24, v72, v73
    v_and_b32 v23, -2, v23
    v_fma_f32 v19, v19, v60, v60
    v_mfma_f32_32x32x16_bf16 v[96:111], a[236:239], v[220:223], v[96:111]
    ds_read_b64_tr_b16 a[232:233], v29 offset:53760
    ds_read_b64_tr_b16 a[234:235], v29 offset:54784
    v_exp_f32 v16, v16
    v_fma_f32 v17, v17, v58, v59
    v_rcp_f32 v19, v19
    v_mul_f32 v74, v74, v18
    v_mfma_f32_32x32x16_bf16 v[112:127], a[240:243], v[224:227], v[112:127]
    s_waitcnt lgkmcnt(4)
    ds_read_b64_tr_b16 a[236:237], v29 offset:53248
    ds_read_b64_tr_b16 a[238:239], v29 offset:54272
    v_mul_f32 v17, v17, v77
    v_mul_f32 v18, v78, v78
    v_exp_f32 v17, v17
    v_fma_f32 v16, v16, v60, v60
    v_mfma_f32_32x32x16_bf16 v[96:111], a[244:247], v[224:227], v[96:111]
    ds_read_b64_tr_b16 a[240:241], v29 offset:55808
    ds_read_b64_tr_b16 a[242:243], v29 offset:56832
    v_fma_f32 v18, v18, v58, v59
    v_rcp_f32 v16, v16
    v_mul_f32 v75, v75, v19
    v_mul_f32 v18, v18, v78
    v_mul_f32 v19, v79, v79
    v_mfma_f32_32x32x16_bf16 v[112:127], a[248:251], v[228:231], v[112:127]
    s_waitcnt lgkmcnt(4)
    ds_read_b64_tr_b16 a[244:245], v29 offset:55296
    ds_read_b64_tr_b16 a[246:247], v29 offset:56320
    v_cvt_pk_bf16_f32 v25, v74, v75
    v_exp_f32 v18, v18
    v_fma_f32 v17, v17, v60, v60
    v_fma_f32 v19, v19, v58, v59
    v_mfma_f32_32x32x16_bf16 v[96:111], a[252:255], v[228:231], v[96:111]
    ds_read_b64_tr_b16 a[248:249], v29 offset:57856
    ds_read_b64_tr_b16 a[250:251], v29 offset:58880
    v_rcp_f32 v17, v17
    v_mul_f32 v76, v76, v16
    v_mul_f32 v19, v19, v79
    v_mul_f32 v16, v80, v80
    v_fma_f32 v18, v18, v60, v60
    v_mfma_f32_32x32x16_bf16 v[112:127], a[232:235], v[232:235], v[112:127]
    s_waitcnt lgkmcnt(4)
    ds_read_b64_tr_b16 a[252:253], v29 offset:57344
    ds_read_b64_tr_b16 a[254:255], v29 offset:58368
    v_exp_f32 v19, v19
    v_fma_f32 v16, v16, v58, v59
    v_rcp_f32 v18, v18
    v_mfma_f32_32x32x16_bf16 v[96:111], a[236:239], v[232:235], v[96:111]
    ds_read_b64_tr_b16 a[232:233], v29 offset:59904
    ds_read_b64_tr_b16 a[234:235], v29 offset:60928
    v_mul_f32 v77, v77, v17
    v_mul_f32 v16, v16, v80
    v_mul_f32 v17, v81, v81
    v_cvt_pk_bf16_f32 v26, v76, v77
    v_exp_f32 v16, v16
    v_mfma_f32_32x32x16_bf16 v[112:127], a[240:243], v[236:239], v[112:127]
    s_waitcnt lgkmcnt(4)
    ds_read_b64_tr_b16 a[236:237], v29 offset:59392
    ds_read_b64_tr_b16 a[238:239], v29 offset:60416
    v_fma_f32 v19, v19, v60, v60
    v_fma_f32 v17, v17, v58, v59
    v_rcp_f32 v19, v19
    v_mul_f32 v78, v78, v18
    v_mfma_f32_32x32x16_bf16 v[96:111], a[244:247], v[236:239], v[96:111]
    ds_read_b64_tr_b16 a[240:241], v29 offset:61952
    ds_read_b64_tr_b16 a[242:243], v29 offset:62976
    v_mul_f32 v17, v17, v81
    v_mul_f32 v18, v82, v82
    v_exp_f32 v17, v17
    v_fma_f32 v16, v16, v60, v60
    v_fma_f32 v18, v18, v58, v59
    v_mfma_f32_32x32x16_bf16 v[112:127], a[248:251], v[240:243], v[112:127]
    s_waitcnt lgkmcnt(4)
    ds_read_b64_tr_b16 a[244:245], v29 offset:61440
    ds_read_b64_tr_b16 a[246:247], v29 offset:62464
    v_rcp_f32 v16, v16
    v_mul_f32 v79, v79, v19
    v_mul_f32 v18, v18, v82
    v_mul_f32 v19, v83, v83
    v_mfma_f32_32x32x16_bf16 v[96:111], a[252:255], v[240:243], v[96:111]
    ds_read_b64_tr_b16 a[248:249], v29 offset:64000
    ds_read_b64_tr_b16 a[250:251], v29 offset:65024
    v_cvt_pk_bf16_f32 v27, v78, v79
    v_and_b32 v27, -2, v27
    v_exp_f32 v18, v18
    v_fma_f32 v17, v17, v60, v60
    v_fma_f32 v19, v19, v58, v59
    v_mfma_f32_32x32x16_bf16 v[112:127], a[232:235], v[244:247], v[112:127]
    s_waitcnt lgkmcnt(4)
    ds_read_b64_tr_b16 a[252:253], v29 offset:63488
    ds_read_b64_tr_b16 a[254:255], v29 offset:64512
    buffer_store_dwordx4 v[20:23], v1, s[8:11], s60 offen offset:0 nt
    buffer_store_dwordx4 v[24:27], v1, s[8:11], s60 offen offset:1024 nt
    v_mul_f32 v80, v80, v16
    v_mfma_f32_32x32x16_bf16 v[96:111], a[236:239], v[244:247], v[96:111]
    ds_read_b64_tr_b16 a[232:233], v29 offset:8704
    ds_read_b64_tr_b16 a[234:235], v29 offset:9728
    v_rcp_f32 v17, v17
    v_mul_f32 v19, v19, v83
    v_mul_f32 v16, v84, v84
    v_exp_f32 v19, v19
    v_mfma_f32_32x32x16_bf16 v[112:127], a[240:243], v[248:251], v[112:127]
    s_waitcnt lgkmcnt(4)
    ds_read_b64_tr_b16 a[236:237], v29 offset:8192
    ds_read_b64_tr_b16 a[238:239], v29 offset:9216
    v_fma_f32 v18, v18, v60, v60
    v_fma_f32 v16, v16, v58, v59
    v_rcp_f32 v18, v18
    v_mul_f32 v81, v81, v17
    v_mfma_f32_32x32x16_bf16 v[96:111], a[244:247], v[248:251], v[96:111]
    ds_read_b64_tr_b16 a[240:241], v29 offset:10752
    ds_read_b64_tr_b16 a[242:243], v29 offset:11776
    v_mul_f32 v16, v16, v84
    v_mul_f32 v17, v85, v85
    v_cvt_pk_bf16_f32 v20, v80, v81
    v_exp_f32 v16, v16
    v_fma_f32 v19, v19, v60, v60
    v_mfma_f32_32x32x16_bf16 v[112:127], a[248:251], v[252:255], v[112:127]
    s_waitcnt lgkmcnt(4)
    ds_read_b64_tr_b16 a[244:245], v29 offset:10240
    ds_read_b64_tr_b16 a[246:247], v29 offset:11264
    v_fma_f32 v17, v17, v58, v59
    v_rcp_f32 v19, v19
    v_mul_f32 v82, v82, v18
    v_mul_f32 v17, v17, v85
    v_mfma_f32_32x32x16_bf16 v[96:111], a[252:255], v[252:255], v[96:111]
    ds_read_b64_tr_b16 a[248:249], v29 offset:12800
    ds_read_b64_tr_b16 a[250:251], v29 offset:13824
    v_mul_f32 v18, v86, v86
    v_exp_f32 v17, v17
    v_fma_f32 v16, v16, v60, v60
    v_fma_f32 v18, v18, v58, v59
    v_mul_f32 v83, v83, v19
    v_mfma_f32_32x32x16_bf16 v[112:127], a[232:235], v[144:147], v[112:127]
    s_waitcnt lgkmcnt(4)
    ds_read_b64_tr_b16 a[252:253], v29 offset:12288
    ds_read_b64_tr_b16 a[254:255], v29 offset:13312
    v_rcp_f32 v16, v16
    v_mul_f32 v18, v18, v86
    v_mul_f32 v19, v87, v87
    v_cvt_pk_bf16_f32 v21, v82, v83
    v_mfma_f32_32x32x16_bf16 v[96:111], a[236:239], v[144:147], v[96:111]
    ds_read_b64_tr_b16 a[232:233], v29 offset:14848
    ds_read_b64_tr_b16 a[234:235], v29 offset:15872
    v_exp_f32 v18, v18
    v_fma_f32 v17, v17, v60, v60
    v_fma_f32 v19, v19, v58, v59
    v_rcp_f32 v17, v17
    v_mfma_f32_32x32x16_bf16 v[112:127], a[240:243], v[148:151], v[112:127]
    s_waitcnt lgkmcnt(4)
    ds_read_b64_tr_b16 a[236:237], v29 offset:14336
    ds_read_b64_tr_b16 a[238:239], v29 offset:15360
    v_mul_f32 v84, v84, v16
    v_mul_f32 v19, v19, v87
    v_mul_f32 v16, v88, v88
    v_exp_f32 v19, v19
    v_mfma_f32_32x32x16_bf16 v[96:111], a[244:247], v[148:151], v[96:111]
    ds_read_b64_tr_b16 a[240:241], v29 offset:16896
    ds_read_b64_tr_b16 a[242:243], v29 offset:17920
    v_fma_f32 v18, v18, v60, v60
    v_fma_f32 v16, v16, v58, v59
    v_rcp_f32 v18, v18
    v_mul_f32 v85, v85, v17
    v_mul_f32 v16, v16, v88
    v_mfma_f32_32x32x16_bf16 v[112:127], a[248:251], v[152:155], v[112:127]
    s_waitcnt lgkmcnt(4)
    ds_read_b64_tr_b16 a[244:245], v29 offset:16384
    ds_read_b64_tr_b16 a[246:247], v29 offset:17408
    buffer_load_dwordx4 v[192:195], v1, s[8:11], s51 offen offset:0 sc1
    v_mul_f32 v17, v89, v89
    v_cvt_pk_bf16_f32 v22, v84, v85
    v_fma_f32 v19, v19, v60, v60
    v_mfma_f32_32x32x16_bf16 v[96:111], a[252:255], v[152:155], v[96:111]
    ds_read_b64_tr_b16 a[248:249], v29 offset:18944
    ds_read_b64_tr_b16 a[250:251], v29 offset:19968
    buffer_load_dwordx4 v[196:199], v1, s[8:11], s51 offen offset:1024 sc1
    v_exp_f32 v16, v16
    v_fma_f32 v17, v17, v58, v59
    v_mul_f32 v86, v86, v18
    v_mfma_f32_32x32x16_bf16 v[112:127], a[232:235], v[156:159], v[112:127]
    s_waitcnt lgkmcnt(4)
    ds_read_b64_tr_b16 a[252:253], v29 offset:18432
    ds_read_b64_tr_b16 a[254:255], v29 offset:19456
    buffer_load_dwordx4 v[200:203], v1, s[8:11], s51 offen offset:2048 sc1
    v_rcp_f32 v19, v19
    v_mul_f32 v17, v17, v89
    v_mfma_f32_32x32x16_bf16 v[96:111], a[236:239], v[156:159], v[96:111]
    ds_read_b64_tr_b16 a[232:233], v29 offset:20992
    ds_read_b64_tr_b16 a[234:235], v29 offset:22016
    buffer_load_dwordx4 v[204:207], v1, s[8:11], s51 offen offset:3072 sc1
    v_mul_f32 v18, v90, v90
    v_exp_f32 v17, v17
    v_fma_f32 v16, v16, v60, v60
    v_mfma_f32_32x32x16_bf16 v[112:127], a[240:243], v[160:163], v[112:127]
    s_waitcnt lgkmcnt(4)
    ds_read_b64_tr_b16 a[236:237], v29 offset:20480
    ds_read_b64_tr_b16 a[238:239], v29 offset:21504
    s_add_u32 s78, s51, 0x1000
    buffer_load_dwordx4 v[208:211], v1, s[8:11], s78 offen offset:0 sc1
    v_fma_f32 v18, v18, v58, v59
    v_mul_f32 v87, v87, v19
    v_mfma_f32_32x32x16_bf16 v[96:111], a[244:247], v[160:163], v[96:111]
    ds_read_b64_tr_b16 a[240:241], v29 offset:23040
    ds_read_b64_tr_b16 a[242:243], v29 offset:24064
    buffer_load_dwordx4 v[212:215], v1, s[8:11], s78 offen offset:1024 sc1
    v_rcp_f32 v16, v16
    v_mul_f32 v18, v18, v90
    v_mul_f32 v19, v91, v91
    v_mfma_f32_32x32x16_bf16 v[112:127], a[248:251], v[164:167], v[112:127]
    s_waitcnt lgkmcnt(4)
    ds_read_b64_tr_b16 a[244:245], v29 offset:22528
    ds_read_b64_tr_b16 a[246:247], v29 offset:23552
    buffer_load_dwordx4 v[216:219], v1, s[8:11], s78 offen offset:2048 sc1
    v_cvt_pk_bf16_f32 v23, v86, v87
    v_exp_f32 v18, v18
    v_mfma_f32_32x32x16_bf16 v[96:111], a[252:255], v[164:167], v[96:111]
    ds_read_b64_tr_b16 a[248:249], v29 offset:25088
    ds_read_b64_tr_b16 a[250:251], v29 offset:26112
    buffer_load_dwordx4 v[220:223], v1, s[8:11], s78 offen offset:3072 sc1
    v_fma_f32 v17, v17, v60, v60
    v_fma_f32 v19, v19, v58, v59
    v_rcp_f32 v17, v17
    v_mfma_f32_32x32x16_bf16 v[112:127], a[232:235], v[168:171], v[112:127]
    s_waitcnt lgkmcnt(4)
    ds_read_b64_tr_b16 a[252:253], v29 offset:24576
    ds_read_b64_tr_b16 a[254:255], v29 offset:25600
    buffer_load_dwordx4 v[224:227], v1, s[8:11], s50 offen offset:0 sc1
    v_mul_f32 v88, v88, v16
    v_mul_f32 v19, v19, v91
    v_mul_f32 v16, v92, v92
    v_mfma_f32_32x32x16_bf16 v[96:111], a[236:239], v[168:171], v[96:111]
    ds_read_b64_tr_b16 a[232:233], v29 offset:27136
    ds_read_b64_tr_b16 a[234:235], v29 offset:28160
    buffer_load_dwordx4 v[228:231], v1, s[8:11], s50 offen offset:1024 sc1
    v_exp_f32 v19, v19
    v_fma_f32 v18, v18, v60, v60
    v_fma_f32 v16, v16, v58, v59
    v_mfma_f32_32x32x16_bf16 v[112:127], a[240:243], v[172:175], v[112:127]
    s_waitcnt lgkmcnt(4)
    ds_read_b64_tr_b16 a[236:237], v29 offset:26624
    ds_read_b64_tr_b16 a[238:239], v29 offset:27648
    buffer_load_dwordx4 v[232:235], v1, s[8:11], s50 offen offset:2048 sc1
    v_rcp_f32 v18, v18
    v_mul_f32 v89, v89, v17
    v_mfma_f32_32x32x16_bf16 v[96:111], a[244:247], v[172:175], v[96:111]
    ds_read_b64_tr_b16 a[240:241], v29 offset:29184
    ds_read_b64_tr_b16 a[242:243], v29 offset:30208
    buffer_load_dwordx4 v[236:239], v1, s[8:11], s50 offen offset:3072 sc1
    v_mul_f32 v16, v16, v92
    v_mul_f32 v17, v93, v93
    v_cvt_pk_bf16_f32 v24, v88, v89
    v_and_b32 v23, -2, v23
    v_mfma_f32_32x32x16_bf16 v[112:127], a[248:251], v[176:179], v[112:127]
    s_waitcnt lgkmcnt(4)
    ds_read_b64_tr_b16 a[244:245], v29 offset:28672
    ds_read_b64_tr_b16 a[246:247], v29 offset:29696
    v_exp_f32 v16, v16
    v_fma_f32 v19, v19, v60, v60
    v_fma_f32 v17, v17, v58, v59
    v_mul_f32 v90, v90, v18
    v_mfma_f32_32x32x16_bf16 v[96:111], a[252:255], v[176:179], v[96:111]
    ds_read_b64_tr_b16 a[248:249], v29 offset:31232
    ds_read_b64_tr_b16 a[250:251], v29 offset:32256
    v_rcp_f32 v19, v19
    v_mul_f32 v17, v17, v93
    v_mul_f32 v18, v94, v94
    v_exp_f32 v17, v17
    v_mfma_f32_32x32x16_bf16 v[112:127], a[232:235], v[180:183], v[112:127]
    s_waitcnt lgkmcnt(4)
    ds_read_b64_tr_b16 a[252:253], v29 offset:30720
    ds_read_b64_tr_b16 a[254:255], v29 offset:31744
    v_fma_f32 v16, v16, v60, v60
    v_fma_f32 v18, v18, v58, v59
    v_rcp_f32 v16, v16
    v_mul_f32 v91, v91, v19
    v_mfma_f32_32x32x16_bf16 v[96:111], a[236:239], v[180:183], v[96:111]
    ds_read_b64_tr_b16 a[232:233], v29 offset:512
    ds_read_b64_tr_b16 a[234:235], v29 offset:1536
    v_mul_f32 v18, v18, v94
    v_mul_f32 v19, v95, v95
    v_cvt_pk_bf16_f32 v25, v90, v91
    v_exp_f32 v18, v18
    v_fma_f32 v17, v17, v60, v60
    v_mfma_f32_32x32x16_bf16 v[112:127], a[240:243], v[184:187], v[112:127]
    s_waitcnt lgkmcnt(4)
    ds_read_b64_tr_b16 a[236:237], v29 offset:0
    ds_read_b64_tr_b16 a[238:239], v29 offset:1024
    v_fma_f32 v19, v19, v58, v59
    v_rcp_f32 v17, v17
    v_mul_f32 v92, v92, v16
    v_mul_f32 v19, v19, v95
    v_mfma_f32_32x32x16_bf16 v[96:111], a[244:247], v[184:187], v[96:111]
    ds_read_b64_tr_b16 a[240:241], v29 offset:2560
    ds_read_b64_tr_b16 a[242:243], v29 offset:3584
    v_exp_f32 v19, v19
    v_fma_f32 v18, v18, v60, v60
    v_rcp_f32 v18, v18
    v_mul_f32 v93, v93, v17
    v_mfma_f32_32x32x16_bf16 v[112:127], a[248:251], v[188:191], v[112:127]
    s_waitcnt lgkmcnt(4)
    ds_read_b64_tr_b16 a[244:245], v29 offset:2048
    ds_read_b64_tr_b16 a[246:247], v29 offset:3072
    v_cvt_pk_bf16_f32 v26, v92, v93
    v_fma_f32 v19, v19, v60, v60
    v_rcp_f32 v19, v19
    v_mul_f32 v94, v94, v18
    v_mfma_f32_32x32x16_bf16 v[96:111], a[252:255], v[188:191], v[96:111]
    ds_read_b64_tr_b16 a[248:249], v29 offset:4608
    ds_read_b64_tr_b16 a[250:251], v29 offset:5632
    v_mul_f32 v95, v95, v19
    v_cvt_pk_bf16_f32 v27, v94, v95
    v_and_b32 v27, -2, v27
    v_mfma_f32_32x32x16_bf16 v[112:127], a[232:235], v[128:131], v[112:127]
    s_waitcnt lgkmcnt(4)
    ds_read_b64_tr_b16 a[252:253], v29 offset:4096
    ds_read_b64_tr_b16 a[254:255], v29 offset:5120
    buffer_load_dword v9, v8, s[8:11], 0 offen offset:128 sc1
    v_mfma_f32_32x32x16_bf16 v[96:111], a[236:239], v[128:131], v[96:111]
    ds_read_b64_tr_b16 a[232:233], v29 offset:6656
    ds_read_b64_tr_b16 a[234:235], v29 offset:7680
    s_add_u32 s76, s60, 32768
    buffer_store_dwordx4 v[20:23], v1, s[8:11], s76 offen offset:0 nt
    buffer_store_dwordx4 v[24:27], v1, s[8:11], s76 offen offset:1024 nt
    v_mfma_f32_32x32x16_bf16 v[112:127], a[240:243], v[132:135], v[112:127]
    s_waitcnt lgkmcnt(4)
    ds_read_b64_tr_b16 a[236:237], v29 offset:6144
    ds_read_b64_tr_b16 a[238:239], v29 offset:7168
    v_mfma_f32_32x32x16_bf16 v[96:111], a[244:247], v[132:135], v[96:111]
    v_mfma_f32_32x32x16_bf16 v[112:127], a[248:251], v[136:139], v[112:127]
    s_waitcnt lgkmcnt(2)
    v_mfma_f32_32x32x16_bf16 v[96:111], a[252:255], v[136:139], v[96:111]
    v_mfma_f32_32x32x16_bf16 v[112:127], a[232:235], v[140:143], v[112:127]
    s_waitcnt lgkmcnt(0)
    v_mfma_f32_32x32x16_bf16 v[96:111], a[236:239], v[140:143], v[96:111]
    s_add_u32 s78, s50, 0x1000
    buffer_load_dwordx4 v[240:243], v1, s[8:11], s78 offen offset:0 sc1
    s_waitcnt vmcnt(12)
    v_bitop3_b32 v7, v195, v199, v203 bitop3:0xfe
    v_bitop3_b32 v7, v7, v207, 1 bitop3:0xa8
    v_cmp_ne_u32 vcc, 0, v7
    s_cbranch_vccnz OOL_228
RET_229:
    v_mfma_f32_32x32x16_bf16 v[80:95], a[4:7], v[192:195], 0
    buffer_load_dwordx4 v[244:247], v1, s[8:11], s78 offen offset:1024 sc1
    s_waitcnt vmcnt(4)
    v_subrev_u32 v9, s69, v9
    v_subrev_u32 v9, 2, v9
    v_cmp_lt_u32 vcc, 7, v9
    v_mfma_f32_32x32x16_bf16 v[64:79], a[0:3], v[192:195], 0
    s_cbranch_vccnz OOL_231
RET_232:
    buffer_load_dwordx4 v[248:251], v1, s[8:11], s78 offen offset:2048 sc1
    v_mul_f32 v16, v96, v96
    v_fma_f32 v16, v16, v58, v59
    v_mul_f32 v16, v16, v96
    v_mul_f32 v17, v97, v97
    v_fma_f32 v17, v17, v58, v59
    v_mfma_f32_32x32x16_bf16 v[80:95], a[12:15], v[196:199], v[80:95]
    v_exp_f32 v16, v16
    v_mul_f32 v17, v17, v97
    v_mul_f32 v18, v98, v98
    v_exp_f32 v17, v17
    v_fma_f32 v16, v16, v60, v60
    v_fma_f32 v18, v18, v58, v59
    v_rcp_f32 v16, v16
    v_mfma_f32_32x32x16_bf16 v[64:79], a[8:11], v[196:199], v[64:79]
    buffer_load_dwordx4 v[252:255], v1, s[8:11], s78 offen offset:3072 sc1
    v_mul_f32 v18, v18, v98
    v_mul_f32 v19, v99, v99
    v_exp_f32 v18, v18
    v_fma_f32 v17, v17, v60, v60
    v_fma_f32 v19, v19, v58, v59
    v_rcp_f32 v17, v17
    v_mul_f32 v96, v96, v16
    v_mfma_f32_32x32x16_bf16 v[80:95], a[36:39], v[200:203], v[80:95]
    v_mul_f32 v19, v19, v99
    v_mul_f32 v16, v100, v100
    v_exp_f32 v19, v19
    v_fma_f32 v18, v18, v60, v60
    v_fma_f32 v16, v16, v58, v59
    v_rcp_f32 v18, v18
    v_mul_f32 v97, v97, v17
    v_mul_f32 v16, v16, v100
    v_mfma_f32_32x32x16_bf16 v[64:79], a[32:35], v[200:203], v[64:79]
    s_add_u32 s78, s51, 0x8000
    buffer_load_dwordx4 v[144:147], v1, s[8:11], s78 offen offset:0 sc1
    v_mul_f32 v17, v101, v101
    v_cvt_pk_bf16_f32 v20, v96, v97
    v_exp_f32 v16, v16
    v_fma_f32 v19, v19, v60, v60
    v_fma_f32 v17, v17, v58, v59
    v_rcp_f32 v19, v19
    v_mfma_f32_32x32x16_bf16 v[80:95], a[44:47], v[204:207], v[80:95]
    v_bitop3_b32 v7, v211, v215, v219 bitop3:0xfe
    v_bitop3_b32 v7, v7, v223, 1 bitop3:0xa8
    v_cmp_ne_u32 vcc, 0, v7
    v_mul_f32 v98, v98, v18
    v_mul_f32 v17, v17, v101
    v_mul_f32 v18, v102, v102
    v_exp_f32 v17, v17
    v_fma_f32 v16, v16, v60, v60
    v_fma_f32 v18, v18, v58, v59
    v_mfma_f32_32x32x16_bf16 v[64:79], a[40:43], v[204:207], v[64:79]
    s_cbranch_vccnz OOL_234
RET_235:
    buffer_load_dwordx4 v[148:151], v1, s[8:11], s78 offen offset:1024 sc1
    v_rcp_f32 v16, v16
    v_mul_f32 v99, v99, v19
    v_mul_f32 v18, v18, v102
    v_mul_f32 v19, v103, v103
    v_mfma_f32_32x32x16_bf16 v[80:95], a[68:71], v[208:211], v[80:95]
    v_cvt_pk_bf16_f32 v21, v98, v99
    v_exp_f32 v18, v18
    v_fma_f32 v17, v17, v60, v60
    v_fma_f32 v19, v19, v58, v59
    v_rcp_f32 v17, v17
    v_mul_f32 v100, v100, v16
    v_mul_f32 v19, v19, v103
    v_mul_f32 v16, v104, v104
    v_mfma_f32_32x32x16_bf16 v[64:79], a[64:67], v[208:211], v[64:79]
    buffer_load_dwordx4 v[152:155], v1, s[8:11], s78 offen offset:2048 sc1
    v_exp_f32 v19, v19
    v_fma_f32 v18, v18, v60, v60
    v_fma_f32 v16, v16, v58, v59
    v_rcp_f32 v18, v18
    v_mul_f32 v101, v101, v17
    v_mul_f32 v16, v16, v104
    v_mul_f32 v17, v105, v105
    v_mfma_f32_32x32x16_bf16 v[80:95], a[76:79], v[212:215], v[80:95]
    v_cvt_pk_bf16_f32 v22, v100, v101
    v_exp_f32 v16, v16
    v_fma_f32 v19, v19, v60, v60
    v_fma_f32 v17, v17, v58, v59
    v_rcp_f32 v19, v19
    v_mul_f32 v102, v102, v18
    v_mul_f32 v17, v17, v105
    v_mul_f32 v18, v106, v106
    v_mfma_f32_32x32x16_bf16 v[64:79], a[72:75], v[212:215], v[64:79]
    buffer_load_dwordx4 v[156:159], v1, s[8:11], s78 offen offset:3072 sc1
    v_exp_f32 v17, v17
    v_fma_f32 v16, v16, v60, v60
    v_fma_f32 v18, v18, v58, v59
    v_rcp_f32 v16, v16
    v_mul_f32 v103, v103, v19
    v_mul_f32 v18, v18, v106
    v_mul_f32 v19, v107, v107
    v_mfma_f32_32x32x16_bf16 v[80:95], a[100:103], v[216:219], v[80:95]
    v_cvt_pk_bf16_f32 v23, v102, v103
    v_exp_f32 v18, v18
    v_fma_f32 v17, v17, v60, v60
    v_fma_f32 v19, v19, v58, v59
    v_rcp_f32 v17, v17
    v_mul_f32 v104, v104, v16
    v_mul_f32 v19, v19, v107
    v_mul_f32 v16, v108, v108
    v_mfma_f32_32x32x16_bf16 v[64:79], a[96:99], v[216:219], v[64:79]
    s_add_u32 s78, s51, 0x9000
    buffer_load_dwordx4 v[160:163], v1, s[8:11], s78 offen offset:0 sc1
    v_exp_f32 v19, v19
    v_fma_f32 v18, v18, v60, v60
    v_fma_f32 v16, v16, v58, v59
    v_rcp_f32 v18, v18
    v_mul_f32 v105, v105, v17
    v_mul_f32 v16, v16, v108
    v_mfma_f32_32x32x16_bf16 v[80:95], a[108:111], v[220:223], v[80:95]
    v_bitop3_b32 v7, v227, v231, v235 bitop3:0xfe
    v_bitop3_b32 v7, v7, v239, 1 bitop3:0xa8
    v_cmp_ne_u32 vcc, 0, v7
    v_mul_f32 v17, v109, v109
    v_cvt_pk_bf16_f32 v24, v104, v105
    v_and_b32 v23, -2, v23
    v_exp_f32 v16, v16
    v_fma_f32 v19, v19, v60, v60
    v_fma_f32 v17, v17, v58, v59
    v_mfma_f32_32x32x16_bf16 v[64:79], a[104:107], v[220:223], v[64:79]
    s_cbranch_vccnz OOL_237
RET_238:
    buffer_load_dwordx4 v[164:167], v1, s[8:11], s78 offen offset:1024 sc1
    v_rcp_f32 v19, v19
    v_mul_f32 v106, v106, v18
    v_mul_f32 v17, v17, v109
    v_mul_f32 v18, v110, v110
    v_mfma_f32_32x32x16_bf16 v[128:143], a[4:7], v[224:227], 0
    v_exp_f32 v17, v17
    v_fma_f32 v16, v16, v60, v60
    v_fma_f32 v18, v18, v58, v59
    v_rcp_f32 v16, v16
    v_mul_f32 v107, v107, v19
    v_mul_f32 v18, v18, v110
    v_mul_f32 v19, v111, v111
    v_cvt_pk_bf16_f32 v25, v106, v107
    v_mfma_f32_32x32x16_bf16 v[32:47], a[0:3], v[224:227], v[32:47]
    buffer_load_dwordx4 v[168:171], v1, s[8:11], s78 offen offset:2048 sc1
    v_exp_f32 v18, v18
    v_fma_f32 v17, v17, v60, v60
    v_fma_f32 v19, v19, v58, v59
    v_rcp_f32 v17, v17
    v_mul_f32 v108, v108, v16
    v_mul_f32 v19, v19, v111
    v_mul_f32 v16, v112, v112
    v_mfma_f32_32x32x16_bf16 v[128:143], a[12:15], v[228:231], v[128:143]
    v_exp_f32 v19, v19
    v_fma_f32 v18, v18, v60, v60
    v_fma_f32 v16, v16, v58, v59
    v_rcp_f32 v18, v18
    v_mul_f32 v109, v109, v17
    v_mul_f32 v16, v16, v112
    v_mul_f32 v17, v113, v113
    v_cvt_pk_bf16_f32 v26, v108, v109
    v_mfma_f32_32x32x16_bf16 v[32:47], a[8:11], v[228:231], v[32:47]
    buffer_load_dwordx4 v[172:175], v1, s[8:11], s78 offen offset:3072 sc1
    v_exp_f32 v16, v16
    v_fma_f32 v19, v19, v60, v60
    v_fma_f32 v17, v17, v58, v59
    v_rcp_f32 v19, v19
    v_mul_f32 v110, v110, v18
    v_mul_f32 v17, v17, v113
    v_mul_f32 v18, v114, v114
    v_mfma_f32_32x32x16_bf16 v[128:143], a[36:39], v[232:235], v[128:143]
    v_exp_f32 v17, v17
    v_fma_f32 v16, v16, v60, v60
    v_fma_f32 v18, v18, v58, v59
    v_rcp_f32 v16, v16
    v_mul_f32 v111, v111, v19
    v_mul_f32 v18, v18, v114
    v_mul_f32 v19, v115, v115
    v_cvt_pk_bf16_f32 v27, v110, v111
    v_mfma_f32_32x32x16_bf16 v[32:47], a[32:35], v[232:235], v[32:47]
    s_add_u32 s78, s50, 0x8000
    buffer_load_dwordx4 v[176:179], v1, s[8:11], s78 offen offset:0 sc1
    v_and_b32 v27, -2, v27
    v_exp_f32 v18, v18
    v_fma_f32 v17, v17, v60, v60
    v_fma_f32 v19, v19, v58, v59
    v_rcp_f32 v17, v17
    v_mul_f32 v112, v112, v16
    v_mfma_f32_32x32x16_bf16 v[128:143], a[44:47], v[236:239], v[128:143]
    buffer_store_dwordx4 v[20:23], v1, s[8:11], s61 offen offset:0 nt
    buffer_store_dwordx4 v[24:27], v1, s[8:11], s61 offen offset:1024 nt
    s_waitcnt vmcnt(11)
    v_bitop3_b32 v7, v243, v247, v251 bitop3:0xfe
    v_bitop3_b32 v7, v7, v255, 1 bitop3:0xa8
    v_cmp_ne_u32 vcc, 0, v7
    v_mul_f32 v19, v19, v115
    v_mul_f32 v16, v116, v116
    v_fma_f32 v18, v18, v60, v60
    v_mfma_f32_32x32x16_bf16 v[32:47], a[40:43], v[236:239], v[32:47]
    s_cbranch_vccnz OOL_240
RET_241:
    buffer_load_dwordx4 v[180:183], v1, s[8:11], s78 offen offset:1024 sc1
    v_exp_f32 v19, v19
    v_fma_f32 v16, v16, v58, v59
    v_rcp_f32 v18, v18
    v_mfma_f32_32x32x16_bf16 v[128:143], a[68:71], v[240:243], v[128:143]
    v_mul_f32 v113, v113, v17
    v_mul_f32 v16, v16, v116
    v_mul_f32 v17, v117, v117
    v_cvt_pk_bf16_f32 v20, v112, v113
    v_exp_f32 v16, v16
    v_fma_f32 v19, v19, v60, v60
    v_fma_f32 v17, v17, v58, v59
    v_rcp_f32 v19, v19
    v_mfma_f32_32x32x16_bf16 v[32:47], a[64:67], v[240:243], v[32:47]
    buffer_load_dwordx4 v[184:187], v1, s[8:11], s78 offen offset:2048 sc1
    v_mul_f32 v114, v114, v18
    v_mul_f32 v17, v17, v117
    v_mul_f32 v18, v118, v118
    v_exp_f32 v17, v17
    v_fma_f32 v16, v16, v60, v60
    v_fma_f32 v18, v18, v58, v59
    v_rcp_f32 v16, v16
    v_mfma_f32_32x32x16_bf16 v[128:143], a[76:79], v[244:247], v[128:143]
    v_mul_f32 v115, v115, v19
    v_mul_f32 v18, v18, v118
    v_mul_f32 v19, v119, v119
    v_cvt_pk_bf16_f32 v21, v114, v115
    v_exp_f32 v18, v18
    v_fma_f32 v17, v17, v60, v60
    v_fma_f32 v19, v19, v58, v59
    v_rcp_f32 v17, v17
    v_mfma_f32_32x32x16_bf16 v[32:47], a[72:75], v[244:247], v[32:47]
    buffer_load_dwordx4 v[188:191], v1, s[8:11], s78 offen offset:3072 sc1
    v_mul_f32 v116, v116, v16
    v_mul_f32 v19, v19, v119
    v_mul_f32 v16, v120, v120
    v_exp_f32 v19, v19
    v_fma_f32 v18, v18, v60, v60
    v_fma_f32 v16, v16, v58, v59
    v_rcp_f32 v18, v18
    v_mfma_f32_32x32x16_bf16 v[128:143], a[100:103], v[248:251], v[128:143]
    v_mul_f32 v117, v117, v17
    v_mul_f32 v16, v16, v120
    v_mul_f32 v17, v121, v121
    v_cvt_pk_bf16_f32 v22, v116, v117
    v_exp_f32 v16, v16
    v_fma_f32 v19, v19, v60, v60
    v_fma_f32 v17, v17, v58, v59
    v_rcp_f32 v19, v19
    v_mfma_f32_32x32x16_bf16 v[32:47], a[96:99], v[248:251], v[32:47]
    s_add_u32 s78, s50, 0x9000
    buffer_load_dwordx4 v[192:195], v1, s[8:11], s78 offen offset:0 sc1
    v_mul_f32 v118, v118, v18
    v_mul_f32 v17, v17, v121
    v_mul_f32 v18, v122, v122
    v_exp_f32 v17, v17
    v_fma_f32 v16, v16, v60, v60
    v_fma_f32 v18, v18, v58, v59
    v_mul_f32 v119, v119, v19
    v_mfma_f32_32x32x16_bf16 v[128:143], a[108:111], v[252:255], v[128:143]
    s_waitcnt vmcnt(11)
    v_bitop3_b32 v7, v147, v151, v155 bitop3:0xfe
    v_bitop3_b32 v7, v7, v159, 1 bitop3:0xa8
    v_cmp_ne_u32 vcc, 0, v7
    v_rcp_f32 v16, v16
    v_mul_f32 v18, v18, v122
    v_mul_f32 v19, v123, v123
    v_cvt_pk_bf16_f32 v23, v118, v119
    v_exp_f32 v18, v18
    v_mfma_f32_32x32x16_bf16 v[32:47], a[104:107], v[252:255], v[32:47]
    s_cbranch_vccnz OOL_243
RET_244:
    buffer_load_dwordx4 v[196:199], v1, s[8:11], s78 offen offset:1024 sc1
    v_fma_f32 v17, v17, v60, v60
    v_fma_f32 v19, v19, v58, v59
    v_rcp_f32 v17, v17
    v_mul_f32 v120, v120, v16
    v_mfma_f32_32x32x16_bf16 v[80:95], a[20:23], v[144:147], v[80:95]
    v_mul_f32 v19, v19, v123
    v_mul_f32 v16, v124, v124
    v_exp_f32 v19, v19
    v_fma_f32 v18, v18, v60, v60
    v_fma_f32 v16, v16, v58, v59
    v_rcp_f32 v18, v18
    v_mul_f32 v121, v121, v17
    v_mul_f32 v16, v16, v124
    v_mfma_f32_32x32x16_bf16 v[64:79], a[16:19], v[144:147], v[64:79]
    buffer_load_dwordx4 v[200:203], v1, s[8:11], s78 offen offset:2048 sc1
    v_mul_f32 v17, v125, v125
    v_cvt_pk_bf16_f32 v24, v120, v121
    v_and_b32 v23, -2, v23
    v_exp_f32 v16, v16
    v_fma_f32 v19, v19, v60, v60
    v_fma_f32 v17, v17, v58, v59
    v_rcp_f32 v19, v19
    v_mfma_f32_32x32x16_bf16 v[80:95], a[28:31], v[148:151], v[80:95]
    v_mul_f32 v122, v122, v18
    v_mul_f32 v17, v17, v125
    v_mul_f32 v18, v126, v126
    v_exp_f32 v17, v17
    v_fma_f32 v16, v16, v60, v60
    v_fma_f32 v18, v18, v58, v59
    v_rcp_f32 v16, v16
    v_mul_f32 v123, v123, v19
    v_mfma_f32_32x32x16_bf16 v[64:79], a[24:27], v[148:151], v[64:79]
    buffer_load_dwordx4 v[204:207], v1, s[8:11], s78 offen offset:3072 sc1
    v_mul_f32 v18, v18, v126
    v_mul_f32 v19, v127, v127
    v_cvt_pk_bf16_f32 v25, v122, v123
    v_exp_f32 v18, v18
    v_fma_f32 v17, v17, v60, v60
    v_fma_f32 v19, v19, v58, v59
    v_rcp_f32 v17, v17
    v_mfma_f32_32x32x16_bf16 v[80:95], a[52:55], v[152:155], v[80:95]
    v_mul_f32 v124, v124, v16
    v_mul_f32 v19, v19, v127
    v_exp_f32 v19, v19
    v_fma_f32 v18, v18, v60, v60
    v_rcp_f32 v18, v18
    v_mul_f32 v125, v125, v17
    v_cvt_pk_bf16_f32 v26, v124, v125
    v_fma_f32 v19, v19, v60, v60
    v_mfma_f32_32x32x16_bf16 v[64:79], a[48:51], v[152:155], v[64:79]
    buffer_load_dwordx4 v[208:211], v1, s[8:11], s53 offen offset:0 sc1
    v_rcp_f32 v19, v19
    v_mul_f32 v126, v126, v18
    v_mul_f32 v127, v127, v19
    v_cvt_pk_bf16_f32 v27, v126, v127
    v_and_b32 v27, -2, v27
    v_mfma_f32_32x32x16_bf16 v[80:95], a[60:63], v[156:159], v[80:95]
    s_add_u32 s76, s61, 6144
    buffer_store_dwordx4 v[20:23], v1, s[8:11], s76 offen offset:0 nt
    buffer_store_dwordx4 v[24:27], v1, s[8:11], s76 offen offset:1024 nt
    s_waitcnt vmcnt(13)
    v_bitop3_b32 v7, v163, v167, v171 bitop3:0xfe
    v_bitop3_b32 v7, v7, v175, 1 bitop3:0xa8
    v_cmp_ne_u32 vcc, 0, v7
    v_mfma_f32_32x32x16_bf16 v[64:79], a[56:59], v[156:159], v[64:79]
    s_cbranch_vccnz OOL_246
RET_247:
    buffer_load_dwordx4 v[212:215], v1, s[8:11], s53 offen offset:1024 sc1
    v_mfma_f32_32x32x16_bf16 v[80:95], a[84:87], v[160:163], v[80:95]
    v_mfma_f32_32x32x16_bf16 v[64:79], a[80:83], v[160:163], v[64:79]
    buffer_load_dwordx4 v[216:219], v1, s[8:11], s53 offen offset:2048 sc1
    v_mfma_f32_32x32x16_bf16 v[80:95], a[92:95], v[164:167], v[80:95]
    v_mfma_f32_32x32x16_bf16 v[64:79], a[88:91], v[164:167], v[64:79]
    buffer_load_dwordx4 v[220:223], v1, s[8:11], s53 offen offset:3072 sc1
    v_mfma_f32_32x32x16_bf16 v[80:95], a[116:119], v[168:171], v[80:95]
    v_mfma_f32_32x32x16_bf16 v[64:79], a[112:115], v[168:171], v[64:79]
    s_add_u32 s78, s53, 0x1000
    buffer_load_dwordx4 v[224:227], v1, s[8:11], s78 offen offset:0 sc1
    v_mfma_f32_32x32x16_bf16 v[80:95], a[124:127], v[172:175], v[80:95]
    s_waitcnt vmcnt(11)
    v_bitop3_b32 v7, v179, v183, v187 bitop3:0xfe
    v_bitop3_b32 v7, v7, v191, 1 bitop3:0xa8
    v_cmp_ne_u32 vcc, 0, v7
    v_mfma_f32_32x32x16_bf16 v[64:79], a[120:123], v[172:175], v[64:79]
    s_cbranch_vccnz OOL_249
RET_250:
    buffer_load_dwordx4 v[228:231], v1, s[8:11], s78 offen offset:1024 sc1
    v_mfma_f32_32x32x16_bf16 v[128:143], a[20:23], v[176:179], v[128:143]
    v_mfma_f32_32x32x16_bf16 v[32:47], a[16:19], v[176:179], v[32:47]
    buffer_load_dwordx4 v[232:235], v1, s[8:11], s52 offen offset:0 sc1
    v_mfma_f32_32x32x16_bf16 v[128:143], a[28:31], v[180:183], v[128:143]
    s_lshr_b32 s76, s2, 3
    s_lshl_b32 s76, s76, 2
    s_or_b32 s76, s76, s44
    s_cmp_eq_u32 s76, 0
    s_cbranch_scc1 OOL_251
    buffer_load_dword v62, off, s[8:11], s62
RET_252:
    v_mfma_f32_32x32x16_bf16 v[32:47], a[24:27], v[180:183], v[32:47]
    buffer_load_dwordx4 v[236:239], v1, s[8:11], s52 offen offset:1024 sc1
    v_mfma_f32_32x32x16_bf16 v[128:143], a[52:55], v[184:187], v[128:143]
    v_mfma_f32_32x32x16_bf16 v[32:47], a[48:51], v[184:187], v[32:47]
    buffer_load_dwordx4 v[240:243], v1, s[8:11], s52 offen offset:2048 sc1
    v_mfma_f32_32x32x16_bf16 v[128:143], a[60:63], v[188:191], v[128:143]
    s_waitcnt vmcnt(12)
    v_bitop3_b32 v7, v195, v199, v203 bitop3:0xfe
    v_bitop3_b32 v7, v7, v207, 1 bitop3:0xa8
    v_cmp_ne_u32 vcc, 0, v7
    v_mfma_f32_32x32x16_bf16 v[32:47], a[56:59], v[188:191], v[32:47]
    s_cbranch_vccnz OOL_254
RET_255:
    buffer_load_dwordx4 v[244:247], v1, s[8:11], s52 offen offset:3072 sc1
    v_mfma_f32_32x32x16_bf16 v[128:143], a[84:87], v[192:195], v[128:143]
    v_mfma_f32_32x32x16_bf16 v[32:47], a[80:83], v[192:195], v[32:47]
    s_add_u32 s78, s52, 0x1000
    buffer_load_dwordx4 v[248:251], v1, s[8:11], s78 offen offset:0 sc1
    v_mfma_f32_32x32x16_bf16 v[128:143], a[92:95], v[196:199], v[128:143]
    v_mfma_f32_32x32x16_bf16 v[32:47], a[88:91], v[196:199], v[32:47]
    buffer_load_dwordx4 v[252:255], v1, s[8:11], s78 offen offset:1024 sc1
    v_mfma_f32_32x32x16_bf16 v[128:143], a[116:119], v[200:203], v[128:143]
    v_mfma_f32_32x32x16_bf16 v[32:47], a[112:115], v[200:203], v[32:47]
    s_add_u32 s78, s53, 0x1800
    buffer_load_dwordx4 v[144:147], v1, s[8:11], s78 offen offset:0 sc1
    v_mfma_f32_32x32x16_bf16 v[128:143], a[124:127], v[204:207], v[128:143]
    s_waitcnt vmcnt(10)
    v_bitop3_b32 v7, v211, v215, v219 bitop3:0xfe
    v_bitop3_b32 v7, v7, v223, 1 bitop3:0xa8
    v_cmp_ne_u32 vcc, 0, v7
    v_mfma_f32_32x32x16_bf16 v[32:47], a[120:123], v[204:207], v[32:47]
    s_cbranch_vccnz OOL_257
RET_258:
    buffer_load_dwordx4 v[148:151], v1, s[8:11], s78 offen offset:1024 sc1
    v_mfma_f32_32x32x16_bf16 v[80:95], a[132:135], v[208:211], v[80:95]
    v_mfma_f32_32x32x16_bf16 v[64:79], a[128:131], v[208:211], v[64:79]
    buffer_load_dwordx4 v[152:155], v1, s[8:11], s78 offen offset:2048 sc1
    v_mfma_f32_32x32x16_bf16 v[80:95], a[140:143], v[212:215], v[80:95]
    v_mfma_f32_32x32x16_bf16 v[64:79], a[136:139], v[212:215], v[64:79]
    buffer_load_dwordx4 v[156:159], v1, s[8:11], s78 offen offset:3072 sc1
    v_mfma_f32_32x32x16_bf16 v[80:95], a[164:167], v[216:219], v[80:95]
    v_mfma_f32_32x32x16_bf16 v[64:79], a[160:163], v[216:219], v[64:79]
    s_add_u32 s78, s53, 0x2800
    buffer_load_dwordx4 v[160:163], v1, s[8:11], s78 offen offset:0 sc1
    v_mfma_f32_32x32x16_bf16 v[80:95], a[172:175], v[220:223], v[80:95]
    s_waitcnt vmcnt(12)
    v_bitop3_b32 v7, v227, v231, 1 bitop3:0xa8
    v_cmp_ne_u32 vcc, 0, v7
    v_mfma_f32_32x32x16_bf16 v[64:79], a[168:171], v[220:223], v[64:79]
    s_cbranch_vccnz OOL_260
RET_261:
    buffer_load_dwordx4 v[164:167], v1, s[8:11], s78 offen offset:1024 sc1
    v_mfma_f32_32x32x16_bf16 v[80:95], a[196:199], v[224:227], v[80:95]
    v_mfma_f32_32x32x16_bf16 v[64:79], a[192:195], v[224:227], v[64:79]
    s_add_u32 s78, s52, 0x1800
    buffer_load_dwordx4 v[168:171], v1, s[8:11], s78 offen offset:0 sc1
    v_mfma_f32_32x32x16_bf16 v[80:95], a[204:207], v[228:231], v[80:95]
    s_waitcnt vmcnt(9)
    v_bitop3_b32 v7, v235, v239, v243 bitop3:0xfe
    v_bitop3_b32 v7, v7, v247, 1 bitop3:0xa8
    v_cmp_ne_u32 vcc, 0, v7
    v_mfma_f32_32x32x16_bf16 v[64:79], a[200:203], v[228:231], v[64:79]
    s_cbranch_vccnz OOL_263
RET_264:
    buffer_load_dwordx4 v[172:175], v1, s[8:11], s78 offen offset:1024 sc1
    v_mfma_f32_32x32x16_bf16 v[128:143], a[132:135], v[232:235], v[128:143]
    v_mfma_f32_32x32x16_bf16 v[32:47], a[128:131], v[232:235], v[32:47]
    buffer_load_dwordx4 v[176:179], v1, s[8:11], s78 offen offset:2048 sc1
    v_mfma_f32_32x32x16_bf16 v[128:143], a[140:143], v[236:239], v[128:143]
    v_mfma_f32_32x32x16_bf16 v[32:47], a[136:139], v[236:239], v[32:47]
    buffer_load_dwordx4 v[180:183], v1, s[8:11], s78 offen offset:3072 sc1
    v_mfma_f32_32x32x16_bf16 v[128:143], a[164:167], v[240:243], v[128:143]
    v_mfma_f32_32x32x16_bf16 v[32:47], a[160:163], v[240:243], v[32:47]
    s_add_u32 s78, s52, 0x2800
    buffer_load_dwordx4 v[184:187], v1, s[8:11], s78 offen offset:0 sc1
    v_mfma_f32_32x32x16_bf16 v[128:143], a[172:175], v[244:247], v[128:143]
    s_waitcnt vmcnt(11)
    v_bitop3_b32 v7, v251, v255, 1 bitop3:0xa8
    v_cmp_ne_u32 vcc, 0, v7
    v_mfma_f32_32x32x16_bf16 v[32:47], a[168:171], v[244:247], v[32:47]
    s_cbranch_vccnz OOL_266
RET_267:
    buffer_load_dwordx4 v[188:191], v1, s[8:11], s78 offen offset:1024 sc1
    v_mfma_f32_32x32x16_bf16 v[128:143], a[196:199], v[248:251], v[128:143]
    v_mfma_f32_32x32x16_bf16 v[32:47], a[192:195], v[248:251], v[32:47]
    v_mfma_f32_32x32x16_bf16 v[128:143], a[204:207], v[252:255], v[128:143]
    s_waitcnt vmcnt(8)
    v_bitop3_b32 v7, v147, v151, v155 bitop3:0xfe
    v_bitop3_b32 v7, v7, v159, 1 bitop3:0xa8
    v_cmp_ne_u32 vcc, 0, v7
    v_mfma_f32_32x32x16_bf16 v[32:47], a[200:203], v[252:255], v[32:47]
    s_cbranch_vccnz OOL_269
RET_270:
    v_mfma_f32_32x32x16_bf16 v[80:95], a[148:151], v[144:147], v[80:95]
    v_mfma_f32_32x32x16_bf16 v[64:79], a[144:147], v[144:147], v[64:79]
    v_mfma_f32_32x32x16_bf16 v[80:95], a[156:159], v[148:151], v[80:95]
    v_mfma_f32_32x32x16_bf16 v[64:79], a[152:155], v[148:151], v[64:79]
    v_mfma_f32_32x32x16_bf16 v[80:95], a[180:183], v[152:155], v[80:95]
    v_mfma_f32_32x32x16_bf16 v[64:79], a[176:179], v[152:155], v[64:79]
    v_mfma_f32_32x32x16_bf16 v[80:95], a[188:191], v[156:159], v[80:95]
    s_waitcnt vmcnt(6)
    v_bitop3_b32 v7, v163, v167, 1 bitop3:0xa8
    v_cmp_ne_u32 vcc, 0, v7
    v_mfma_f32_32x32x16_bf16 v[64:79], a[184:187], v[156:159], v[64:79]
    s_cbranch_vccnz OOL_272
RET_273:
    v_mfma_f32_32x32x16_bf16 v[80:95], a[212:215], v[160:163], v[80:95]
    v_mfma_f32_32x32x16_bf16 v[64:79], a[208:211], v[160:163], v[64:79]
    v_mfma_f32_32x32x16_bf16 v[80:95], a[220:223], v[164:167], v[80:95]
    s_waitcnt vmcnt(2)
    v_bitop3_b32 v7, v171, v175, v179 bitop3:0xfe
    v_bitop3_b32 v7, v7, v183, 1 bitop3:0xa8
    v_cmp_ne_u32 vcc, 0, v7
    v_mfma_f32_32x32x16_bf16 v[64:79], a[216:219], v[164:167], v[64:79]
    s_cbranch_vccnz OOL_275
RET_276:
    v_mfma_f32_32x32x16_bf16 v[128:143], a[148:151], v[168:171], v[128:143]
    v_mfma_f32_32x32x16_bf16 v[128:143], a[156:159], v[172:175], v[128:143]
    v_xor_b32 v19, 6144, v2
    s_nop 2
    v_cvt_pk_bf16_f32 v80, v80, v81
    v_cvt_pk_bf16_f32 v81, v82, v83
    v_cvt_pk_bf16_f32 v82, v84, v85
    v_cvt_pk_bf16_f32 v83, v86, v87
    v_mfma_f32_32x32x16_bf16 v[128:143], a[180:183], v[176:179], v[128:143]
    ds_write_b128 v19, v[80:83] offset:16384
    v_cvt_pk_bf16_f32 v84, v88, v89
    v_cvt_pk_bf16_f32 v85, v90, v91
    v_cvt_pk_bf16_f32 v86, v92, v93
    v_mfma_f32_32x32x16_bf16 v[32:47], a[144:147], v[168:171], v[32:47]
    v_cvt_pk_bf16_f32 v87, v94, v95
    v_xor_b32 v17, 2048, v2
    v_cvt_pk_bf16_f32 v64, v64, v65
    v_cvt_pk_bf16_f32 v65, v66, v67
    v_cvt_pk_bf16_f32 v66, v68, v69
    v_cvt_pk_bf16_f32 v67, v70, v71
    v_mfma_f32_32x32x16_bf16 v[128:143], a[188:191], v[180:183], v[128:143]
    ds_write_b128 v19, v[84:87] offset:17408
    s_waitcnt vmcnt(0)
    v_bitop3_b32 v7, v187, v191, 1 bitop3:0xa8
    v_cmp_ne_u32 vcc, 0, v7
    v_mfma_f32_32x32x16_bf16 v[32:47], a[152:155], v[172:175], v[32:47]
    s_cbranch_vccnz OOL_278
RET_279:
    v_cvt_pk_bf16_f32 v68, v72, v73
    v_cvt_pk_bf16_f32 v69, v74, v75
    v_cvt_pk_bf16_f32 v70, v76, v77
    v_mfma_f32_32x32x16_bf16 v[128:143], a[212:215], v[184:187], v[128:143]
    ds_write_b128 v17, v[64:67] offset:0
    v_cvt_pk_bf16_f32 v71, v78, v79
    v_mfma_f32_32x32x16_bf16 v[32:47], a[176:179], v[176:179], v[32:47]
    ds_write_b128 v17, v[68:71] offset:1024
    v_mfma_f32_32x32x16_bf16 v[128:143], a[220:223], v[188:191], v[128:143]
    v_add_u32 v16, 161792, v1
    s_waitcnt lgkmcnt(0)
    s_barrier
    ds_read_b128 v[120:123], v16 offset:0
    ds_read_b128 v[124:127], v16 offset:1024
    ds_read_b128 v[80:83], v2 offset:0
    ds_read_b128 v[84:87], v2 offset:1024
    ds_read_b128 v[112:115], v2 offset:16384
    ds_read_b128 v[116:119], v2 offset:17408
    v_mfma_f32_32x32x16_bf16 v[32:47], a[184:187], v[180:183], v[32:47]
    v_mfma_f32_32x32x16_bf16 v[32:47], a[208:211], v[184:187], v[32:47]
    v_xor_b32 v18, 4096, v2
    v_cvt_pk_bf16_f32 v128, v128, v129
    v_cvt_pk_bf16_f32 v129, v130, v131
    v_cvt_pk_bf16_f32 v130, v132, v133
    v_cvt_pk_bf16_f32 v131, v134, v135
    v_cvt_pk_bf16_f32 v132, v136, v137
    v_mfma_f32_32x32x16_bf16 v[32:47], a[216:219], v[188:191], v[32:47]
    ds_write_b128 v18, v[128:131] offset:8192
    v_cvt_pk_bf16_f32 v133, v138, v139
    v_cvt_pk_bf16_f32 v134, v140, v141
    v_cvt_pk_bf16_f32 v135, v142, v143
    s_waitcnt lgkmcnt(4)
    v_mfma_f32_32x32x16_bf16 v[32:47], v[120:123], v[80:83], v[32:47]
    ds_write_b128 v18, v[132:135] offset:9216
    s_waitcnt lgkmcnt(4)
    v_mfma_f32_32x32x16_bf16 v[32:47], v[124:127], v[84:87], v[32:47]
    s_waitcnt lgkmcnt(0)
    s_barrier
    ds_read_b128 v[96:99], v2 offset:8192
    ds_read_b128 v[100:103], v2 offset:9216
    v_mfma_f32_32x32x16_bf16 v[32:47], v[120:123], v[112:115], v[32:47]
    v_mfma_f32_32x32x16_bf16 v[32:47], v[124:127], v[116:119], v[32:47]
    s_waitcnt lgkmcnt(1)
    s_nop 10
    v_dot2c_f32_bf16 v32, s65, v96
    v_dot2c_f32_bf16 v33, s66, v96
    v_dot2c_f32_bf16 v34, s65, v97
    v_dot2c_f32_bf16 v35, s66, v97
    v_dot2c_f32_bf16 v36, s65, v98
    v_dot2c_f32_bf16 v37, s66, v98
    v_dot2c_f32_bf16 v38, s65, v99
    v_dot2c_f32_bf16 v39, s66, v99
    s_waitcnt lgkmcnt(0)
    v_dot2c_f32_bf16 v40, s65, v100
    v_dot2c_f32_bf16 v41, s66, v100
    v_dot2c_f32_bf16 v42, s65, v101
    v_dot2c_f32_bf16 v43, s66, v101
    v_dot2c_f32_bf16 v44, s65, v102
    v_dot2c_f32_bf16 v45, s66, v102
    v_dot2c_f32_bf16 v46, s65, v103
    v_dot2c_f32_bf16 v47, s66, v103
    v_cvt_pk_bf16_f32 v112, v32, v33
    v_cvt_pk_bf16_f32 v113, v34, v35
    v_cvt_pk_bf16_f32 v114, v36, v37
    v_cvt_pk_bf16_f32 v115, v38, v39
    v_cvt_pk_bf16_f32 v116, v40, v41
    v_cvt_pk_bf16_f32 v117, v42, v43
    v_cvt_pk_bf16_f32 v118, v44, v45
    v_cvt_pk_bf16_f32 v119, v46, v47
    v_and_b32 v16, 31, v0
    v_lshlrev_b32 v16, 10, v16
    v_lshrrev_b32 v17, 5, v0
    v_lshl_add_u32 v16, v17, 4, v16
    s_lshr_b32 s76, s67, 3
    s_bfe_u32 s77, s46, 0x30011
    s_lshl_b32 s77, s77, 15
    s_add_u32 s76, s76, s77
    s_lshl_b32 s77, s70, 6
    s_add_u32 s76, s76, s77
    v_permlane32_swap_b32 v112, v114
    v_permlane32_swap_b32 v113, v115
    buffer_store_dwordx4 v[112:115], v16, s[12:15], s76 offen offset:0
    v_permlane32_swap_b32 v116, v118
    v_permlane32_swap_b32 v117, v119
    buffer_store_dwordx4 v[116:119], v16, s[12:15], s76 offen offset:32
    s_or_b32 s76, s2, s44
    s_mov_b32 s77, 0x1130000
    v_mov_b32 v18, s69
    s_cmp_eq_u32 s76, 0
    s_cbranch_scc1 OOL_280
RET_281:
    s_nop 2
L_end:
    s_endpgm
OOL_1:
    buffer_load_dword v57, v68, s[8:11], s19 offen sc1
    s_sub_u32 s45, s45, 1
    s_nop 1
    s_cbranch_scc1 L_end
    s_waitcnt vmcnt(0)
    v_xor_b32 v57, s88, v57
    s_nop 4
    s_branch L_xc
    s_nop 0
    s_branch RET_2
OOL_4:
    s_nop 3
CHK_3:
    buffer_load_dwordx4 v[136:139], v64, s[8:11], s7 offen sc1
    buffer_load_dwordx4 v[140:143], v64, s[8:11], s85 offen sc1
    buffer_load_dwordx4 v[144:147], v64, s[8:11], s5 offen sc1
    s_sub_u32 s45, s45, 1
    s_nop 0
    s_cbranch_scc1 L_end
    s_waitcnt vmcnt(0)
    v_xor_b32 v116, s69, v139
    v_bitop3_b32 v116, v116, v143, s69 bitop3:0xf6
    v_bitop3_b32 v116, v116, v146, s69 bitop3:0xf6
    v_cmp_ne_u32 vcc, 0, v116
    s_nop 4
    s_cbranch_vccnz CHK_3
    s_nop 0
    s_branch RET_5
OOL_9:
    s_nop 3
CHK_8:
    buffer_load_dword v9, v6, s[8:11], 0 offen offset:0 sc1
    s_sub_u32 s45, s45, 1
    s_nop 0
    s_cbranch_scc1 L_end
    s_waitcnt vmcnt(0)
    v_subrev_u32 v9, s69, v9
    v_subrev_u32 v9, 1, v9
    v_cmp_lt_u32 vcc, 7, v9
    s_nop 4
    s_cbranch_vccnz CHK_8
    s_nop 0
    s_branch RET_10
OOL_12:
    s_nop 3
CHK_11:
    buffer_load_dwordx4 v[80:83], v1, s[8:11], s76 offen offset:0 sc1
    buffer_load_dwordx4 v[84:87], v1, s[8:11], s76 offen offset:1024 sc1
    buffer_load_dwordx4 v[88:91], v1, s[8:11], s76 offen offset:2048 sc1
    buffer_load_dwordx4 v[92:95], v1, s[8:11], s76 offen offset:3072 sc1
    s_sub_u32 s45, s45, 1
    s_nop 0
    s_cbranch_scc1 L_end
    s_waitcnt vmcnt(0)
    v_bitop3_b32 v7, v80, v81, v82 bitop3:0x80
    v_bitop3_b32 v7, v7, v83, v84 bitop3:0x80
    v_bitop3_b32 v7, v7, v85, v86 bitop3:0x80
    v_bitop3_b32 v7, v7, v87, v88 bitop3:0x80
    v_bitop3_b32 v7, v7, v89, v90 bitop3:0x80
    v_bitop3_b32 v7, v7, v91, v92 bitop3:0x80
    v_bitop3_b32 v7, v7, v93, v94 bitop3:0x80
    v_bitop3_b32 v7, v7, v95, 1 bitop3:0x2a
    v_cmp_ne_u32 vcc, 0, v7
    s_nop 4
    s_cbranch_vccnz CHK_11
    s_nop 0
    s_branch RET_13
OOL_15:
    s_nop 3
CHK_14:
    buffer_load_dwordx2 v[160:161], v123, s[8:11], s46 offen offset:0 sc1
    buffer_load_dwordx2 v[162:163], v123, s[8:11], s46 offen offset:256 sc1
    buffer_load_dwordx2 v[164:165], v123, s[8:11], s46 offen offset:1024 sc1
    buffer_load_dwordx2 v[166:167], v123, s[8:11], s46 offen offset:1280 sc1
    buffer_load_dwordx2 v[168:169], v123, s[8:11], s78 offen offset:0 sc1
    buffer_load_dwordx2 v[170:171], v123, s[8:11], s78 offen offset:256 sc1
    buffer_load_dwordx2 v[172:173], v123, s[8:11], s78 offen offset:1024 sc1
    buffer_load_dwordx2 v[174:175], v123, s[8:11], s78 offen offset:1280 sc1
    s_sub_u32 s45, s45, 1
    s_nop 0
    s_cbranch_scc1 L_end
    s_waitcnt vmcnt(0)
    v_xor_b32 v7, s69, v161
    v_bitop3_b32 v7, v7, v163, s69 bitop3:0xf6
    v_bitop3_b32 v7, v7, v165, s69 bitop3:0xf6
    v_bitop3_b32 v7, v7, v167, s69 bitop3:0xf6
    v_bitop3_b32 v7, v7, v169, s69 bitop3:0xf6
    v_bitop3_b32 v7, v7, v171, s69 bitop3:0xf6
    v_bitop3_b32 v7, v7, v173, s69 bitop3:0xf6
    v_bitop3_b32 v7, v7, v175, s69 bitop3:0xf6
    v_cmp_ne_u32 vcc, 0, v7
    s_nop 4
    s_cbranch_vccnz CHK_14
    s_nop 0
    s_branch RET_16
OOL_19:
    s_nop 7
CHK_18:
    s_add_u32 s79, s51, 0x10000
    buffer_load_dwordx4 v[132:135], v1, s[8:11], s79 offen offset:0 sc1
    buffer_load_dwordx4 v[140:143], v1, s[8:11], s79 offen offset:1024 sc1
    buffer_load_dwordx4 v[148:151], v1, s[8:11], s79 offen offset:2048 sc1
    buffer_load_dwordx4 v[156:159], v1, s[8:11], s79 offen offset:3072 sc1
    s_add_u32 s79, s51, 0x11000
    buffer_load_dwordx4 v[164:167], v1, s[8:11], s79 offen offset:0 sc1
    buffer_load_dwordx4 v[172:175], v1, s[8:11], s79 offen offset:1024 sc1
    buffer_load_dwordx4 v[180:183], v1, s[8:11], s79 offen offset:2048 sc1
    buffer_load_dwordx4 v[188:191], v1, s[8:11], s79 offen offset:3072 sc1
    s_sub_u32 s45, s45, 1
    s_nop 0
    s_cbranch_scc1 L_end
    s_waitcnt vmcnt(6)
    v_bitop3_b32 v7, v135, v143, 1 bitop3:0x2a
    v_cmp_ne_u32 vcc, 0, v7
    s_nop 4
    s_cbranch_vccnz CHK_18
    s_nop 0
    s_branch RET_20
OOL_22:
    s_nop 10
CHK_21:
    s_add_u32 s79, s51, 0x10000
    buffer_load_dwordx4 v[148:151], v1, s[8:11], s79 offen offset:2048 sc1
    buffer_load_dwordx4 v[156:159], v1, s[8:11], s79 offen offset:3072 sc1
    s_add_u32 s79, s51, 0x11000
    buffer_load_dwordx4 v[164:167], v1, s[8:11], s79 offen offset:0 sc1
    buffer_load_dwordx4 v[172:175], v1, s[8:11], s79 offen offset:1024 sc1
    buffer_load_dwordx4 v[180:183], v1, s[8:11], s79 offen offset:2048 sc1
    buffer_load_dwordx4 v[188:191], v1, s[8:11], s79 offen offset:3072 sc1
    s_add_u32 s80, s50, 0x10000
    buffer_load_dwordx4 v[128:131], v1, s[8:11], s80 offen offset:0 sc1
    buffer_load_dword v62, off, s[8:11], s62
    buffer_load_dwordx4 v[136:139], v1, s[8:11], s80 offen offset:1024 sc1
    s_sub_u32 s45, s45, 1
    s_nop 0
    s_cbranch_scc1 L_end
    s_waitcnt vmcnt(7)
    v_bitop3_b32 v7, v151, v159, 1 bitop3:0x2a
    v_cmp_ne_u32 vcc, 0, v7
    s_nop 4
    s_cbranch_vccnz CHK_21
    s_nop 0
    s_branch RET_23
OOL_25:
    s_nop 10
CHK_24:
    s_add_u32 s79, s51, 0x11000
    buffer_load_dwordx4 v[164:167], v1, s[8:11], s79 offen offset:0 sc1
    buffer_load_dwordx4 v[172:175], v1, s[8:11], s79 offen offset:1024 sc1
    buffer_load_dwordx4 v[180:183], v1, s[8:11], s79 offen offset:2048 sc1
    buffer_load_dwordx4 v[188:191], v1, s[8:11], s79 offen offset:3072 sc1
    s_add_u32 s80, s50, 0x10000
    buffer_load_dwordx4 v[128:131], v1, s[8:11], s80 offen offset:0 sc1
    buffer_load_dword v62, off, s[8:11], s62
    buffer_load_dwordx4 v[136:139], v1, s[8:11], s80 offen offset:1024 sc1
    buffer_load_dwordx4 v[144:147], v1, s[8:11], s80 offen offset:2048 sc1
    buffer_load_dwordx4 v[152:155], v1, s[8:11], s80 offen offset:3072 sc1
    s_sub_u32 s45, s45, 1
    s_nop 0
    s_cbranch_scc1 L_end
    s_waitcnt vmcnt(5)
    v_bitop3_b32 v7, v167, v175, v183 bitop3:0x80
    v_bitop3_b32 v7, v7, v191, 1 bitop3:0x2a
    v_cmp_ne_u32 vcc, 0, v7
    s_nop 4
    s_cbranch_vccnz CHK_24
    s_nop 0
    s_branch RET_26
OOL_28:
    s_nop 10
CHK_27:
    s_add_u32 s80, s50, 0x10000
    buffer_load_dwordx4 v[128:131], v1, s[8:11], s80 offen offset:0 sc1
    buffer_load_dword v62, off, s[8:11], s62
    buffer_load_dwordx4 v[136:139], v1, s[8:11], s80 offen offset:1024 sc1
    buffer_load_dwordx4 v[144:147], v1, s[8:11], s80 offen offset:2048 sc1
    buffer_load_dwordx4 v[152:155], v1, s[8:11], s80 offen offset:3072 sc1
    s_add_u32 s80, s50, 0x11000
    buffer_load_dwordx4 v[160:163], v1, s[8:11], s80 offen offset:0 sc1
    buffer_load_dwordx4 v[168:171], v1, s[8:11], s80 offen offset:1024 sc1
    buffer_load_dwordx4 v[176:179], v1, s[8:11], s80 offen offset:2048 sc1
    buffer_load_dwordx4 v[184:187], v1, s[8:11], s80 offen offset:3072 sc1
    s_sub_u32 s45, s45, 1
    s_nop 0
    s_cbranch_scc1 L_end
    s_waitcnt vmcnt(4)
    v_bitop3_b32 v7, v131, v139, v147 bitop3:0x80
    v_bitop3_b32 v7, v7, v155, 1 bitop3:0x2a
    v_cmp_ne_u32 vcc, 0, v7
    s_nop 4
    s_cbranch_vccnz CHK_27
    s_nop 0
    s_branch RET_29
OOL_31:
    s_nop 10
CHK_30:
    s_add_u32 s80, s50, 0x11000
    buffer_load_dwordx4 v[160:163], v1, s[8:11], s80 offen offset:0 sc1
    buffer_load_dwordx4 v[168:171], v1, s[8:11], s80 offen offset:1024 sc1
    buffer_load_dwordx4 v[176:179], v1, s[8:11], s80 offen offset:2048 sc1
    buffer_load_dwordx4 v[184:187], v1, s[8:11], s80 offen offset:3072 sc1
    buffer_load_dword v62, off, s[8:11], s62
    buffer_load_dword v62, off, s[8:11], s62
    buffer_load_dword v62, off, s[8:11], s62
    buffer_load_dword v62, off, s[8:11], s62
    buffer_load_dword v62, off, s[8:11], s62
    buffer_load_dword v62, off, s[8:11], s62
    buffer_load_dword v62, off, s[8:11], s62
    buffer_load_dword v62, off, s[8:11], s62
    buffer_load_dword v62, off, s[8:11], s62
    s_sub_u32 s45, s45, 1
    s_nop 0
    s_cbranch_scc1 L_end
    s_waitcnt vmcnt(11)
    v_bitop3_b32 v7, v163, v171, 1 bitop3:0x2a
    v_cmp_ne_u32 vcc, 0, v7
    s_nop 4
    s_cbranch_vccnz CHK_30
    s_nop 0
    s_branch RET_32
OOL_34:
    s_nop 10
CHK_33:
    s_add_u32 s80, s50, 0x11000
    buffer_load_dwordx4 v[176:179], v1, s[8:11], s80 offen offset:2048 sc1
    buffer_load_dwordx4 v[184:187], v1, s[8:11], s80 offen offset:3072 sc1
    buffer_load_dword v62, off, s[8:11], s62
    buffer_load_dword v62, off, s[8:11], s62
    buffer_load_dword v62, off, s[8:11], s62
    buffer_load_dword v62, off, s[8:11], s62
    buffer_load_dword v62, off, s[8:11], s62
    buffer_load_dword v62, off, s[8:11], s62
    buffer_load_dword v62, off, s[8:11], s62
    buffer_load_dword v62, off, s[8:11], s62
    buffer_load_dword v62, off, s[8:11], s62
    buffer_load_dword v62, off, s[8:11], s62
    buffer_load_dword v62, off, s[8:11], s62
    buffer_load_dword v62, off, s[8:11], s62
    buffer_load_dword v62, off, s[8:11], s62
    s_sub_u32 s45, s45, 1
    s_nop 0
    s_cbranch_scc1 L_end
    s_waitcnt vmcnt(13)
    v_bitop3_b32 v7, v179, v187, 1 bitop3:0x2a
    v_cmp_ne_u32 vcc, 0, v7
    s_nop 4
    s_cbranch_vccnz CHK_33
    s_nop 0
    s_branch RET_35
OOL_37:
    s_nop 3
CHK_36:
    buffer_load_dwordx4 v[132:135], v1, s[8:11], s49 offen offset:0 sc1
    buffer_load_dwordx4 v[140:143], v1, s[8:11], s49 offen offset:1024 sc1
    buffer_load_dwordx4 v[148:151], v1, s[8:11], s49 offen offset:2048 sc1
    buffer_load_dwordx4 v[156:159], v1, s[8:11], s49 offen offset:3072 sc1
    s_sub_u32 s45, s45, 1
    s_nop 0
    s_cbranch_scc1 L_end
    s_waitcnt vmcnt(0)
    v_bitop3_b32 v7, v132, v133, v134 bitop3:0x80
    v_bitop3_b32 v7, v7, v135, v140 bitop3:0x80
    v_bitop3_b32 v7, v7, v141, v142 bitop3:0x80
    v_bitop3_b32 v7, v7, v143, v148 bitop3:0x80
    v_bitop3_b32 v7, v7, v149, v150 bitop3:0x80
    v_bitop3_b32 v7, v7, v151, v156 bitop3:0x80
    v_bitop3_b32 v7, v7, v157, v158 bitop3:0x80
    v_bitop3_b32 v7, v7, v159, 1 bitop3:0x2a
    v_cmp_ne_u32 vcc, 0, v7
    s_nop 4
    s_cbranch_vccnz CHK_36
    s_nop 0
    s_branch RET_38
OOL_40:
    s_nop 3
CHK_39:
    buffer_load_dword v9, v8, s[8:11], 0 offen offset:0 sc1
    s_sub_u32 s45, s45, 1
    s_nop 0
    s_cbranch_scc1 L_end
    s_waitcnt vmcnt(0)
    v_subrev_u32 v9, s69, v9
    v_subrev_u32 v9, 2, v9
    v_cmp_lt_u32 vcc, 7, v9
    s_nop 4
    s_cbranch_vccnz CHK_39
    s_nop 0
    s_branch RET_41
OOL_43:
    s_add_u32 s76, s46, 0x8000
    buffer_store_dwordx4 v[112:115], v4, s[8:11], s76 offen offset:0
    buffer_store_dwordx4 v[116:119], v4, s[8:11], s76 offen offset:1024
    s_nop 1
    s_branch RET_44
OOL_46:
    s_nop 3
CHK_45:
    s_add_u32 s79, s51, 0x8000
    buffer_load_dwordx4 v[132:135], v1, s[8:11], s79 offen offset:0 sc1
    buffer_load_dwordx4 v[140:143], v1, s[8:11], s79 offen offset:1024 sc1
    buffer_load_dwordx4 v[148:151], v1, s[8:11], s79 offen offset:2048 sc1
    buffer_load_dwordx4 v[156:159], v1, s[8:11], s79 offen offset:3072 sc1
    s_add_u32 s79, s51, 0x9000
    buffer_load_dwordx4 v[164:167], v1, s[8:11], s79 offen offset:0 sc1
    buffer_load_dwordx4 v[172:175], v1, s[8:11], s79 offen offset:1024 sc1
    buffer_load_dwordx4 v[180:183], v1, s[8:11], s79 offen offset:2048 sc1
    buffer_load_dwordx4 v[188:191], v1, s[8:11], s79 offen offset:3072 sc1
    s_sub_u32 s45, s45, 1
    s_nop 0
    s_cbranch_scc1 L_end
    s_waitcnt vmcnt(6)
    v_bitop3_b32 v7, v135, v143, 1 bitop3:0x2a
    v_cmp_ne_u32 vcc, 0, v7
    s_nop 4
    s_cbranch_vccnz CHK_45
    s_nop 0
    s_branch RET_47
OOL_49:
    s_nop 10
CHK_48:
    s_add_u32 s79, s51, 0x8000
    buffer_load_dwordx4 v[148:151], v1, s[8:11], s79 offen offset:2048 sc1
    buffer_load_dwordx4 v[156:159], v1, s[8:11], s79 offen offset:3072 sc1
    s_add_u32 s79, s51, 0x9000
    buffer_load_dwordx4 v[164:167], v1, s[8:11], s79 offen offset:0 sc1
    buffer_load_dwordx4 v[172:175], v1, s[8:11], s79 offen offset:1024 sc1
    buffer_load_dwordx4 v[180:183], v1, s[8:11], s79 offen offset:2048 sc1
    buffer_load_dwordx4 v[188:191], v1, s[8:11], s79 offen offset:3072 sc1
    s_add_u32 s80, s50, 0x8000
    buffer_load_dwordx4 v[128:131], v5, s[8:11], s80 offen offset:0 sc1
    buffer_load_dwordx4 v[136:139], v5, s[8:11], s80 offen offset:1024 sc1
    s_sub_u32 s45, s45, 1
    s_nop 0
    s_cbranch_scc1 L_end
    s_waitcnt vmcnt(6)
    v_bitop3_b32 v7, v151, v159, 1 bitop3:0x2a
    v_cmp_ne_u32 vcc, 0, v7
    s_nop 4
    s_cbranch_vccnz CHK_48
    s_nop 0
    s_branch RET_50
OOL_52:
    s_nop 10
CHK_51:
    s_add_u32 s79, s51, 0x9000
    buffer_load_dwordx4 v[164:167], v1, s[8:11], s79 offen offset:0 sc1
    buffer_load_dwordx4 v[172:175], v1, s[8:11], s79 offen offset:1024 sc1
    buffer_load_dwordx4 v[180:183], v1, s[8:11], s79 offen offset:2048 sc1
    buffer_load_dwordx4 v[188:191], v1, s[8:11], s79 offen offset:3072 sc1
    s_add_u32 s80, s50, 0x8000
    buffer_load_dwordx4 v[128:131], v5, s[8:11], s80 offen offset:0 sc1
    buffer_load_dwordx4 v[136:139], v5, s[8:11], s80 offen offset:1024 sc1
    buffer_load_dwordx4 v[144:147], v5, s[8:11], s80 offen offset:2048 sc1
    buffer_load_dwordx4 v[152:155], v5, s[8:11], s80 offen offset:3072 sc1
    s_sub_u32 s45, s45, 1
    s_nop 0
    s_cbranch_scc1 L_end
    s_waitcnt vmcnt(4)
    v_bitop3_b32 v7, v167, v175, v183 bitop3:0x80
    v_bitop3_b32 v7, v7, v191, 1 bitop3:0x2a
    v_cmp_ne_u32 vcc, 0, v7
    s_nop 4
    s_cbranch_vccnz CHK_51
    s_nop 0
    s_branch RET_53
OOL_55:
    s_nop 10
CHK_54:
    s_add_u32 s80, s50, 0x8000
    buffer_load_dwordx4 v[128:131], v5, s[8:11], s80 offen offset:0 sc1
    buffer_load_dwordx4 v[136:139], v5, s[8:11], s80 offen offset:1024 sc1
    buffer_load_dwordx4 v[144:147], v5, s[8:11], s80 offen offset:2048 sc1
    buffer_load_dwordx4 v[152:155], v5, s[8:11], s80 offen offset:3072 sc1
    s_add_u32 s80, s50, 0x9000
    buffer_load_dwordx4 v[160:163], v5, s[8:11], s80 offen offset:0 sc1
    buffer_load_dwordx4 v[168:171], v5, s[8:11], s80 offen offset:1024 sc1
    buffer_load_dwordx4 v[176:179], v5, s[8:11], s80 offen offset:2048 sc1
    buffer_load_dwordx4 v[184:187], v5, s[8:11], s80 offen offset:3072 sc1
    s_sub_u32 s45, s45, 1
    s_nop 0
    s_cbranch_scc1 L_end
    s_waitcnt vmcnt(4)
    v_bitop3_b32 v7, v131, v139, v147 bitop3:0x80
    v_bitop3_b32 v7, v7, v155, 1 bitop3:0x2a
    v_cmp_ne_u32 vcc, 0, v7
    s_nop 4
    s_cbranch_vccnz CHK_54
    s_nop 0
    s_branch RET_56
OOL_58:
    s_nop 10
CHK_57:
    s_add_u32 s80, s50, 0x9000
    buffer_load_dwordx4 v[160:163], v5, s[8:11], s80 offen offset:0 sc1
    buffer_load_dwordx4 v[168:171], v5, s[8:11], s80 offen offset:1024 sc1
    buffer_load_dwordx4 v[176:179], v5, s[8:11], s80 offen offset:2048 sc1
    buffer_load_dwordx4 v[184:187], v5, s[8:11], s80 offen offset:3072 sc1
    buffer_load_dword v62, off, s[8:11], s62
    buffer_load_dword v62, off, s[8:11], s62
    buffer_load_dword v62, off, s[8:11], s62
    buffer_load_dword v62, off, s[8:11], s62
    buffer_load_dword v62, off, s[8:11], s62
    s_sub_u32 s45, s45, 1
    s_nop 0
    s_cbranch_scc1 L_end
    s_waitcnt vmcnt(7)
    v_bitop3_b32 v7, v163, v171, 1 bitop3:0x2a
    v_cmp_ne_u32 vcc, 0, v7
    s_nop 4
    s_cbranch_vccnz CHK_57
    s_nop 0
    s_branch RET_59
OOL_61:
    s_nop 10
CHK_60:
    s_add_u32 s80, s50, 0x9000
    buffer_load_dwordx4 v[176:179], v5, s[8:11], s80 offen offset:2048 sc1
    buffer_load_dwordx4 v[184:187], v5, s[8:11], s80 offen offset:3072 sc1
    buffer_load_dword v62, off, s[8:11], s62
    buffer_load_dword v62, off, s[8:11], s62
    buffer_load_dword v62, off, s[8:11], s62
    buffer_load_dword v62, off, s[8:11], s62
    buffer_load_dword v62, off, s[8:11], s62
    buffer_load_dword v62, off, s[8:11], s62
    buffer_load_dword v62, off, s[8:11], s62
    buffer_load_dword v62, off, s[8:11], s62
    buffer_load_dword v62, off, s[8:11], s62
    s_sub_u32 s45, s45, 1
    s_nop 0
    s_cbranch_scc1 L_end
    s_waitcnt vmcnt(9)
    v_bitop3_b32 v7, v179, v187, 1 bitop3:0x2a
    v_cmp_ne_u32 vcc, 0, v7
    s_nop 4
    s_cbranch_vccnz CHK_60
    s_nop 0
    s_branch RET_62
OOL_64:
    s_nop 3
CHK_63:
    buffer_load_dwordx4 v[128:131], v1, s[8:11], s59 offen offset:0 sc1
    buffer_load_dwordx4 v[132:135], v1, s[8:11], s59 offen offset:1024 sc1
    buffer_load_dwordx4 v[136:139], v1, s[8:11], s59 offen offset:2048 sc1
    buffer_load_dwordx4 v[140:143], v1, s[8:11], s59 offen offset:3072 sc1
    s_add_u32 s79, s59, 0x1000
    buffer_load_dwordx4 v[144:147], v1, s[8:11], s79 offen offset:0 sc1
    buffer_load_dwordx4 v[148:151], v1, s[8:11], s79 offen offset:1024 sc1
    buffer_load_dwordx4 v[152:155], v1, s[8:11], s79 offen offset:2048 sc1
    buffer_load_dwordx4 v[156:159], v1, s[8:11], s79 offen offset:3072 sc1
    s_add_u32 s79, s59, 0x2000
    buffer_load_dwordx4 v[160:163], v1, s[8:11], s79 offen offset:0 sc1
    buffer_load_dwordx4 v[164:167], v1, s[8:11], s79 offen offset:1024 sc1
    buffer_load_dwordx4 v[168:171], v1, s[8:11], s79 offen offset:2048 sc1
    buffer_load_dwordx4 v[172:175], v1, s[8:11], s79 offen offset:3072 sc1
    s_sub_u32 s45, s45, 1
    s_nop 0
    s_cbranch_scc1 L_end
    s_waitcnt vmcnt(10)
    v_bitop3_b32 v7, v131, v135, 1 bitop3:0xa8
    v_cmp_ne_u32 vcc, 0, v7
    s_nop 4
    s_cbranch_vccnz CHK_63
    s_nop 0
    s_branch RET_65
OOL_68:
    s_nop 10
CHK_67:
    buffer_load_dwordx4 v[136:139], v1, s[8:11], s59 offen offset:2048 sc1
    buffer_load_dwordx4 v[140:143], v1, s[8:11], s59 offen offset:3072 sc1
    s_add_u32 s79, s59, 0x1000
    buffer_load_dwordx4 v[144:147], v1, s[8:11], s79 offen offset:0 sc1
    buffer_load_dwordx4 v[148:151], v1, s[8:11], s79 offen offset:1024 sc1
    buffer_load_dwordx4 v[152:155], v1, s[8:11], s79 offen offset:2048 sc1
    buffer_load_dwordx4 v[156:159], v1, s[8:11], s79 offen offset:3072 sc1
    s_add_u32 s79, s59, 0x2000
    buffer_load_dwordx4 v[160:163], v1, s[8:11], s79 offen offset:0 sc1
    buffer_load_dwordx4 v[164:167], v1, s[8:11], s79 offen offset:1024 sc1
    buffer_load_dwordx4 v[168:171], v1, s[8:11], s79 offen offset:2048 sc1
    buffer_load_dwordx4 v[172:175], v1, s[8:11], s79 offen offset:3072 sc1
    s_add_u32 s79, s59, 0x3000
    buffer_load_dwordx4 v[176:179], v1, s[8:11], s79 offen offset:0 sc1
    buffer_load_dwordx4 v[180:183], v1, s[8:11], s79 offen offset:1024 sc1
    s_sub_u32 s45, s45, 1
    s_nop 0
    s_cbranch_scc1 L_end
    s_waitcnt vmcnt(10)
    v_bitop3_b32 v7, v139, v143, 1 bitop3:0xa8
    v_cmp_ne_u32 vcc, 0, v7
    s_nop 4
    s_cbranch_vccnz CHK_67
    s_nop 0
    s_branch RET_69
OOL_71:
    s_nop 10
CHK_70:
    s_add_u32 s79, s59, 0x1000
    buffer_load_dwordx4 v[144:147], v1, s[8:11], s79 offen offset:0 sc1
    buffer_load_dwordx4 v[148:151], v1, s[8:11], s79 offen offset:1024 sc1
    buffer_load_dwordx4 v[152:155], v1, s[8:11], s79 offen offset:2048 sc1
    buffer_load_dwordx4 v[156:159], v1, s[8:11], s79 offen offset:3072 sc1
    s_add_u32 s79, s59, 0x2000
    buffer_load_dwordx4 v[160:163], v1, s[8:11], s79 offen offset:0 sc1
    buffer_load_dwordx4 v[164:167], v1, s[8:11], s79 offen offset:1024 sc1
    buffer_load_dwordx4 v[168:171], v1, s[8:11], s79 offen offset:2048 sc1
    buffer_load_dwordx4 v[172:175], v1, s[8:11], s79 offen offset:3072 sc1
    s_add_u32 s79, s59, 0x3000
    buffer_load_dwordx4 v[176:179], v1, s[8:11], s79 offen offset:0 sc1
    buffer_load_dwordx4 v[180:183], v1, s[8:11], s79 offen offset:1024 sc1
    buffer_load_dwordx4 v[184:187], v1, s[8:11], s79 offen offset:2048 sc1
    buffer_load_dwordx4 v[188:191], v1, s[8:11], s79 offen offset:3072 sc1
    s_sub_u32 s45, s45, 1
    s_nop 0
    s_cbranch_scc1 L_end
    s_waitcnt vmcnt(8)
    v_bitop3_b32 v7, v147, v151, v155 bitop3:0xfe
    v_bitop3_b32 v7, v7, v159, 1 bitop3:0xa8
    v_cmp_ne_u32 vcc, 0, v7
    s_nop 4
    s_cbranch_vccnz CHK_70
    s_nop 0
    s_branch RET_72
OOL_74:
    s_nop 10
CHK_73:
    s_add_u32 s79, s59, 0x2000
    buffer_load_dwordx4 v[160:163], v1, s[8:11], s79 offen offset:0 sc1
    buffer_load_dwordx4 v[164:167], v1, s[8:11], s79 offen offset:1024 sc1
    buffer_load_dwordx4 v[168:171], v1, s[8:11], s79 offen offset:2048 sc1
    buffer_load_dwordx4 v[172:175], v1, s[8:11], s79 offen offset:3072 sc1
    s_add_u32 s79, s59, 0x3000
    buffer_load_dwordx4 v[176:179], v1, s[8:11], s79 offen offset:0 sc1
    buffer_load_dwordx4 v[180:183], v1, s[8:11], s79 offen offset:1024 sc1
    buffer_load_dwordx4 v[184:187], v1, s[8:11], s79 offen offset:2048 sc1
    buffer_load_dwordx4 v[188:191], v1, s[8:11], s79 offen offset:3072 sc1
    s_add_u32 s79, s59, 0x4000
    buffer_load_dwordx4 v[192:195], v1, s[8:11], s79 offen offset:0 sc1
    buffer_load_dwordx4 v[196:199], v1, s[8:11], s79 offen offset:1024 sc1
    buffer_load_dwordx4 v[200:203], v1, s[8:11], s79 offen offset:2048 sc1
    buffer_load_dwordx4 v[204:207], v1, s[8:11], s79 offen offset:3072 sc1
    s_sub_u32 s45, s45, 1
    s_nop 0
    s_cbranch_scc1 L_end
    s_waitcnt vmcnt(8)
    v_bitop3_b32 v7, v163, v167, v171 bitop3:0xfe
    v_bitop3_b32 v7, v7, v175, 1 bitop3:0xa8
    v_cmp_ne_u32 vcc, 0, v7
    s_nop 4
    s_cbranch_vccnz CHK_73
    s_nop 0
    s_branch RET_75
OOL_77:
    s_nop 10
CHK_76:
    s_add_u32 s79, s59, 0x3000
    buffer_load_dwordx4 v[176:179], v1, s[8:11], s79 offen offset:0 sc1
    buffer_load_dwordx4 v[180:183], v1, s[8:11], s79 offen offset:1024 sc1
    buffer_load_dwordx4 v[184:187], v1, s[8:11], s79 offen offset:2048 sc1
    buffer_load_dwordx4 v[188:191], v1, s[8:11], s79 offen offset:3072 sc1
    s_add_u32 s79, s59, 0x4000
    buffer_load_dwordx4 v[192:195], v1, s[8:11], s79 offen offset:0 sc1
    buffer_load_dwordx4 v[196:199], v1, s[8:11], s79 offen offset:1024 sc1
    buffer_load_dwordx4 v[200:203], v1, s[8:11], s79 offen offset:2048 sc1
    buffer_load_dwordx4 v[204:207], v1, s[8:11], s79 offen offset:3072 sc1
    s_add_u32 s79, s59, 0x5000
    buffer_load_dwordx4 v[208:211], v1, s[8:11], s79 offen offset:0 sc1
    buffer_load_dwordx4 v[212:215], v1, s[8:11], s79 offen offset:1024 sc1
    buffer_load_dwordx4 v[216:219], v1, s[8:11], s79 offen offset:2048 sc1
    buffer_load_dwordx4 v[220:223], v1, s[8:11], s79 offen offset:3072 sc1
    s_sub_u32 s45, s45, 1
    s_nop 0
    s_cbranch_scc1 L_end
    s_waitcnt vmcnt(8)
    v_bitop3_b32 v7, v179, v183, v187 bitop3:0xfe
    v_bitop3_b32 v7, v7, v191, 1 bitop3:0xa8
    v_cmp_ne_u32 vcc, 0, v7
    s_nop 4
    s_cbranch_vccnz CHK_76
    s_nop 0
    s_branch RET_78
OOL_80:
    s_nop 10
CHK_79:
    s_add_u32 s79, s59, 0x4000
    buffer_load_dwordx4 v[192:195], v1, s[8:11], s79 offen offset:0 sc1
    buffer_load_dwordx4 v[196:199], v1, s[8:11], s79 offen offset:1024 sc1
    buffer_load_dwordx4 v[200:203], v1, s[8:11], s79 offen offset:2048 sc1
    buffer_load_dwordx4 v[204:207], v1, s[8:11], s79 offen offset:3072 sc1
    s_add_u32 s79, s59, 0x5000
    buffer_load_dwordx4 v[208:211], v1, s[8:11], s79 offen offset:0 sc1
    buffer_load_dwordx4 v[212:215], v1, s[8:11], s79 offen offset:1024 sc1
    buffer_load_dwordx4 v[216:219], v1, s[8:11], s79 offen offset:2048 sc1
    buffer_load_dwordx4 v[220:223], v1, s[8:11], s79 offen offset:3072 sc1
    s_add_u32 s79, s59, 0x6000
    buffer_load_dwordx4 v[224:227], v1, s[8:11], s79 offen offset:0 sc1
    buffer_load_dwordx4 v[228:231], v1, s[8:11], s79 offen offset:1024 sc1
    buffer_load_dwordx4 v[232:235], v1, s[8:11], s79 offen offset:2048 sc1
    buffer_load_dwordx4 v[236:239], v1, s[8:11], s79 offen offset:3072 sc1
    s_sub_u32 s45, s45, 1
    s_nop 0
    s_cbranch_scc1 L_end
    s_waitcnt vmcnt(8)
    v_bitop3_b32 v7, v195, v199, v203 bitop3:0xfe
    v_bitop3_b32 v7, v7, v207, 1 bitop3:0xa8
    v_cmp_ne_u32 vcc, 0, v7
    s_nop 4
    s_cbranch_vccnz CHK_79
    s_nop 0
    s_branch RET_81
OOL_83:
    s_nop 10
CHK_82:
    s_add_u32 s79, s59, 0x5000
    buffer_load_dwordx4 v[208:211], v1, s[8:11], s79 offen offset:0 sc1
    buffer_load_dwordx4 v[212:215], v1, s[8:11], s79 offen offset:1024 sc1
    buffer_load_dwordx4 v[216:219], v1, s[8:11], s79 offen offset:2048 sc1
    buffer_load_dwordx4 v[220:223], v1, s[8:11], s79 offen offset:3072 sc1
    s_add_u32 s79, s59, 0x6000
    buffer_load_dwordx4 v[224:227], v1, s[8:11], s79 offen offset:0 sc1
    buffer_load_dwordx4 v[228:231], v1, s[8:11], s79 offen offset:1024 sc1
    buffer_load_dwordx4 v[232:235], v1, s[8:11], s79 offen offset:2048 sc1
    buffer_load_dwordx4 v[236:239], v1, s[8:11], s79 offen offset:3072 sc1
    s_add_u32 s79, s59, 0x7000
    buffer_load_dwordx4 v[240:243], v1, s[8:11], s79 offen offset:0 sc1
    buffer_load_dwordx4 v[244:247], v1, s[8:11], s79 offen offset:1024 sc1
    buffer_load_dwordx4 v[248:251], v1, s[8:11], s79 offen offset:2048 sc1
    buffer_load_dwordx4 v[252:255], v1, s[8:11], s79 offen offset:3072 sc1
    s_sub_u32 s45, s45, 1
    s_nop 0
    s_cbranch_scc1 L_end
    s_waitcnt vmcnt(8)
    v_bitop3_b32 v7, v211, v215, v219 bitop3:0xfe
    v_bitop3_b32 v7, v7, v223, 1 bitop3:0xa8
    v_cmp_ne_u32 vcc, 0, v7
    s_nop 4
    s_cbranch_vccnz CHK_82
    s_nop 0
    s_branch RET_84
OOL_86:
    s_nop 10
CHK_85:
    s_add_u32 s79, s59, 0x6000
    buffer_load_dwordx4 v[224:227], v1, s[8:11], s79 offen offset:0 sc1
    buffer_load_dwordx4 v[228:231], v1, s[8:11], s79 offen offset:1024 sc1
    buffer_load_dwordx4 v[232:235], v1, s[8:11], s79 offen offset:2048 sc1
    buffer_load_dwordx4 v[236:239], v1, s[8:11], s79 offen offset:3072 sc1
    s_add_u32 s79, s59, 0x7000
    buffer_load_dwordx4 v[240:243], v1, s[8:11], s79 offen offset:0 sc1
    buffer_load_dwordx4 v[244:247], v1, s[8:11], s79 offen offset:1024 sc1
    buffer_load_dwordx4 v[248:251], v1, s[8:11], s79 offen offset:2048 sc1
    buffer_load_dwordx4 v[252:255], v1, s[8:11], s79 offen offset:3072 sc1
    buffer_load_dword v62, off, s[8:11], s62
    buffer_load_dword v62, off, s[8:11], s62
    buffer_load_dword v62, off, s[8:11], s62
    buffer_load_dword v62, off, s[8:11], s62
    buffer_load_dword v62, off, s[8:11], s62
    buffer_load_dword v62, off, s[8:11], s62
    buffer_load_dword v62, off, s[8:11], s62
    s_sub_u32 s45, s45, 1
    s_nop 0
    s_cbranch_scc1 L_end
    s_waitcnt vmcnt(11)
    v_bitop3_b32 v7, v227, v231, v235 bitop3:0xfe
    v_bitop3_b32 v7, v7, v239, 1 bitop3:0xa8
    v_cmp_ne_u32 vcc, 0, v7
    s_nop 4
    s_cbranch_vccnz CHK_85
    s_nop 0
    s_branch RET_87
OOL_89:
    s_nop 10
CHK_88:
    buffer_load_dwordx4 v[112:115], v1, s[8:11], s77 offen offset:0 sc1
    buffer_load_dwordx4 v[116:119], v1, s[8:11], s77 offen offset:1024 sc1
    buffer_load_dwordx4 v[120:123], v1, s[8:11], s77 offen offset:2048 sc1
    buffer_load_dwordx4 v[124:127], v1, s[8:11], s77 offen offset:3072 sc1
    s_sub_u32 s45, s45, 1
    s_nop 0
    s_cbranch_scc1 L_end
    s_waitcnt vmcnt(0)
    v_bitop3_b32 v7, v112, v113, v114 bitop3:0xfe
    v_bitop3_b32 v7, v7, v115, v116 bitop3:0xfe
    v_bitop3_b32 v7, v7, v117, v118 bitop3:0xfe
    v_bitop3_b32 v7, v7, v119, v120 bitop3:0xfe
    v_bitop3_b32 v7, v7, v121, v122 bitop3:0xfe
    v_bitop3_b32 v7, v7, v123, v124 bitop3:0xfe
    v_bitop3_b32 v7, v7, v125, v126 bitop3:0xfe
    v_bitop3_b32 v7, v7, v127, 1 bitop3:0xa8
    v_cmp_ne_u32 vcc, 0, v7
    s_nop 4
    s_cbranch_vccnz CHK_88
    s_nop 0
    s_branch RET_90
OOL_92:
    s_nop 10
CHK_91:
    s_add_u32 s79, s59, 0x7000
    buffer_load_dwordx4 v[240:243], v1, s[8:11], s79 offen offset:0 sc1
    buffer_load_dwordx4 v[244:247], v1, s[8:11], s79 offen offset:1024 sc1
    buffer_load_dwordx4 v[248:251], v1, s[8:11], s79 offen offset:2048 sc1
    buffer_load_dwordx4 v[252:255], v1, s[8:11], s79 offen offset:3072 sc1
    buffer_load_dword v62, off, s[8:11], s62
    buffer_load_dword v62, off, s[8:11], s62
    buffer_load_dword v62, off, s[8:11], s62
    buffer_load_dword v62, off, s[8:11], s62
    buffer_load_dword v62, off, s[8:11], s62
    buffer_load_dword v62, off, s[8:11], s62
    buffer_load_dword v62, off, s[8:11], s62
    buffer_load_dword v62, off, s[8:11], s62
    buffer_load_dword v62, off, s[8:11], s62
    buffer_load_dword v62, off, s[8:11], s62
    buffer_load_dword v62, off, s[8:11], s62
    s_sub_u32 s45, s45, 1
    s_nop 0
    s_cbranch_scc1 L_end
    s_waitcnt vmcnt(11)
    v_bitop3_b32 v7, v243, v247, v251 bitop3:0xfe
    v_bitop3_b32 v7, v7, v255, 1 bitop3:0xa8
    v_cmp_ne_u32 vcc, 0, v7
    s_nop 4
    s_cbranch_vccnz CHK_91
    s_nop 0
    s_branch RET_93
OOL_95:
    s_nop 3
CHK_94:
    buffer_load_dwordx4 v[192:195], v1, s[8:11], s51 offen offset:0 sc1
    buffer_load_dwordx4 v[196:199], v1, s[8:11], s51 offen offset:1024 sc1
    buffer_load_dword v62, off, s[8:11], s62
    buffer_load_dwordx4 v[200:203], v1, s[8:11], s51 offen offset:2048 sc1
    buffer_load_dwordx4 v[204:207], v1, s[8:11], s51 offen offset:3072 sc1
    s_add_u32 s78, s51, 0x1000
    buffer_load_dwordx4 v[208:211], v1, s[8:11], s78 offen offset:0 sc1
    buffer_load_dwordx4 v[212:215], v1, s[8:11], s78 offen offset:1024 sc1
    buffer_load_dwordx4 v[216:219], v1, s[8:11], s78 offen offset:2048 sc1
    buffer_load_dwordx4 v[220:223], v1, s[8:11], s78 offen offset:3072 sc1
    buffer_load_dwordx4 v[224:227], v1, s[8:11], s50 offen offset:0 sc1
    buffer_load_dword v62, off, s[8:11], s62
    buffer_load_dword v62, off, s[8:11], s62
    s_sub_u32 s45, s45, 1
    s_nop 0
    s_cbranch_scc1 L_end
    s_waitcnt vmcnt(7)
    v_bitop3_b32 v7, v195, v199, v203 bitop3:0x80
    v_bitop3_b32 v7, v7, v207, 1 bitop3:0x2a
    v_cmp_ne_u32 vcc, 0, v7
    s_nop 4
    s_cbranch_vccnz CHK_94
    s_nop 0
    s_branch RET_96
OOL_98:
    s_nop 10
CHK_97:
    buffer_load_dword v9, v8, s[8:11], 0 offen offset:128 sc1
    s_sub_u32 s45, s45, 1
    s_nop 0
    s_cbranch_scc1 L_end
    s_waitcnt vmcnt(0)
    v_subrev_u32 v9, s69, v9
    v_subrev_u32 v9, 1, v9
    v_cmp_lt_u32 vcc, 7, v9
    s_nop 4
    s_cbranch_vccnz CHK_97
    s_nop 0
    s_branch RET_99
OOL_101:
    s_nop 10
CHK_100:
    s_add_u32 s78, s51, 0x1000
    buffer_load_dwordx4 v[208:211], v1, s[8:11], s78 offen offset:0 sc1
    buffer_load_dwordx4 v[212:215], v1, s[8:11], s78 offen offset:1024 sc1
    buffer_load_dwordx4 v[216:219], v1, s[8:11], s78 offen offset:2048 sc1
    buffer_load_dwordx4 v[220:223], v1, s[8:11], s78 offen offset:3072 sc1
    buffer_load_dwordx4 v[224:227], v1, s[8:11], s50 offen offset:0 sc1
    buffer_load_dword v62, off, s[8:11], s62
    buffer_load_dword v62, off, s[8:11], s62
    buffer_load_dwordx4 v[228:231], v1, s[8:11], s50 offen offset:1024 sc1
    buffer_load_dwordx4 v[232:235], v1, s[8:11], s50 offen offset:2048 sc1
    buffer_load_dwordx4 v[236:239], v1, s[8:11], s50 offen offset:3072 sc1
    s_add_u32 s78, s50, 0x1000
    buffer_load_dwordx4 v[240:243], v1, s[8:11], s78 offen offset:0 sc1
    buffer_load_dwordx4 v[244:247], v1, s[8:11], s78 offen offset:1024 sc1
    buffer_load_dwordx4 v[248:251], v1, s[8:11], s78 offen offset:2048 sc1
    s_sub_u32 s45, s45, 1
    s_nop 0
    s_cbranch_scc1 L_end
    s_waitcnt vmcnt(9)
    v_bitop3_b32 v7, v211, v215, v219 bitop3:0x80
    v_bitop3_b32 v7, v7, v223, 1 bitop3:0x2a
    v_cmp_ne_u32 vcc, 0, v7
    s_nop 4
    s_cbranch_vccnz CHK_100
    s_nop 0
    s_branch RET_102
OOL_104:
    s_nop 10
CHK_103:
    buffer_load_dwordx4 v[224:227], v1, s[8:11], s50 offen offset:0 sc1
    buffer_load_dword v62, off, s[8:11], s62
    buffer_load_dword v62, off, s[8:11], s62
    buffer_load_dwordx4 v[228:231], v1, s[8:11], s50 offen offset:1024 sc1
    buffer_load_dwordx4 v[232:235], v1, s[8:11], s50 offen offset:2048 sc1
    buffer_load_dwordx4 v[236:239], v1, s[8:11], s50 offen offset:3072 sc1
    s_add_u32 s78, s50, 0x1000
    buffer_load_dwordx4 v[240:243], v1, s[8:11], s78 offen offset:0 sc1
    buffer_load_dwordx4 v[244:247], v1, s[8:11], s78 offen offset:1024 sc1
    buffer_load_dwordx4 v[248:251], v1, s[8:11], s78 offen offset:2048 sc1
    buffer_load_dwordx4 v[252:255], v1, s[8:11], s78 offen offset:3072 sc1
    buffer_load_dword v62, off, s[8:11], s62
    s_add_u32 s78, s51, 0x8000
    buffer_load_dwordx4 v[144:147], v1, s[8:11], s78 offen offset:0 sc1
    buffer_load_dword v62, off, s[8:11], s62
    buffer_load_dwordx4 v[148:151], v1, s[8:11], s78 offen offset:1024 sc1
    buffer_load_dword v62, off, s[8:11], s62
    buffer_load_dwordx4 v[152:155], v1, s[8:11], s78 offen offset:2048 sc1
    s_sub_u32 s45, s45, 1
    s_nop 0
    s_cbranch_scc1 L_end
    s_waitcnt vmcnt(10)
    v_bitop3_b32 v7, v227, v231, v235 bitop3:0x80
    v_bitop3_b32 v7, v7, v239, 1 bitop3:0x2a
    v_cmp_ne_u32 vcc, 0, v7
    s_nop 4
    s_cbranch_vccnz CHK_103
    s_nop 0
    s_branch RET_105
OOL_107:
    s_nop 10
CHK_106:
    s_add_u32 s78, s50, 0x1000
    buffer_load_dwordx4 v[240:243], v1, s[8:11], s78 offen offset:0 sc1
    buffer_load_dwordx4 v[244:247], v1, s[8:11], s78 offen offset:1024 sc1
    buffer_load_dwordx4 v[248:251], v1, s[8:11], s78 offen offset:2048 sc1
    buffer_load_dwordx4 v[252:255], v1, s[8:11], s78 offen offset:3072 sc1
    buffer_load_dword v62, off, s[8:11], s62
    s_add_u32 s78, s51, 0x8000
    buffer_load_dwordx4 v[144:147], v1, s[8:11], s78 offen offset:0 sc1
    buffer_load_dword v62, off, s[8:11], s62
    buffer_load_dwordx4 v[148:151], v1, s[8:11], s78 offen offset:1024 sc1
    buffer_load_dword v62, off, s[8:11], s62
    buffer_load_dwordx4 v[152:155], v1, s[8:11], s78 offen offset:2048 sc1
    buffer_load_dwordx4 v[156:159], v1, s[8:11], s78 offen offset:3072 sc1
    buffer_load_dword v62, off, s[8:11], s62
    s_add_u32 s78, s51, 0x9000
    buffer_load_dwordx4 v[160:163], v1, s[8:11], s78 offen offset:0 sc1
    buffer_load_dword v62, off, s[8:11], s62
    buffer_load_dwordx4 v[164:167], v1, s[8:11], s78 offen offset:1024 sc1
    buffer_load_dword v62, off, s[8:11], s62
    buffer_load_dwordx4 v[168:171], v1, s[8:11], s78 offen offset:2048 sc1
    s_sub_u32 s45, s45, 1
    s_nop 0
    s_cbranch_scc1 L_end
    s_waitcnt vmcnt(13)
    v_bitop3_b32 v7, v243, v247, v251 bitop3:0x80
    v_bitop3_b32 v7, v7, v255, 1 bitop3:0x2a
    v_cmp_ne_u32 vcc, 0, v7
    s_nop 4
    s_cbranch_vccnz CHK_106
    s_nop 0
    s_branch RET_108
OOL_110:
    s_nop 10
CHK_109:
    s_add_u32 s78, s51, 0x8000
    buffer_load_dwordx4 v[144:147], v1, s[8:11], s78 offen offset:0 sc1
    buffer_load_dword v62, off, s[8:11], s62
    buffer_load_dwordx4 v[148:151], v1, s[8:11], s78 offen offset:1024 sc1
    buffer_load_dword v62, off, s[8:11], s62
    buffer_load_dwordx4 v[152:155], v1, s[8:11], s78 offen offset:2048 sc1
    buffer_load_dwordx4 v[156:159], v1, s[8:11], s78 offen offset:3072 sc1
    buffer_load_dword v62, off, s[8:11], s62
    s_add_u32 s78, s51, 0x9000
    buffer_load_dwordx4 v[160:163], v1, s[8:11], s78 offen offset:0 sc1
    buffer_load_dword v62, off, s[8:11], s62
    buffer_load_dwordx4 v[164:167], v1, s[8:11], s78 offen offset:1024 sc1
    buffer_load_dword v62, off, s[8:11], s62
    buffer_load_dwordx4 v[168:171], v1, s[8:11], s78 offen offset:2048 sc1
    buffer_load_dwordx4 v[172:175], v1, s[8:11], s78 offen offset:3072 sc1
    buffer_load_dword v62, off, s[8:11], s62
    buffer_load_dword v62, off, s[8:11], s62
    buffer_load_dword v62, off, s[8:11], s62
    s_add_u32 s78, s50, 0x8000
    buffer_load_dwordx4 v[176:179], v1, s[8:11], s78 offen offset:0 sc1
    buffer_load_dword v62, off, s[8:11], s62
    buffer_load_dwordx4 v[180:183], v1, s[8:11], s78 offen offset:1024 sc1
    buffer_load_dword v62, off, s[8:11], s62
    buffer_load_dwordx4 v[184:187], v1, s[8:11], s78 offen offset:2048 sc1
    s_sub_u32 s45, s45, 1
    s_nop 0
    s_cbranch_scc1 L_end
    s_waitcnt vmcnt(15)
    v_bitop3_b32 v7, v147, v151, v155 bitop3:0xfe
    v_bitop3_b32 v7, v7, v159, 1 bitop3:0xa8
    v_cmp_ne_u32 vcc, 0, v7
    s_nop 4
    s_cbranch_vccnz CHK_109
    s_nop 0
    s_branch RET_111
OOL_113:
    s_nop 10
CHK_112:
    s_add_u32 s78, s51, 0x9000
    buffer_load_dwordx4 v[160:163], v1, s[8:11], s78 offen offset:0 sc1
    buffer_load_dword v62, off, s[8:11], s62
    buffer_load_dwordx4 v[164:167], v1, s[8:11], s78 offen offset:1024 sc1
    buffer_load_dword v62, off, s[8:11], s62
    buffer_load_dwordx4 v[168:171], v1, s[8:11], s78 offen offset:2048 sc1
    buffer_load_dwordx4 v[172:175], v1, s[8:11], s78 offen offset:3072 sc1
    buffer_load_dword v62, off, s[8:11], s62
    buffer_load_dword v62, off, s[8:11], s62
    buffer_load_dword v62, off, s[8:11], s62
    s_add_u32 s78, s50, 0x8000
    buffer_load_dwordx4 v[176:179], v1, s[8:11], s78 offen offset:0 sc1
    buffer_load_dword v62, off, s[8:11], s62
    buffer_load_dwordx4 v[180:183], v1, s[8:11], s78 offen offset:1024 sc1
    buffer_load_dword v62, off, s[8:11], s62
    buffer_load_dwordx4 v[184:187], v1, s[8:11], s78 offen offset:2048 sc1
    buffer_load_dwordx4 v[188:191], v1, s[8:11], s78 offen offset:3072 sc1
    buffer_load_dword v62, off, s[8:11], s62
    s_add_u32 s78, s50, 0x9000
    buffer_load_dwordx4 v[192:195], v1, s[8:11], s78 offen offset:0 sc1
    buffer_load_dwordx4 v[196:199], v1, s[8:11], s78 offen offset:1024 sc1
    buffer_load_dwordx4 v[200:203], v1, s[8:11], s78 offen offset:2048 sc1
    s_sub_u32 s45, s45, 1
    s_nop 0
    s_cbranch_scc1 L_end
    s_waitcnt vmcnt(13)
    v_bitop3_b32 v7, v163, v167, v171 bitop3:0xfe
    v_bitop3_b32 v7, v7, v175, 1 bitop3:0xa8
    v_cmp_ne_u32 vcc, 0, v7
    s_nop 4
    s_cbranch_vccnz CHK_112
    s_nop 0
    s_branch RET_114
OOL_116:
    s_nop 10
CHK_115:
    s_add_u32 s78, s50, 0x8000
    buffer_load_dwordx4 v[176:179], v1, s[8:11], s78 offen offset:0 sc1
    buffer_load_dword v62, off, s[8:11], s62
    buffer_load_dwordx4 v[180:183], v1, s[8:11], s78 offen offset:1024 sc1
    buffer_load_dword v62, off, s[8:11], s62
    buffer_load_dwordx4 v[184:187], v1, s[8:11], s78 offen offset:2048 sc1
    buffer_load_dwordx4 v[188:191], v1, s[8:11], s78 offen offset:3072 sc1
    buffer_load_dword v62, off, s[8:11], s62
    s_add_u32 s78, s50, 0x9000
    buffer_load_dwordx4 v[192:195], v1, s[8:11], s78 offen offset:0 sc1
    buffer_load_dwordx4 v[196:199], v1, s[8:11], s78 offen offset:1024 sc1
    buffer_load_dwordx4 v[200:203], v1, s[8:11], s78 offen offset:2048 sc1
    buffer_load_dwordx4 v[204:207], v1, s[8:11], s78 offen offset:3072 sc1
    buffer_load_dwordx4 v[208:211], v1, s[8:11], s53 offen offset:0 sc1
    buffer_load_dword v62, off, s[8:11], s62
    buffer_load_dword v62, off, s[8:11], s62
    buffer_load_dwordx4 v[212:215], v1, s[8:11], s53 offen offset:1024 sc1
    buffer_load_dwordx4 v[216:219], v1, s[8:11], s53 offen offset:2048 sc1
    s_sub_u32 s45, s45, 1
    s_nop 0
    s_cbranch_scc1 L_end
    s_waitcnt vmcnt(10)
    v_bitop3_b32 v7, v179, v183, v187 bitop3:0xfe
    v_bitop3_b32 v7, v7, v191, 1 bitop3:0xa8
    v_cmp_ne_u32 vcc, 0, v7
    s_nop 4
    s_cbranch_vccnz CHK_115
    s_nop 0
    s_branch RET_117
OOL_119:
    s_nop 10
CHK_118:
    s_add_u32 s78, s50, 0x9000
    buffer_load_dwordx4 v[192:195], v1, s[8:11], s78 offen offset:0 sc1
    buffer_load_dwordx4 v[196:199], v1, s[8:11], s78 offen offset:1024 sc1
    buffer_load_dwordx4 v[200:203], v1, s[8:11], s78 offen offset:2048 sc1
    buffer_load_dwordx4 v[204:207], v1, s[8:11], s78 offen offset:3072 sc1
    buffer_load_dwordx4 v[208:211], v1, s[8:11], s53 offen offset:0 sc1
    buffer_load_dword v62, off, s[8:11], s62
    buffer_load_dword v62, off, s[8:11], s62
    buffer_load_dwordx4 v[212:215], v1, s[8:11], s53 offen offset:1024 sc1
    buffer_load_dwordx4 v[216:219], v1, s[8:11], s53 offen offset:2048 sc1
    buffer_load_dwordx4 v[220:223], v1, s[8:11], s53 offen offset:3072 sc1
    s_add_u32 s78, s53, 0x1000
    buffer_load_dwordx4 v[224:227], v1, s[8:11], s78 offen offset:0 sc1
    buffer_load_dwordx4 v[228:231], v1, s[8:11], s78 offen offset:1024 sc1
    buffer_load_dwordx4 v[232:235], v1, s[8:11], s52 offen offset:0 sc1
    s_sub_u32 s45, s45, 1
    s_nop 0
    s_cbranch_scc1 L_end
    s_waitcnt vmcnt(9)
    v_bitop3_b32 v7, v195, v199, v203 bitop3:0xfe
    v_bitop3_b32 v7, v7, v207, 1 bitop3:0xa8
    v_cmp_ne_u32 vcc, 0, v7
    s_nop 4
    s_cbranch_vccnz CHK_118
    s_nop 0
    s_branch RET_120
OOL_122:
    s_nop 10
CHK_121:
    buffer_load_dwordx4 v[208:211], v1, s[8:11], s53 offen offset:0 sc1
    buffer_load_dword v62, off, s[8:11], s62
    buffer_load_dword v62, off, s[8:11], s62
    buffer_load_dwordx4 v[212:215], v1, s[8:11], s53 offen offset:1024 sc1
    buffer_load_dwordx4 v[216:219], v1, s[8:11], s53 offen offset:2048 sc1
    buffer_load_dwordx4 v[220:223], v1, s[8:11], s53 offen offset:3072 sc1
    s_add_u32 s78, s53, 0x1000
    buffer_load_dwordx4 v[224:227], v1, s[8:11], s78 offen offset:0 sc1
    buffer_load_dwordx4 v[228:231], v1, s[8:11], s78 offen offset:1024 sc1
    buffer_load_dwordx4 v[232:235], v1, s[8:11], s52 offen offset:0 sc1
    buffer_load_dwordx4 v[236:239], v1, s[8:11], s52 offen offset:1024 sc1
    buffer_load_dwordx4 v[240:243], v1, s[8:11], s52 offen offset:2048 sc1
    buffer_load_dwordx4 v[244:247], v1, s[8:11], s52 offen offset:3072 sc1
    s_add_u32 s78, s52, 0x1000
    buffer_load_dwordx4 v[248:251], v1, s[8:11], s78 offen offset:0 sc1
    s_sub_u32 s45, s45, 1
    s_nop 0
    s_cbranch_scc1 L_end
    s_waitcnt vmcnt(7)
    v_bitop3_b32 v7, v211, v215, v219 bitop3:0x80
    v_bitop3_b32 v7, v7, v223, 1 bitop3:0x2a
    v_cmp_ne_u32 vcc, 0, v7
    s_nop 4
    s_cbranch_vccnz CHK_121
    s_nop 0
    s_branch RET_123
OOL_125:
    s_nop 10
CHK_124:
    s_add_u32 s78, s53, 0x1000
    buffer_load_dwordx4 v[224:227], v1, s[8:11], s78 offen offset:0 sc1
    buffer_load_dwordx4 v[228:231], v1, s[8:11], s78 offen offset:1024 sc1
    buffer_load_dwordx4 v[232:235], v1, s[8:11], s52 offen offset:0 sc1
    buffer_load_dwordx4 v[236:239], v1, s[8:11], s52 offen offset:1024 sc1
    buffer_load_dwordx4 v[240:243], v1, s[8:11], s52 offen offset:2048 sc1
    buffer_load_dwordx4 v[244:247], v1, s[8:11], s52 offen offset:3072 sc1
    s_add_u32 s78, s52, 0x1000
    buffer_load_dwordx4 v[248:251], v1, s[8:11], s78 offen offset:0 sc1
    buffer_load_dwordx4 v[252:255], v1, s[8:11], s78 offen offset:1024 sc1
    s_add_u32 s78, s53, 0x1800
    buffer_load_dwordx4 v[144:147], v1, s[8:11], s78 offen offset:0 sc1
    buffer_load_dwordx4 v[148:151], v1, s[8:11], s78 offen offset:1024 sc1
    buffer_load_dwordx4 v[152:155], v1, s[8:11], s78 offen offset:2048 sc1
    s_sub_u32 s45, s45, 1
    s_nop 0
    s_cbranch_scc1 L_end
    s_waitcnt vmcnt(9)
    v_bitop3_b32 v7, v227, v231, 1 bitop3:0x2a
    v_cmp_ne_u32 vcc, 0, v7
    s_nop 4
    s_cbranch_vccnz CHK_124
    s_nop 0
    s_branch RET_126
OOL_128:
    s_nop 10
CHK_127:
    buffer_load_dwordx4 v[232:235], v1, s[8:11], s52 offen offset:0 sc1
    buffer_load_dwordx4 v[236:239], v1, s[8:11], s52 offen offset:1024 sc1
    buffer_load_dwordx4 v[240:243], v1, s[8:11], s52 offen offset:2048 sc1
    buffer_load_dwordx4 v[244:247], v1, s[8:11], s52 offen offset:3072 sc1
    s_add_u32 s78, s52, 0x1000
    buffer_load_dwordx4 v[248:251], v1, s[8:11], s78 offen offset:0 sc1
    buffer_load_dwordx4 v[252:255], v1, s[8:11], s78 offen offset:1024 sc1
    s_add_u32 s78, s53, 0x1800
    buffer_load_dwordx4 v[144:147], v1, s[8:11], s78 offen offset:0 sc1
    buffer_load_dwordx4 v[148:151], v1, s[8:11], s78 offen offset:1024 sc1
    buffer_load_dwordx4 v[152:155], v1, s[8:11], s78 offen offset:2048 sc1
    buffer_load_dwordx4 v[156:159], v1, s[8:11], s78 offen offset:3072 sc1
    s_add_u32 s78, s53, 0x2800
    buffer_load_dwordx4 v[160:163], v1, s[8:11], s78 offen offset:0 sc1
    s_sub_u32 s45, s45, 1
    s_nop 0
    s_cbranch_scc1 L_end
    s_waitcnt vmcnt(7)
    v_bitop3_b32 v7, v235, v239, v243 bitop3:0x80
    v_bitop3_b32 v7, v7, v247, 1 bitop3:0x2a
    v_cmp_ne_u32 vcc, 0, v7
    s_nop 4
    s_cbranch_vccnz CHK_127
    s_nop 0
    s_branch RET_129
OOL_131:
    s_nop 10
CHK_130:
    s_add_u32 s78, s52, 0x1000
    buffer_load_dwordx4 v[248:251], v1, s[8:11], s78 offen offset:0 sc1
    buffer_load_dwordx4 v[252:255], v1, s[8:11], s78 offen offset:1024 sc1
    s_add_u32 s78, s53, 0x1800
    buffer_load_dwordx4 v[144:147], v1, s[8:11], s78 offen offset:0 sc1
    buffer_load_dwordx4 v[148:151], v1, s[8:11], s78 offen offset:1024 sc1
    buffer_load_dwordx4 v[152:155], v1, s[8:11], s78 offen offset:2048 sc1
    buffer_load_dwordx4 v[156:159], v1, s[8:11], s78 offen offset:3072 sc1
    s_add_u32 s78, s53, 0x2800
    buffer_load_dwordx4 v[160:163], v1, s[8:11], s78 offen offset:0 sc1
    buffer_load_dwordx4 v[164:167], v1, s[8:11], s78 offen offset:1024 sc1
    s_add_u32 s78, s52, 0x1800
    buffer_load_dwordx4 v[168:171], v1, s[8:11], s78 offen offset:0 sc1
    buffer_load_dwordx4 v[172:175], v1, s[8:11], s78 offen offset:1024 sc1
    buffer_load_dwordx4 v[176:179], v1, s[8:11], s78 offen offset:2048 sc1
    s_sub_u32 s45, s45, 1
    s_nop 0
    s_cbranch_scc1 L_end
    s_waitcnt vmcnt(9)
    v_bitop3_b32 v7, v251, v255, 1 bitop3:0x2a
    v_cmp_ne_u32 vcc, 0, v7
    s_nop 4
    s_cbranch_vccnz CHK_130
    s_nop 0
    s_branch RET_132
OOL_134:
    s_nop 10
CHK_133:
    s_add_u32 s78, s53, 0x1800
    buffer_load_dwordx4 v[144:147], v1, s[8:11], s78 offen offset:0 sc1
    buffer_load_dwordx4 v[148:151], v1, s[8:11], s78 offen offset:1024 sc1
    buffer_load_dwordx4 v[152:155], v1, s[8:11], s78 offen offset:2048 sc1
    buffer_load_dwordx4 v[156:159], v1, s[8:11], s78 offen offset:3072 sc1
    s_add_u32 s78, s53, 0x2800
    buffer_load_dwordx4 v[160:163], v1, s[8:11], s78 offen offset:0 sc1
    buffer_load_dwordx4 v[164:167], v1, s[8:11], s78 offen offset:1024 sc1
    s_add_u32 s78, s52, 0x1800
    buffer_load_dwordx4 v[168:171], v1, s[8:11], s78 offen offset:0 sc1
    buffer_load_dwordx4 v[172:175], v1, s[8:11], s78 offen offset:1024 sc1
    buffer_load_dwordx4 v[176:179], v1, s[8:11], s78 offen offset:2048 sc1
    buffer_load_dwordx4 v[180:183], v1, s[8:11], s78 offen offset:3072 sc1
    s_add_u32 s78, s52, 0x2800
    buffer_load_dwordx4 v[184:187], v1, s[8:11], s78 offen offset:0 sc1
    s_sub_u32 s45, s45, 1
    s_nop 0
    s_cbranch_scc1 L_end
    s_waitcnt vmcnt(7)
    v_bitop3_b32 v7, v147, v151, v155 bitop3:0x80
    v_bitop3_b32 v7, v7, v159, 1 bitop3:0x2a
    v_cmp_ne_u32 vcc, 0, v7
    s_nop 4
    s_cbranch_vccnz CHK_133
    s_nop 0
    s_branch RET_135
OOL_137:
    s_nop 10
CHK_136:
    s_add_u32 s78, s53, 0x2800
    buffer_load_dwordx4 v[160:163], v1, s[8:11], s78 offen offset:0 sc1
    buffer_load_dwordx4 v[164:167], v1, s[8:11], s78 offen offset:1024 sc1
    s_add_u32 s78, s52, 0x1800
    buffer_load_dwordx4 v[168:171], v1, s[8:11], s78 offen offset:0 sc1
    buffer_load_dwordx4 v[172:175], v1, s[8:11], s78 offen offset:1024 sc1
    buffer_load_dwordx4 v[176:179], v1, s[8:11], s78 offen offset:2048 sc1
    buffer_load_dwordx4 v[180:183], v1, s[8:11], s78 offen offset:3072 sc1
    s_add_u32 s78, s52, 0x2800
    buffer_load_dwordx4 v[184:187], v1, s[8:11], s78 offen offset:0 sc1
    buffer_load_dwordx4 v[188:191], v1, s[8:11], s78 offen offset:1024 sc1
    buffer_load_dword v62, off, s[8:11], s62
    buffer_load_dword v62, off, s[8:11], s62
    buffer_load_dword v62, off, s[8:11], s62
    s_sub_u32 s45, s45, 1
    s_nop 0
    s_cbranch_scc1 L_end
    s_waitcnt vmcnt(9)
    v_bitop3_b32 v7, v163, v167, 1 bitop3:0x2a
    v_cmp_ne_u32 vcc, 0, v7
    s_nop 4
    s_cbranch_vccnz CHK_136
    s_nop 0
    s_branch RET_138
OOL_140:
    s_nop 10
CHK_139:
    s_add_u32 s78, s52, 0x1800
    buffer_load_dwordx4 v[168:171], v1, s[8:11], s78 offen offset:0 sc1
    buffer_load_dwordx4 v[172:175], v1, s[8:11], s78 offen offset:1024 sc1
    buffer_load_dwordx4 v[176:179], v1, s[8:11], s78 offen offset:2048 sc1
    buffer_load_dwordx4 v[180:183], v1, s[8:11], s78 offen offset:3072 sc1
    s_add_u32 s78, s52, 0x2800
    buffer_load_dwordx4 v[184:187], v1, s[8:11], s78 offen offset:0 sc1
    buffer_load_dwordx4 v[188:191], v1, s[8:11], s78 offen offset:1024 sc1
    buffer_load_dword v62, off, s[8:11], s62
    buffer_load_dword v62, off, s[8:11], s62
    buffer_load_dword v62, off, s[8:11], s62
    buffer_load_dword v62, off, s[8:11], s62
    buffer_load_dword v62, off, s[8:11], s62
    s_sub_u32 s45, s45, 1
    s_nop 0
    s_cbranch_scc1 L_end
    s_waitcnt vmcnt(7)
    v_bitop3_b32 v7, v171, v175, v179 bitop3:0x80
    v_bitop3_b32 v7, v7, v183, 1 bitop3:0x2a
    v_cmp_ne_u32 vcc, 0, v7
    s_nop 4
    s_cbranch_vccnz CHK_139
    s_nop 0
    s_branch RET_141
OOL_144:
    s_nop 10
CHK_143:
    s_add_u32 s78, s52, 0x2800
    buffer_load_dwordx4 v[184:187], v1, s[8:11], s78 offen offset:0 sc1
    buffer_load_dwordx4 v[188:191], v1, s[8:11], s78 offen offset:1024 sc1
    buffer_load_dword v62, off, s[8:11], s62
    buffer_load_dword v62, off, s[8:11], s62
    buffer_load_dword v62, off, s[8:11], s62
    buffer_load_dword v62, off, s[8:11], s62
    buffer_load_dword v62, off, s[8:11], s62
    buffer_load_dword v62, off, s[8:11], s62
    buffer_load_dword v62, off, s[8:11], s62
    buffer_load_dword v62, off, s[8:11], s62
    s_sub_u32 s45, s45, 1
    s_nop 0
    s_cbranch_scc1 L_end
    s_waitcnt vmcnt(8)
    v_bitop3_b32 v7, v187, v191, 1 bitop3:0x2a
    v_cmp_ne_u32 vcc, 0, v7
    s_nop 4
    s_cbranch_vccnz CHK_143
    s_nop 0
    s_branch RET_145
OOL_147:
    s_nop 3
CHK_146:
    buffer_load_dwordx4 v[80:83], v1, s[8:11], s76 offen offset:0 sc1
    buffer_load_dwordx4 v[84:87], v1, s[8:11], s76 offen offset:1024 sc1
    buffer_load_dwordx4 v[88:91], v1, s[8:11], s76 offen offset:2048 sc1
    buffer_load_dwordx4 v[92:95], v1, s[8:11], s76 offen offset:3072 sc1
    s_sub_u32 s45, s45, 1
    s_nop 0
    s_cbranch_scc1 L_end
    s_waitcnt vmcnt(0)
    v_bitop3_b32 v7, v80, v81, v82 bitop3:0xfe
    v_bitop3_b32 v7, v7, v83, v84 bitop3:0xfe
    v_bitop3_b32 v7, v7, v85, v86 bitop3:0xfe
    v_bitop3_b32 v7, v7, v87, v88 bitop3:0xfe
    v_bitop3_b32 v7, v7, v89, v90 bitop3:0xfe
    v_bitop3_b32 v7, v7, v91, v92 bitop3:0xfe
    v_bitop3_b32 v7, v7, v93, v94 bitop3:0xfe
    v_bitop3_b32 v7, v7, v95, 1 bitop3:0xa8
    v_cmp_ne_u32 vcc, 0, v7
    s_nop 4
    s_cbranch_vccnz CHK_146
    s_nop 0
    s_branch RET_148
OOL_150:
    s_nop 3
CHK_149:
    s_add_u32 s79, s51, 0x10000
    buffer_load_dwordx4 v[132:135], v1, s[8:11], s79 offen offset:0 sc1
    buffer_load_dwordx4 v[140:143], v1, s[8:11], s79 offen offset:1024 sc1
    buffer_load_dwordx4 v[148:151], v1, s[8:11], s79 offen offset:2048 sc1
    buffer_load_dwordx4 v[156:159], v1, s[8:11], s79 offen offset:3072 sc1
    s_add_u32 s79, s51, 0x11000
    buffer_load_dwordx4 v[164:167], v1, s[8:11], s79 offen offset:0 sc1
    buffer_load_dwordx4 v[172:175], v1, s[8:11], s79 offen offset:1024 sc1
    buffer_load_dwordx4 v[180:183], v1, s[8:11], s79 offen offset:2048 sc1
    buffer_load_dwordx4 v[188:191], v1, s[8:11], s79 offen offset:3072 sc1
    s_sub_u32 s45, s45, 1
    s_nop 0
    s_cbranch_scc1 L_end
    s_waitcnt vmcnt(6)
    v_bitop3_b32 v7, v135, v143, 1 bitop3:0xa8
    v_cmp_ne_u32 vcc, 0, v7
    s_nop 4
    s_cbranch_vccnz CHK_149
    s_nop 0
    s_branch RET_151
OOL_153:
    s_nop 10
CHK_152:
    s_add_u32 s79, s51, 0x10000
    buffer_load_dwordx4 v[148:151], v1, s[8:11], s79 offen offset:2048 sc1
    buffer_load_dwordx4 v[156:159], v1, s[8:11], s79 offen offset:3072 sc1
    s_add_u32 s79, s51, 0x11000
    buffer_load_dwordx4 v[164:167], v1, s[8:11], s79 offen offset:0 sc1
    buffer_load_dwordx4 v[172:175], v1, s[8:11], s79 offen offset:1024 sc1
    buffer_load_dwordx4 v[180:183], v1, s[8:11], s79 offen offset:2048 sc1
    buffer_load_dwordx4 v[188:191], v1, s[8:11], s79 offen offset:3072 sc1
    s_add_u32 s80, s50, 0x10000
    buffer_load_dwordx4 v[128:131], v1, s[8:11], s80 offen offset:0 sc1
    buffer_load_dword v62, off, s[8:11], s62
    buffer_load_dwordx4 v[136:139], v1, s[8:11], s80 offen offset:1024 sc1
    s_sub_u32 s45, s45, 1
    s_nop 0
    s_cbranch_scc1 L_end
    s_waitcnt vmcnt(7)
    v_bitop3_b32 v7, v151, v159, 1 bitop3:0xa8
    v_cmp_ne_u32 vcc, 0, v7
    s_nop 4
    s_cbranch_vccnz CHK_152
    s_nop 0
    s_branch RET_154
OOL_156:
    s_nop 10
CHK_155:
    s_add_u32 s79, s51, 0x11000
    buffer_load_dwordx4 v[164:167], v1, s[8:11], s79 offen offset:0 sc1
    buffer_load_dwordx4 v[172:175], v1, s[8:11], s79 offen offset:1024 sc1
    buffer_load_dwordx4 v[180:183], v1, s[8:11], s79 offen offset:2048 sc1
    buffer_load_dwordx4 v[188:191], v1, s[8:11], s79 offen offset:3072 sc1
    s_add_u32 s80, s50, 0x10000
    buffer_load_dwordx4 v[128:131], v1, s[8:11], s80 offen offset:0 sc1
    buffer_load_dword v62, off, s[8:11], s62
    buffer_load_dwordx4 v[136:139], v1, s[8:11], s80 offen offset:1024 sc1
    buffer_load_dwordx4 v[144:147], v1, s[8:11], s80 offen offset:2048 sc1
    buffer_load_dwordx4 v[152:155], v1, s[8:11], s80 offen offset:3072 sc1
    s_sub_u32 s45, s45, 1
    s_nop 0
    s_cbranch_scc1 L_end
    s_waitcnt vmcnt(5)
    v_bitop3_b32 v7, v167, v175, v183 bitop3:0xfe
    v_bitop3_b32 v7, v7, v191, 1 bitop3:0xa8
    v_cmp_ne_u32 vcc, 0, v7
    s_nop 4
    s_cbranch_vccnz CHK_155
    s_nop 0
    s_branch RET_157
OOL_159:
    s_nop 10
CHK_158:
    s_add_u32 s80, s50, 0x10000
    buffer_load_dwordx4 v[128:131], v1, s[8:11], s80 offen offset:0 sc1
    buffer_load_dword v62, off, s[8:11], s62
    buffer_load_dwordx4 v[136:139], v1, s[8:11], s80 offen offset:1024 sc1
    buffer_load_dwordx4 v[144:147], v1, s[8:11], s80 offen offset:2048 sc1
    buffer_load_dwordx4 v[152:155], v1, s[8:11], s80 offen offset:3072 sc1
    s_add_u32 s80, s50, 0x11000
    buffer_load_dwordx4 v[160:163], v1, s[8:11], s80 offen offset:0 sc1
    buffer_load_dwordx4 v[168:171], v1, s[8:11], s80 offen offset:1024 sc1
    buffer_load_dwordx4 v[176:179], v1, s[8:11], s80 offen offset:2048 sc1
    buffer_load_dwordx4 v[184:187], v1, s[8:11], s80 offen offset:3072 sc1
    s_sub_u32 s45, s45, 1
    s_nop 0
    s_cbranch_scc1 L_end
    s_waitcnt vmcnt(4)
    v_bitop3_b32 v7, v131, v139, v147 bitop3:0xfe
    v_bitop3_b32 v7, v7, v155, 1 bitop3:0xa8
    v_cmp_ne_u32 vcc, 0, v7
    s_nop 4
    s_cbranch_vccnz CHK_158
    s_nop 0
    s_branch RET_160
OOL_162:
    s_nop 10
CHK_161:
    s_add_u32 s80, s50, 0x11000
    buffer_load_dwordx4 v[160:163], v1, s[8:11], s80 offen offset:0 sc1
    buffer_load_dwordx4 v[168:171], v1, s[8:11], s80 offen offset:1024 sc1
    buffer_load_dwordx4 v[176:179], v1, s[8:11], s80 offen offset:2048 sc1
    buffer_load_dwordx4 v[184:187], v1, s[8:11], s80 offen offset:3072 sc1
    buffer_load_dword v62, off, s[8:11], s62
    buffer_load_dword v62, off, s[8:11], s62
    buffer_load_dword v62, off, s[8:11], s62
    buffer_load_dword v62, off, s[8:11], s62
    buffer_load_dword v62, off, s[8:11], s62
    s_sub_u32 s45, s45, 1
    s_nop 0
    s_cbranch_scc1 L_end
    s_waitcnt vmcnt(7)
    v_bitop3_b32 v7, v163, v171, 1 bitop3:0xa8
    v_cmp_ne_u32 vcc, 0, v7
    s_nop 4
    s_cbranch_vccnz CHK_161
    s_nop 0
    s_branch RET_163
OOL_165:
    s_nop 10
CHK_164:
    s_add_u32 s80, s50, 0x11000
    buffer_load_dwordx4 v[176:179], v1, s[8:11], s80 offen offset:2048 sc1
    buffer_load_dwordx4 v[184:187], v1, s[8:11], s80 offen offset:3072 sc1
    buffer_load_dword v62, off, s[8:11], s62
    buffer_load_dword v62, off, s[8:11], s62
    buffer_load_dword v62, off, s[8:11], s62
    buffer_load_dword v62, off, s[8:11], s62
    buffer_load_dword v62, off, s[8:11], s62
    buffer_load_dword v62, off, s[8:11], s62
    buffer_load_dword v62, off, s[8:11], s62
    buffer_load_dword v62, off, s[8:11], s62
    buffer_load_dword v62, off, s[8:11], s62
    s_sub_u32 s45, s45, 1
    s_nop 0
    s_cbranch_scc1 L_end
    s_waitcnt vmcnt(9)
    v_bitop3_b32 v7, v179, v187, 1 bitop3:0xa8
    v_cmp_ne_u32 vcc, 0, v7
    s_nop 4
    s_cbranch_vccnz CHK_164
    s_nop 0
    s_branch RET_166
OOL_168:
    s_nop 3
CHK_167:
    buffer_load_dwordx4 v[132:135], v1, s[8:11], s49 offen offset:0 sc1
    buffer_load_dwordx4 v[140:143], v1, s[8:11], s49 offen offset:1024 sc1
    buffer_load_dwordx4 v[148:151], v1, s[8:11], s49 offen offset:2048 sc1
    buffer_load_dwordx4 v[156:159], v1, s[8:11], s49 offen offset:3072 sc1
    s_sub_u32 s45, s45, 1
    s_nop 0
    s_cbranch_scc1 L_end
    s_waitcnt vmcnt(0)
    v_bitop3_b32 v7, v132, v133, v134 bitop3:0x80
    v_bitop3_b32 v7, v7, v135, v140 bitop3:0x80
    v_bitop3_b32 v7, v7, v141, v142 bitop3:0x80
    v_bitop3_b32 v7, v7, v143, v148 bitop3:0x80
    v_bitop3_b32 v7, v7, v149, v150 bitop3:0x80
    v_bitop3_b32 v7, v7, v151, v156 bitop3:0x80
    v_bitop3_b32 v7, v7, v157, v158 bitop3:0x80
    v_bitop3_b32 v7, v7, v159, 1 bitop3:0x2a
    v_cmp_ne_u32 vcc, 0, v7
    s_nop 4
    s_cbranch_vccnz CHK_167
    s_nop 0
    s_branch RET_169
OOL_171:
    s_nop 3
CHK_170:
    buffer_load_dword v9, v8, s[8:11], 0 offen offset:0 sc1
    s_sub_u32 s45, s45, 1
    s_nop 0
    s_cbranch_scc1 L_end
    s_waitcnt vmcnt(0)
    v_subrev_u32 v9, s69, v9
    v_subrev_u32 v9, 3, v9
    v_cmp_lt_u32 vcc, 7, v9
    s_nop 4
    s_cbranch_vccnz CHK_170
    s_nop 0
    s_branch RET_172
OOL_174:
    s_add_u32 s76, s46, 0x8000
    buffer_store_dwordx4 v[112:115], v4, s[8:11], s76 offen offset:0
    buffer_store_dwordx4 v[116:119], v4, s[8:11], s76 offen offset:1024
    s_nop 1
    s_branch RET_175
OOL_177:
    s_nop 3
CHK_176:
    s_add_u32 s79, s51, 0x8000
    buffer_load_dwordx4 v[132:135], v1, s[8:11], s79 offen offset:0 sc1
    buffer_load_dwordx4 v[140:143], v1, s[8:11], s79 offen offset:1024 sc1
    buffer_load_dwordx4 v[148:151], v1, s[8:11], s79 offen offset:2048 sc1
    buffer_load_dwordx4 v[156:159], v1, s[8:11], s79 offen offset:3072 sc1
    s_add_u32 s79, s51, 0x9000
    buffer_load_dwordx4 v[164:167], v1, s[8:11], s79 offen offset:0 sc1
    buffer_load_dwordx4 v[172:175], v1, s[8:11], s79 offen offset:1024 sc1
    buffer_load_dwordx4 v[180:183], v1, s[8:11], s79 offen offset:2048 sc1
    buffer_load_dwordx4 v[188:191], v1, s[8:11], s79 offen offset:3072 sc1
    s_sub_u32 s45, s45, 1
    s_nop 0
    s_cbranch_scc1 L_end
    s_waitcnt vmcnt(6)
    v_bitop3_b32 v7, v135, v143, 1 bitop3:0x2a
    v_cmp_ne_u32 vcc, 0, v7
    s_nop 4
    s_cbranch_vccnz CHK_176
    s_nop 0
    s_branch RET_178
OOL_180:
    s_nop 10
CHK_179:
    s_add_u32 s79, s51, 0x8000
    buffer_load_dwordx4 v[148:151], v1, s[8:11], s79 offen offset:2048 sc1
    buffer_load_dwordx4 v[156:159], v1, s[8:11], s79 offen offset:3072 sc1
    s_add_u32 s79, s51, 0x9000
    buffer_load_dwordx4 v[164:167], v1, s[8:11], s79 offen offset:0 sc1
    buffer_load_dwordx4 v[172:175], v1, s[8:11], s79 offen offset:1024 sc1
    buffer_load_dwordx4 v[180:183], v1, s[8:11], s79 offen offset:2048 sc1
    buffer_load_dwordx4 v[188:191], v1, s[8:11], s79 offen offset:3072 sc1
    s_add_u32 s80, s50, 0x8000
    buffer_load_dwordx4 v[128:131], v5, s[8:11], s80 offen offset:0 sc1
    buffer_load_dwordx4 v[136:139], v5, s[8:11], s80 offen offset:1024 sc1
    s_sub_u32 s45, s45, 1
    s_nop 0
    s_cbranch_scc1 L_end
    s_waitcnt vmcnt(6)
    v_bitop3_b32 v7, v151, v159, 1 bitop3:0x2a
    v_cmp_ne_u32 vcc, 0, v7
    s_nop 4
    s_cbranch_vccnz CHK_179
    s_nop 0
    s_branch RET_181
OOL_183:
    s_nop 10
CHK_182:
    s_add_u32 s79, s51, 0x9000
    buffer_load_dwordx4 v[164:167], v1, s[8:11], s79 offen offset:0 sc1
    buffer_load_dwordx4 v[172:175], v1, s[8:11], s79 offen offset:1024 sc1
    buffer_load_dwordx4 v[180:183], v1, s[8:11], s79 offen offset:2048 sc1
    buffer_load_dwordx4 v[188:191], v1, s[8:11], s79 offen offset:3072 sc1
    s_add_u32 s80, s50, 0x8000
    buffer_load_dwordx4 v[128:131], v5, s[8:11], s80 offen offset:0 sc1
    buffer_load_dwordx4 v[136:139], v5, s[8:11], s80 offen offset:1024 sc1
    buffer_load_dwordx4 v[144:147], v5, s[8:11], s80 offen offset:2048 sc1
    buffer_load_dwordx4 v[152:155], v5, s[8:11], s80 offen offset:3072 sc1
    s_sub_u32 s45, s45, 1
    s_nop 0
    s_cbranch_scc1 L_end
    s_waitcnt vmcnt(6)
    v_bitop3_b32 v7, v167, v175, 1 bitop3:0x2a
    v_cmp_ne_u32 vcc, 0, v7
    s_nop 4
    s_cbranch_vccnz CHK_182
    s_nop 0
    s_branch RET_184
OOL_186:
    s_nop 10
CHK_185:
    s_add_u32 s79, s51, 0x9000
    buffer_load_dwordx4 v[180:183], v1, s[8:11], s79 offen offset:2048 sc1
    buffer_load_dwordx4 v[188:191], v1, s[8:11], s79 offen offset:3072 sc1
    s_add_u32 s80, s50, 0x8000
    buffer_load_dwordx4 v[128:131], v5, s[8:11], s80 offen offset:0 sc1
    buffer_load_dwordx4 v[136:139], v5, s[8:11], s80 offen offset:1024 sc1
    buffer_load_dwordx4 v[144:147], v5, s[8:11], s80 offen offset:2048 sc1
    buffer_load_dwordx4 v[152:155], v5, s[8:11], s80 offen offset:3072 sc1
    s_add_u32 s80, s50, 0x9000
    buffer_load_dwordx4 v[160:163], v5, s[8:11], s80 offen offset:0 sc1
    buffer_load_dwordx4 v[168:171], v5, s[8:11], s80 offen offset:1024 sc1
    s_sub_u32 s45, s45, 1
    s_nop 0
    s_cbranch_scc1 L_end
    s_waitcnt vmcnt(6)
    v_bitop3_b32 v7, v183, v191, 1 bitop3:0x2a
    v_cmp_ne_u32 vcc, 0, v7
    s_nop 4
    s_cbranch_vccnz CHK_185
    s_nop 0
    s_branch RET_187
OOL_189:
    s_nop 10
CHK_188:
    s_add_u32 s80, s50, 0x8000
    buffer_load_dwordx4 v[128:131], v5, s[8:11], s80 offen offset:0 sc1
    buffer_load_dwordx4 v[136:139], v5, s[8:11], s80 offen offset:1024 sc1
    buffer_load_dwordx4 v[144:147], v5, s[8:11], s80 offen offset:2048 sc1
    buffer_load_dwordx4 v[152:155], v5, s[8:11], s80 offen offset:3072 sc1
    s_add_u32 s80, s50, 0x9000
    buffer_load_dwordx4 v[160:163], v5, s[8:11], s80 offen offset:0 sc1
    buffer_load_dwordx4 v[168:171], v5, s[8:11], s80 offen offset:1024 sc1
    buffer_load_dwordx4 v[176:179], v5, s[8:11], s80 offen offset:2048 sc1
    buffer_load_dwordx4 v[184:187], v5, s[8:11], s80 offen offset:3072 sc1
    s_sub_u32 s45, s45, 1
    s_nop 0
    s_cbranch_scc1 L_end
    s_waitcnt vmcnt(4)
    v_bitop3_b32 v7, v131, v139, v147 bitop3:0x80
    v_bitop3_b32 v7, v7, v155, 1 bitop3:0x2a
    v_cmp_ne_u32 vcc, 0, v7
    s_nop 4
    s_cbranch_vccnz CHK_188
    s_nop 0
    s_branch RET_190
OOL_192:
    s_nop 10
CHK_191:
    s_add_u32 s80, s50, 0x9000
    buffer_load_dwordx4 v[160:163], v5, s[8:11], s80 offen offset:0 sc1
    buffer_load_dwordx4 v[168:171], v5, s[8:11], s80 offen offset:1024 sc1
    buffer_load_dwordx4 v[176:179], v5, s[8:11], s80 offen offset:2048 sc1
    buffer_load_dwordx4 v[184:187], v5, s[8:11], s80 offen offset:3072 sc1
    s_sub_u32 s45, s45, 1
    s_nop 0
    s_cbranch_scc1 L_end
    s_waitcnt vmcnt(2)
    v_bitop3_b32 v7, v163, v171, 1 bitop3:0x2a
    v_cmp_ne_u32 vcc, 0, v7
    s_nop 4
    s_cbranch_vccnz CHK_191
    s_nop 0
    s_branch RET_193
OOL_195:
    s_nop 10
CHK_194:
    s_add_u32 s80, s50, 0x9000
    buffer_load_dwordx4 v[176:179], v5, s[8:11], s80 offen offset:2048 sc1
    buffer_load_dwordx4 v[184:187], v5, s[8:11], s80 offen offset:3072 sc1
    s_sub_u32 s45, s45, 1
    s_nop 0
    s_cbranch_scc1 L_end
    s_waitcnt vmcnt(0)
    v_bitop3_b32 v7, v179, v187, 1 bitop3:0x2a
    v_cmp_ne_u32 vcc, 0, v7
    s_nop 4
    s_cbranch_vccnz CHK_194
    s_nop 0
    s_branch RET_196
OOL_198:
    s_nop 3
CHK_197:
    buffer_load_dwordx4 v[128:131], v1, s[8:11], s59 offen offset:0 sc1
    buffer_load_dwordx4 v[132:135], v1, s[8:11], s59 offen offset:1024 sc1
    buffer_load_dwordx4 v[136:139], v1, s[8:11], s59 offen offset:2048 sc1
    buffer_load_dwordx4 v[140:143], v1, s[8:11], s59 offen offset:3072 sc1
    s_add_u32 s79, s59, 0x1000
    buffer_load_dwordx4 v[144:147], v1, s[8:11], s79 offen offset:0 sc1
    buffer_load_dwordx4 v[148:151], v1, s[8:11], s79 offen offset:1024 sc1
    buffer_load_dwordx4 v[152:155], v1, s[8:11], s79 offen offset:2048 sc1
    buffer_load_dwordx4 v[156:159], v1, s[8:11], s79 offen offset:3072 sc1
    s_add_u32 s79, s59, 0x2000
    buffer_load_dwordx4 v[160:163], v1, s[8:11], s79 offen offset:0 sc1
    buffer_load_dwordx4 v[164:167], v1, s[8:11], s79 offen offset:1024 sc1
    buffer_load_dwordx4 v[168:171], v1, s[8:11], s79 offen offset:2048 sc1
    buffer_load_dwordx4 v[172:175], v1, s[8:11], s79 offen offset:3072 sc1
    s_sub_u32 s45, s45, 1
    s_nop 0
    s_cbranch_scc1 L_end
    s_waitcnt vmcnt(10)
    v_bitop3_b32 v7, v131, v135, 1 bitop3:0x2a
    v_cmp_ne_u32 vcc, 0, v7
    s_nop 4
    s_cbranch_vccnz CHK_197
    s_nop 0
    s_branch RET_199
OOL_201:
    s_nop 10
CHK_200:
    buffer_load_dwordx4 v[136:139], v1, s[8:11], s59 offen offset:2048 sc1
    buffer_load_dwordx4 v[140:143], v1, s[8:11], s59 offen offset:3072 sc1
    s_add_u32 s79, s59, 0x1000
    buffer_load_dwordx4 v[144:147], v1, s[8:11], s79 offen offset:0 sc1
    buffer_load_dwordx4 v[148:151], v1, s[8:11], s79 offen offset:1024 sc1
    buffer_load_dwordx4 v[152:155], v1, s[8:11], s79 offen offset:2048 sc1
    buffer_load_dwordx4 v[156:159], v1, s[8:11], s79 offen offset:3072 sc1
    s_add_u32 s79, s59, 0x2000
    buffer_load_dwordx4 v[160:163], v1, s[8:11], s79 offen offset:0 sc1
    buffer_load_dwordx4 v[164:167], v1, s[8:11], s79 offen offset:1024 sc1
    buffer_load_dwordx4 v[168:171], v1, s[8:11], s79 offen offset:2048 sc1
    buffer_load_dwordx4 v[172:175], v1, s[8:11], s79 offen offset:3072 sc1
    s_add_u32 s79, s59, 0x3000
    buffer_load_dwordx4 v[176:179], v1, s[8:11], s79 offen offset:0 sc1
    buffer_load_dwordx4 v[180:183], v1, s[8:11], s79 offen offset:1024 sc1
    s_sub_u32 s45, s45, 1
    s_nop 0
    s_cbranch_scc1 L_end
    s_waitcnt vmcnt(10)
    v_bitop3_b32 v7, v139, v143, 1 bitop3:0x2a
    v_cmp_ne_u32 vcc, 0, v7
    s_nop 4
    s_cbranch_vccnz CHK_200
    s_nop 0
    s_branch RET_202
OOL_204:
    s_nop 10
CHK_203:
    s_add_u32 s79, s59, 0x1000
    buffer_load_dwordx4 v[144:147], v1, s[8:11], s79 offen offset:0 sc1
    buffer_load_dwordx4 v[148:151], v1, s[8:11], s79 offen offset:1024 sc1
    buffer_load_dwordx4 v[152:155], v1, s[8:11], s79 offen offset:2048 sc1
    buffer_load_dwordx4 v[156:159], v1, s[8:11], s79 offen offset:3072 sc1
    s_add_u32 s79, s59, 0x2000
    buffer_load_dwordx4 v[160:163], v1, s[8:11], s79 offen offset:0 sc1
    buffer_load_dwordx4 v[164:167], v1, s[8:11], s79 offen offset:1024 sc1
    buffer_load_dwordx4 v[168:171], v1, s[8:11], s79 offen offset:2048 sc1
    buffer_load_dwordx4 v[172:175], v1, s[8:11], s79 offen offset:3072 sc1
    s_add_u32 s79, s59, 0x3000
    buffer_load_dwordx4 v[176:179], v1, s[8:11], s79 offen offset:0 sc1
    buffer_load_dwordx4 v[180:183], v1, s[8:11], s79 offen offset:1024 sc1
    buffer_load_dwordx4 v[184:187], v1, s[8:11], s79 offen offset:2048 sc1
    buffer_load_dwordx4 v[188:191], v1, s[8:11], s79 offen offset:3072 sc1
    s_sub_u32 s45, s45, 1
    s_nop 0
    s_cbranch_scc1 L_end
    s_waitcnt vmcnt(8)
    v_bitop3_b32 v7, v147, v151, v155 bitop3:0x80
    v_bitop3_b32 v7, v7, v159, 1 bitop3:0x2a
    v_cmp_ne_u32 vcc, 0, v7
    s_nop 4
    s_cbranch_vccnz CHK_203
    s_nop 0
    s_branch RET_205
OOL_207:
    s_nop 10
CHK_206:
    s_add_u32 s79, s59, 0x2000
    buffer_load_dwordx4 v[160:163], v1, s[8:11], s79 offen offset:0 sc1
    buffer_load_dwordx4 v[164:167], v1, s[8:11], s79 offen offset:1024 sc1
    buffer_load_dwordx4 v[168:171], v1, s[8:11], s79 offen offset:2048 sc1
    buffer_load_dwordx4 v[172:175], v1, s[8:11], s79 offen offset:3072 sc1
    s_add_u32 s79, s59, 0x3000
    buffer_load_dwordx4 v[176:179], v1, s[8:11], s79 offen offset:0 sc1
    buffer_load_dwordx4 v[180:183], v1, s[8:11], s79 offen offset:1024 sc1
    buffer_load_dwordx4 v[184:187], v1, s[8:11], s79 offen offset:2048 sc1
    buffer_load_dwordx4 v[188:191], v1, s[8:11], s79 offen offset:3072 sc1
    s_add_u32 s79, s59, 0x4000
    buffer_load_dwordx4 v[192:195], v1, s[8:11], s79 offen offset:0 sc1
    buffer_load_dwordx4 v[196:199], v1, s[8:11], s79 offen offset:1024 sc1
    buffer_load_dwordx4 v[200:203], v1, s[8:11], s79 offen offset:2048 sc1
    buffer_load_dwordx4 v[204:207], v1, s[8:11], s79 offen offset:3072 sc1
    s_sub_u32 s45, s45, 1
    s_nop 0
    s_cbranch_scc1 L_end
    s_waitcnt vmcnt(8)
    v_bitop3_b32 v7, v163, v167, v171 bitop3:0x80
    v_bitop3_b32 v7, v7, v175, 1 bitop3:0x2a
    v_cmp_ne_u32 vcc, 0, v7
    s_nop 4
    s_cbranch_vccnz CHK_206
    s_nop 0
    s_branch RET_208
OOL_210:
    s_nop 10
CHK_209:
    s_add_u32 s79, s59, 0x3000
    buffer_load_dwordx4 v[176:179], v1, s[8:11], s79 offen offset:0 sc1
    buffer_load_dwordx4 v[180:183], v1, s[8:11], s79 offen offset:1024 sc1
    buffer_load_dwordx4 v[184:187], v1, s[8:11], s79 offen offset:2048 sc1
    buffer_load_dwordx4 v[188:191], v1, s[8:11], s79 offen offset:3072 sc1
    s_add_u32 s79, s59, 0x4000
    buffer_load_dwordx4 v[192:195], v1, s[8:11], s79 offen offset:0 sc1
    buffer_load_dwordx4 v[196:199], v1, s[8:11], s79 offen offset:1024 sc1
    buffer_load_dwordx4 v[200:203], v1, s[8:11], s79 offen offset:2048 sc1
    buffer_load_dwordx4 v[204:207], v1, s[8:11], s79 offen offset:3072 sc1
    s_add_u32 s79, s59, 0x5000
    buffer_load_dwordx4 v[208:211], v1, s[8:11], s79 offen offset:0 sc1
    buffer_load_dwordx4 v[212:215], v1, s[8:11], s79 offen offset:1024 sc1
    buffer_load_dwordx4 v[216:219], v1, s[8:11], s79 offen offset:2048 sc1
    buffer_load_dwordx4 v[220:223], v1, s[8:11], s79 offen offset:3072 sc1
    s_sub_u32 s45, s45, 1
    s_nop 0
    s_cbranch_scc1 L_end
    s_waitcnt vmcnt(8)
    v_bitop3_b32 v7, v179, v183, v187 bitop3:0x80
    v_bitop3_b32 v7, v7, v191, 1 bitop3:0x2a
    v_cmp_ne_u32 vcc, 0, v7
    s_nop 4
    s_cbranch_vccnz CHK_209
    s_nop 0
    s_branch RET_211
OOL_213:
    s_nop 10
CHK_212:
    s_add_u32 s79, s59, 0x4000
    buffer_load_dwordx4 v[192:195], v1, s[8:11], s79 offen offset:0 sc1
    buffer_load_dwordx4 v[196:199], v1, s[8:11], s79 offen offset:1024 sc1
    buffer_load_dwordx4 v[200:203], v1, s[8:11], s79 offen offset:2048 sc1
    buffer_load_dwordx4 v[204:207], v1, s[8:11], s79 offen offset:3072 sc1
    s_add_u32 s79, s59, 0x5000
    buffer_load_dwordx4 v[208:211], v1, s[8:11], s79 offen offset:0 sc1
    buffer_load_dwordx4 v[212:215], v1, s[8:11], s79 offen offset:1024 sc1
    buffer_load_dwordx4 v[216:219], v1, s[8:11], s79 offen offset:2048 sc1
    buffer_load_dwordx4 v[220:223], v1, s[8:11], s79 offen offset:3072 sc1
    s_add_u32 s79, s59, 0x6000
    buffer_load_dwordx4 v[224:227], v1, s[8:11], s79 offen offset:0 sc1
    buffer_load_dwordx4 v[228:231], v1, s[8:11], s79 offen offset:1024 sc1
    buffer_load_dwordx4 v[232:235], v1, s[8:11], s79 offen offset:2048 sc1
    buffer_load_dwordx4 v[236:239], v1, s[8:11], s79 offen offset:3072 sc1
    s_sub_u32 s45, s45, 1
    s_nop 0
    s_cbranch_scc1 L_end
    s_waitcnt vmcnt(8)
    v_bitop3_b32 v7, v195, v199, v203 bitop3:0x80
    v_bitop3_b32 v7, v7, v207, 1 bitop3:0x2a
    v_cmp_ne_u32 vcc, 0, v7
    s_nop 4
    s_cbranch_vccnz CHK_212
    s_nop 0
    s_branch RET_214
OOL_216:
    s_nop 10
CHK_215:
    s_add_u32 s79, s59, 0x5000
    buffer_load_dwordx4 v[208:211], v1, s[8:11], s79 offen offset:0 sc1
    buffer_load_dwordx4 v[212:215], v1, s[8:11], s79 offen offset:1024 sc1
    buffer_load_dwordx4 v[216:219], v1, s[8:11], s79 offen offset:2048 sc1
    buffer_load_dwordx4 v[220:223], v1, s[8:11], s79 offen offset:3072 sc1
    s_add_u32 s79, s59, 0x6000
    buffer_load_dwordx4 v[224:227], v1, s[8:11], s79 offen offset:0 sc1
    buffer_load_dwordx4 v[228:231], v1, s[8:11], s79 offen offset:1024 sc1
    buffer_load_dwordx4 v[232:235], v1, s[8:11], s79 offen offset:2048 sc1
    buffer_load_dwordx4 v[236:239], v1, s[8:11], s79 offen offset:3072 sc1
    s_add_u32 s79, s59, 0x7000
    buffer_load_dwordx4 v[240:243], v1, s[8:11], s79 offen offset:0 sc1
    buffer_load_dwordx4 v[244:247], v1, s[8:11], s79 offen offset:1024 sc1
    buffer_load_dwordx4 v[248:251], v1, s[8:11], s79 offen offset:2048 sc1
    buffer_load_dwordx4 v[252:255], v1, s[8:11], s79 offen offset:3072 sc1
    s_sub_u32 s45, s45, 1
    s_nop 0
    s_cbranch_scc1 L_end
    s_waitcnt vmcnt(8)
    v_bitop3_b32 v7, v211, v215, v219 bitop3:0x80
    v_bitop3_b32 v7, v7, v223, 1 bitop3:0x2a
    v_cmp_ne_u32 vcc, 0, v7
    s_nop 4
    s_cbranch_vccnz CHK_215
    s_nop 0
    s_branch RET_217
OOL_219:
    s_nop 10
CHK_218:
    s_add_u32 s79, s59, 0x6000
    buffer_load_dwordx4 v[224:227], v1, s[8:11], s79 offen offset:0 sc1
    buffer_load_dwordx4 v[228:231], v1, s[8:11], s79 offen offset:1024 sc1
    buffer_load_dwordx4 v[232:235], v1, s[8:11], s79 offen offset:2048 sc1
    buffer_load_dwordx4 v[236:239], v1, s[8:11], s79 offen offset:3072 sc1
    s_add_u32 s79, s59, 0x7000
    buffer_load_dwordx4 v[240:243], v1, s[8:11], s79 offen offset:0 sc1
    buffer_load_dwordx4 v[244:247], v1, s[8:11], s79 offen offset:1024 sc1
    buffer_load_dwordx4 v[248:251], v1, s[8:11], s79 offen offset:2048 sc1
    buffer_load_dwordx4 v[252:255], v1, s[8:11], s79 offen offset:3072 sc1
    buffer_load_dword v62, off, s[8:11], s62
    buffer_load_dword v62, off, s[8:11], s62
    buffer_load_dword v62, off, s[8:11], s62
    buffer_load_dword v62, off, s[8:11], s62
    s_sub_u32 s45, s45, 1
    s_nop 0
    s_cbranch_scc1 L_end
    s_waitcnt vmcnt(8)
    v_bitop3_b32 v7, v227, v231, v235 bitop3:0x80
    v_bitop3_b32 v7, v7, v239, 1 bitop3:0x2a
    v_cmp_ne_u32 vcc, 0, v7
    s_nop 4
    s_cbranch_vccnz CHK_218
    s_nop 0
    s_branch RET_220
OOL_222:
    s_nop 10
CHK_221:
    buffer_load_dwordx4 v[112:115], v1, s[8:11], s77 offen offset:0 sc1
    buffer_load_dwordx4 v[116:119], v1, s[8:11], s77 offen offset:1024 sc1
    buffer_load_dwordx4 v[120:123], v1, s[8:11], s77 offen offset:2048 sc1
    buffer_load_dwordx4 v[124:127], v1, s[8:11], s77 offen offset:3072 sc1
    s_sub_u32 s45, s45, 1
    s_nop 0
    s_cbranch_scc1 L_end
    s_waitcnt vmcnt(0)
    v_bitop3_b32 v7, v112, v113, v114 bitop3:0xfe
    v_bitop3_b32 v7, v7, v115, v116 bitop3:0xfe
    v_bitop3_b32 v7, v7, v117, v118 bitop3:0xfe
    v_bitop3_b32 v7, v7, v119, v120 bitop3:0xfe
    v_bitop3_b32 v7, v7, v121, v122 bitop3:0xfe
    v_bitop3_b32 v7, v7, v123, v124 bitop3:0xfe
    v_bitop3_b32 v7, v7, v125, v126 bitop3:0xfe
    v_bitop3_b32 v7, v7, v127, 1 bitop3:0xa8
    v_cmp_ne_u32 vcc, 0, v7
    s_nop 4
    s_cbranch_vccnz CHK_221
    s_nop 0
    s_branch RET_223
OOL_225:
    s_nop 10
CHK_224:
    s_add_u32 s79, s59, 0x7000
    buffer_load_dwordx4 v[240:243], v1, s[8:11], s79 offen offset:0 sc1
    buffer_load_dwordx4 v[244:247], v1, s[8:11], s79 offen offset:1024 sc1
    buffer_load_dwordx4 v[248:251], v1, s[8:11], s79 offen offset:2048 sc1
    buffer_load_dwordx4 v[252:255], v1, s[8:11], s79 offen offset:3072 sc1
    buffer_load_dword v62, off, s[8:11], s62
    buffer_load_dword v62, off, s[8:11], s62
    buffer_load_dword v62, off, s[8:11], s62
    buffer_load_dword v62, off, s[8:11], s62
    s_sub_u32 s45, s45, 1
    s_nop 0
    s_cbranch_scc1 L_end
    s_waitcnt vmcnt(4)
    v_bitop3_b32 v7, v243, v247, v251 bitop3:0x80
    v_bitop3_b32 v7, v7, v255, 1 bitop3:0x2a
    v_cmp_ne_u32 vcc, 0, v7
    s_nop 4
    s_cbranch_vccnz CHK_224
    s_nop 0
    s_branch RET_226
OOL_228:
    s_nop 4
CHK_227:
    buffer_load_dwordx4 v[192:195], v1, s[8:11], s51 offen offset:0 sc1
    buffer_load_dwordx4 v[196:199], v1, s[8:11], s51 offen offset:1024 sc1
    buffer_load_dwordx4 v[200:203], v1, s[8:11], s51 offen offset:2048 sc1
    buffer_load_dwordx4 v[204:207], v1, s[8:11], s51 offen offset:3072 sc1
    s_add_u32 s78, s51, 0x1000
    buffer_load_dwordx4 v[208:211], v1, s[8:11], s78 offen offset:0 sc1
    buffer_load_dwordx4 v[212:215], v1, s[8:11], s78 offen offset:1024 sc1
    buffer_load_dwordx4 v[216:219], v1, s[8:11], s78 offen offset:2048 sc1
    buffer_load_dwordx4 v[220:223], v1, s[8:11], s78 offen offset:3072 sc1
    buffer_load_dwordx4 v[224:227], v1, s[8:11], s50 offen offset:0 sc1
    buffer_load_dwordx4 v[228:231], v1, s[8:11], s50 offen offset:1024 sc1
    buffer_load_dwordx4 v[232:235], v1, s[8:11], s50 offen offset:2048 sc1
    buffer_load_dwordx4 v[236:239], v1, s[8:11], s50 offen offset:3072 sc1
    buffer_load_dword v62, off, s[8:11], s62
    buffer_load_dword v62, off, s[8:11], s62
    buffer_load_dword v62, off, s[8:11], s62
    s_add_u32 s78, s50, 0x1000
    buffer_load_dwordx4 v[240:243], v1, s[8:11], s78 offen offset:0 sc1
    s_sub_u32 s45, s45, 1
    s_nop 0
    s_cbranch_scc1 L_end
    s_waitcnt vmcnt(12)
    v_bitop3_b32 v7, v195, v199, v203 bitop3:0xfe
    v_bitop3_b32 v7, v7, v207, 1 bitop3:0xa8
    v_cmp_ne_u32 vcc, 0, v7
    s_nop 4
    s_cbranch_vccnz CHK_227
    s_nop 0
    s_branch RET_229
OOL_231:
    s_nop 10
CHK_230:
    buffer_load_dword v9, v8, s[8:11], 0 offen offset:128 sc1
    s_sub_u32 s45, s45, 1
    s_nop 0
    s_cbranch_scc1 L_end
    s_waitcnt vmcnt(0)
    v_subrev_u32 v9, s69, v9
    v_subrev_u32 v9, 2, v9
    v_cmp_lt_u32 vcc, 7, v9
    s_nop 4
    s_cbranch_vccnz CHK_230
    s_nop 0
    s_branch RET_232
OOL_234:
    s_nop 10
CHK_233:
    s_add_u32 s78, s51, 0x1000
    buffer_load_dwordx4 v[208:211], v1, s[8:11], s78 offen offset:0 sc1
    buffer_load_dwordx4 v[212:215], v1, s[8:11], s78 offen offset:1024 sc1
    buffer_load_dwordx4 v[216:219], v1, s[8:11], s78 offen offset:2048 sc1
    buffer_load_dwordx4 v[220:223], v1, s[8:11], s78 offen offset:3072 sc1
    buffer_load_dwordx4 v[224:227], v1, s[8:11], s50 offen offset:0 sc1
    buffer_load_dwordx4 v[228:231], v1, s[8:11], s50 offen offset:1024 sc1
    buffer_load_dwordx4 v[232:235], v1, s[8:11], s50 offen offset:2048 sc1
    buffer_load_dwordx4 v[236:239], v1, s[8:11], s50 offen offset:3072 sc1
    buffer_load_dword v62, off, s[8:11], s62
    buffer_load_dword v62, off, s[8:11], s62
    buffer_load_dword v62, off, s[8:11], s62
    s_add_u32 s78, s50, 0x1000
    buffer_load_dwordx4 v[240:243], v1, s[8:11], s78 offen offset:0 sc1
    buffer_load_dwordx4 v[244:247], v1, s[8:11], s78 offen offset:1024 sc1
    buffer_load_dwordx4 v[248:251], v1, s[8:11], s78 offen offset:2048 sc1
    buffer_load_dwordx4 v[252:255], v1, s[8:11], s78 offen offset:3072 sc1
    s_add_u32 s78, s51, 0x8000
    buffer_load_dwordx4 v[144:147], v1, s[8:11], s78 offen offset:0 sc1
    s_sub_u32 s45, s45, 1
    s_nop 0
    s_cbranch_scc1 L_end
    s_waitcnt vmcnt(12)
    v_bitop3_b32 v7, v211, v215, v219 bitop3:0xfe
    v_bitop3_b32 v7, v7, v223, 1 bitop3:0xa8
    v_cmp_ne_u32 vcc, 0, v7
    s_nop 4
    s_cbranch_vccnz CHK_233
    s_nop 0
    s_branch RET_235
OOL_237:
    s_nop 10
CHK_236:
    buffer_load_dwordx4 v[224:227], v1, s[8:11], s50 offen offset:0 sc1
    buffer_load_dwordx4 v[228:231], v1, s[8:11], s50 offen offset:1024 sc1
    buffer_load_dwordx4 v[232:235], v1, s[8:11], s50 offen offset:2048 sc1
    buffer_load_dwordx4 v[236:239], v1, s[8:11], s50 offen offset:3072 sc1
    buffer_load_dword v62, off, s[8:11], s62
    buffer_load_dword v62, off, s[8:11], s62
    buffer_load_dword v62, off, s[8:11], s62
    s_add_u32 s78, s50, 0x1000
    buffer_load_dwordx4 v[240:243], v1, s[8:11], s78 offen offset:0 sc1
    buffer_load_dwordx4 v[244:247], v1, s[8:11], s78 offen offset:1024 sc1
    buffer_load_dwordx4 v[248:251], v1, s[8:11], s78 offen offset:2048 sc1
    buffer_load_dwordx4 v[252:255], v1, s[8:11], s78 offen offset:3072 sc1
    s_add_u32 s78, s51, 0x8000
    buffer_load_dwordx4 v[144:147], v1, s[8:11], s78 offen offset:0 sc1
    buffer_load_dwordx4 v[148:151], v1, s[8:11], s78 offen offset:1024 sc1
    buffer_load_dwordx4 v[152:155], v1, s[8:11], s78 offen offset:2048 sc1
    buffer_load_dwordx4 v[156:159], v1, s[8:11], s78 offen offset:3072 sc1
    s_add_u32 s78, s51, 0x9000
    buffer_load_dwordx4 v[160:163], v1, s[8:11], s78 offen offset:0 sc1
    s_sub_u32 s45, s45, 1
    s_nop 0
    s_cbranch_scc1 L_end
    s_waitcnt vmcnt(12)
    v_bitop3_b32 v7, v227, v231, v235 bitop3:0xfe
    v_bitop3_b32 v7, v7, v239, 1 bitop3:0xa8
    v_cmp_ne_u32 vcc, 0, v7
    s_nop 4
    s_cbranch_vccnz CHK_236
    s_nop 0
    s_branch RET_238
OOL_240:
    s_nop 10
CHK_239:
    s_add_u32 s78, s50, 0x1000
    buffer_load_dwordx4 v[240:243], v1, s[8:11], s78 offen offset:0 sc1
    buffer_load_dwordx4 v[244:247], v1, s[8:11], s78 offen offset:1024 sc1
    buffer_load_dwordx4 v[248:251], v1, s[8:11], s78 offen offset:2048 sc1
    buffer_load_dwordx4 v[252:255], v1, s[8:11], s78 offen offset:3072 sc1
    s_add_u32 s78, s51, 0x8000
    buffer_load_dwordx4 v[144:147], v1, s[8:11], s78 offen offset:0 sc1
    buffer_load_dwordx4 v[148:151], v1, s[8:11], s78 offen offset:1024 sc1
    buffer_load_dwordx4 v[152:155], v1, s[8:11], s78 offen offset:2048 sc1
    buffer_load_dwordx4 v[156:159], v1, s[8:11], s78 offen offset:3072 sc1
    s_add_u32 s78, s51, 0x9000
    buffer_load_dwordx4 v[160:163], v1, s[8:11], s78 offen offset:0 sc1
    buffer_load_dwordx4 v[164:167], v1, s[8:11], s78 offen offset:1024 sc1
    buffer_load_dwordx4 v[168:171], v1, s[8:11], s78 offen offset:2048 sc1
    buffer_load_dwordx4 v[172:175], v1, s[8:11], s78 offen offset:3072 sc1
    s_add_u32 s78, s50, 0x8000
    buffer_load_dwordx4 v[176:179], v1, s[8:11], s78 offen offset:0 sc1
    buffer_load_dword v62, off, s[8:11], s62
    buffer_load_dword v62, off, s[8:11], s62
    s_sub_u32 s45, s45, 1
    s_nop 0
    s_cbranch_scc1 L_end
    s_waitcnt vmcnt(11)
    v_bitop3_b32 v7, v243, v247, v251 bitop3:0xfe
    v_bitop3_b32 v7, v7, v255, 1 bitop3:0xa8
    v_cmp_ne_u32 vcc, 0, v7
    s_nop 4
    s_cbranch_vccnz CHK_239
    s_nop 0
    s_branch RET_241
OOL_243:
    s_nop 10
CHK_242:
    s_add_u32 s78, s51, 0x8000
    buffer_load_dwordx4 v[144:147], v1, s[8:11], s78 offen offset:0 sc1
    buffer_load_dwordx4 v[148:151], v1, s[8:11], s78 offen offset:1024 sc1
    buffer_load_dwordx4 v[152:155], v1, s[8:11], s78 offen offset:2048 sc1
    buffer_load_dwordx4 v[156:159], v1, s[8:11], s78 offen offset:3072 sc1
    s_add_u32 s78, s51, 0x9000
    buffer_load_dwordx4 v[160:163], v1, s[8:11], s78 offen offset:0 sc1
    buffer_load_dwordx4 v[164:167], v1, s[8:11], s78 offen offset:1024 sc1
    buffer_load_dwordx4 v[168:171], v1, s[8:11], s78 offen offset:2048 sc1
    buffer_load_dwordx4 v[172:175], v1, s[8:11], s78 offen offset:3072 sc1
    s_add_u32 s78, s50, 0x8000
    buffer_load_dwordx4 v[176:179], v1, s[8:11], s78 offen offset:0 sc1
    buffer_load_dword v62, off, s[8:11], s62
    buffer_load_dword v62, off, s[8:11], s62
    buffer_load_dwordx4 v[180:183], v1, s[8:11], s78 offen offset:1024 sc1
    buffer_load_dwordx4 v[184:187], v1, s[8:11], s78 offen offset:2048 sc1
    buffer_load_dwordx4 v[188:191], v1, s[8:11], s78 offen offset:3072 sc1
    s_add_u32 s78, s50, 0x9000
    buffer_load_dwordx4 v[192:195], v1, s[8:11], s78 offen offset:0 sc1
    s_sub_u32 s45, s45, 1
    s_nop 0
    s_cbranch_scc1 L_end
    s_waitcnt vmcnt(11)
    v_bitop3_b32 v7, v147, v151, v155 bitop3:0xfe
    v_bitop3_b32 v7, v7, v159, 1 bitop3:0xa8
    v_cmp_ne_u32 vcc, 0, v7
    s_nop 4
    s_cbranch_vccnz CHK_242
    s_nop 0
    s_branch RET_244
OOL_246:
    s_nop 10
CHK_245:
    s_add_u32 s78, s51, 0x9000
    buffer_load_dwordx4 v[160:163], v1, s[8:11], s78 offen offset:0 sc1
    buffer_load_dwordx4 v[164:167], v1, s[8:11], s78 offen offset:1024 sc1
    buffer_load_dwordx4 v[168:171], v1, s[8:11], s78 offen offset:2048 sc1
    buffer_load_dwordx4 v[172:175], v1, s[8:11], s78 offen offset:3072 sc1
    s_add_u32 s78, s50, 0x8000
    buffer_load_dwordx4 v[176:179], v1, s[8:11], s78 offen offset:0 sc1
    buffer_load_dword v62, off, s[8:11], s62
    buffer_load_dword v62, off, s[8:11], s62
    buffer_load_dwordx4 v[180:183], v1, s[8:11], s78 offen offset:1024 sc1
    buffer_load_dwordx4 v[184:187], v1, s[8:11], s78 offen offset:2048 sc1
    buffer_load_dwordx4 v[188:191], v1, s[8:11], s78 offen offset:3072 sc1
    s_add_u32 s78, s50, 0x9000
    buffer_load_dwordx4 v[192:195], v1, s[8:11], s78 offen offset:0 sc1
    buffer_load_dwordx4 v[196:199], v1, s[8:11], s78 offen offset:1024 sc1
    buffer_load_dwordx4 v[200:203], v1, s[8:11], s78 offen offset:2048 sc1
    buffer_load_dwordx4 v[204:207], v1, s[8:11], s78 offen offset:3072 sc1
    buffer_load_dwordx4 v[208:211], v1, s[8:11], s53 offen offset:0 sc1
    buffer_load_dword v62, off, s[8:11], s62
    buffer_load_dword v62, off, s[8:11], s62
    s_sub_u32 s45, s45, 1
    s_nop 0
    s_cbranch_scc1 L_end
    s_waitcnt vmcnt(13)
    v_bitop3_b32 v7, v163, v167, v171 bitop3:0xfe
    v_bitop3_b32 v7, v7, v175, 1 bitop3:0xa8
    v_cmp_ne_u32 vcc, 0, v7
    s_nop 4
    s_cbranch_vccnz CHK_245
    s_nop 0
    s_branch RET_247
OOL_249:
    s_nop 10
CHK_248:
    s_add_u32 s78, s50, 0x8000
    buffer_load_dwordx4 v[176:179], v1, s[8:11], s78 offen offset:0 sc1
    buffer_load_dword v62, off, s[8:11], s62
    buffer_load_dword v62, off, s[8:11], s62
    buffer_load_dwordx4 v[180:183], v1, s[8:11], s78 offen offset:1024 sc1
    buffer_load_dwordx4 v[184:187], v1, s[8:11], s78 offen offset:2048 sc1
    buffer_load_dwordx4 v[188:191], v1, s[8:11], s78 offen offset:3072 sc1
    s_add_u32 s78, s50, 0x9000
    buffer_load_dwordx4 v[192:195], v1, s[8:11], s78 offen offset:0 sc1
    buffer_load_dwordx4 v[196:199], v1, s[8:11], s78 offen offset:1024 sc1
    buffer_load_dwordx4 v[200:203], v1, s[8:11], s78 offen offset:2048 sc1
    buffer_load_dwordx4 v[204:207], v1, s[8:11], s78 offen offset:3072 sc1
    buffer_load_dwordx4 v[208:211], v1, s[8:11], s53 offen offset:0 sc1
    buffer_load_dword v62, off, s[8:11], s62
    buffer_load_dword v62, off, s[8:11], s62
    buffer_load_dwordx4 v[212:215], v1, s[8:11], s53 offen offset:1024 sc1
    buffer_load_dwordx4 v[216:219], v1, s[8:11], s53 offen offset:2048 sc1
    buffer_load_dwordx4 v[220:223], v1, s[8:11], s53 offen offset:3072 sc1
    s_add_u32 s78, s53, 0x1000
    buffer_load_dwordx4 v[224:227], v1, s[8:11], s78 offen offset:0 sc1
    s_sub_u32 s45, s45, 1
    s_nop 0
    s_cbranch_scc1 L_end
    s_waitcnt vmcnt(11)
    v_bitop3_b32 v7, v179, v183, v187 bitop3:0xfe
    v_bitop3_b32 v7, v7, v191, 1 bitop3:0xa8
    v_cmp_ne_u32 vcc, 0, v7
    s_nop 4
    s_cbranch_vccnz CHK_248
    s_nop 0
    s_branch RET_250
OOL_251:
    buffer_wbl2 sc1
    s_nop 5
    s_branch RET_252
OOL_254:
    s_nop 10
CHK_253:
    s_add_u32 s78, s50, 0x9000
    buffer_load_dwordx4 v[192:195], v1, s[8:11], s78 offen offset:0 sc1
    buffer_load_dwordx4 v[196:199], v1, s[8:11], s78 offen offset:1024 sc1
    buffer_load_dwordx4 v[200:203], v1, s[8:11], s78 offen offset:2048 sc1
    buffer_load_dwordx4 v[204:207], v1, s[8:11], s78 offen offset:3072 sc1
    buffer_load_dwordx4 v[208:211], v1, s[8:11], s53 offen offset:0 sc1
    buffer_load_dword v62, off, s[8:11], s62
    buffer_load_dword v62, off, s[8:11], s62
    buffer_load_dwordx4 v[212:215], v1, s[8:11], s53 offen offset:1024 sc1
    buffer_load_dwordx4 v[216:219], v1, s[8:11], s53 offen offset:2048 sc1
    buffer_load_dwordx4 v[220:223], v1, s[8:11], s53 offen offset:3072 sc1
    s_add_u32 s78, s53, 0x1000
    buffer_load_dwordx4 v[224:227], v1, s[8:11], s78 offen offset:0 sc1
    buffer_load_dwordx4 v[228:231], v1, s[8:11], s78 offen offset:1024 sc1
    buffer_load_dwordx4 v[232:235], v1, s[8:11], s52 offen offset:0 sc1
    buffer_load_dword v62, off, s[8:11], s62
    buffer_load_dwordx4 v[236:239], v1, s[8:11], s52 offen offset:1024 sc1
    buffer_load_dwordx4 v[240:243], v1, s[8:11], s52 offen offset:2048 sc1
    s_sub_u32 s45, s45, 1
    s_nop 0
    s_cbranch_scc1 L_end
    s_waitcnt vmcnt(12)
    v_bitop3_b32 v7, v195, v199, v203 bitop3:0xfe
    v_bitop3_b32 v7, v7, v207, 1 bitop3:0xa8
    v_cmp_ne_u32 vcc, 0, v7
    s_nop 4
    s_cbranch_vccnz CHK_253
    s_nop 0
    s_branch RET_255
OOL_257:
    s_nop 10
CHK_256:
    buffer_load_dwordx4 v[208:211], v1, s[8:11], s53 offen offset:0 sc1
    buffer_load_dword v62, off, s[8:11], s62
    buffer_load_dword v62, off, s[8:11], s62
    buffer_load_dwordx4 v[212:215], v1, s[8:11], s53 offen offset:1024 sc1
    buffer_load_dwordx4 v[216:219], v1, s[8:11], s53 offen offset:2048 sc1
    buffer_load_dwordx4 v[220:223], v1, s[8:11], s53 offen offset:3072 sc1
    s_add_u32 s78, s53, 0x1000
    buffer_load_dwordx4 v[224:227], v1, s[8:11], s78 offen offset:0 sc1
    buffer_load_dwordx4 v[228:231], v1, s[8:11], s78 offen offset:1024 sc1
    buffer_load_dwordx4 v[232:235], v1, s[8:11], s52 offen offset:0 sc1
    buffer_load_dword v62, off, s[8:11], s62
    buffer_load_dwordx4 v[236:239], v1, s[8:11], s52 offen offset:1024 sc1
    buffer_load_dwordx4 v[240:243], v1, s[8:11], s52 offen offset:2048 sc1
    buffer_load_dwordx4 v[244:247], v1, s[8:11], s52 offen offset:3072 sc1
    s_add_u32 s78, s52, 0x1000
    buffer_load_dwordx4 v[248:251], v1, s[8:11], s78 offen offset:0 sc1
    buffer_load_dwordx4 v[252:255], v1, s[8:11], s78 offen offset:1024 sc1
    s_add_u32 s78, s53, 0x1800
    buffer_load_dwordx4 v[144:147], v1, s[8:11], s78 offen offset:0 sc1
    s_sub_u32 s45, s45, 1
    s_nop 0
    s_cbranch_scc1 L_end
    s_waitcnt vmcnt(10)
    v_bitop3_b32 v7, v211, v215, v219 bitop3:0xfe
    v_bitop3_b32 v7, v7, v223, 1 bitop3:0xa8
    v_cmp_ne_u32 vcc, 0, v7
    s_nop 4
    s_cbranch_vccnz CHK_256
    s_nop 0
    s_branch RET_258
OOL_260:
    s_nop 10
CHK_259:
    s_add_u32 s78, s53, 0x1000
    buffer_load_dwordx4 v[224:227], v1, s[8:11], s78 offen offset:0 sc1
    buffer_load_dwordx4 v[228:231], v1, s[8:11], s78 offen offset:1024 sc1
    buffer_load_dwordx4 v[232:235], v1, s[8:11], s52 offen offset:0 sc1
    buffer_load_dword v62, off, s[8:11], s62
    buffer_load_dwordx4 v[236:239], v1, s[8:11], s52 offen offset:1024 sc1
    buffer_load_dwordx4 v[240:243], v1, s[8:11], s52 offen offset:2048 sc1
    buffer_load_dwordx4 v[244:247], v1, s[8:11], s52 offen offset:3072 sc1
    s_add_u32 s78, s52, 0x1000
    buffer_load_dwordx4 v[248:251], v1, s[8:11], s78 offen offset:0 sc1
    buffer_load_dwordx4 v[252:255], v1, s[8:11], s78 offen offset:1024 sc1
    s_add_u32 s78, s53, 0x1800
    buffer_load_dwordx4 v[144:147], v1, s[8:11], s78 offen offset:0 sc1
    buffer_load_dwordx4 v[148:151], v1, s[8:11], s78 offen offset:1024 sc1
    buffer_load_dwordx4 v[152:155], v1, s[8:11], s78 offen offset:2048 sc1
    buffer_load_dwordx4 v[156:159], v1, s[8:11], s78 offen offset:3072 sc1
    s_add_u32 s78, s53, 0x2800
    buffer_load_dwordx4 v[160:163], v1, s[8:11], s78 offen offset:0 sc1
    s_sub_u32 s45, s45, 1
    s_nop 0
    s_cbranch_scc1 L_end
    s_waitcnt vmcnt(12)
    v_bitop3_b32 v7, v227, v231, 1 bitop3:0xa8
    v_cmp_ne_u32 vcc, 0, v7
    s_nop 4
    s_cbranch_vccnz CHK_259
    s_nop 0
    s_branch RET_261
OOL_263:
    s_nop 10
CHK_262:
    buffer_load_dwordx4 v[232:235], v1, s[8:11], s52 offen offset:0 sc1
    buffer_load_dword v62, off, s[8:11], s62
    buffer_load_dwordx4 v[236:239], v1, s[8:11], s52 offen offset:1024 sc1
    buffer_load_dwordx4 v[240:243], v1, s[8:11], s52 offen offset:2048 sc1
    buffer_load_dwordx4 v[244:247], v1, s[8:11], s52 offen offset:3072 sc1
    s_add_u32 s78, s52, 0x1000
    buffer_load_dwordx4 v[248:251], v1, s[8:11], s78 offen offset:0 sc1
    buffer_load_dwordx4 v[252:255], v1, s[8:11], s78 offen offset:1024 sc1
    s_add_u32 s78, s53, 0x1800
    buffer_load_dwordx4 v[144:147], v1, s[8:11], s78 offen offset:0 sc1
    buffer_load_dwordx4 v[148:151], v1, s[8:11], s78 offen offset:1024 sc1
    buffer_load_dwordx4 v[152:155], v1, s[8:11], s78 offen offset:2048 sc1
    buffer_load_dwordx4 v[156:159], v1, s[8:11], s78 offen offset:3072 sc1
    s_add_u32 s78, s53, 0x2800
    buffer_load_dwordx4 v[160:163], v1, s[8:11], s78 offen offset:0 sc1
    buffer_load_dwordx4 v[164:167], v1, s[8:11], s78 offen offset:1024 sc1
    s_add_u32 s78, s52, 0x1800
    buffer_load_dwordx4 v[168:171], v1, s[8:11], s78 offen offset:0 sc1
    s_sub_u32 s45, s45, 1
    s_nop 0
    s_cbranch_scc1 L_end
    s_waitcnt vmcnt(9)
    v_bitop3_b32 v7, v235, v239, v243 bitop3:0xfe
    v_bitop3_b32 v7, v7, v247, 1 bitop3:0xa8
    v_cmp_ne_u32 vcc, 0, v7
    s_nop 4
    s_cbranch_vccnz CHK_262
    s_nop 0
    s_branch RET_264
OOL_266:
    s_nop 10
CHK_265:
    s_add_u32 s78, s52, 0x1000
    buffer_load_dwordx4 v[248:251], v1, s[8:11], s78 offen offset:0 sc1
    buffer_load_dwordx4 v[252:255], v1, s[8:11], s78 offen offset:1024 sc1
    s_add_u32 s78, s53, 0x1800
    buffer_load_dwordx4 v[144:147], v1, s[8:11], s78 offen offset:0 sc1
    buffer_load_dwordx4 v[148:151], v1, s[8:11], s78 offen offset:1024 sc1
    buffer_load_dwordx4 v[152:155], v1, s[8:11], s78 offen offset:2048 sc1
    buffer_load_dwordx4 v[156:159], v1, s[8:11], s78 offen offset:3072 sc1
    s_add_u32 s78, s53, 0x2800
    buffer_load_dwordx4 v[160:163], v1, s[8:11], s78 offen offset:0 sc1
    buffer_load_dwordx4 v[164:167], v1, s[8:11], s78 offen offset:1024 sc1
    s_add_u32 s78, s52, 0x1800
    buffer_load_dwordx4 v[168:171], v1, s[8:11], s78 offen offset:0 sc1
    buffer_load_dwordx4 v[172:175], v1, s[8:11], s78 offen offset:1024 sc1
    buffer_load_dwordx4 v[176:179], v1, s[8:11], s78 offen offset:2048 sc1
    buffer_load_dwordx4 v[180:183], v1, s[8:11], s78 offen offset:3072 sc1
    s_add_u32 s78, s52, 0x2800
    buffer_load_dwordx4 v[184:187], v1, s[8:11], s78 offen offset:0 sc1
    s_sub_u32 s45, s45, 1
    s_nop 0
    s_cbranch_scc1 L_end
    s_waitcnt vmcnt(11)
    v_bitop3_b32 v7, v251, v255, 1 bitop3:0xa8
    v_cmp_ne_u32 vcc, 0, v7
    s_nop 4
    s_cbranch_vccnz CHK_265
    s_nop 0
    s_branch RET_267
OOL_269:
    s_nop 10
CHK_268:
    s_add_u32 s78, s53, 0x1800
    buffer_load_dwordx4 v[144:147], v1, s[8:11], s78 offen offset:0 sc1
    buffer_load_dwordx4 v[148:151], v1, s[8:11], s78 offen offset:1024 sc1
    buffer_load_dwordx4 v[152:155], v1, s[8:11], s78 offen offset:2048 sc1
    buffer_load_dwordx4 v[156:159], v1, s[8:11], s78 offen offset:3072 sc1
    s_add_u32 s78, s53, 0x2800
    buffer_load_dwordx4 v[160:163], v1, s[8:11], s78 offen offset:0 sc1
    buffer_load_dwordx4 v[164:167], v1, s[8:11], s78 offen offset:1024 sc1
    s_add_u32 s78, s52, 0x1800
    buffer_load_dwordx4 v[168:171], v1, s[8:11], s78 offen offset:0 sc1
    buffer_load_dwordx4 v[172:175], v1, s[8:11], s78 offen offset:1024 sc1
    buffer_load_dwordx4 v[176:179], v1, s[8:11], s78 offen offset:2048 sc1
    buffer_load_dwordx4 v[180:183], v1, s[8:11], s78 offen offset:3072 sc1
    s_add_u32 s78, s52, 0x2800
    buffer_load_dwordx4 v[184:187], v1, s[8:11], s78 offen offset:0 sc1
    buffer_load_dwordx4 v[188:191], v1, s[8:11], s78 offen offset:1024 sc1
    s_sub_u32 s45, s45, 1
    s_nop 0
    s_cbranch_scc1 L_end
    s_waitcnt vmcnt(8)
    v_bitop3_b32 v7, v147, v151, v155 bitop3:0xfe
    v_bitop3_b32 v7, v7, v159, 1 bitop3:0xa8
    v_cmp_ne_u32 vcc, 0, v7
    s_nop 4
    s_cbranch_vccnz CHK_268
    s_nop 0
    s_branch RET_270
OOL_272:
    s_nop 10
CHK_271:
    s_add_u32 s78, s53, 0x2800
    buffer_load_dwordx4 v[160:163], v1, s[8:11], s78 offen offset:0 sc1
    buffer_load_dwordx4 v[164:167], v1, s[8:11], s78 offen offset:1024 sc1
    s_add_u32 s78, s52, 0x1800
    buffer_load_dwordx4 v[168:171], v1, s[8:11], s78 offen offset:0 sc1
    buffer_load_dwordx4 v[172:175], v1, s[8:11], s78 offen offset:1024 sc1
    buffer_load_dwordx4 v[176:179], v1, s[8:11], s78 offen offset:2048 sc1
    buffer_load_dwordx4 v[180:183], v1, s[8:11], s78 offen offset:3072 sc1
    s_add_u32 s78, s52, 0x2800
    buffer_load_dwordx4 v[184:187], v1, s[8:11], s78 offen offset:0 sc1
    buffer_load_dwordx4 v[188:191], v1, s[8:11], s78 offen offset:1024 sc1
    s_sub_u32 s45, s45, 1
    s_nop 0
    s_cbranch_scc1 L_end
    s_waitcnt vmcnt(6)
    v_bitop3_b32 v7, v163, v167, 1 bitop3:0xa8
    v_cmp_ne_u32 vcc, 0, v7
    s_nop 4
    s_cbranch_vccnz CHK_271
    s_nop 0
    s_branch RET_273
OOL_275:
    s_nop 10
CHK_274:
    s_add_u32 s78, s52, 0x1800
    buffer_load_dwordx4 v[168:171], v1, s[8:11], s78 offen offset:0 sc1
    buffer_load_dwordx4 v[172:175], v1, s[8:11], s78 offen offset:1024 sc1
    buffer_load_dwordx4 v[176:179], v1, s[8:11], s78 offen offset:2048 sc1
    buffer_load_dwordx4 v[180:183], v1, s[8:11], s78 offen offset:3072 sc1
    s_add_u32 s78, s52, 0x2800
    buffer_load_dwordx4 v[184:187], v1, s[8:11], s78 offen offset:0 sc1
    buffer_load_dwordx4 v[188:191], v1, s[8:11], s78 offen offset:1024 sc1
    s_sub_u32 s45, s45, 1
    s_nop 0
    s_cbranch_scc1 L_end
    s_waitcnt vmcnt(2)
    v_bitop3_b32 v7, v171, v175, v179 bitop3:0xfe
    v_bitop3_b32 v7, v7, v183, 1 bitop3:0xa8
    v_cmp_ne_u32 vcc, 0, v7
    s_nop 4
    s_cbranch_vccnz CHK_274
    s_nop 0
    s_branch RET_276
OOL_278:
    s_nop 10
CHK_277:
    s_add_u32 s78, s52, 0x2800
    buffer_load_dwordx4 v[184:187], v1, s[8:11], s78 offen offset:0 sc1
    buffer_load_dwordx4 v[188:191], v1, s[8:11], s78 offen offset:1024 sc1
    s_sub_u32 s45, s45, 1
    s_nop 0
    s_cbranch_scc1 L_end
    s_waitcnt vmcnt(0)
    v_bitop3_b32 v7, v187, v191, 1 bitop3:0xa8
    v_cmp_ne_u32 vcc, 0, v7
    s_nop 4
    s_cbranch_vccnz CHK_277
    s_nop 0
    s_branch RET_279
OOL_280:
    s_mov_b64 exec, 1
    buffer_store_dword v18, off, s[8:11], s77 sc1
    s_mov_b64 exec, -1
    s_nop 0
    s_branch RET_281
L_codeend:
    s_nop 0
L_slow:
    s_add_u32 s22, s22, 0x100000
    s_add_u32 s23, s23, 0x100000
    s_add_u32 s84, s84, 0x100000
    s_add_u32 s85, s85, 0x100000
    s_add_u32 s7, s7, 0x100000
    s_add_u32 s5, s5, 0x100000
    buffer_store_dwordx4 v[224:227], v66, s[8:11], s22 offen sc1
    buffer_store_dwordx4 v[228:231], v66, s[8:11], s23 offen sc1
    buffer_store_dwordx4 v[232:235], v67, s[8:11], s84 offen sc1
    s_waitcnt vmcnt(0) lgkmcnt(0)
    buffer_load_dwordx4 v[136:139], v64, s[8:11], s7 offen sc1
    buffer_load_dwordx4 v[140:143], v64, s[8:11], s85 offen sc1
    buffer_load_dwordx4 v[144:147], v64, s[8:11], s5 offen sc1
    buffer_store_dword v122, v1, s[8:11], s48 offen sc1
    buffer_store_dword v122, v1, s[8:11], s78 offen sc1
    s_waitcnt vmcnt(2)
    v_xor_b32 v116, s69, v139
    v_bitop3_b32 v116, v116, v143, s69 bitop3:0xf6
    v_bitop3_b32 v116, v116, v146, s69 bitop3:0xf6
    v_cmp_ne_u32 vcc, 0, v116
    s_cbranch_vccnz OOL_283
RET_284:
    v_mov_b32 v139, v144
    v_mov_b32 v143, v145
    ds_write_b128 v118, v[136:139] offset:0
    ds_write_b128 v118, v[140:143] offset:4608
    s_add_u32 m0, s97, 6144
    s_lshl_b32 s17, s81, 4
    s_add_u32 s17, s17, s21
    buffer_load_dwordx4 v61, s[24:27], s17 offen lds
    s_add_u32 s17, s17, 7168
    buffer_load_dwordx4 v61, s[24:27], s17 offen offset:1024 lds
    s_add_u32 m0, s97, 2048
    s_nop 0
    buffer_load_dwordx4 v60, s[32:35], s73 offen offset:0 lds
    s_add_u32 s73, s73, s20
    buffer_load_dwordx4 v60, s[32:35], s73 offen offset:1024 lds
    s_add_u32 s73, s73, s20
    buffer_load_dwordx4 v60, s[32:35], s73 offen offset:2048 lds
    s_add_u32 s73, s73, s20
    buffer_load_dwordx4 v60, s[32:35], s73 offen offset:3072 lds
    buffer_load_dword v62, v110, s[40:43], s77 offen
    s_waitcnt lgkmcnt(0)
    s_barrier
    ds_read_b128 a[0:3], v16 offset:3584
    ds_read2_b32 a[32:33], v17 offset0:0 offset1:1
    ds_read2_b32 a[34:35], v17 offset0:2 offset1:3
    ds_read_b128 a[4:7], v16 offset:3072
    ds_read2_b32 a[36:37], v18 offset0:0 offset1:1
    ds_read2_b32 a[38:39], v18 offset0:2 offset1:3
    ds_read_b128 a[8:11], v16 offset:2560
    ds_read2_b32 a[40:41], v19 offset0:0 offset1:1
    ds_read2_b32 a[42:43], v19 offset0:2 offset1:3
    ds_read_b128 a[12:15], v16 offset:2048
    ds_read2_b32 a[44:45], v20 offset0:0 offset1:1
    ds_read2_b32 a[46:47], v20 offset0:2 offset1:3
    ds_read_b128 a[16:19], v16 offset:1536
    ds_read2_b32 a[48:49], v21 offset0:0 offset1:1
    ds_read2_b32 a[50:51], v21 offset0:2 offset1:3
    ds_read_b128 a[20:23], v16 offset:1024
    ds_read2_b32 a[52:53], v22 offset0:0 offset1:1
    ds_read2_b32 a[54:55], v22 offset0:2 offset1:3
    ds_read_b128 a[24:27], v16 offset:512
    ds_read2_b32 a[56:57], v23 offset0:0 offset1:1
    ds_read2_b32 a[58:59], v23 offset0:2 offset1:3
    ds_read_b128 a[28:31], v16 offset:0
    ds_read2_b32 a[60:61], v24 offset0:0 offset1:1
    ds_read2_b32 a[62:63], v24 offset0:2 offset1:3
    s_waitcnt lgkmcnt(15)
    v_mfma_f32_16x16x32_bf16 v[64:67], v[26:29], a[0:3], 0
    v_mfma_f32_16x16x32_bf16 v[68:71], v[26:29], a[4:7], 0
    v_mfma_f32_16x16x32_bf16 v[72:75], v[26:29], a[8:11], 0
    s_waitcnt lgkmcnt(14)
    v_mfma_f32_16x16x32_bf16 v[76:79], v[26:29], a[12:15], 0
    s_waitcnt lgkmcnt(11)
    v_mfma_f32_16x16x32_bf16 v[80:83], v[26:29], a[16:19], 0
    s_waitcnt vmcnt(7)
    v_mov_b32 v30, s69
    v_add_u32 v30, 1, v30
    s_mov_b64 exec, 1
    buffer_store_dword v30, off, s[8:11], s62 sc1
    s_mov_b64 exec, -1
    s_waitcnt lgkmcnt(8)
    v_mfma_f32_16x16x32_bf16 v[84:87], v[26:29], a[20:23], 0
    s_waitcnt lgkmcnt(5)
    v_mfma_f32_16x16x32_bf16 v[88:91], v[26:29], a[24:27], 0
    s_waitcnt lgkmcnt(2)
    v_mfma_f32_16x16x32_bf16 v[92:95], v[26:29], a[28:31], 0
    v_mfma_f32_16x16x32_bf16 v[64:67], a[32:35], a[0:3], v[64:67]
    ds_read_b128 a[64:67], v16 offset:3648
    v_mfma_f32_16x16x32_bf16 v[68:71], a[32:35], a[4:7], v[68:71]
    ds_read2_b32 a[96:97], v17 offset0:16 offset1:17
    s_add_u32 m0, s97, 8192
    s_add_u32 s17, s21, 0
    buffer_load_dwordx4 v61, s[24:27], s17 offen lds
    v_mfma_f32_16x16x32_bf16 v[68:71], a[36:39], a[0:3], v[68:71]
    ds_read2_b32 a[98:99], v17 offset0:18 offset1:19
    v_mfma_f32_16x16x32_bf16 v[72:75], a[36:39], a[4:7], v[72:75]
    ds_read_b128 a[68:71], v16 offset:3136
    v_mfma_f32_16x16x32_bf16 v[72:75], a[32:35], a[8:11], v[72:75]
    ds_read2_b32 a[100:101], v18 offset0:16 offset1:17
    v_mfma_f32_16x16x32_bf16 v[76:79], a[36:39], a[8:11], v[76:79]
    ds_read2_b32 a[102:103], v18 offset0:18 offset1:19
    v_mfma_f32_16x16x32_bf16 v[72:75], a[40:43], a[0:3], v[72:75]
    ds_read_b128 a[72:75], v16 offset:2624
    s_add_u32 m0, s97, 9216
    s_add_u32 s17, s21, 8192
    buffer_load_dwordx4 v61, s[24:27], s17 offen lds
    v_mfma_f32_16x16x32_bf16 v[76:79], a[40:43], a[4:7], v[76:79]
    ds_read2_b32 a[104:105], v19 offset0:16 offset1:17
    v_mfma_f32_16x16x32_bf16 v[80:83], a[40:43], a[8:11], v[80:83]
    ds_read2_b32 a[106:107], v19 offset0:18 offset1:19
    v_mfma_f32_16x16x32_bf16 v[76:79], a[32:35], a[12:15], v[76:79]
    ds_read_b128 a[76:79], v16 offset:2112
    v_mfma_f32_16x16x32_bf16 v[80:83], a[36:39], a[12:15], v[80:83]
    ds_read2_b32 a[108:109], v20 offset0:16 offset1:17
    v_mfma_f32_16x16x32_bf16 v[84:87], a[40:43], a[12:15], v[84:87]
    ds_read2_b32 a[110:111], v20 offset0:18 offset1:19
    s_add_u32 m0, s97, 10240
    s_add_u32 s17, s21, 16384
    buffer_load_dwordx4 v61, s[24:27], s17 offen lds
    v_mfma_f32_16x16x32_bf16 v[76:79], a[44:47], a[0:3], v[76:79]
    ds_read_b128 a[80:83], v16 offset:1600
    v_mfma_f32_16x16x32_bf16 v[80:83], a[44:47], a[4:7], v[80:83]
    ds_read2_b32 a[112:113], v21 offset0:16 offset1:17
    v_mfma_f32_16x16x32_bf16 v[84:87], a[44:47], a[8:11], v[84:87]
    ds_read2_b32 a[114:115], v21 offset0:18 offset1:19
    v_mfma_f32_16x16x32_bf16 v[88:91], a[44:47], a[12:15], v[88:91]
    ds_read_b128 a[84:87], v16 offset:1088
    v_mfma_f32_16x16x32_bf16 v[80:83], a[32:35], a[16:19], v[80:83]
    ds_read2_b32 a[116:117], v22 offset0:16 offset1:17
    s_add_u32 m0, s97, 11264
    s_add_u32 s17, s21, 24576
    buffer_load_dwordx4 v61, s[24:27], s17 offen lds
    v_mfma_f32_16x16x32_bf16 v[84:87], a[36:39], a[16:19], v[84:87]
    ds_read2_b32 a[118:119], v22 offset0:18 offset1:19
    v_mfma_f32_16x16x32_bf16 v[88:91], a[40:43], a[16:19], v[88:91]
    ds_read_b128 a[88:91], v16 offset:576
    v_mfma_f32_16x16x32_bf16 v[92:95], a[44:47], a[16:19], v[92:95]
    ds_read2_b32 a[120:121], v23 offset0:16 offset1:17
    v_mfma_f32_16x16x32_bf16 v[80:83], a[48:51], a[0:3], v[80:83]
    ds_read2_b32 a[122:123], v23 offset0:18 offset1:19
    v_mfma_f32_16x16x32_bf16 v[84:87], a[48:51], a[4:7], v[84:87]
    ds_read_b128 a[92:95], v16 offset:64
    s_add_u32 m0, s97, 12288
    s_add_u32 s17, s21, 32768
    buffer_load_dwordx4 v61, s[24:27], s17 offen lds
    v_mfma_f32_16x16x32_bf16 v[88:91], a[48:51], a[8:11], v[88:91]
    ds_read2_b32 a[124:125], v24 offset0:16 offset1:17
    v_mfma_f32_16x16x32_bf16 v[92:95], a[48:51], a[12:15], v[92:95]
    ds_read2_b32 a[126:127], v24 offset0:18 offset1:19
    v_mfma_f32_16x16x32_bf16 v[84:87], a[32:35], a[20:23], v[84:87]
    v_mfma_f32_16x16x32_bf16 v[88:91], a[36:39], a[20:23], v[88:91]
    v_mfma_f32_16x16x32_bf16 v[92:95], a[40:43], a[20:23], v[92:95]
    s_add_u32 m0, s97, 13312
    s_add_u32 s17, s21, 40960
    buffer_load_dwordx4 v61, s[24:27], s17 offen lds
    v_mfma_f32_16x16x32_bf16 v[84:87], a[52:55], a[0:3], v[84:87]
    v_mfma_f32_16x16x32_bf16 v[88:91], a[52:55], a[4:7], v[88:91]
    v_mfma_f32_16x16x32_bf16 v[92:95], a[52:55], a[8:11], v[92:95]
    v_mfma_f32_16x16x32_bf16 v[88:91], a[32:35], a[24:27], v[88:91]
    v_mfma_f32_16x16x32_bf16 v[92:95], a[36:39], a[24:27], v[92:95]
    s_add_u32 m0, s97, 14336
    s_add_u32 s17, s21, 49152
    buffer_load_dwordx4 v61, s[24:27], s17 offen lds
    v_mfma_f32_16x16x32_bf16 v[88:91], a[56:59], a[0:3], v[88:91]
    v_mfma_f32_16x16x32_bf16 v[92:95], a[56:59], a[4:7], v[92:95]
    v_mfma_f32_16x16x32_bf16 v[92:95], a[32:35], a[28:31], v[92:95]
    s_waitcnt lgkmcnt(15)
    v_mfma_f32_16x16x32_bf16 v[92:95], a[60:63], a[0:3], v[92:95]
    v_mfma_f32_16x16x32_bf16 v[64:67], a[96:99], a[64:67], v[64:67]
    s_add_u32 m0, s97, 15360
    s_add_u32 s17, s21, 57344
    buffer_load_dwordx4 v61, s[24:27], s17 offen lds
    v_mfma_f32_16x16x32_bf16 v[68:71], a[96:99], a[68:71], v[68:71]
    v_mfma_f32_16x16x32_bf16 v[68:71], a[100:103], a[64:67], v[68:71]
    v_mfma_f32_16x16x32_bf16 v[72:75], a[100:103], a[68:71], v[72:75]
    v_mfma_f32_16x16x32_bf16 v[72:75], a[96:99], a[72:75], v[72:75]
    v_mfma_f32_16x16x32_bf16 v[76:79], a[100:103], a[72:75], v[76:79]
    s_add_u32 m0, s97, 16384
    s_add_u32 s17, s21, 65536
    buffer_load_dwordx4 v61, s[24:27], s17 offen lds
    v_mfma_f32_16x16x32_bf16 v[72:75], a[104:107], a[64:67], v[72:75]
    v_mfma_f32_16x16x32_bf16 v[76:79], a[104:107], a[68:71], v[76:79]
    v_mfma_f32_16x16x32_bf16 v[80:83], a[104:107], a[72:75], v[80:83]
    ds_read_b128 a[0:3], v16 offset:3712
    s_waitcnt lgkmcnt(15)
    v_mfma_f32_16x16x32_bf16 v[76:79], a[96:99], a[76:79], v[76:79]
    ds_read2_b32 a[32:33], v17 offset0:32 offset1:33
    v_mfma_f32_16x16x32_bf16 v[80:83], a[100:103], a[76:79], v[80:83]
    ds_read2_b32 a[34:35], v17 offset0:34 offset1:35
    s_add_u32 m0, s97, 17408
    s_add_u32 s17, s21, 73728
    buffer_load_dwordx4 v61, s[24:27], s17 offen lds
    v_mfma_f32_16x16x32_bf16 v[84:87], a[104:107], a[76:79], v[84:87]
    ds_read_b128 a[4:7], v16 offset:3200
    s_waitcnt lgkmcnt(15)
    v_mfma_f32_16x16x32_bf16 v[76:79], a[108:111], a[64:67], v[76:79]
    ds_read2_b32 a[36:37], v18 offset0:32 offset1:33
    v_mfma_f32_16x16x32_bf16 v[80:83], a[108:111], a[68:71], v[80:83]
    ds_read2_b32 a[38:39], v18 offset0:34 offset1:35
    v_mfma_f32_16x16x32_bf16 v[84:87], a[108:111], a[72:75], v[84:87]
    ds_read_b128 a[8:11], v16 offset:2688
    v_mfma_f32_16x16x32_bf16 v[88:91], a[108:111], a[76:79], v[88:91]
    ds_read2_b32 a[40:41], v19 offset0:32 offset1:33
    s_add_u32 m0, s97, 18432
    s_add_u32 s17, s21, 81920
    buffer_load_dwordx4 v61, s[24:27], s17 offen lds
    v_mfma_f32_16x16x32_bf16 v[80:83], a[96:99], a[80:83], v[80:83]
    ds_read2_b32 a[42:43], v19 offset0:34 offset1:35
    v_mfma_f32_16x16x32_bf16 v[84:87], a[100:103], a[80:83], v[84:87]
    ds_read_b128 a[12:15], v16 offset:2176
    v_mfma_f32_16x16x32_bf16 v[88:91], a[104:107], a[80:83], v[88:91]
    ds_read2_b32 a[44:45], v20 offset0:32 offset1:33
    v_mfma_f32_16x16x32_bf16 v[92:95], a[108:111], a[80:83], v[92:95]
    ds_read2_b32 a[46:47], v20 offset0:34 offset1:35
    s_waitcnt lgkmcnt(15)
    v_mfma_f32_16x16x32_bf16 v[80:83], a[112:115], a[64:67], v[80:83]
    ds_read_b128 a[16:19], v16 offset:1664
    s_add_u32 m0, s97, 19456
    s_add_u32 s17, s21, 90112
    buffer_load_dwordx4 v61, s[24:27], s17 offen lds
    v_mfma_f32_16x16x32_bf16 v[84:87], a[112:115], a[68:71], v[84:87]
    ds_read2_b32 a[48:49], v21 offset0:32 offset1:33
    v_mfma_f32_16x16x32_bf16 v[88:91], a[112:115], a[72:75], v[88:91]
    ds_read2_b32 a[50:51], v21 offset0:34 offset1:35
    v_mfma_f32_16x16x32_bf16 v[92:95], a[112:115], a[76:79], v[92:95]
    ds_read_b128 a[20:23], v16 offset:1152
    v_mfma_f32_16x16x32_bf16 v[84:87], a[96:99], a[84:87], v[84:87]
    ds_read2_b32 a[52:53], v22 offset0:32 offset1:33
    v_mfma_f32_16x16x32_bf16 v[88:91], a[100:103], a[84:87], v[88:91]
    ds_read2_b32 a[54:55], v22 offset0:34 offset1:35
    s_add_u32 m0, s97, 20480
    s_add_u32 s17, s21, 98304
    buffer_load_dwordx4 v61, s[24:27], s17 offen lds
    v_mfma_f32_16x16x32_bf16 v[92:95], a[104:107], a[84:87], v[92:95]
    ds_read_b128 a[24:27], v16 offset:640
    v_mfma_f32_16x16x32_bf16 v[84:87], a[116:119], a[64:67], v[84:87]
    ds_read2_b32 a[56:57], v23 offset0:32 offset1:33
    v_mfma_f32_16x16x32_bf16 v[88:91], a[116:119], a[68:71], v[88:91]
    ds_read2_b32 a[58:59], v23 offset0:34 offset1:35
    v_mfma_f32_16x16x32_bf16 v[92:95], a[116:119], a[72:75], v[92:95]
    ds_read_b128 a[28:31], v16 offset:128
    v_mfma_f32_16x16x32_bf16 v[88:91], a[96:99], a[88:91], v[88:91]
    ds_read2_b32 a[60:61], v24 offset0:32 offset1:33
    s_add_u32 m0, s97, 21504
    s_add_u32 s17, s21, 106496
    buffer_load_dwordx4 v61, s[24:27], s17 offen lds
    v_mfma_f32_16x16x32_bf16 v[92:95], a[100:103], a[88:91], v[92:95]
    ds_read2_b32 a[62:63], v24 offset0:34 offset1:35
    v_mfma_f32_16x16x32_bf16 v[88:91], a[120:123], a[64:67], v[88:91]
    v_mfma_f32_16x16x32_bf16 v[92:95], a[120:123], a[68:71], v[92:95]
    s_waitcnt lgkmcnt(15)
    v_mfma_f32_16x16x32_bf16 v[92:95], a[96:99], a[92:95], v[92:95]
    v_mfma_f32_16x16x32_bf16 v[92:95], a[124:127], a[64:67], v[92:95]
    s_add_u32 m0, s97, 22528
    s_add_u32 s17, s21, 114688
    buffer_load_dwordx4 v61, s[24:27], s17 offen lds
    v_mfma_f32_16x16x32_bf16 v[64:67], a[32:35], a[0:3], v[64:67]
    v_mfma_f32_16x16x32_bf16 v[68:71], a[32:35], a[4:7], v[68:71]
    v_mfma_f32_16x16x32_bf16 v[68:71], a[36:39], a[0:3], v[68:71]
    v_mfma_f32_16x16x32_bf16 v[72:75], a[36:39], a[4:7], v[72:75]
    v_mfma_f32_16x16x32_bf16 v[72:75], a[32:35], a[8:11], v[72:75]
    s_add_u32 m0, s97, 23552
    s_add_u32 s17, s21, 122880
    buffer_load_dwordx4 v61, s[24:27], s17 offen lds
    v_mfma_f32_16x16x32_bf16 v[76:79], a[36:39], a[8:11], v[76:79]
    v_mfma_f32_16x16x32_bf16 v[72:75], a[40:43], a[0:3], v[72:75]
    v_mfma_f32_16x16x32_bf16 v[76:79], a[40:43], a[4:7], v[76:79]
    v_mfma_f32_16x16x32_bf16 v[80:83], a[40:43], a[8:11], v[80:83]
    ds_read_b128 a[64:67], v16 offset:3776
    s_waitcnt lgkmcnt(15)
    v_mfma_f32_16x16x32_bf16 v[76:79], a[32:35], a[12:15], v[76:79]
    ds_read2_b32 a[96:97], v17 offset0:48 offset1:49
    v_mfma_f32_16x16x32_bf16 v[80:83], a[36:39], a[12:15], v[80:83]
    ds_read2_b32 a[98:99], v17 offset0:50 offset1:51
    v_mfma_f32_16x16x32_bf16 v[84:87], a[40:43], a[12:15], v[84:87]
    ds_read_b128 a[68:71], v16 offset:3264
    s_waitcnt lgkmcnt(15)
    v_mfma_f32_16x16x32_bf16 v[76:79], a[44:47], a[0:3], v[76:79]
    ds_read2_b32 a[100:101], v18 offset0:48 offset1:49
    v_mfma_f32_16x16x32_bf16 v[80:83], a[44:47], a[4:7], v[80:83]
    ds_read2_b32 a[102:103], v18 offset0:50 offset1:51
    v_mfma_f32_16x16x32_bf16 v[84:87], a[44:47], a[8:11], v[84:87]
    ds_read_b128 a[72:75], v16 offset:2752
    s_waitcnt vmcnt(18)
    ds_read_b64_tr_b16 v[176:177], v119 offset:2048
    ds_read_b64_tr_b16 v[178:179], v119 offset:3072
    ds_read_b64_tr_b16 v[180:181], v119 offset:4096
    ds_read_b64_tr_b16 v[182:183], v119 offset:5120
    ds_read_b64_tr_b16 v[184:185], v119 offset:2560
    ds_read_b64_tr_b16 v[186:187], v119 offset:3584
    ds_read_b64_tr_b16 v[188:189], v119 offset:4608
    ds_read_b64_tr_b16 v[190:191], v119 offset:5632
    ds_read_b64_tr_b16 v[128:129], v112 offset:6144
    ds_read_b64_tr_b16 v[130:131], v112 offset:7168
    ds_read_b64_tr_b16 v[132:133], v113 offset:6144
    ds_read_b64_tr_b16 v[134:135], v113 offset:7168
    v_mfma_f32_16x16x32_bf16 v[88:91], a[44:47], a[12:15], v[88:91]
    ds_read2_b32 a[104:105], v19 offset0:48 offset1:49
    v_mfma_f32_16x16x32_bf16 v[80:83], a[32:35], a[16:19], v[80:83]
    ds_read2_b32 a[106:107], v19 offset0:50 offset1:51
    v_mfma_f32_16x16x32_bf16 v[84:87], a[36:39], a[16:19], v[84:87]
    ds_read_b128 a[76:79], v16 offset:2240
    v_mfma_f32_16x16x32_bf16 v[88:91], a[40:43], a[16:19], v[88:91]
    ds_read2_b32 a[108:109], v20 offset0:48 offset1:49
    buffer_load_dwordx4 v[100:103], v108, s[40:43], s76 offen offset:0
    buffer_load_dwordx4 v[104:107], v108, s[40:43], s76 offen offset:32
    v_mfma_f32_16x16x32_bf16 v[92:95], a[44:47], a[16:19], v[92:95]
    ds_read2_b32 a[110:111], v20 offset0:50 offset1:51
    s_waitcnt lgkmcnt(15)
    v_mfma_f32_16x16x32_bf16 v[80:83], a[48:51], a[0:3], v[80:83]
    ds_read_b128 a[80:83], v16 offset:1728
    s_cmp_eq_u32 s72, 0
    s_waitcnt lgkmcnt(12)
    s_waitcnt lgkmcnt(10)
    s_cbranch_scc1 ELSE_285
    v_mfma_f32_32x32x16_bf16 v[144:159], v[124:127], v[176:179], 0
    v_mfma_f32_32x32x16_bf16 v[160:175], v[124:127], v[184:187], 0
    v_mfma_f32_32x32x16_bf16 v[144:159], v[124:127], v[180:183], v[144:159]
    v_mfma_f32_32x32x16_bf16 v[160:175], v[124:127], v[188:191], v[160:175]
    v_cmp_gt_u32 vcc, 32, v0
    s_nop 10
    v_cndmask_b32 v144, v160, v144, vcc
    buffer_store_dword v144, v111, s[8:11], s3 offen sc1
    s_nop 3
    s_branch JOIN_286
ELSE_285:
    s_add_u32 s89, s3, s4
    buffer_store_dwordx4 v[176:179], v1, s[8:11], s3 offen offset:0 sc1
    buffer_store_dwordx4 v[180:183], v1, s[8:11], s3 offen offset:1024 sc1
    buffer_store_dwordx4 v[184:187], v1, s[8:11], s89 offen offset:0 sc1
    buffer_store_dwordx4 v[188:191], v1, s[8:11], s89 offen offset:1024 sc1
JOIN_286:
    s_add_u32 s93, s81, s56
    s_add_u32 s89, s81, s55
    s_waitcnt lgkmcnt(8)
    buffer_store_dwordx4 v[128:131], v1, s[8:11], s89 offen sc1
    s_waitcnt lgkmcnt(6)
    buffer_store_dwordx4 v[132:135], v1, s[8:11], s93 offen sc1
    buffer_load_dword v9, v6, s[8:11], 0 offen offset:0 sc1
    v_mfma_f32_16x16x32_bf16 v[84:87], a[48:51], a[4:7], v[84:87]
    ds_read2_b32 a[112:113], v21 offset0:48 offset1:49
    v_mfma_f32_16x16x32_bf16 v[88:91], a[48:51], a[8:11], v[88:91]
    ds_read2_b32 a[114:115], v21 offset0:50 offset1:51
    v_mfma_f32_16x16x32_bf16 v[92:95], a[48:51], a[12:15], v[92:95]
    ds_read_b128 a[84:87], v16 offset:1216
    v_mfma_f32_16x16x32_bf16 v[84:87], a[32:35], a[20:23], v[84:87]
    ds_read2_b32 a[116:117], v22 offset0:48 offset1:49
    v_mfma_f32_16x16x32_bf16 v[88:91], a[36:39], a[20:23], v[88:91]
    ds_read2_b32 a[118:119], v22 offset0:50 offset1:51
    s_add_u32 m0, s97, 0
    s_add_u32 s17, s96, 0
    buffer_load_dwordx4 v63, s[36:39], s17 offen lds
    v_mfma_f32_16x16x32_bf16 v[92:95], a[40:43], a[20:23], v[92:95]
    ds_read_b128 a[88:91], v16 offset:704
    v_mfma_f32_16x16x32_bf16 v[84:87], a[52:55], a[0:3], v[84:87]
    ds_read2_b32 a[120:121], v23 offset0:48 offset1:49
    v_mfma_f32_16x16x32_bf16 v[88:91], a[52:55], a[4:7], v[88:91]
    ds_read2_b32 a[122:123], v23 offset0:50 offset1:51
    v_mfma_f32_16x16x32_bf16 v[92:95], a[52:55], a[8:11], v[92:95]
    ds_read_b128 a[92:95], v16 offset:192
    v_mfma_f32_16x16x32_bf16 v[88:91], a[32:35], a[24:27], v[88:91]
    ds_read2_b32 a[124:125], v24 offset0:48 offset1:49
    s_add_u32 m0, s97, 1024
    s_add_u32 s17, s96, 28672
    buffer_load_dwordx4 v63, s[36:39], s17 offen lds
    v_mfma_f32_16x16x32_bf16 v[92:95], a[36:39], a[24:27], v[92:95]
    ds_read2_b32 a[126:127], v24 offset0:50 offset1:51
    v_mfma_f32_16x16x32_bf16 v[88:91], a[56:59], a[0:3], v[88:91]
    v_mfma_f32_16x16x32_bf16 v[92:95], a[56:59], a[4:7], v[92:95]
    v_mfma_f32_16x16x32_bf16 v[92:95], a[32:35], a[28:31], v[92:95]
    v_mfma_f32_16x16x32_bf16 v[92:95], a[60:63], a[0:3], v[92:95]
    s_add_u32 m0, s97, 2048
    s_add_u32 s17, s96, 57344
    buffer_load_dwordx4 v63, s[36:39], s17 offen lds
    v_mfma_f32_16x16x32_bf16 v[64:67], a[96:99], a[64:67], v[64:67]
    v_mfma_f32_16x16x32_bf16 v[68:71], a[100:103], a[64:67], v[68:71]
    s_waitcnt lgkmcnt(15)
    v_mfma_f32_16x16x32_bf16 v[72:75], a[104:107], a[64:67], v[72:75]
    v_mfma_f32_16x16x32_bf16 v[68:71], a[96:99], a[68:71], v[68:71]
    v_mfma_f32_16x16x32_bf16 v[72:75], a[100:103], a[68:71], v[72:75]
    s_add_u32 m0, s97, 3072
    s_add_u32 s17, s96, 86016
    buffer_load_dwordx4 v63, s[36:39], s17 offen lds
    s_waitcnt lgkmcnt(12)
    v_mfma_f32_16x16x32_bf16 v[76:79], a[108:111], a[64:67], v[76:79]
    ds_write_b128 v96, v[64:67] offset:24576
    v_mfma_f32_16x16x32_bf16 v[72:75], a[96:99], a[72:75], v[72:75]
    ds_write_b128 v96, v[68:71] offset:25600
    v_mfma_f32_16x16x32_bf16 v[76:79], a[104:107], a[68:71], v[76:79]
    s_waitcnt lgkmcnt(11)
    v_mfma_f32_16x16x32_bf16 v[80:83], a[112:115], a[64:67], v[80:83]
    v_mfma_f32_16x16x32_bf16 v[76:79], a[100:103], a[72:75], v[76:79]
    s_add_u32 m0, s97, 4096
    s_add_u32 s17, s96, 114688
    buffer_load_dwordx4 v63, s[36:39], s17 offen lds
    v_mfma_f32_16x16x32_bf16 v[80:83], a[108:111], a[68:71], v[80:83]
    ds_write_b128 v96, v[72:75] offset:26624
    v_mfma_f32_16x16x32_bf16 v[76:79], a[96:99], a[76:79], v[76:79]
    v_mfma_f32_16x16x32_bf16 v[80:83], a[104:107], a[72:75], v[80:83]
    s_waitcnt lgkmcnt(9)
    v_mfma_f32_16x16x32_bf16 v[84:87], a[116:119], a[64:67], v[84:87]
    v_mfma_f32_16x16x32_bf16 v[80:83], a[100:103], a[76:79], v[80:83]
    s_add_u32 m0, s97, 5120
    s_add_u32 s17, s96, 143360
    buffer_load_dwordx4 v63, s[36:39], s17 offen lds
    v_mfma_f32_16x16x32_bf16 v[84:87], a[112:115], a[68:71], v[84:87]
    ds_write_b128 v96, v[76:79] offset:27648
    v_mfma_f32_16x16x32_bf16 v[80:83], a[96:99], a[80:83], v[80:83]
    v_mfma_f32_16x16x32_bf16 v[84:87], a[108:111], a[72:75], v[84:87]
    s_waitcnt lgkmcnt(7)
    v_mfma_f32_16x16x32_bf16 v[88:91], a[120:123], a[64:67], v[88:91]
    v_mfma_f32_16x16x32_bf16 v[84:87], a[104:107], a[76:79], v[84:87]
    s_add_u32 m0, s97, 6144
    s_add_u32 s17, s96, 172032
    buffer_load_dwordx4 v63, s[36:39], s17 offen lds
    v_mfma_f32_16x16x32_bf16 v[88:91], a[116:119], a[68:71], v[88:91]
    ds_write_b128 v96, v[80:83] offset:28672
    s_waitcnt lgkmcnt(5)
    v_mfma_f32_16x16x32_bf16 v[92:95], a[124:127], a[64:67], v[92:95]
    v_mfma_f32_16x16x32_bf16 v[84:87], a[100:103], a[80:83], v[84:87]
    v_mfma_f32_16x16x32_bf16 v[92:95], a[120:123], a[68:71], v[92:95]
    v_mfma_f32_16x16x32_bf16 v[84:87], a[96:99], a[84:87], v[84:87]
    s_add_u32 m0, s97, 7168
    s_add_u32 s17, s96, 200704
    buffer_load_dwordx4 v63, s[36:39], s17 offen lds
    v_mfma_f32_16x16x32_bf16 v[92:95], a[116:119], a[72:75], v[92:95]
    v_mfma_f32_16x16x32_bf16 v[88:91], a[112:115], a[72:75], v[88:91]
    v_mfma_f32_16x16x32_bf16 v[92:95], a[112:115], a[76:79], v[92:95]
    v_mfma_f32_16x16x32_bf16 v[88:91], a[108:111], a[76:79], v[88:91]
    v_mfma_f32_16x16x32_bf16 v[92:95], a[108:111], a[80:83], v[92:95]
    ds_write_b128 v96, v[84:87] offset:29696
    v_mfma_f32_16x16x32_bf16 v[88:91], a[104:107], a[80:83], v[88:91]
    v_mfma_f32_16x16x32_bf16 v[92:95], a[104:107], a[84:87], v[92:95]
    v_mfma_f32_16x16x32_bf16 v[88:91], a[100:103], a[84:87], v[88:91]
    v_mfma_f32_16x16x32_bf16 v[92:95], a[100:103], a[88:91], v[92:95]
    v_mfma_f32_16x16x32_bf16 v[88:91], a[96:99], a[88:91], v[88:91]
    v_mfma_f32_16x16x32_bf16 v[92:95], a[96:99], a[92:95], v[92:95]
    s_nop 6
    ds_write_b128 v96, v[88:91] offset:30720
    ds_write_b128 v96, v[92:95] offset:31744
    s_waitcnt vmcnt(9) lgkmcnt(0)
    s_barrier
    ds_read2st64_b64 v[64:67], v97 offset0:0 offset1:128
    ds_read2st64_b64 v[68:71], v97 offset0:64 offset1:192
    ds_read2st64_b64 v[72:75], v97 offset0:1 offset1:129
    ds_read2st64_b64 v[76:79], v97 offset0:65 offset1:193
    ds_read2st64_b64 v[80:83], v97 offset0:2 offset1:130
    ds_read2st64_b64 v[84:87], v97 offset0:66 offset1:194
    ds_read2st64_b64 v[88:91], v97 offset0:3 offset1:131
    ds_read2st64_b64 v[92:95], v97 offset0:67 offset1:195
    s_waitcnt lgkmcnt(7)
    v_pk_add_f32 v[64:65], v[64:65], v[66:67]
    s_waitcnt lgkmcnt(6)
    v_pk_add_f32 v[68:69], v[68:69], v[70:71]
    v_cvt_pk_bf16_f32 v32, v64, v68
    v_cvt_pk_bf16_f32 v34, v65, v69
    buffer_store_dwordx4 v[32:35], v98, s[8:11], s6 offen sc1
    s_add_u32 s93, s6, 0x80000
    s_waitcnt lgkmcnt(5)
    v_pk_add_f32 v[72:73], v[72:73], v[74:75]
    s_waitcnt lgkmcnt(4)
    v_pk_add_f32 v[76:77], v[76:77], v[78:79]
    v_cvt_pk_bf16_f32 v36, v72, v76
    v_cvt_pk_bf16_f32 v38, v73, v77
    buffer_store_dwordx4 v[36:39], v98, s[8:11], s93 offen sc1
    s_add_u32 s93, s6, 0x200000
    s_waitcnt lgkmcnt(3)
    v_pk_add_f32 v[80:81], v[80:81], v[82:83]
    s_waitcnt lgkmcnt(2)
    v_pk_add_f32 v[84:85], v[84:85], v[86:87]
    v_cvt_pk_bf16_f32 v40, v80, v84
    v_cvt_pk_bf16_f32 v42, v81, v85
    buffer_store_dwordx4 v[40:43], v98, s[8:11], s93 offen sc1
    s_add_u32 s93, s6, 0x280000
    s_waitcnt lgkmcnt(1)
    v_pk_add_f32 v[88:89], v[88:89], v[90:91]
    s_waitcnt lgkmcnt(0)
    v_pk_add_f32 v[92:93], v[92:93], v[94:95]
    v_cvt_pk_bf16_f32 v44, v88, v92
    v_cvt_pk_bf16_f32 v46, v89, v93
    buffer_store_dwordx4 v[44:47], v98, s[8:11], s93 offen sc1
    v_permlane32_swap_b32 v100, v102
    v_permlane32_swap_b32 v101, v103
    v_permlane32_swap_b32 v104, v106
    v_permlane32_swap_b32 v105, v107
    v_lshlrev_b32 v32, 16, v100
    v_and_b32 v33, 0xffff0000, v100
    v_lshlrev_b32 v34, 16, v101
    v_and_b32 v35, 0xffff0000, v101
    v_lshlrev_b32 v36, 16, v102
    v_and_b32 v37, 0xffff0000, v102
    v_lshlrev_b32 v38, 16, v103
    v_and_b32 v39, 0xffff0000, v103
    v_lshlrev_b32 v40, 16, v104
    v_and_b32 v41, 0xffff0000, v104
    v_lshlrev_b32 v42, 16, v105
    v_and_b32 v43, 0xffff0000, v105
    v_lshlrev_b32 v44, 16, v106
    v_and_b32 v45, 0xffff0000, v106
    v_lshlrev_b32 v46, 16, v107
    v_and_b32 v47, 0xffff0000, v107
    s_add_u32 s77, s48, 0x1000
    s_add_u32 s76, s49, 0x1000
    v_pk_add_f32 v[18:19], v[32:33], v[34:35]
    v_pk_mul_f32 v[20:21], v[32:33], v[32:33]
    v_pk_fma_f32 v[20:21], v[34:35], v[34:35], v[20:21]
    v_pk_add_f32 v[18:19], v[18:19], v[36:37]
    v_pk_fma_f32 v[20:21], v[36:37], v[36:37], v[20:21]
    v_pk_add_f32 v[18:19], v[18:19], v[38:39]
    v_pk_fma_f32 v[20:21], v[38:39], v[38:39], v[20:21]
    v_pk_add_f32 v[18:19], v[18:19], v[40:41]
    v_pk_fma_f32 v[20:21], v[40:41], v[40:41], v[20:21]
    v_pk_add_f32 v[18:19], v[18:19], v[42:43]
    v_pk_fma_f32 v[20:21], v[42:43], v[42:43], v[20:21]
    v_pk_add_f32 v[18:19], v[18:19], v[44:45]
    v_pk_fma_f32 v[20:21], v[44:45], v[44:45], v[20:21]
    v_pk_add_f32 v[18:19], v[18:19], v[46:47]
    v_pk_fma_f32 v[20:21], v[46:47], v[46:47], v[20:21]
    v_add_f32 v18, v18, v19
    v_add_f32 v20, v20, v21
    s_nop 1
    v_permlane32_swap_b32 v18, v20
    v_add_f32 v18, v18, v20
    v_or_b32 v18, 1, v18
    buffer_store_dword v18, v1, s[8:11], s77 offen sc1
    s_waitcnt vmcnt(13)
    v_subrev_u32 v9, s69, v9
    v_subrev_u32 v9, 1, v9
    v_cmp_lt_u32 vcc, 7, v9
    s_cbranch_vccnz OOL_288
RET_289:
    s_waitcnt vmcnt(19)
    ds_read_b64_tr_b16 v[192:193], v112 offset:8192
    ds_read_b64_tr_b16 v[194:195], v112 offset:9216
    ds_read_b64_tr_b16 v[196:197], v113 offset:8192
    ds_read_b64_tr_b16 v[198:199], v113 offset:9216
    ds_read_b64_tr_b16 v[200:201], v112 offset:10240
    ds_read_b64_tr_b16 v[202:203], v112 offset:11264
    ds_read_b64_tr_b16 v[204:205], v113 offset:10240
    ds_read_b64_tr_b16 v[206:207], v113 offset:11264
    ds_read_b64_tr_b16 v[208:209], v112 offset:12288
    ds_read_b64_tr_b16 v[210:211], v112 offset:13312
    ds_read_b64_tr_b16 v[212:213], v113 offset:12288
    ds_read_b64_tr_b16 v[214:215], v113 offset:13312
    ds_read_b64_tr_b16 v[216:217], v112 offset:14336
    ds_read_b64_tr_b16 v[218:219], v112 offset:15360
    ds_read_b64_tr_b16 v[220:221], v113 offset:14336
    ds_read_b64_tr_b16 v[222:223], v113 offset:15360
    ds_read_b64_tr_b16 v[224:225], v112 offset:16384
    ds_read_b64_tr_b16 v[226:227], v112 offset:17408
    ds_read_b64_tr_b16 v[228:229], v113 offset:16384
    ds_read_b64_tr_b16 v[230:231], v113 offset:17408
    ds_read_b64_tr_b16 v[232:233], v112 offset:18432
    ds_read_b64_tr_b16 v[234:235], v112 offset:19456
    ds_read_b64_tr_b16 v[236:237], v113 offset:18432
    ds_read_b64_tr_b16 v[238:239], v113 offset:19456
    ds_read_b64_tr_b16 v[240:241], v112 offset:20480
    ds_read_b64_tr_b16 v[242:243], v112 offset:21504
    ds_read_b64_tr_b16 v[244:245], v113 offset:20480
    ds_read_b64_tr_b16 v[246:247], v113 offset:21504
    ds_read_b64_tr_b16 v[248:249], v112 offset:22528
    ds_read_b64_tr_b16 v[250:251], v112 offset:23552
    ds_read_b64_tr_b16 v[252:253], v113 offset:22528
    ds_read_b64_tr_b16 v[254:255], v113 offset:23552
    s_waitcnt lgkmcnt(0)
    s_add_u32 m0, s97, 8192
    s_add_u32 s17, s96, 229376
    buffer_load_dwordx4 v63, s[36:39], s17 offen lds
    s_add_u32 m0, s97, 9216
    s_add_u32 s17, s96, 258048
    buffer_load_dwordx4 v63, s[36:39], s17 offen lds
    s_add_u32 m0, s97, 10240
    s_add_u32 s17, s96, 286720
    buffer_load_dwordx4 v63, s[36:39], s17 offen lds
    s_add_u32 m0, s97, 11264
    s_add_u32 s17, s96, 315392
    buffer_load_dwordx4 v63, s[36:39], s17 offen lds
    s_add_u32 s78, s46, 0x8000
    buffer_load_dwordx4 v[80:83], v1, s[8:11], s76 offen offset:0 sc1
    buffer_load_dwordx4 v[84:87], v1, s[8:11], s76 offen offset:1024 sc1
    buffer_load_dwordx4 v[88:91], v1, s[8:11], s76 offen offset:2048 sc1
    buffer_load_dwordx4 v[92:95], v1, s[8:11], s76 offen offset:3072 sc1
    s_lshr_b32 s28, s87, 3
    s_lshl_b32 s28, s28, 1
    s_and_b32 s29, s44, 1
    s_add_u32 s4, s28, s29
    s_lshl_b32 s5, s4, 17
    s_add_u32 s5, s5, s67
    s_lshl_b32 s3, s44, 13
    s_add_u32 s47, s46, 0x110000
    s_lshl_b32 s30, s70, 11
    s_add_u32 s54, s30, s67
    s_add_u32 s54, s54, 0x8000
    s_add_u32 s50, s5, s3
    s_xor_b32 s51, s50, 0x20000
    s_mul_i32 s52, s44, 12288
    s_add_u32 s52, s52, s5
    s_add_u32 s52, s52, 0x110000
    s_xor_b32 s53, s52, 0x20000
    s_mul_i32 s3, s44, 28672
    s_add_u32 s3, s3, 0x1200000
    s_mul_i32 s57, s70, 114688
    s_add_u32 s57, s57, s3
    s_xor_b32 s31, s70, 1
    s_mul_i32 s58, s31, 114688
    s_add_u32 s58, s58, s3
    s_lshr_b32 s31, s87, 4
    s_lshl_b32 s31, s31, 2
    s_add_u32 s31, s31, s44
    s_lshl_b32 s31, s31, 17
    s_add_u32 s31, s31, s67
    s_add_u32 s59, s31, 0x110000
    s_and_b32 s30, s87, 15
    s_lshl_b32 s60, s30, 11
    s_add_u32 s60, s60, s31
    s_lshl_b32 s30, s30, 2
    s_add_u32 s31, s31, 0x1e000
    s_add_u32 s63, s31, s30
    s_add_u32 s63, s63, 128
    s_bfe_u32 s71, s87, 0x20002
    s_lshl_b32 s30, s71, 12
    s_add_u32 s61, s60, s30
    s_add_u32 s61, s61, 0x110000
    s_and_b32 s3, s87, 3
    s_cmp_lg_u32 s3, 3
    s_cselect_b32 s61, s61, 0x40000000
    s_mul_i32 s71, s71, 7
    s_add_u32 s71, s71, s3
    s_lshl_b32 s71, s71, 1
    s_add_u32 s71, s71, s29
    s_and_b32 s3, s44, 2
    s_lshl_b32 s3, s3, 2
    s_add_u32 s71, s71, s3
    s_lshl_b32 s71, s71, 11
    s_add_u32 s71, s71, 0x1100000
    v_add_u32 v8, s31, v8
    s_mul_i32 s30, s29, 3
    s_sub_u32 s30, s30, 1
    s_add_u32 s3, s28, s30
    s_cmp_lt_u32 s3, 8
    s_cselect_b32 s3, 0, 1
    s_or_b32 s30, s44, 1
    s_brev_b32 s31, s30
    s_cmp_eq_u32 s29, 0
    s_cselect_b32 s30, s30, s31
    s_mul_i32 s30, s30, s3
    s_mov_b32 vcc_lo, s30
    s_mov_b32 vcc_hi, s30
    s_lshl_b32 s72, s44, 13
    s_add_u32 s72, s72, s67
    s_add_u32 s72, s72, 0x100000
    s_cmp_lg_u32 s3, 0
    s_cselect_b32 s72, s72, 0x40000000
    s_lshl_b32 s3, s4, 17
    s_sub_u32 s3, 0xf8000, s3
    v_and_b32 v128, 0x210, v1
    v_add_u32 v128, s3, v128
    v_cndmask_b32 v5, v1, v128, vcc
    v_mov_b32 v128, 128
    v_cndmask_b32 v14, 0, v128, vcc
    s_lshr_b32 s30, s70, 3
    s_add_u32 s30, s30, 1
    s_sub_u32 s31, 0, s30
    s_bitcmp1_b32 s70, 2
    s_cselect_b32 s30, s31, s30
    s_cselect_b32 s31, -1, 1
    s_lshl_b32 s3, s4, 5
    s_sub_u32 s28, s3, s30
    s_add_u32 s30, s30, s3
    v_and_b32 v128, 31, v0
    v_add_u32 v131, s28, v128
    v_add_u32 v128, s30, v128
    v_and_b32 v129, 0x200, v1
    v_and_b32 v130, 31, v128
    v_lshl_add_u32 v130, v130, 4, v129
    v_lshrrev_b32 v3, 5, v128
    v_lshl_add_u32 v3, v3, 17, v130
    v_and_b32 v130, 0x210, v130
    v_mov_b32 v129, 0x40000000
    v_cmp_gt_u32 vcc, 256, v128
    s_nop 1
    v_cndmask_b32 v3, v129, v3, vcc
    v_cndmask_b32 v4, v130, v129, vcc
    v_cmp_gt_u32 vcc, 256, v131
    s_nop 1
    v_cndmask_b32 v4, v1, v4, vcc
    s_sub_u32 s3, s4, s31
    s_cmp_ge_u32 s3, 8
    s_cselect_b32 s28, 2, 0
    s_add_u32 s3, s4, s31
    s_lshl_b32 s30, s31, 17
    s_add_u32 s31, s86, s31
    s_cmp_lt_u32 s3, 8
    s_cselect_b32 s30, s30, 0
    s_add_u32 s30, s30, s62
    v_mov_b32 v128, s30
    v_cmp_gt_u32 vcc, 32, v0
    s_nop 1
    v_cndmask_b32 v8, v128, v8, vcc
    s_cmp_ge_u32 s3, 8
    s_cselect_b32 s64, 1, 0
    s_cmp_lt_u32 s31, 8
    s_cselect_b32 s64, s64, 0
    s_or_b32 s64, s64, s28
    s_lshl_b32 s68, s31, 21
    s_lshl_b32 s30, s70, 11
    s_add_u32 s68, s68, s30
    s_add_u32 s68, s68, 0x100000
    s_cmp_eq_u32 s64, 1
    s_cselect_b32 s68, s68, 0x40000000
    s_lshl_b32 s30, s44, 11
    s_add_u32 s30, s30, 131072
    v_add_u32 v2, s30, v1
    v_bfe_u32 v128, v0, 3, 2
    v_bfe_u32 v129, v0, 1, 1
    v_lshl_add_u32 v128, v128, 1, v129
    v_lshrrev_b32 v129, 3, v0
    v_xor_b32 v129, v129, v0
    v_and_b32 v129, 4, v129
    v_lshl_add_u32 v128, v129, 1, v128
    v_and_b32 v129, 16, v1
    v_lshlrev_b32 v129, v129, s65
    v_add_u32 v130, 161792, v1
    v_cmp_eq_u32 vcc, 0, v128
    s_nop 1
    v_cndmask_b32 v132, 0, v129, vcc
    v_cmp_eq_u32 vcc, 1, v128
    s_nop 1
    v_cndmask_b32 v133, 0, v129, vcc
    v_cmp_eq_u32 vcc, 2, v128
    s_nop 1
    v_cndmask_b32 v134, 0, v129, vcc
    v_cmp_eq_u32 vcc, 3, v128
    s_nop 1
    v_cndmask_b32 v135, 0, v129, vcc
    v_cmp_eq_u32 vcc, 4, v128
    s_nop 1
    v_cndmask_b32 v136, 0, v129, vcc
    v_cmp_eq_u32 vcc, 5, v128
    s_nop 1
    v_cndmask_b32 v137, 0, v129, vcc
    v_cmp_eq_u32 vcc, 6, v128
    s_nop 1
    v_cndmask_b32 v138, 0, v129, vcc
    v_cmp_eq_u32 vcc, 7, v128
    s_nop 1
    v_cndmask_b32 v139, 0, v129, vcc
    ds_write_b128 v130, v[132:135] offset:0
    ds_write_b128 v130, v[136:139] offset:1024
    s_waitcnt vmcnt(0)
    v_bitop3_b32 v7, v80, v81, v82 bitop3:0x80
    v_bitop3_b32 v7, v7, v83, v84 bitop3:0x80
    v_bitop3_b32 v7, v7, v85, v86 bitop3:0x80
    v_bitop3_b32 v7, v7, v87, v88 bitop3:0x80
    v_bitop3_b32 v7, v7, v89, v90 bitop3:0x80
    v_bitop3_b32 v7, v7, v91, v92 bitop3:0x80
    v_bitop3_b32 v7, v7, v93, v94 bitop3:0x80
    v_bitop3_b32 v7, v7, v95, 1 bitop3:0x2a
    v_cmp_ne_u32 vcc, 0, v7
    s_cbranch_vccnz OOL_291
RET_292:
    buffer_load_dwordx2 v[160:161], v123, s[8:11], s46 offen offset:0 sc1
    buffer_load_dwordx2 v[162:163], v123, s[8:11], s46 offen offset:256 sc1
    buffer_load_dwordx2 v[164:165], v123, s[8:11], s46 offen offset:1024 sc1
    buffer_load_dwordx2 v[166:167], v123, s[8:11], s46 offen offset:1280 sc1
    buffer_load_dwordx2 v[168:169], v123, s[8:11], s78 offen offset:0 sc1
    buffer_load_dwordx2 v[170:171], v123, s[8:11], s78 offen offset:256 sc1
    buffer_load_dwordx2 v[172:173], v123, s[8:11], s78 offen offset:1024 sc1
    buffer_load_dwordx2 v[174:175], v123, s[8:11], s78 offen offset:1280 sc1
    v_pk_add_f32 v[80:81], v[80:81], v[88:89]
    v_pk_add_f32 v[82:83], v[82:83], v[90:91]
    v_pk_add_f32 v[84:85], v[84:85], v[92:93]
    v_pk_add_f32 v[86:87], v[86:87], v[94:95]
    v_pk_add_f32 v[80:81], v[80:81], v[84:85]
    v_pk_add_f32 v[82:83], v[82:83], v[86:87]
    v_pk_add_f32 v[80:81], v[80:81], v[82:83]
    v_add_f32 v80, v80, v81
    v_mov_b32 v81, v80
    s_nop 1
    v_permlane32_swap_b32 v80, v81
    v_mul_f32 v80, 0xbb000000, v80
    v_mul_f32 v81, 0x3b000000, v81
    v_fma_f32 v81, -v80, v80, v81
    v_max_f32 v81, 0, v81
    v_add_f32 v81, 0x3727c5ac, v81
    v_rsq_f32 v82, v81
    s_nop 0
    v_mul_f32 v83, v80, v82
    v_pk_fma_f32 v[96:97], v[32:33], v[82:83], v[82:83] op_sel:[0,0,1] op_sel_hi:[1,0,1]
    v_pk_fma_f32 v[98:99], v[34:35], v[82:83], v[82:83] op_sel:[0,0,1] op_sel_hi:[1,0,1]
    v_pk_fma_f32 v[100:101], v[36:37], v[82:83], v[82:83] op_sel:[0,0,1] op_sel_hi:[1,0,1]
    v_pk_fma_f32 v[102:103], v[38:39], v[82:83], v[82:83] op_sel:[0,0,1] op_sel_hi:[1,0,1]
    v_pk_fma_f32 v[104:105], v[40:41], v[82:83], v[82:83] op_sel:[0,0,1] op_sel_hi:[1,0,1]
    v_pk_fma_f32 v[106:107], v[42:43], v[82:83], v[82:83] op_sel:[0,0,1] op_sel_hi:[1,0,1]
    v_pk_fma_f32 v[108:109], v[44:45], v[82:83], v[82:83] op_sel:[0,0,1] op_sel_hi:[1,0,1]
    v_pk_fma_f32 v[110:111], v[46:47], v[82:83], v[82:83] op_sel:[0,0,1] op_sel_hi:[1,0,1]
    s_waitcnt vmcnt(0)
    v_xor_b32 v7, s69, v161
    v_bitop3_b32 v7, v7, v163, s69 bitop3:0xf6
    v_bitop3_b32 v7, v7, v165, s69 bitop3:0xf6
    v_bitop3_b32 v7, v7, v167, s69 bitop3:0xf6
    v_bitop3_b32 v7, v7, v169, s69 bitop3:0xf6
    v_bitop3_b32 v7, v7, v171, s69 bitop3:0xf6
    v_bitop3_b32 v7, v7, v173, s69 bitop3:0xf6
    v_bitop3_b32 v7, v7, v175, s69 bitop3:0xf6
    v_cmp_ne_u32 vcc, 0, v7
    s_cbranch_vccnz OOL_294
RET_295:
    v_lshlrev_b32 v64, 16, v160
    v_and_b32 v65, 0xffff0000, v160
    v_lshlrev_b32 v66, 16, v162
    v_and_b32 v67, 0xffff0000, v162
    v_lshlrev_b32 v68, 16, v164
    v_and_b32 v69, 0xffff0000, v164
    v_lshlrev_b32 v70, 16, v166
    v_and_b32 v71, 0xffff0000, v166
    v_lshlrev_b32 v72, 16, v168
    v_and_b32 v73, 0xffff0000, v168
    v_lshlrev_b32 v74, 16, v170
    v_and_b32 v75, 0xffff0000, v170
    v_lshlrev_b32 v76, 16, v172
    v_and_b32 v77, 0xffff0000, v172
    v_lshlrev_b32 v78, 16, v174
    v_and_b32 v79, 0xffff0000, v174
    v_pk_fma_f32 v[32:33], v[96:97], v[64:65], v[32:33]
    v_pk_fma_f32 v[34:35], v[98:99], v[66:67], v[34:35]
    v_pk_fma_f32 v[36:37], v[100:101], v[68:69], v[36:37]
    v_pk_fma_f32 v[38:39], v[102:103], v[70:71], v[38:39]
    v_pk_fma_f32 v[40:41], v[104:105], v[72:73], v[40:41]
    v_pk_fma_f32 v[42:43], v[106:107], v[74:75], v[42:43]
    v_pk_fma_f32 v[44:45], v[108:109], v[76:77], v[44:45]
    v_pk_fma_f32 v[46:47], v[110:111], v[78:79], v[46:47]
    v_cvt_pk_bf16_f32 v112, v32, v33
    v_cvt_pk_bf16_f32 v113, v34, v35
    v_cvt_pk_bf16_f32 v114, v36, v37
    v_cvt_pk_bf16_f32 v115, v38, v39
    v_cvt_pk_bf16_f32 v116, v40, v41
    v_cvt_pk_bf16_f32 v117, v42, v43
    v_cvt_pk_bf16_f32 v118, v44, v45
    v_cvt_pk_bf16_f32 v119, v46, v47
    v_or_b32 v115, 1, v115
    v_or_b32 v119, 1, v119
    buffer_store_dwordx4 v[112:115], v1, s[8:11], s47 offen offset:0 sc1
    buffer_store_dwordx4 v[116:119], v1, s[8:11], s47 offen offset:1024 sc1
    v_pk_add_f32 v[120:121], v[32:33], v[34:35]
    v_pk_mul_f32 v[122:123], v[32:33], v[32:33]
    v_pk_fma_f32 v[122:123], v[34:35], v[34:35], v[122:123]
    v_pk_add_f32 v[120:121], v[120:121], v[36:37]
    v_pk_fma_f32 v[122:123], v[36:37], v[36:37], v[122:123]
    v_pk_add_f32 v[120:121], v[120:121], v[38:39]
    v_pk_fma_f32 v[122:123], v[38:39], v[38:39], v[122:123]
    v_pk_add_f32 v[120:121], v[120:121], v[40:41]
    v_pk_fma_f32 v[122:123], v[40:41], v[40:41], v[122:123]
    v_pk_add_f32 v[120:121], v[120:121], v[42:43]
    v_pk_fma_f32 v[122:123], v[42:43], v[42:43], v[122:123]
    v_pk_add_f32 v[120:121], v[120:121], v[44:45]
    v_pk_fma_f32 v[122:123], v[44:45], v[44:45], v[122:123]
    v_pk_add_f32 v[120:121], v[120:121], v[46:47]
    v_pk_fma_f32 v[122:123], v[46:47], v[46:47], v[122:123]
    v_add_f32 v120, v120, v121
    v_add_f32 v122, v122, v123
    s_nop 1
    v_permlane32_swap_b32 v120, v122
    v_add_f32 v120, v120, v122
    v_or_b32 v120, 1, v120
    buffer_store_dword v120, v1, s[8:11], s48 offen sc1
    v_mov_b32 v48, v160
    v_mov_b32 v49, v162
    v_mov_b32 v50, v164
    v_mov_b32 v51, v166
    v_mov_b32 v52, v168
    v_mov_b32 v53, v170
    v_mov_b32 v54, v172
    v_mov_b32 v55, v174
    s_add_u32 s79, s51, 0x110000
    buffer_load_dwordx4 v[132:135], v1, s[8:11], s79 offen offset:0 sc1
    buffer_load_dwordx4 v[140:143], v1, s[8:11], s79 offen offset:1024 sc1
    buffer_load_dwordx4 v[148:151], v1, s[8:11], s79 offen offset:2048 sc1
    buffer_load_dwordx4 v[156:159], v1, s[8:11], s79 offen offset:3072 sc1
    s_add_u32 s79, s51, 0x111000
    buffer_load_dwordx4 v[164:167], v1, s[8:11], s79 offen offset:0 sc1
    buffer_load_dwordx4 v[172:175], v1, s[8:11], s79 offen offset:1024 sc1
    buffer_load_dwordx4 v[180:183], v1, s[8:11], s79 offen offset:2048 sc1
    buffer_load_dwordx4 v[188:191], v1, s[8:11], s79 offen offset:3072 sc1
    v_mfma_f32_32x32x16_bf16 v[64:79], v[124:127], v[192:195], 0
    v_mfma_f32_32x32x16_bf16 v[96:111], v[124:127], v[196:199], 0
    v_mfma_f32_32x32x16_bf16 v[64:79], v[124:127], v[200:203], v[64:79]
    v_mfma_f32_32x32x16_bf16 v[96:111], v[124:127], v[204:207], v[96:111]
    v_mfma_f32_32x32x16_bf16 v[64:79], v[124:127], v[208:211], v[64:79]
    v_mfma_f32_32x32x16_bf16 v[96:111], v[124:127], v[212:215], v[96:111]
    v_mfma_f32_32x32x16_bf16 v[64:79], v[124:127], v[216:219], v[64:79]
    v_mfma_f32_32x32x16_bf16 v[96:111], v[124:127], v[220:223], v[96:111]
    v_mfma_f32_32x32x16_bf16 v[64:79], v[124:127], v[224:227], v[64:79]
    v_mfma_f32_32x32x16_bf16 v[96:111], v[124:127], v[228:231], v[96:111]
    v_mfma_f32_32x32x16_bf16 v[64:79], v[124:127], v[232:235], v[64:79]
    v_mfma_f32_32x32x16_bf16 v[96:111], v[124:127], v[236:239], v[96:111]
    v_mfma_f32_32x32x16_bf16 v[64:79], v[124:127], v[240:243], v[64:79]
    v_mfma_f32_32x32x16_bf16 v[96:111], v[124:127], v[244:247], v[96:111]
    v_mfma_f32_32x32x16_bf16 v[64:79], v[124:127], v[248:251], v[64:79]
    v_mfma_f32_32x32x16_bf16 v[96:111], v[124:127], v[252:255], v[96:111]
    s_waitcnt vmcnt(6)
    v_bitop3_b32 v7, v135, v143, 1 bitop3:0x2a
    v_cmp_ne_u32 vcc, 0, v7
    s_cbranch_vccnz OOL_297
RET_298:
    v_mfma_f32_32x32x16_bf16 v[112:127], v[196:199], v[132:135], 0
    s_add_u32 s80, s50, 0x110000
    buffer_load_dwordx4 v[128:131], v1, s[8:11], s80 offen offset:0 sc1
    v_mov_b32 v30, s69
    v_add_u32 v30, 2, v30
    v_mfma_f32_32x32x16_bf16 v[80:95], v[192:195], v[132:135], 0
    s_mov_b64 exec, 1
    buffer_store_dword v30, off, s[8:11], s62 sc1
    s_mov_b64 exec, -1
    v_mfma_f32_32x32x16_bf16 v[112:127], v[204:207], v[140:143], v[112:127]
    buffer_load_dwordx4 v[136:139], v1, s[8:11], s80 offen offset:1024 sc1
    v_cmp_gt_u32 vcc, 32, v0
    s_nop 1
    v_cndmask_b32 v64, v96, v64, vcc
    ds_write_b32 v10, v64
    s_waitcnt vmcnt(7)
    v_bitop3_b32 v7, v151, v159, 1 bitop3:0x2a
    v_cmp_ne_u32 vcc, 0, v7
    v_mfma_f32_32x32x16_bf16 v[80:95], v[200:203], v[140:143], v[80:95]
    s_cbranch_vccnz OOL_300
RET_301:
    v_mfma_f32_32x32x16_bf16 v[112:127], v[212:215], v[148:151], v[112:127]
    buffer_load_dwordx4 v[144:147], v1, s[8:11], s80 offen offset:2048 sc1
    v_mfma_f32_32x32x16_bf16 v[80:95], v[208:211], v[148:151], v[80:95]
    v_mfma_f32_32x32x16_bf16 v[112:127], v[220:223], v[156:159], v[112:127]
    buffer_load_dwordx4 v[152:155], v1, s[8:11], s80 offen offset:3072 sc1
    s_waitcnt vmcnt(5)
    v_bitop3_b32 v7, v167, v175, v183 bitop3:0x80
    v_bitop3_b32 v7, v7, v191, 1 bitop3:0x2a
    v_cmp_ne_u32 vcc, 0, v7
    v_mfma_f32_32x32x16_bf16 v[80:95], v[216:219], v[156:159], v[80:95]
    s_cbranch_vccnz OOL_303
RET_304:
    v_mfma_f32_32x32x16_bf16 v[112:127], v[228:231], v[164:167], v[112:127]
    s_add_u32 s80, s50, 0x111000
    buffer_load_dwordx4 v[160:163], v1, s[8:11], s80 offen offset:0 sc1
    v_mfma_f32_32x32x16_bf16 v[80:95], v[224:227], v[164:167], v[80:95]
    v_mfma_f32_32x32x16_bf16 v[112:127], v[236:239], v[172:175], v[112:127]
    buffer_load_dwordx4 v[168:171], v1, s[8:11], s80 offen offset:1024 sc1
    v_mfma_f32_32x32x16_bf16 v[80:95], v[232:235], v[172:175], v[80:95]
    v_mfma_f32_32x32x16_bf16 v[112:127], v[244:247], v[180:183], v[112:127]
    buffer_load_dwordx4 v[176:179], v1, s[8:11], s80 offen offset:2048 sc1
    v_mfma_f32_32x32x16_bf16 v[80:95], v[240:243], v[180:183], v[80:95]
    v_mfma_f32_32x32x16_bf16 v[112:127], v[252:255], v[188:191], v[112:127]
    buffer_load_dwordx4 v[184:187], v1, s[8:11], s80 offen offset:3072 sc1
    s_waitcnt vmcnt(4)
    v_bitop3_b32 v7, v131, v139, v147 bitop3:0x80
    v_bitop3_b32 v7, v7, v155, 1 bitop3:0x2a
    v_cmp_ne_u32 vcc, 0, v7
    v_mfma_f32_32x32x16_bf16 v[80:95], v[248:251], v[188:191], v[80:95]
    s_cbranch_vccnz OOL_306
RET_307:
    buffer_load_dwordx4 v[132:135], v1, s[8:11], s49 offen offset:0 sc1
    buffer_load_dwordx4 v[140:143], v1, s[8:11], s49 offen offset:1024 sc1
    v_mfma_f32_32x32x16_bf16 v[96:111], v[196:199], v[128:131], 0
    buffer_load_dwordx4 v[148:151], v1, s[8:11], s49 offen offset:2048 sc1
    buffer_load_dwordx4 v[156:159], v1, s[8:11], s49 offen offset:3072 sc1
    buffer_load_dword v9, v8, s[8:11], 0 offen offset:0 sc1
    v_mfma_f32_32x32x16_bf16 v[96:111], v[204:207], v[136:139], v[96:111]
    s_nop 0
    v_xor_b32 v19, 6144, v2
    v_cvt_pk_bf16_f32 v112, v112, v113
    v_cvt_pk_bf16_f32 v113, v114, v115
    v_cvt_pk_bf16_f32 v114, v116, v117
    v_cvt_pk_bf16_f32 v115, v118, v119
    v_cvt_pk_bf16_f32 v116, v120, v121
    v_mfma_f32_32x32x16_bf16 v[96:111], v[212:215], v[144:147], v[96:111]
    s_add_u32 m0, s97, 12288
    s_add_u32 s17, s96, 344064
    buffer_load_dwordx4 v63, s[36:39], s17 offen lds
    v_cvt_pk_bf16_f32 v117, v122, v123
    v_cvt_pk_bf16_f32 v118, v124, v125
    v_cvt_pk_bf16_f32 v119, v126, v127
    v_mfma_f32_32x32x16_bf16 v[64:79], v[192:195], v[128:131], 0
    s_add_u32 m0, s97, 13312
    s_add_u32 s17, s96, 372736
    buffer_load_dwordx4 v63, s[36:39], s17 offen lds
    v_xor_b32 v17, 2048, v2
    v_cvt_pk_bf16_f32 v80, v80, v81
    v_cvt_pk_bf16_f32 v81, v82, v83
    v_mfma_f32_32x32x16_bf16 v[96:111], v[220:223], v[152:155], v[96:111]
    s_add_u32 m0, s97, 14336
    s_add_u32 s17, s96, 401408
    buffer_load_dwordx4 v63, s[36:39], s17 offen lds
    s_waitcnt vmcnt(10)
    v_bitop3_b32 v7, v163, v171, 1 bitop3:0x2a
    v_cmp_ne_u32 vcc, 0, v7
    v_mfma_f32_32x32x16_bf16 v[64:79], v[200:203], v[136:139], v[64:79]
    s_cbranch_vccnz OOL_309
RET_310:
    s_add_u32 m0, s97, 15360
    s_add_u32 s17, s96, 430080
    buffer_load_dwordx4 v63, s[36:39], s17 offen lds
    v_mfma_f32_32x32x16_bf16 v[96:111], v[228:231], v[160:163], v[96:111]
    s_add_u32 m0, s97, 16384
    s_add_u32 s17, s96, 458752
    buffer_load_dwordx4 v63, s[36:39], s17 offen lds
    v_cvt_pk_bf16_f32 v82, v84, v85
    v_cvt_pk_bf16_f32 v83, v86, v87
    v_cvt_pk_bf16_f32 v84, v88, v89
    v_mfma_f32_32x32x16_bf16 v[64:79], v[208:211], v[144:147], v[64:79]
    s_add_u32 m0, s97, 17408
    s_add_u32 s17, s96, 487424
    buffer_load_dwordx4 v63, s[36:39], s17 offen lds
    v_cvt_pk_bf16_f32 v85, v90, v91
    v_cvt_pk_bf16_f32 v86, v92, v93
    v_cvt_pk_bf16_f32 v87, v94, v95
    v_mfma_f32_32x32x16_bf16 v[96:111], v[236:239], v[168:171], v[96:111]
    s_add_u32 m0, s97, 18432
    s_add_u32 s17, s96, 516096
    buffer_load_dwordx4 v63, s[36:39], s17 offen lds
    s_waitcnt vmcnt(12)
    v_bitop3_b32 v7, v179, v187, 1 bitop3:0x2a
    v_cmp_ne_u32 vcc, 0, v7
    v_mfma_f32_32x32x16_bf16 v[64:79], v[216:219], v[152:155], v[64:79]
    s_cbranch_vccnz OOL_312
RET_313:
    s_add_u32 m0, s97, 19456
    s_add_u32 s17, s96, 544768
    buffer_load_dwordx4 v63, s[36:39], s17 offen lds
    v_mfma_f32_32x32x16_bf16 v[96:111], v[244:247], v[176:179], v[96:111]
    s_add_u32 s89, s56, 0x80000
    buffer_load_dwordx4 v[196:199], v1, s[8:11], s89 offen offset:0 sc1
    ds_write_b128 v19, v[112:115] offset:16384
    v_mfma_f32_32x32x16_bf16 v[64:79], v[224:227], v[160:163], v[64:79]
    buffer_load_dwordx4 v[204:207], v1, s[8:11], s89 offen offset:1024 sc1
    ds_write_b128 v19, v[116:119] offset:17408
    ds_write_b128 v17, v[80:83] offset:0
    ds_write_b128 v17, v[84:87] offset:1024
    v_add_u32 v16, 161792, v1
    s_waitcnt lgkmcnt(0)
    s_barrier
    ds_read_b128 v[120:123], v16 offset:0
    ds_read_b128 v[124:127], v16 offset:1024
    ds_read_b128 v[80:83], v2 offset:0
    ds_read_b128 v[84:87], v2 offset:1024
    ds_read_b128 v[112:115], v2 offset:16384
    ds_read_b128 v[116:119], v2 offset:17408
    v_mfma_f32_32x32x16_bf16 v[96:111], v[252:255], v[184:187], v[96:111]
    buffer_load_dwordx4 v[212:215], v1, s[8:11], s89 offen offset:2048 sc1
    v_mfma_f32_32x32x16_bf16 v[64:79], v[232:235], v[168:171], v[64:79]
    s_add_u32 s88, s55, 0x80000
    buffer_load_dwordx4 v[192:195], v1, s[8:11], s88 offen offset:0 sc1
    v_mfma_f32_32x32x16_bf16 v[64:79], v[240:243], v[176:179], v[64:79]
    buffer_load_dwordx4 v[220:223], v1, s[8:11], s89 offen offset:3072 sc1
    v_xor_b32 v18, 4096, v2
    s_nop 4
    v_cvt_pk_bf16_f32 v96, v96, v97
    v_cvt_pk_bf16_f32 v97, v98, v99
    v_cvt_pk_bf16_f32 v98, v100, v101
    v_mfma_f32_32x32x16_bf16 v[64:79], v[248:251], v[184:187], v[64:79]
    buffer_load_dwordx4 v[200:203], v1, s[8:11], s88 offen offset:1024 sc1
    v_cvt_pk_bf16_f32 v99, v102, v103
    v_cvt_pk_bf16_f32 v100, v104, v105
    v_cvt_pk_bf16_f32 v101, v106, v107
    v_cvt_pk_bf16_f32 v102, v108, v109
    v_cvt_pk_bf16_f32 v103, v110, v111
    s_waitcnt lgkmcnt(3)
    v_mfma_f32_32x32x16_bf16 v[64:79], v[120:123], v[80:83], v[64:79]
    s_add_u32 s89, s56, 0x81000
    buffer_load_dwordx4 v[228:231], v1, s[8:11], s89 offen offset:0 sc1
    ds_write_b128 v18, v[96:99] offset:8192
    s_waitcnt lgkmcnt(3)
    v_mfma_f32_32x32x16_bf16 v[64:79], v[124:127], v[84:87], v[64:79]
    buffer_load_dwordx4 v[208:211], v1, s[8:11], s88 offen offset:2048 sc1
    ds_write_b128 v18, v[100:103] offset:9216
    s_waitcnt lgkmcnt(3)
    v_mfma_f32_32x32x16_bf16 v[64:79], v[120:123], v[112:115], v[64:79]
    buffer_load_dwordx4 v[236:239], v1, s[8:11], s89 offen offset:1024 sc1
    s_waitcnt lgkmcnt(0)
    s_barrier
    ds_read_b128 v[96:99], v2 offset:8192
    ds_read_b128 v[100:103], v2 offset:9216
    v_mfma_f32_32x32x16_bf16 v[64:79], v[124:127], v[116:119], v[64:79]
    buffer_load_dwordx4 v[216:219], v1, s[8:11], s88 offen offset:3072 sc1
    buffer_load_dwordx4 v[244:247], v1, s[8:11], s89 offen offset:2048 sc1
    s_add_u32 s88, s55, 0x81000
    buffer_load_dwordx4 v[224:227], v1, s[8:11], s88 offen offset:0 sc1
    ds_read2_b32 v[18:19], v11 offset0:0 offset1:32
    s_waitcnt vmcnt(21)
    v_bitop3_b32 v7, v132, v133, v134 bitop3:0x80
    v_bitop3_b32 v7, v7, v135, v140 bitop3:0x80
    v_bitop3_b32 v7, v7, v141, v142 bitop3:0x80
    v_bitop3_b32 v7, v7, v143, v148 bitop3:0x80
    v_bitop3_b32 v7, v7, v149, v150 bitop3:0x80
    v_bitop3_b32 v7, v7, v151, v156 bitop3:0x80
    v_bitop3_b32 v7, v7, v157, v158 bitop3:0x80
    v_bitop3_b32 v7, v7, v159, 1 bitop3:0x2a
    v_cmp_ne_u32 vcc, 0, v7
    s_cbranch_vccnz OOL_315
RET_316:
    v_pk_add_f32 v[132:133], v[132:133], v[148:149]
    v_pk_add_f32 v[134:135], v[134:135], v[150:151]
    v_pk_add_f32 v[140:141], v[140:141], v[156:157]
    v_pk_add_f32 v[142:143], v[142:143], v[158:159]
    v_pk_add_f32 v[132:133], v[132:133], v[140:141]
    v_pk_add_f32 v[134:135], v[134:135], v[142:143]
    v_pk_add_f32 v[132:133], v[132:133], v[134:135]
    v_add_f32 v132, v132, v133
    v_mov_b32 v133, v132
    s_nop 1
    v_permlane32_swap_b32 v132, v133
    v_mul_f32 v132, 0xbb000000, v132
    v_mul_f32 v133, 0x3b000000, v133
    v_fma_f32 v133, -v132, v132, v133
    v_max_f32 v133, 0, v133
    v_cvt_pk_bf16_f32 v134, v132, v132
    v_and_b32 v134, 0xffff0000, v134
    v_sub_f32 v135, v132, v134
    v_cvt_pk_bf16_f32 v12, v134, v135
    v_mov_b32 v13, v12
    s_waitcnt lgkmcnt(0)
    v_add_f32 v18, v18, v19
    v_cvt_pk_bf16_f32 v10, v18, v18
    v_and_b32 v11, 0xffff0000, v10
    v_sub_f32 v11, v18, v11
    v_cvt_pk_bf16_f32 v11, v11, v11
    s_nop 1
    v_mfma_f32_32x32x8_bf16 v[64:79], v[10:11], v[12:13], v[64:79]
    s_waitcnt vmcnt(20)
    v_subrev_u32 v9, s69, v9
    v_subrev_u32 v9, 2, v9
    v_cmp_lt_u32 vcc, 7, v9
    v_add_f32 v134, 0x3727c5ac, v133
    v_mov_b32 v140, 0x2edbe6ff
    v_rsq_f32 v56, v134
    v_fmac_f32 v140, 0x3f800054, v133
    v_mul_f32 v57, v132, v56
    v_rsq_f32 v141, v140
    s_nop 0
    v_mul_f32 v60, v140, v141
    v_mul_f32 v59, 0xc0135761, v141
    v_mul_f32 v58, v141, v141
    v_mul_f32 v141, 0xbdd2d3e8, v141
    v_mul_f32 v58, v58, v141
    v_mov_b32 v61, v60
    s_cbranch_vccnz OOL_318
RET_319:
    v_dot2c_f32_bf16 v64, s65, v96
    v_dot2c_f32_bf16 v65, s66, v96
    v_dot2c_f32_bf16 v66, s65, v97
    v_dot2c_f32_bf16 v67, s66, v97
    v_dot2c_f32_bf16 v68, s65, v98
    v_dot2c_f32_bf16 v69, s66, v98
    v_dot2c_f32_bf16 v70, s65, v99
    v_dot2c_f32_bf16 v71, s66, v99
    buffer_load_dwordx4 v[252:255], v1, s[8:11], s89 offen offset:3072 sc1
    v_dot2c_f32_bf16 v72, s65, v100
    v_dot2c_f32_bf16 v73, s66, v100
    v_dot2c_f32_bf16 v74, s65, v101
    v_dot2c_f32_bf16 v75, s66, v101
    v_dot2c_f32_bf16 v76, s65, v102
    v_dot2c_f32_bf16 v77, s66, v102
    v_dot2c_f32_bf16 v78, s65, v103
    v_dot2c_f32_bf16 v79, s66, v103
    buffer_load_dwordx4 v[232:235], v1, s[8:11], s88 offen offset:1024 sc1
    v_pk_mul_f32 v[80:81], v[64:65], v[64:65]
    v_pk_mul_f32 v[82:83], v[66:67], v[66:67]
    v_pk_mul_f32 v[84:85], v[68:69], v[68:69]
    v_pk_mul_f32 v[86:87], v[70:71], v[70:71]
    v_pk_fma_f32 v[80:81], v[80:81], v[58:59], v[58:59] op_sel:[0,0,1] op_sel_hi:[1,0,1]
    v_pk_fma_f32 v[82:83], v[82:83], v[58:59], v[58:59] op_sel:[0,0,1] op_sel_hi:[1,0,1]
    buffer_load_dwordx4 v[240:243], v1, s[8:11], s88 offen offset:2048 sc1
    v_pk_fma_f32 v[84:85], v[84:85], v[58:59], v[58:59] op_sel:[0,0,1] op_sel_hi:[1,0,1]
    v_pk_fma_f32 v[86:87], v[86:87], v[58:59], v[58:59] op_sel:[0,0,1] op_sel_hi:[1,0,1]
    v_pk_mul_f32 v[80:81], v[80:81], v[64:65]
    v_pk_mul_f32 v[82:83], v[82:83], v[66:67]
    v_pk_mul_f32 v[84:85], v[84:85], v[68:69]
    v_pk_mul_f32 v[86:87], v[86:87], v[70:71]
    buffer_load_dwordx4 v[248:251], v1, s[8:11], s88 offen offset:3072 sc1
    v_exp_f32 v80, v80
    v_exp_f32 v81, v81
    v_exp_f32 v82, v82
    v_exp_f32 v83, v83
    v_exp_f32 v84, v84
    v_exp_f32 v85, v85
    v_and_b32 v28, 31, v0
    v_lshlrev_b32 v28, 2, v28
    v_lshrrev_b32 v29, 5, v0
    v_lshl_add_u32 v28, v29, 10, v28
    buffer_load_dword v20, v28, s[8:11], s71 offen offset:0 sc1
    buffer_load_dword v21, v28, s[8:11], s71 offen offset:128 sc1
    buffer_load_dword v22, v28, s[8:11], s71 offen offset:256 sc1
    buffer_load_dword v23, v28, s[8:11], s71 offen offset:384 sc1
    buffer_load_dword v24, v28, s[8:11], s71 offen offset:512 sc1
    buffer_load_dword v25, v28, s[8:11], s71 offen offset:640 sc1
    buffer_load_dword v26, v28, s[8:11], s71 offen offset:768 sc1
    buffer_load_dword v27, v28, s[8:11], s71 offen offset:896 sc1
    v_exp_f32 v86, v86
    v_exp_f32 v87, v87
    v_pk_fma_f32 v[80:81], v[80:81], v[60:61], v[60:61]
    v_pk_fma_f32 v[82:83], v[82:83], v[60:61], v[60:61]
    v_pk_fma_f32 v[84:85], v[84:85], v[60:61], v[60:61]
    v_pk_fma_f32 v[86:87], v[86:87], v[60:61], v[60:61]
    v_rcp_f32 v80, v80
    v_rcp_f32 v81, v81
    v_rcp_f32 v82, v82
    v_rcp_f32 v83, v83
    v_rcp_f32 v84, v84
    v_rcp_f32 v85, v85
    v_rcp_f32 v86, v86
    v_rcp_f32 v87, v87
    v_pk_mul_f32 v[64:65], v[64:65], v[80:81]
    v_pk_mul_f32 v[66:67], v[66:67], v[82:83]
    v_pk_mul_f32 v[68:69], v[68:69], v[84:85]
    v_pk_mul_f32 v[70:71], v[70:71], v[86:87]
    v_pk_mul_f32 v[80:81], v[72:73], v[72:73]
    v_pk_mul_f32 v[82:83], v[74:75], v[74:75]
    v_pk_mul_f32 v[84:85], v[76:77], v[76:77]
    v_pk_mul_f32 v[86:87], v[78:79], v[78:79]
    v_pk_fma_f32 v[80:81], v[80:81], v[58:59], v[58:59] op_sel:[0,0,1] op_sel_hi:[1,0,1]
    v_pk_fma_f32 v[82:83], v[82:83], v[58:59], v[58:59] op_sel:[0,0,1] op_sel_hi:[1,0,1]
    v_pk_fma_f32 v[84:85], v[84:85], v[58:59], v[58:59] op_sel:[0,0,1] op_sel_hi:[1,0,1]
    v_pk_fma_f32 v[86:87], v[86:87], v[58:59], v[58:59] op_sel:[0,0,1] op_sel_hi:[1,0,1]
    v_pk_mul_f32 v[80:81], v[80:81], v[72:73]
    v_pk_mul_f32 v[82:83], v[82:83], v[74:75]
    v_pk_mul_f32 v[84:85], v[84:85], v[76:77]
    v_pk_mul_f32 v[86:87], v[86:87], v[78:79]
    v_exp_f32 v80, v80
    v_exp_f32 v81, v81
    v_exp_f32 v82, v82
    v_exp_f32 v83, v83
    v_exp_f32 v84, v84
    v_exp_f32 v85, v85
    v_exp_f32 v86, v86
    v_exp_f32 v87, v87
    v_pk_fma_f32 v[80:81], v[80:81], v[60:61], v[60:61]
    v_pk_fma_f32 v[82:83], v[82:83], v[60:61], v[60:61]
    v_pk_fma_f32 v[84:85], v[84:85], v[60:61], v[60:61]
    v_pk_fma_f32 v[86:87], v[86:87], v[60:61], v[60:61]
    v_rcp_f32 v80, v80
    v_rcp_f32 v81, v81
    v_rcp_f32 v82, v82
    v_rcp_f32 v83, v83
    v_rcp_f32 v84, v84
    v_rcp_f32 v85, v85
    v_rcp_f32 v86, v86
    v_rcp_f32 v87, v87
    v_pk_mul_f32 v[72:73], v[72:73], v[80:81]
    v_pk_mul_f32 v[74:75], v[74:75], v[82:83]
    v_pk_mul_f32 v[76:77], v[76:77], v[84:85]
    v_pk_mul_f32 v[78:79], v[78:79], v[86:87]
    v_cvt_pk_bf16_f32 v112, v64, v65
    v_cvt_pk_bf16_f32 v113, v66, v67
    v_cvt_pk_bf16_f32 v114, v68, v69
    v_cvt_pk_bf16_f32 v115, v70, v71
    v_cvt_pk_bf16_f32 v116, v72, v73
    v_cvt_pk_bf16_f32 v117, v74, v75
    v_cvt_pk_bf16_f32 v118, v76, v77
    v_cvt_pk_bf16_f32 v119, v78, v79
    v_or_b32 v115, 1, v115
    v_or_b32 v119, 1, v119
    buffer_store_dwordx4 v[112:115], v3, s[8:11], s54 offen offset:0 sc1
    buffer_store_dwordx4 v[116:119], v3, s[8:11], s54 offen offset:1024 sc1
    buffer_store_dwordx4 v[112:115], v4, s[8:11], s68 offen offset:0 sc1
    buffer_store_dwordx4 v[116:119], v4, s[8:11], s68 offen offset:1024 sc1
    s_cmp_eq_u32 s64, 2
    s_cbranch_scc1 OOL_321
RET_322:
    v_pk_fma_f32 v[64:65], v[32:33], v[56:57], v[56:57] op_sel:[0,0,1] op_sel_hi:[1,0,1]
    v_pk_fma_f32 v[66:67], v[34:35], v[56:57], v[56:57] op_sel:[0,0,1] op_sel_hi:[1,0,1]
    v_pk_fma_f32 v[68:69], v[36:37], v[56:57], v[56:57] op_sel:[0,0,1] op_sel_hi:[1,0,1]
    v_pk_fma_f32 v[70:71], v[38:39], v[56:57], v[56:57] op_sel:[0,0,1] op_sel_hi:[1,0,1]
    v_pk_fma_f32 v[72:73], v[40:41], v[56:57], v[56:57] op_sel:[0,0,1] op_sel_hi:[1,0,1]
    v_pk_fma_f32 v[74:75], v[42:43], v[56:57], v[56:57] op_sel:[0,0,1] op_sel_hi:[1,0,1]
    v_pk_fma_f32 v[76:77], v[44:45], v[56:57], v[56:57] op_sel:[0,0,1] op_sel_hi:[1,0,1]
    v_pk_fma_f32 v[78:79], v[46:47], v[56:57], v[56:57] op_sel:[0,0,1] op_sel_hi:[1,0,1]
    s_add_u32 s79, s51, 0x8000
    buffer_load_dwordx4 v[132:135], v1, s[8:11], s79 offen offset:0 sc1
    buffer_load_dwordx4 v[140:143], v1, s[8:11], s79 offen offset:1024 sc1
    buffer_load_dwordx4 v[148:151], v1, s[8:11], s79 offen offset:2048 sc1
    buffer_load_dwordx4 v[156:159], v1, s[8:11], s79 offen offset:3072 sc1
    s_add_u32 s79, s51, 0x9000
    buffer_load_dwordx4 v[164:167], v1, s[8:11], s79 offen offset:0 sc1
    buffer_load_dwordx4 v[172:175], v1, s[8:11], s79 offen offset:1024 sc1
    buffer_load_dwordx4 v[180:183], v1, s[8:11], s79 offen offset:2048 sc1
    buffer_load_dwordx4 v[188:191], v1, s[8:11], s79 offen offset:3072 sc1
    s_waitcnt vmcnt(6)
    v_bitop3_b32 v7, v135, v143, 1 bitop3:0x2a
    v_cmp_ne_u32 vcc, 0, v7
    s_cbranch_vccnz OOL_324
RET_325:
    v_mfma_f32_32x32x16_bf16 v[112:127], v[196:199], v[132:135], 0
    s_add_u32 s80, s50, 0x8000
    buffer_load_dwordx4 v[128:131], v5, s[8:11], s80 offen offset:0 sc1
    v_add_f32 v20, v20, v24
    v_add_f32 v21, v21, v25
    v_add_f32 v22, v22, v26
    v_add_f32 v23, v23, v27
    v_mfma_f32_32x32x16_bf16 v[80:95], v[192:195], v[132:135], 0
    v_add_f32 v20, v20, v22
    v_add_f32 v21, v21, v23
    v_add_f32 v20, v20, v21
    v_cvt_pk_bf16_f32 v22, v20, v20
    v_and_b32 v23, 0xffff0000, v22
    v_sub_f32 v23, v20, v23
    v_mfma_f32_32x32x16_bf16 v[112:127], v[204:207], v[140:143], v[112:127]
    buffer_load_dwordx4 v[136:139], v5, s[8:11], s80 offen offset:1024 sc1
    s_waitcnt vmcnt(6)
    v_bitop3_b32 v7, v151, v159, 1 bitop3:0x2a
    v_cmp_ne_u32 vcc, 0, v7
    v_cvt_pk_bf16_f32 v23, v23, v23
    v_mfma_f32_32x32x16_bf16 v[80:95], v[200:203], v[140:143], v[80:95]
    s_cbranch_vccnz OOL_327
RET_328:
    s_lshl_b32 s76, s44, 9
    s_add_u32 s76, s76, 131072
    v_lshl_add_u32 v20, v0, 3, s76
    v_mfma_f32_32x32x16_bf16 v[112:127], v[212:215], v[148:151], v[112:127]
    buffer_load_dwordx4 v[144:147], v5, s[8:11], s80 offen offset:2048 sc1
    ds_write_b64 v20, v[22:23] offset:24576
    v_mfma_f32_32x32x16_bf16 v[80:95], v[208:211], v[148:151], v[80:95]
    v_mfma_f32_32x32x16_bf16 v[112:127], v[220:223], v[156:159], v[112:127]
    buffer_load_dwordx4 v[152:155], v5, s[8:11], s80 offen offset:3072 sc1
    s_waitcnt vmcnt(4)
    v_bitop3_b32 v7, v167, v175, v183 bitop3:0x80
    v_bitop3_b32 v7, v7, v191, 1 bitop3:0x2a
    v_cmp_ne_u32 vcc, 0, v7
    v_mfma_f32_32x32x16_bf16 v[80:95], v[216:219], v[156:159], v[80:95]
    s_cbranch_vccnz OOL_330
RET_331:
    v_mfma_f32_32x32x16_bf16 v[112:127], v[228:231], v[164:167], v[112:127]
    s_add_u32 s80, s50, 0x9000
    buffer_load_dwordx4 v[160:163], v5, s[8:11], s80 offen offset:0 sc1
    v_mfma_f32_32x32x16_bf16 v[80:95], v[224:227], v[164:167], v[80:95]
    v_mfma_f32_32x32x16_bf16 v[112:127], v[236:239], v[172:175], v[112:127]
    buffer_load_dwordx4 v[168:171], v5, s[8:11], s80 offen offset:1024 sc1
    v_mfma_f32_32x32x16_bf16 v[80:95], v[232:235], v[172:175], v[80:95]
    v_mfma_f32_32x32x16_bf16 v[112:127], v[244:247], v[180:183], v[112:127]
    buffer_load_dwordx4 v[176:179], v5, s[8:11], s80 offen offset:2048 sc1
    v_mfma_f32_32x32x16_bf16 v[80:95], v[240:243], v[180:183], v[80:95]
    v_mfma_f32_32x32x16_bf16 v[112:127], v[252:255], v[188:191], v[112:127]
    buffer_load_dwordx4 v[184:187], v5, s[8:11], s80 offen offset:3072 sc1
    s_waitcnt vmcnt(4)
    v_bitop3_b32 v7, v131, v139, v147 bitop3:0x80
    v_bitop3_b32 v7, v7, v155, 1 bitop3:0x2a
    v_cmp_ne_u32 vcc, 0, v7
    v_mfma_f32_32x32x16_bf16 v[80:95], v[248:251], v[188:191], v[80:95]
    s_cbranch_vccnz OOL_333
RET_334:
    v_lshlrev_b32 v28, 2, v1
    s_lshl_b32 s90, s70, 10
    s_sub_u32 s90, 0x17800, s90
    v_add_u32 v7, s90, v28
    s_mov_b32 exec_lo, 0
    v_mov_b32 v28, v7
    s_mul_i32 s90, s70, 1792
    s_sub_u32 s90, 0x1cd00, s90
    s_mov_b32 exec_hi, 0xffff0000
    v_add_u32 v28, s90, v1
    s_mov_b64 exec, -1
    buffer_load_dword v62, v28, s[8:11], s46 offen sc1
    v_mfma_f32_32x32x16_bf16 v[96:111], v[196:199], v[128:131], 0
    s_add_u32 m0, s97, 20480
    s_add_u32 s17, s96, 573440
    buffer_load_dwordx4 v63, s[36:39], s17 offen lds
    v_mfma_f32_32x32x16_bf16 v[96:111], v[204:207], v[136:139], v[96:111]
    s_add_u32 m0, s97, 21504
    s_add_u32 s17, s96, 602112
    buffer_load_dwordx4 v63, s[36:39], s17 offen lds
    v_xor_b32 v19, 6144, v2
    v_cvt_pk_bf16_f32 v112, v112, v113
    v_cvt_pk_bf16_f32 v113, v114, v115
    v_mfma_f32_32x32x16_bf16 v[96:111], v[212:215], v[144:147], v[96:111]
    s_add_u32 m0, s97, 22528
    s_add_u32 s17, s96, 630784
    buffer_load_dwordx4 v63, s[36:39], s17 offen lds
    v_cvt_pk_bf16_f32 v114, v116, v117
    v_cvt_pk_bf16_f32 v115, v118, v119
    v_cvt_pk_bf16_f32 v116, v120, v121
    v_mfma_f32_32x32x16_bf16 v[96:111], v[220:223], v[152:155], v[96:111]
    s_add_u32 m0, s97, 23552
    s_add_u32 s17, s96, 659456
    buffer_load_dwordx4 v63, s[36:39], s17 offen lds
    s_waitcnt vmcnt(7)
    v_bitop3_b32 v7, v163, v171, 1 bitop3:0x2a
    v_cmp_ne_u32 vcc, 0, v7
    v_mfma_f32_32x32x16_bf16 v[64:79], v[192:195], v[128:131], v[64:79]
    s_cbranch_vccnz OOL_336
RET_337:
    s_add_u32 m0, s97, 24576
    s_add_u32 s17, s96, 688128
    buffer_load_dwordx4 v63, s[36:39], s17 offen lds
    v_mfma_f32_32x32x16_bf16 v[96:111], v[228:231], v[160:163], v[96:111]
    s_add_u32 m0, s97, 25600
    s_add_u32 s17, s96, 716800
    buffer_load_dwordx4 v63, s[36:39], s17 offen lds
    v_cvt_pk_bf16_f32 v117, v122, v123
    v_cvt_pk_bf16_f32 v118, v124, v125
    v_cvt_pk_bf16_f32 v119, v126, v127
    v_mfma_f32_32x32x16_bf16 v[64:79], v[200:203], v[136:139], v[64:79]
    s_add_u32 m0, s97, 26624
    s_add_u32 s17, s96, 745472
    buffer_load_dwordx4 v63, s[36:39], s17 offen lds
    v_xor_b32 v17, 2048, v2
    v_cvt_pk_bf16_f32 v80, v80, v81
    v_cvt_pk_bf16_f32 v81, v82, v83
    v_mfma_f32_32x32x16_bf16 v[96:111], v[236:239], v[168:171], v[96:111]
    s_add_u32 m0, s97, 27648
    s_add_u32 s17, s96, 774144
    buffer_load_dwordx4 v63, s[36:39], s17 offen lds
    s_waitcnt vmcnt(9)
    v_bitop3_b32 v7, v179, v187, 1 bitop3:0x2a
    v_cmp_ne_u32 vcc, 0, v7
    v_mfma_f32_32x32x16_bf16 v[64:79], v[208:211], v[144:147], v[64:79]
    s_cbranch_vccnz OOL_339
RET_340:
    s_add_u32 m0, s97, 28672
    s_add_u32 s17, s96, 802816
    buffer_load_dwordx4 v63, s[36:39], s17 offen lds
    v_mfma_f32_32x32x16_bf16 v[96:111], v[244:247], v[176:179], v[96:111]
    s_add_u32 m0, s97, 29696
    s_add_u32 s17, s96, 831488
    buffer_load_dwordx4 v63, s[36:39], s17 offen lds
    v_cvt_pk_bf16_f32 v82, v84, v85
    v_cvt_pk_bf16_f32 v83, v86, v87
    v_cvt_pk_bf16_f32 v84, v88, v89
    v_mfma_f32_32x32x16_bf16 v[64:79], v[216:219], v[152:155], v[64:79]
    s_add_u32 m0, s97, 30720
    s_add_u32 s17, s96, 860160
    buffer_load_dwordx4 v63, s[36:39], s17 offen lds
    v_cvt_pk_bf16_f32 v85, v90, v91
    v_cvt_pk_bf16_f32 v86, v92, v93
    v_cvt_pk_bf16_f32 v87, v94, v95
    ds_write_b128 v19, v[112:115] offset:16384
    ds_write_b128 v19, v[116:119] offset:17408
    ds_write_b128 v17, v[80:83] offset:0
    ds_write_b128 v17, v[84:87] offset:1024
    v_add_u32 v16, 161792, v1
    s_waitcnt lgkmcnt(0)
    s_barrier
    ds_read_b128 v[120:123], v16 offset:0
    ds_read_b128 v[124:127], v16 offset:1024
    ds_read_b128 v[80:83], v2 offset:0
    ds_read_b128 v[84:87], v2 offset:1024
    ds_read_b128 v[112:115], v2 offset:16384
    ds_read_b128 v[116:119], v2 offset:17408
    v_mfma_f32_32x32x16_bf16 v[96:111], v[252:255], v[184:187], v[96:111]
    s_add_u32 m0, s97, 31744
    s_add_u32 s17, s96, 888832
    buffer_load_dwordx4 v63, s[36:39], s17 offen lds
    v_mfma_f32_32x32x16_bf16 v[64:79], v[224:227], v[160:163], v[64:79]
    buffer_load_dwordx4 a[0:3], v1, s[8:11], s57 offen offset:0 sc1
    v_mfma_f32_32x32x16_bf16 v[64:79], v[232:235], v[168:171], v[64:79]
    buffer_load_dwordx4 a[4:7], v1, s[8:11], s58 offen offset:0 sc1
    v_xor_b32 v18, 4096, v2
    s_nop 3
    v_cvt_pk_bf16_f32 v96, v96, v97
    v_cvt_pk_bf16_f32 v97, v98, v99
    v_cvt_pk_bf16_f32 v98, v100, v101
    v_mfma_f32_32x32x16_bf16 v[64:79], v[240:243], v[176:179], v[64:79]
    buffer_load_dwordx4 a[8:11], v1, s[8:11], s57 offen offset:1024 sc1
    v_cvt_pk_bf16_f32 v99, v102, v103
    v_cvt_pk_bf16_f32 v100, v104, v105
    v_cvt_pk_bf16_f32 v101, v106, v107
    v_cvt_pk_bf16_f32 v102, v108, v109
    v_cvt_pk_bf16_f32 v103, v110, v111
    v_mfma_f32_32x32x16_bf16 v[64:79], v[248:251], v[184:187], v[64:79]
    buffer_load_dwordx4 a[12:15], v1, s[8:11], s58 offen offset:1024 sc1
    ds_write_b128 v18, v[96:99] offset:8192
    s_waitcnt lgkmcnt(4)
    v_mfma_f32_32x32x16_bf16 v[64:79], v[120:123], v[80:83], v[64:79]
    buffer_load_dwordx4 a[16:19], v1, s[8:11], s57 offen offset:2048 sc1
    ds_write_b128 v18, v[100:103] offset:9216
    s_waitcnt lgkmcnt(4)
    v_mfma_f32_32x32x16_bf16 v[64:79], v[124:127], v[84:87], v[64:79]
    buffer_load_dwordx4 a[20:23], v1, s[8:11], s58 offen offset:2048 sc1
    s_waitcnt lgkmcnt(0)
    s_barrier
    ds_read_b128 v[96:99], v2 offset:8192
    ds_read_b128 v[100:103], v2 offset:9216
    v_mfma_f32_32x32x16_bf16 v[64:79], v[120:123], v[112:115], v[64:79]
    buffer_load_dwordx4 a[24:27], v1, s[8:11], s57 offen offset:3072 sc1
    v_mfma_f32_32x32x16_bf16 v[64:79], v[124:127], v[116:119], v[64:79]
    buffer_load_dwordx4 a[28:31], v1, s[8:11], s58 offen offset:3072 sc1
    s_add_u32 s91, s57, 0x1000
    buffer_load_dwordx4 a[32:35], v1, s[8:11], s91 offen offset:0 sc1
    s_add_u32 s92, s58, 0x1000
    buffer_load_dwordx4 a[36:39], v1, s[8:11], s92 offen offset:0 sc1
    s_waitcnt lgkmcnt(1)
    s_nop 5
    v_dot2c_f32_bf16 v64, s65, v96
    v_dot2c_f32_bf16 v65, s66, v96
    v_dot2c_f32_bf16 v66, s65, v97
    v_dot2c_f32_bf16 v67, s66, v97
    v_dot2c_f32_bf16 v68, s65, v98
    v_dot2c_f32_bf16 v69, s66, v98
    v_dot2c_f32_bf16 v70, s65, v99
    v_dot2c_f32_bf16 v71, s66, v99
    s_waitcnt lgkmcnt(0)
    v_dot2c_f32_bf16 v72, s65, v100
    v_dot2c_f32_bf16 v73, s66, v100
    v_dot2c_f32_bf16 v74, s65, v101
    v_dot2c_f32_bf16 v75, s66, v101
    v_dot2c_f32_bf16 v76, s65, v102
    v_dot2c_f32_bf16 v77, s66, v102
    v_dot2c_f32_bf16 v78, s65, v103
    v_dot2c_f32_bf16 v79, s66, v103
    v_cvt_pk_bf16_f32 v112, v64, v65
    v_cvt_pk_bf16_f32 v113, v66, v67
    v_cvt_pk_bf16_f32 v114, v68, v69
    v_cvt_pk_bf16_f32 v115, v70, v71
    v_cvt_pk_bf16_f32 v116, v72, v73
    v_cvt_pk_bf16_f32 v117, v74, v75
    v_cvt_pk_bf16_f32 v118, v76, v77
    v_cvt_pk_bf16_f32 v119, v78, v79
    v_and_b32 v115, -2, v115
    v_and_b32 v119, -2, v119
    buffer_store_dwordx4 v[112:115], v1, s[8:11], s47 offen offset:0 sc1
    buffer_store_dwordx4 v[116:119], v1, s[8:11], s47 offen offset:1024 sc1
    v_pk_add_f32 v[120:121], v[64:65], v[66:67]
    v_pk_mul_f32 v[122:123], v[64:65], v[64:65]
    v_pk_fma_f32 v[122:123], v[66:67], v[66:67], v[122:123]
    v_pk_add_f32 v[120:121], v[120:121], v[68:69]
    v_pk_fma_f32 v[122:123], v[68:69], v[68:69], v[122:123]
    v_pk_add_f32 v[120:121], v[120:121], v[70:71]
    v_pk_fma_f32 v[122:123], v[70:71], v[70:71], v[122:123]
    v_pk_add_f32 v[120:121], v[120:121], v[72:73]
    v_pk_fma_f32 v[122:123], v[72:73], v[72:73], v[122:123]
    v_pk_add_f32 v[120:121], v[120:121], v[74:75]
    v_pk_fma_f32 v[122:123], v[74:75], v[74:75], v[122:123]
    v_pk_add_f32 v[120:121], v[120:121], v[76:77]
    v_pk_fma_f32 v[122:123], v[76:77], v[76:77], v[122:123]
    v_pk_add_f32 v[120:121], v[120:121], v[78:79]
    v_pk_fma_f32 v[122:123], v[78:79], v[78:79], v[122:123]
    v_add_f32 v120, v120, v121
    v_add_f32 v122, v122, v123
    s_nop 1
    v_permlane32_swap_b32 v120, v122
    v_add_f32 v120, v120, v122
    v_and_b32 v120, -2, v120
    buffer_store_dword v120, v1, s[8:11], s48 offen sc1
    v_pk_add_f32 v[32:33], v[32:33], v[64:65]
    v_pk_add_f32 v[34:35], v[34:35], v[66:67]
    v_pk_add_f32 v[36:37], v[36:37], v[68:69]
    v_pk_add_f32 v[38:39], v[38:39], v[70:71]
    v_pk_add_f32 v[40:41], v[40:41], v[72:73]
    v_pk_add_f32 v[42:43], v[42:43], v[74:75]
    v_pk_add_f32 v[44:45], v[44:45], v[76:77]
    v_pk_add_f32 v[46:47], v[46:47], v[78:79]
    v_add_u32 v29, 65536, v15
    buffer_load_dwordx4 v[128:131], v1, s[8:11], s59 offen offset:0 sc1
    buffer_load_dwordx4 v[132:135], v1, s[8:11], s59 offen offset:1024 sc1
    buffer_load_dwordx4 v[136:139], v1, s[8:11], s59 offen offset:2048 sc1
    buffer_load_dwordx4 v[140:143], v1, s[8:11], s59 offen offset:3072 sc1
    s_add_u32 s79, s59, 0x1000
    buffer_load_dwordx4 v[144:147], v1, s[8:11], s79 offen offset:0 sc1
    buffer_load_dwordx4 v[148:151], v1, s[8:11], s79 offen offset:1024 sc1
    buffer_load_dwordx4 v[152:155], v1, s[8:11], s79 offen offset:2048 sc1
    buffer_load_dwordx4 v[156:159], v1, s[8:11], s79 offen offset:3072 sc1
    s_add_u32 s79, s59, 0x2000
    buffer_load_dwordx4 v[160:163], v1, s[8:11], s79 offen offset:0 sc1
    buffer_load_dwordx4 v[164:167], v1, s[8:11], s79 offen offset:1024 sc1
    buffer_load_dwordx4 v[168:171], v1, s[8:11], s79 offen offset:2048 sc1
    buffer_load_dwordx4 v[172:175], v1, s[8:11], s79 offen offset:3072 sc1
    v_lshlrev_b32 v30, 3, v0
    v_add_u32 v30, 131072, v30
    s_waitcnt vmcnt(25) lgkmcnt(0)
    s_barrier
    ds_read_b64 a[224:225], v30 offset:24576
    ds_read_b64 a[226:227], v30 offset:25088
    ds_read_b64 a[228:229], v30 offset:25600
    ds_read_b64 a[230:231], v30 offset:26112
    ds_read_b64_tr_b16 a[232:233], v15 offset:0
    ds_read_b64_tr_b16 a[234:235], v15 offset:1024
    ds_read_b64_tr_b16 a[236:237], v15 offset:512
    ds_read_b64_tr_b16 a[238:239], v15 offset:1536
    ds_read_b64_tr_b16 a[240:241], v15 offset:2048
    ds_read_b64_tr_b16 a[242:243], v15 offset:3072
    ds_read_b64_tr_b16 a[244:245], v15 offset:2560
    ds_read_b64_tr_b16 a[246:247], v15 offset:3584
    ds_read_b64_tr_b16 a[248:249], v15 offset:4096
    ds_read_b64_tr_b16 a[250:251], v15 offset:5120
    s_add_u32 s77, s59, 0xfff0c000
    s_waitcnt vmcnt(10)
    v_bitop3_b32 v7, v131, v135, 1 bitop3:0xa8
    v_cmp_ne_u32 vcc, 0, v7
    s_cbranch_vccnz OOL_342
RET_343:
    s_waitcnt lgkmcnt(8)
    v_mfma_f32_32x32x16_bf16 v[64:79], a[232:235], v[128:131], 0
    s_waitcnt lgkmcnt(4)
    ds_read_b64_tr_b16 a[252:253], v15 offset:4608
    ds_read_b64_tr_b16 a[254:255], v15 offset:5632
    s_add_u32 s79, s59, 0x3000
    buffer_load_dwordx4 v[176:179], v1, s[8:11], s79 offen offset:0 sc1
    v_mfma_f32_32x32x16_bf16 v[80:95], a[236:239], v[128:131], 0
    ds_read_b64_tr_b16 a[232:233], v15 offset:6144
    ds_read_b64_tr_b16 a[234:235], v15 offset:7168
    v_mfma_f32_32x32x16_bf16 v[64:79], a[240:243], v[132:135], v[64:79]
    s_waitcnt lgkmcnt(4)
    ds_read_b64_tr_b16 a[236:237], v15 offset:6656
    ds_read_b64_tr_b16 a[238:239], v15 offset:7680
    buffer_load_dwordx4 v[180:183], v1, s[8:11], s79 offen offset:1024 sc1
    s_waitcnt vmcnt(10)
    v_bitop3_b32 v7, v139, v143, 1 bitop3:0xa8
    v_cmp_ne_u32 vcc, 0, v7
    v_mfma_f32_32x32x16_bf16 v[80:95], a[244:247], v[132:135], v[80:95]
    s_cbranch_vccnz OOL_345
RET_346:
    ds_read_b64_tr_b16 a[240:241], v15 offset:8192
    ds_read_b64_tr_b16 a[242:243], v15 offset:9216
    v_mfma_f32_32x32x16_bf16 v[64:79], a[248:251], v[136:139], v[64:79]
    s_waitcnt lgkmcnt(4)
    ds_read_b64_tr_b16 a[244:245], v15 offset:8704
    ds_read_b64_tr_b16 a[246:247], v15 offset:9728
    buffer_load_dwordx4 v[184:187], v1, s[8:11], s79 offen offset:2048 sc1
    v_mfma_f32_32x32x16_bf16 v[80:95], a[252:255], v[136:139], v[80:95]
    ds_read_b64_tr_b16 a[248:249], v15 offset:10240
    ds_read_b64_tr_b16 a[250:251], v15 offset:11264
    v_mfma_f32_32x32x16_bf16 v[64:79], a[232:235], v[140:143], v[64:79]
    s_waitcnt lgkmcnt(4)
    ds_read_b64_tr_b16 a[252:253], v15 offset:10752
    ds_read_b64_tr_b16 a[254:255], v15 offset:11776
    buffer_load_dwordx4 v[188:191], v1, s[8:11], s79 offen offset:3072 sc1
    s_waitcnt vmcnt(8)
    v_bitop3_b32 v7, v147, v151, v155 bitop3:0xfe
    v_bitop3_b32 v7, v7, v159, 1 bitop3:0xa8
    v_cmp_ne_u32 vcc, 0, v7
    v_mfma_f32_32x32x16_bf16 v[80:95], a[236:239], v[140:143], v[80:95]
    s_cbranch_vccnz OOL_348
RET_349:
    ds_read_b64_tr_b16 a[232:233], v15 offset:12288
    ds_read_b64_tr_b16 a[234:235], v15 offset:13312
    v_mfma_f32_32x32x16_bf16 v[64:79], a[240:243], v[144:147], v[64:79]
    s_waitcnt lgkmcnt(4)
    ds_read_b64_tr_b16 a[236:237], v15 offset:12800
    ds_read_b64_tr_b16 a[238:239], v15 offset:13824
    s_add_u32 s79, s59, 0x4000
    buffer_load_dwordx4 v[192:195], v1, s[8:11], s79 offen offset:0 sc1
    v_mfma_f32_32x32x16_bf16 v[80:95], a[244:247], v[144:147], v[80:95]
    ds_read_b64_tr_b16 a[240:241], v15 offset:14336
    ds_read_b64_tr_b16 a[242:243], v15 offset:15360
    v_mfma_f32_32x32x16_bf16 v[64:79], a[248:251], v[148:151], v[64:79]
    s_waitcnt lgkmcnt(4)
    ds_read_b64_tr_b16 a[244:245], v15 offset:14848
    ds_read_b64_tr_b16 a[246:247], v15 offset:15872
    buffer_load_dwordx4 v[196:199], v1, s[8:11], s79 offen offset:1024 sc1
    v_mfma_f32_32x32x16_bf16 v[80:95], a[252:255], v[148:151], v[80:95]
    ds_read_b64_tr_b16 a[248:249], v15 offset:16384
    ds_read_b64_tr_b16 a[250:251], v15 offset:17408
    v_mfma_f32_32x32x16_bf16 v[64:79], a[232:235], v[152:155], v[64:79]
    s_waitcnt lgkmcnt(4)
    ds_read_b64_tr_b16 a[252:253], v15 offset:16896
    ds_read_b64_tr_b16 a[254:255], v15 offset:17920
    buffer_load_dwordx4 v[200:203], v1, s[8:11], s79 offen offset:2048 sc1
    v_mfma_f32_32x32x16_bf16 v[80:95], a[236:239], v[152:155], v[80:95]
    ds_read_b64_tr_b16 a[232:233], v15 offset:18432
    ds_read_b64_tr_b16 a[234:235], v15 offset:19456
    v_mfma_f32_32x32x16_bf16 v[64:79], a[240:243], v[156:159], v[64:79]
    s_waitcnt lgkmcnt(4)
    ds_read_b64_tr_b16 a[236:237], v15 offset:18944
    ds_read_b64_tr_b16 a[238:239], v15 offset:19968
    buffer_load_dwordx4 v[204:207], v1, s[8:11], s79 offen offset:3072 sc1
    s_waitcnt vmcnt(8)
    v_bitop3_b32 v7, v163, v167, v171 bitop3:0xfe
    v_bitop3_b32 v7, v7, v175, 1 bitop3:0xa8
    v_cmp_ne_u32 vcc, 0, v7
    v_mfma_f32_32x32x16_bf16 v[80:95], a[244:247], v[156:159], v[80:95]
    s_cbranch_vccnz OOL_351
RET_352:
    ds_read_b64_tr_b16 a[240:241], v15 offset:20480
    ds_read_b64_tr_b16 a[242:243], v15 offset:21504
    v_mfma_f32_32x32x16_bf16 v[64:79], a[248:251], v[160:163], v[64:79]
    s_waitcnt lgkmcnt(4)
    ds_read_b64_tr_b16 a[244:245], v15 offset:20992
    ds_read_b64_tr_b16 a[246:247], v15 offset:22016
    s_add_u32 s79, s59, 0x5000
    buffer_load_dwordx4 v[208:211], v1, s[8:11], s79 offen offset:0 sc1
    v_mfma_f32_32x32x16_bf16 v[80:95], a[252:255], v[160:163], v[80:95]
    ds_read_b64_tr_b16 a[248:249], v15 offset:22528
    ds_read_b64_tr_b16 a[250:251], v15 offset:23552
    v_mfma_f32_32x32x16_bf16 v[64:79], a[232:235], v[164:167], v[64:79]
    s_waitcnt lgkmcnt(4)
    ds_read_b64_tr_b16 a[252:253], v15 offset:23040
    ds_read_b64_tr_b16 a[254:255], v15 offset:24064
    buffer_load_dwordx4 v[212:215], v1, s[8:11], s79 offen offset:1024 sc1
    v_mfma_f32_32x32x16_bf16 v[80:95], a[236:239], v[164:167], v[80:95]
    ds_read_b64_tr_b16 a[232:233], v15 offset:24576
    ds_read_b64_tr_b16 a[234:235], v15 offset:25600
    v_mfma_f32_32x32x16_bf16 v[64:79], a[240:243], v[168:171], v[64:79]
    s_waitcnt lgkmcnt(4)
    ds_read_b64_tr_b16 a[236:237], v15 offset:25088
    ds_read_b64_tr_b16 a[238:239], v15 offset:26112
    buffer_load_dwordx4 v[216:219], v1, s[8:11], s79 offen offset:2048 sc1
    v_mfma_f32_32x32x16_bf16 v[80:95], a[244:247], v[168:171], v[80:95]
    ds_read_b64_tr_b16 a[240:241], v15 offset:26624
    ds_read_b64_tr_b16 a[242:243], v15 offset:27648
    v_mfma_f32_32x32x16_bf16 v[64:79], a[248:251], v[172:175], v[64:79]
    s_waitcnt lgkmcnt(4)
    ds_read_b64_tr_b16 a[244:245], v15 offset:27136
    ds_read_b64_tr_b16 a[246:247], v15 offset:28160
    buffer_load_dwordx4 v[220:223], v1, s[8:11], s79 offen offset:3072 sc1
    s_waitcnt vmcnt(8)
    v_bitop3_b32 v7, v179, v183, v187 bitop3:0xfe
    v_bitop3_b32 v7, v7, v191, 1 bitop3:0xa8
    v_cmp_ne_u32 vcc, 0, v7
    v_mfma_f32_32x32x16_bf16 v[80:95], a[252:255], v[172:175], v[80:95]
    s_cbranch_vccnz OOL_354
RET_355:
    ds_read_b64_tr_b16 a[248:249], v15 offset:28672
    ds_read_b64_tr_b16 a[250:251], v15 offset:29696
    v_mfma_f32_32x32x16_bf16 v[64:79], a[232:235], v[176:179], v[64:79]
    s_waitcnt lgkmcnt(4)
    ds_read_b64_tr_b16 a[252:253], v15 offset:29184
    ds_read_b64_tr_b16 a[254:255], v15 offset:30208
    s_add_u32 s79, s59, 0x6000
    buffer_load_dwordx4 v[224:227], v1, s[8:11], s79 offen offset:0 sc1
    v_mfma_f32_32x32x16_bf16 v[80:95], a[236:239], v[176:179], v[80:95]
    ds_read_b64_tr_b16 a[232:233], v15 offset:30720
    ds_read_b64_tr_b16 a[234:235], v15 offset:31744
    v_mfma_f32_32x32x16_bf16 v[64:79], a[240:243], v[180:183], v[64:79]
    s_waitcnt lgkmcnt(4)
    ds_read_b64_tr_b16 a[236:237], v15 offset:31232
    ds_read_b64_tr_b16 a[238:239], v15 offset:32256
    buffer_load_dwordx4 v[228:231], v1, s[8:11], s79 offen offset:1024 sc1
    v_mfma_f32_32x32x16_bf16 v[80:95], a[244:247], v[180:183], v[80:95]
    ds_read_b64_tr_b16 a[240:241], v15 offset:32768
    ds_read_b64_tr_b16 a[242:243], v15 offset:33792
    v_mfma_f32_32x32x16_bf16 v[64:79], a[248:251], v[184:187], v[64:79]
    s_waitcnt lgkmcnt(4)
    ds_read_b64_tr_b16 a[244:245], v15 offset:33280
    ds_read_b64_tr_b16 a[246:247], v15 offset:34304
    buffer_load_dwordx4 v[232:235], v1, s[8:11], s79 offen offset:2048 sc1
    v_mfma_f32_32x32x16_bf16 v[80:95], a[252:255], v[184:187], v[80:95]
    ds_read_b64_tr_b16 a[248:249], v15 offset:34816
    ds_read_b64_tr_b16 a[250:251], v15 offset:35840
    v_mfma_f32_32x32x16_bf16 v[64:79], a[232:235], v[188:191], v[64:79]
    s_waitcnt lgkmcnt(4)
    ds_read_b64_tr_b16 a[252:253], v15 offset:35328
    ds_read_b64_tr_b16 a[254:255], v15 offset:36352
    buffer_load_dwordx4 v[236:239], v1, s[8:11], s79 offen offset:3072 sc1
    s_waitcnt vmcnt(8)
    v_bitop3_b32 v7, v195, v199, v203 bitop3:0xfe
    v_bitop3_b32 v7, v7, v207, 1 bitop3:0xa8
    v_cmp_ne_u32 vcc, 0, v7
    v_mfma_f32_32x32x16_bf16 v[80:95], a[236:239], v[188:191], v[80:95]
    s_cbranch_vccnz OOL_357
RET_358:
    ds_read_b64_tr_b16 a[232:233], v15 offset:36864
    ds_read_b64_tr_b16 a[234:235], v15 offset:37888
    v_mfma_f32_32x32x16_bf16 v[64:79], a[240:243], v[192:195], v[64:79]
    s_waitcnt lgkmcnt(4)
    ds_read_b64_tr_b16 a[236:237], v15 offset:37376
    ds_read_b64_tr_b16 a[238:239], v15 offset:38400
    s_add_u32 s79, s59, 0x7000
    buffer_load_dwordx4 v[240:243], v1, s[8:11], s79 offen offset:0 sc1
    v_mfma_f32_32x32x16_bf16 v[80:95], a[244:247], v[192:195], v[80:95]
    ds_read_b64_tr_b16 a[240:241], v15 offset:38912
    ds_read_b64_tr_b16 a[242:243], v15 offset:39936
    v_mfma_f32_32x32x16_bf16 v[64:79], a[248:251], v[196:199], v[64:79]
    s_waitcnt lgkmcnt(4)
    ds_read_b64_tr_b16 a[244:245], v15 offset:39424
    ds_read_b64_tr_b16 a[246:247], v15 offset:40448
    buffer_load_dwordx4 v[244:247], v1, s[8:11], s79 offen offset:1024 sc1
    v_mfma_f32_32x32x16_bf16 v[80:95], a[252:255], v[196:199], v[80:95]
    ds_read_b64_tr_b16 a[248:249], v15 offset:40960
    ds_read_b64_tr_b16 a[250:251], v15 offset:41984
    v_mfma_f32_32x32x16_bf16 v[64:79], a[232:235], v[200:203], v[64:79]
    s_waitcnt lgkmcnt(4)
    ds_read_b64_tr_b16 a[252:253], v15 offset:41472
    ds_read_b64_tr_b16 a[254:255], v15 offset:42496
    buffer_load_dwordx4 v[248:251], v1, s[8:11], s79 offen offset:2048 sc1
    v_mfma_f32_32x32x16_bf16 v[80:95], a[236:239], v[200:203], v[80:95]
    ds_read_b64_tr_b16 a[232:233], v15 offset:43008
    ds_read_b64_tr_b16 a[234:235], v15 offset:44032
    v_mfma_f32_32x32x16_bf16 v[64:79], a[240:243], v[204:207], v[64:79]
    s_waitcnt lgkmcnt(4)
    ds_read_b64_tr_b16 a[236:237], v15 offset:43520
    ds_read_b64_tr_b16 a[238:239], v15 offset:44544
    buffer_load_dwordx4 v[252:255], v1, s[8:11], s79 offen offset:3072 sc1
    s_waitcnt vmcnt(8)
    v_bitop3_b32 v7, v211, v215, v219 bitop3:0xfe
    v_bitop3_b32 v7, v7, v223, 1 bitop3:0xa8
    v_cmp_ne_u32 vcc, 0, v7
    v_mfma_f32_32x32x16_bf16 v[80:95], a[244:247], v[204:207], v[80:95]
    s_cbranch_vccnz OOL_360
RET_361:
    ds_read_b64_tr_b16 a[240:241], v15 offset:45056
    ds_read_b64_tr_b16 a[242:243], v15 offset:46080
    v_mfma_f32_32x32x16_bf16 v[64:79], a[248:251], v[208:211], v[64:79]
    s_waitcnt lgkmcnt(4)
    ds_read_b64_tr_b16 a[244:245], v15 offset:45568
    ds_read_b64_tr_b16 a[246:247], v15 offset:46592
    v_mfma_f32_32x32x16_bf16 v[80:95], a[252:255], v[208:211], v[80:95]
    ds_read_b64_tr_b16 a[248:249], v15 offset:47104
    ds_read_b64_tr_b16 a[250:251], v15 offset:48128
    buffer_load_dwordx4 v[112:115], v1, s[8:11], s77 offen offset:0 sc1
    buffer_load_dwordx4 v[116:119], v1, s[8:11], s77 offen offset:1024 sc1
    buffer_load_dwordx4 v[120:123], v1, s[8:11], s77 offen offset:2048 sc1
    buffer_load_dwordx4 v[124:127], v1, s[8:11], s77 offen offset:3072 sc1
    v_mfma_f32_32x32x16_bf16 v[64:79], a[232:235], v[212:215], v[64:79]
    s_waitcnt lgkmcnt(4)
    ds_read_b64_tr_b16 a[252:253], v15 offset:47616
    ds_read_b64_tr_b16 a[254:255], v15 offset:48640
    v_lshlrev_b32 v28, 2, v1
    s_lshl_b32 s90, s70, 10
    s_sub_u32 s90, 0x17800, s90
    v_add_u32 v7, s90, v28
    s_mov_b32 exec_lo, 0
    v_mov_b32 v28, v7
    s_mul_i32 s90, s70, 1792
    s_sub_u32 s90, 0x1cd00, s90
    s_mov_b32 exec_hi, 0xffff0000
    v_add_u32 v28, s90, v1
    s_mov_b64 exec, -1
    buffer_load_dword v62, v28, s[8:11], s46 offen sc1
    v_mfma_f32_32x32x16_bf16 v[80:95], a[236:239], v[212:215], v[80:95]
    ds_read_b64_tr_b16 a[232:233], v15 offset:49152
    ds_read_b64_tr_b16 a[234:235], v15 offset:50176
    v_mfma_f32_32x32x16_bf16 v[64:79], a[240:243], v[216:219], v[64:79]
    s_waitcnt lgkmcnt(4)
    ds_read_b64_tr_b16 a[236:237], v15 offset:49664
    ds_read_b64_tr_b16 a[238:239], v15 offset:50688
    v_and_b32 v28, 48, v1
    v_bfe_u32 v7, v0, 2, 3
    v_lshlrev_b32 v28, 2, v28
    v_lshl_add_u32 v28, v7, 10, v28
    v_lshrrev_b32 v7, 5, v0
    v_lshl_add_u32 v28, v7, 15, v28
    s_lshr_b32 s90, s2, 6
    s_lshl_b32 s90, s90, 8
    s_add_u32 s90, s90, s55
    s_and_b32 s90, s90, 0xffff7fff
    s_add_u32 s90, s90, 0x80000
    buffer_load_dword v62, v28, s[8:11], s90 offen sc1
    v_mfma_f32_32x32x16_bf16 v[80:95], a[244:247], v[216:219], v[80:95]
    ds_read_b64_tr_b16 a[240:241], v15 offset:51200
    ds_read_b64_tr_b16 a[242:243], v15 offset:52224
    v_mfma_f32_32x32x16_bf16 v[64:79], a[248:251], v[220:223], v[64:79]
    s_waitcnt lgkmcnt(4)
    ds_read_b64_tr_b16 a[244:245], v15 offset:51712
    ds_read_b64_tr_b16 a[246:247], v15 offset:52736
    buffer_load_dwordx4 a[40:43], v1, s[8:11], s91 offen offset:1024 sc1
    s_waitcnt vmcnt(11)
    v_bitop3_b32 v7, v227, v231, v235 bitop3:0xfe
    v_bitop3_b32 v7, v7, v239, 1 bitop3:0xa8
    v_cmp_ne_u32 vcc, 0, v7
    v_mfma_f32_32x32x16_bf16 v[80:95], a[252:255], v[220:223], v[80:95]
    s_cbranch_vccnz OOL_363
RET_364:
    ds_read_b64_tr_b16 a[248:249], v15 offset:53248
    ds_read_b64_tr_b16 a[250:251], v15 offset:54272
    v_mfma_f32_32x32x16_bf16 v[64:79], a[232:235], v[224:227], v[64:79]
    s_waitcnt lgkmcnt(4)
    ds_read_b64_tr_b16 a[252:253], v15 offset:53760
    ds_read_b64_tr_b16 a[254:255], v15 offset:54784
    buffer_load_dwordx4 a[44:47], v1, s[8:11], s92 offen offset:1024 sc1
    v_mfma_f32_32x32x16_bf16 v[80:95], a[236:239], v[224:227], v[80:95]
    ds_read_b64_tr_b16 a[232:233], v15 offset:55296
    ds_read_b64_tr_b16 a[234:235], v15 offset:56320
    v_mfma_f32_32x32x16_bf16 v[64:79], a[240:243], v[228:231], v[64:79]
    s_waitcnt lgkmcnt(4)
    ds_read_b64_tr_b16 a[236:237], v15 offset:55808
    ds_read_b64_tr_b16 a[238:239], v15 offset:56832
    buffer_load_dwordx4 a[48:51], v1, s[8:11], s91 offen offset:2048 sc1
    v_mfma_f32_32x32x16_bf16 v[80:95], a[244:247], v[228:231], v[80:95]
    ds_read_b64_tr_b16 a[240:241], v15 offset:57344
    ds_read_b64_tr_b16 a[242:243], v15 offset:58368
    v_mfma_f32_32x32x16_bf16 v[64:79], a[248:251], v[232:235], v[64:79]
    s_waitcnt lgkmcnt(4)
    ds_read_b64_tr_b16 a[244:245], v15 offset:57856
    ds_read_b64_tr_b16 a[246:247], v15 offset:58880
    buffer_load_dwordx4 a[52:55], v1, s[8:11], s92 offen offset:2048 sc1
    v_mfma_f32_32x32x16_bf16 v[80:95], a[252:255], v[232:235], v[80:95]
    ds_read_b64_tr_b16 a[248:249], v15 offset:59392
    ds_read_b64_tr_b16 a[250:251], v15 offset:60416
    s_waitcnt vmcnt(6)
    v_bitop3_b32 v7, v112, v113, v114 bitop3:0xfe
    v_bitop3_b32 v7, v7, v115, v116 bitop3:0xfe
    v_bitop3_b32 v7, v7, v117, v118 bitop3:0xfe
    v_bitop3_b32 v7, v7, v119, v120 bitop3:0xfe
    v_bitop3_b32 v7, v7, v121, v122 bitop3:0xfe
    v_bitop3_b32 v7, v7, v123, v124 bitop3:0xfe
    v_bitop3_b32 v7, v7, v125, v126 bitop3:0xfe
    v_bitop3_b32 v7, v7, v127, 1 bitop3:0xa8
    v_cmp_ne_u32 vcc, 0, v7
    v_mfma_f32_32x32x16_bf16 v[64:79], a[232:235], v[236:239], v[64:79]
    s_cbranch_vccnz OOL_366
RET_367:
    s_waitcnt lgkmcnt(4)
    ds_read_b64_tr_b16 a[252:253], v15 offset:61440
    ds_read_b64_tr_b16 a[254:255], v15 offset:62464
    buffer_load_dwordx4 a[56:59], v1, s[8:11], s91 offen offset:3072 sc1
    v_bitop3_b32 v7, v243, v247, v251 bitop3:0xfe
    v_bitop3_b32 v7, v7, v255, 1 bitop3:0xa8
    v_cmp_ne_u32 vcc, 0, v7
    v_mfma_f32_32x32x16_bf16 v[80:95], a[236:239], v[236:239], v[80:95]
    s_cbranch_vccnz OOL_369
RET_370:
    ds_read_b64_tr_b16 a[232:233], v15 offset:63488
    ds_read_b64_tr_b16 a[234:235], v15 offset:64512
    v_add_f32 v112, v112, v120
    v_mfma_f32_32x32x16_bf16 v[64:79], a[240:243], v[240:243], v[64:79]
    s_waitcnt lgkmcnt(4)
    ds_read_b64_tr_b16 a[236:237], v15 offset:59904
    ds_read_b64_tr_b16 a[238:239], v15 offset:60928
    buffer_load_dwordx4 a[60:63], v1, s[8:11], s92 offen offset:3072 sc1
    v_add_f32 v113, v113, v121
    v_add_f32 v114, v114, v122
    v_mfma_f32_32x32x16_bf16 v[80:95], a[244:247], v[240:243], v[80:95]
    ds_read_b64_tr_b16 a[240:241], v15 offset:61952
    ds_read_b64_tr_b16 a[242:243], v15 offset:62976
    v_add_f32 v115, v115, v123
    v_add_f32 v116, v116, v124
    v_add_f32 v117, v117, v125
    v_add_f32 v118, v118, v126
    v_add_f32 v119, v119, v127
    v_mfma_f32_32x32x16_bf16 v[64:79], a[248:251], v[244:247], v[64:79]
    s_waitcnt lgkmcnt(4)
    ds_read_b64_tr_b16 a[244:245], v15 offset:64000
    ds_read_b64_tr_b16 a[246:247], v15 offset:65024
    s_add_u32 s91, s57, 0x2000
    buffer_load_dwordx4 a[64:67], v1, s[8:11], s91 offen offset:0 sc1
    v_add_f32 v112, v112, v116
    v_mfma_f32_32x32x16_bf16 v[64:79], a[252:255], v[248:251], v[64:79]
    ds_read_b64_tr_b16 a[248:249], v29 offset:33280
    ds_read_b64_tr_b16 a[250:251], v29 offset:34304
    v_add_f32 v113, v113, v117
    v_add_f32 v114, v114, v118
    v_add_f32 v115, v115, v119
    v_add_f32 v112, v112, v114
    v_add_f32 v113, v113, v115
    v_mfma_f32_32x32x16_bf16 v[64:79], a[232:235], v[252:255], v[64:79]
    s_waitcnt lgkmcnt(4)
    ds_read_b64_tr_b16 a[252:253], v29 offset:32768
    ds_read_b64_tr_b16 a[254:255], v29 offset:33792
    s_add_u32 s92, s58, 0x2000
    buffer_load_dwordx4 a[68:71], v1, s[8:11], s92 offen offset:0 sc1
    v_add_f32 v112, v112, v113
    v_mov_b32 v113, v112
    s_nop 1
    v_permlane32_swap_b32 v112, v113
    v_mul_f32 v112, 0xbb000000, v112
    v_mul_f32 v113, 0x3b000000, v113
    v_fma_f32 v113, -v112, v112, v113
    v_max_f32 v113, 0, v113
    v_cvt_pk_bf16_f32 v114, v112, v112
    v_and_b32 v114, 0xffff0000, v114
    v_sub_f32 v115, v112, v114
    v_cvt_pk_bf16_f32 v12, v114, v115
    v_mov_b32 v13, v12
    v_add_f32 v116, 0x3727c5ac, v113
    v_rsq_f32 v117, v116
    s_nop 0
    v_mul_f32 v60, v116, v117
    v_mul_f32 v59, 0xc0135761, v117
    v_mul_f32 v58, v117, v117
    v_mul_f32 v117, 0xbdd2d3e8, v117
    v_mul_f32 v58, v58, v117
    v_mov_b32 v61, v60
    v_mfma_f32_32x32x8_bf16 v[64:79], a[224:225], v[12:13], v[64:79]
    v_mov_b32 v30, s69
    v_add_u32 v30, 1, v30
    v_mfma_f32_32x32x16_bf16 v[80:95], a[236:239], v[244:247], v[80:95]
    ds_read_b64_tr_b16 a[232:233], v29 offset:35328
    ds_read_b64_tr_b16 a[234:235], v29 offset:36352
    s_mov_b64 exec, 1
    buffer_store_dword v30, off, s[8:11], s63 sc1
    s_mov_b64 exec, -1
    v_mfma_f32_32x32x16_bf16 v[80:95], a[240:243], v[248:251], v[80:95]
    s_waitcnt lgkmcnt(4)
    ds_read_b64_tr_b16 a[236:237], v29 offset:34816
    ds_read_b64_tr_b16 a[238:239], v29 offset:35840
    buffer_load_dwordx4 a[72:75], v1, s[8:11], s91 offen offset:1024 sc1
    v_mul_f32 v16, v64, v64
    v_fma_f32 v16, v16, v58, v59
    v_mfma_f32_32x32x16_bf16 v[80:95], a[244:247], v[252:255], v[80:95]
    ds_read_b64_tr_b16 a[240:241], v29 offset:37376
    ds_read_b64_tr_b16 a[242:243], v29 offset:38400
    v_mul_f32 v16, v16, v64
    v_mul_f32 v17, v65, v65
    v_exp_f32 v16, v16
    v_fma_f32 v17, v17, v58, v59
    v_mfma_f32_32x32x8_bf16 v[80:95], a[226:227], v[12:13], v[80:95]
    v_mul_f32 v17, v17, v65
    v_mul_f32 v18, v66, v66
    v_exp_f32 v17, v17
    v_fma_f32 v16, v16, v60, v60
    v_fma_f32 v18, v18, v58, v59
    v_mfma_f32_32x32x8_bf16 v[96:111], a[228:229], v[12:13], 0
    v_rcp_f32 v16, v16
    v_mul_f32 v18, v18, v66
    v_mul_f32 v19, v67, v67
    v_exp_f32 v18, v18
    v_mfma_f32_32x32x8_bf16 v[112:127], a[230:231], v[12:13], 0
    v_fma_f32 v17, v17, v60, v60
    v_fma_f32 v19, v19, v58, v59
    v_rcp_f32 v17, v17
    v_mul_f32 v64, v64, v16
    v_mul_f32 v19, v19, v67
    v_mfma_f32_32x32x16_bf16 v[112:127], a[248:251], v[192:195], v[112:127]
    s_waitcnt lgkmcnt(4)
    ds_read_b64_tr_b16 a[244:245], v29 offset:36864
    ds_read_b64_tr_b16 a[246:247], v29 offset:37888
    buffer_load_dwordx4 a[76:79], v1, s[8:11], s92 offen offset:1024 sc1
    v_mul_f32 v16, v68, v68
    v_fma_f32 v18, v18, v60, v60
    v_mfma_f32_32x32x16_bf16 v[96:111], a[252:255], v[192:195], v[96:111]
    ds_read_b64_tr_b16 a[248:249], v29 offset:39424
    ds_read_b64_tr_b16 a[250:251], v29 offset:40448
    v_exp_f32 v19, v19
    v_fma_f32 v16, v16, v58, v59
    v_rcp_f32 v18, v18
    v_mfma_f32_32x32x16_bf16 v[112:127], a[232:235], v[196:199], v[112:127]
    s_waitcnt lgkmcnt(4)
    ds_read_b64_tr_b16 a[252:253], v29 offset:38912
    ds_read_b64_tr_b16 a[254:255], v29 offset:39936
    buffer_load_dwordx4 a[80:83], v1, s[8:11], s91 offen offset:2048 sc1
    v_mul_f32 v65, v65, v17
    v_mul_f32 v16, v16, v68
    v_mfma_f32_32x32x16_bf16 v[96:111], a[236:239], v[196:199], v[96:111]
    ds_read_b64_tr_b16 a[232:233], v29 offset:41472
    ds_read_b64_tr_b16 a[234:235], v29 offset:42496
    v_mul_f32 v17, v69, v69
    v_cvt_pk_bf16_f32 v20, v64, v65
    v_exp_f32 v16, v16
    v_fma_f32 v19, v19, v60, v60
    v_mfma_f32_32x32x16_bf16 v[112:127], a[240:243], v[200:203], v[112:127]
    s_waitcnt lgkmcnt(4)
    ds_read_b64_tr_b16 a[236:237], v29 offset:40960
    ds_read_b64_tr_b16 a[238:239], v29 offset:41984
    buffer_load_dwordx4 a[84:87], v1, s[8:11], s92 offen offset:2048 sc1
    v_fma_f32 v17, v17, v58, v59
    v_mul_f32 v66, v66, v18
    v_mfma_f32_32x32x16_bf16 v[96:111], a[244:247], v[200:203], v[96:111]
    ds_read_b64_tr_b16 a[240:241], v29 offset:43520
    ds_read_b64_tr_b16 a[242:243], v29 offset:44544
    v_rcp_f32 v19, v19
    v_mul_f32 v17, v17, v69
    v_mul_f32 v18, v70, v70
    v_fma_f32 v16, v16, v60, v60
    v_mfma_f32_32x32x16_bf16 v[112:127], a[248:251], v[204:207], v[112:127]
    s_waitcnt lgkmcnt(4)
    ds_read_b64_tr_b16 a[244:245], v29 offset:43008
    ds_read_b64_tr_b16 a[246:247], v29 offset:44032
    buffer_load_dwordx4 a[88:91], v1, s[8:11], s91 offen offset:3072 sc1
    v_exp_f32 v17, v17
    v_mfma_f32_32x32x16_bf16 v[96:111], a[252:255], v[204:207], v[96:111]
    ds_read_b64_tr_b16 a[248:249], v29 offset:45568
    ds_read_b64_tr_b16 a[250:251], v29 offset:46592
    v_fma_f32 v18, v18, v58, v59
    v_rcp_f32 v16, v16
    v_mul_f32 v67, v67, v19
    v_mul_f32 v18, v18, v70
    v_mfma_f32_32x32x16_bf16 v[112:127], a[232:235], v[208:211], v[112:127]
    s_waitcnt lgkmcnt(4)
    ds_read_b64_tr_b16 a[252:253], v29 offset:45056
    ds_read_b64_tr_b16 a[254:255], v29 offset:46080
    buffer_load_dwordx4 a[92:95], v1, s[8:11], s92 offen offset:3072 sc1
    v_mul_f32 v19, v71, v71
    v_cvt_pk_bf16_f32 v21, v66, v67
    v_mfma_f32_32x32x16_bf16 v[96:111], a[236:239], v[208:211], v[96:111]
    ds_read_b64_tr_b16 a[232:233], v29 offset:47616
    ds_read_b64_tr_b16 a[234:235], v29 offset:48640
    v_exp_f32 v18, v18
    v_fma_f32 v17, v17, v60, v60
    v_fma_f32 v19, v19, v58, v59
    v_mul_f32 v68, v68, v16
    v_mfma_f32_32x32x16_bf16 v[112:127], a[240:243], v[212:215], v[112:127]
    s_waitcnt lgkmcnt(4)
    ds_read_b64_tr_b16 a[236:237], v29 offset:47104
    ds_read_b64_tr_b16 a[238:239], v29 offset:48128
    s_add_u32 s91, s57, 0x3000
    buffer_load_dwordx4 a[96:99], v1, s[8:11], s91 offen offset:0 sc1
    v_mul_f32 v19, v19, v71
    v_mfma_f32_32x32x16_bf16 v[96:111], a[244:247], v[212:215], v[96:111]
    ds_read_b64_tr_b16 a[240:241], v29 offset:49664
    ds_read_b64_tr_b16 a[242:243], v29 offset:50688
    v_rcp_f32 v17, v17
    v_mul_f32 v16, v72, v72
    v_exp_f32 v19, v19
    v_mfma_f32_32x32x16_bf16 v[112:127], a[248:251], v[216:219], v[112:127]
    s_waitcnt lgkmcnt(4)
    ds_read_b64_tr_b16 a[244:245], v29 offset:49152
    ds_read_b64_tr_b16 a[246:247], v29 offset:50176
    s_add_u32 s92, s58, 0x3000
    buffer_load_dwordx4 a[100:103], v1, s[8:11], s92 offen offset:0 sc1
    v_fma_f32 v18, v18, v60, v60
    v_mfma_f32_32x32x16_bf16 v[96:111], a[252:255], v[216:219], v[96:111]
    ds_read_b64_tr_b16 a[248:249], v29 offset:51712
    ds_read_b64_tr_b16 a[250:251], v29 offset:52736
    v_fma_f32 v16, v16, v58, v59
    v_rcp_f32 v18, v18
    v_mul_f32 v69, v69, v17
    v_mul_f32 v16, v16, v72
    v_mfma_f32_32x32x16_bf16 v[112:127], a[232:235], v[220:223], v[112:127]
    s_waitcnt lgkmcnt(4)
    ds_read_b64_tr_b16 a[252:253], v29 offset:51200
    ds_read_b64_tr_b16 a[254:255], v29 offset:52224
    buffer_load_dwordx4 a[104:107], v1, s[8:11], s91 offen offset:1024 sc1
    v_mul_f32 v17, v73, v73
    v_cvt_pk_bf16_f32 v22, v68, v69
    v_mfma_f32_32x32x16_bf16 v[96:111], a[236:239], v[220:223], v[96:111]
    ds_read_b64_tr_b16 a[232:233], v29 offset:53760
    ds_read_b64_tr_b16 a[234:235], v29 offset:54784
    v_exp_f32 v16, v16
    v_fma_f32 v19, v19, v60, v60
    v_fma_f32 v17, v17, v58, v59
    v_mul_f32 v70, v70, v18
    v_mfma_f32_32x32x16_bf16 v[112:127], a[240:243], v[224:227], v[112:127]
    s_waitcnt lgkmcnt(4)
    ds_read_b64_tr_b16 a[236:237], v29 offset:53248
    ds_read_b64_tr_b16 a[238:239], v29 offset:54272
    buffer_load_dwordx4 a[108:111], v1, s[8:11], s92 offen offset:1024 sc1
    v_rcp_f32 v19, v19
    v_mfma_f32_32x32x16_bf16 v[96:111], a[244:247], v[224:227], v[96:111]
    ds_read_b64_tr_b16 a[240:241], v29 offset:55808
    ds_read_b64_tr_b16 a[242:243], v29 offset:56832
    v_mul_f32 v17, v17, v73
    v_mul_f32 v18, v74, v74
    v_exp_f32 v17, v17
    v_fma_f32 v16, v16, v60, v60
    v_mfma_f32_32x32x16_bf16 v[112:127], a[248:251], v[228:231], v[112:127]
    s_waitcnt lgkmcnt(4)
    ds_read_b64_tr_b16 a[244:245], v29 offset:55296
    ds_read_b64_tr_b16 a[246:247], v29 offset:56320
    buffer_load_dwordx4 a[112:115], v1, s[8:11], s91 offen offset:2048 sc1
    v_fma_f32 v18, v18, v58, v59
    v_mul_f32 v71, v71, v19
    v_mfma_f32_32x32x16_bf16 v[96:111], a[252:255], v[228:231], v[96:111]
    ds_read_b64_tr_b16 a[248:249], v29 offset:57856
    ds_read_b64_tr_b16 a[250:251], v29 offset:58880
    v_rcp_f32 v16, v16
    v_mul_f32 v18, v18, v74
    v_mul_f32 v19, v75, v75
    v_cvt_pk_bf16_f32 v23, v70, v71
    v_mfma_f32_32x32x16_bf16 v[112:127], a[232:235], v[232:235], v[112:127]
    s_waitcnt lgkmcnt(4)
    ds_read_b64_tr_b16 a[252:253], v29 offset:57344
    ds_read_b64_tr_b16 a[254:255], v29 offset:58368
    buffer_load_dwordx4 a[116:119], v1, s[8:11], s92 offen offset:2048 sc1
    v_exp_f32 v18, v18
    v_mfma_f32_32x32x16_bf16 v[96:111], a[236:239], v[232:235], v[96:111]
    ds_read_b64_tr_b16 a[232:233], v29 offset:59904
    ds_read_b64_tr_b16 a[234:235], v29 offset:60928
    v_fma_f32 v17, v17, v60, v60
    v_fma_f32 v19, v19, v58, v59
    v_rcp_f32 v17, v17
    v_mul_f32 v72, v72, v16
    v_mfma_f32_32x32x16_bf16 v[112:127], a[240:243], v[236:239], v[112:127]
    s_waitcnt lgkmcnt(4)
    ds_read_b64_tr_b16 a[236:237], v29 offset:59392
    ds_read_b64_tr_b16 a[238:239], v29 offset:60416
    buffer_load_dwordx4 a[120:123], v1, s[8:11], s91 offen offset:3072 sc1
    v_mul_f32 v19, v19, v75
    v_mul_f32 v16, v76, v76
    v_mfma_f32_32x32x16_bf16 v[96:111], a[244:247], v[236:239], v[96:111]
    ds_read_b64_tr_b16 a[240:241], v29 offset:61952
    ds_read_b64_tr_b16 a[242:243], v29 offset:62976
    v_exp_f32 v19, v19
    v_fma_f32 v18, v18, v60, v60
    v_fma_f32 v16, v16, v58, v59
    v_mul_f32 v73, v73, v17
    v_mfma_f32_32x32x16_bf16 v[112:127], a[248:251], v[240:243], v[112:127]
    s_waitcnt lgkmcnt(4)
    ds_read_b64_tr_b16 a[244:245], v29 offset:61440
    ds_read_b64_tr_b16 a[246:247], v29 offset:62464
    buffer_load_dwordx4 a[124:127], v1, s[8:11], s92 offen offset:3072 sc1
    v_rcp_f32 v18, v18
    v_mfma_f32_32x32x16_bf16 v[96:111], a[252:255], v[240:243], v[96:111]
    ds_read_b64_tr_b16 a[248:249], v29 offset:64000
    ds_read_b64_tr_b16 a[250:251], v29 offset:65024
    v_mul_f32 v16, v16, v76
    v_mul_f32 v17, v77, v77
    v_cvt_pk_bf16_f32 v24, v72, v73
    v_or_b32 v23, 1, v23
    v_fma_f32 v19, v19, v60, v60
    v_mfma_f32_32x32x16_bf16 v[112:127], a[232:235], v[244:247], v[112:127]
    s_waitcnt lgkmcnt(4)
    ds_read_b64_tr_b16 a[252:253], v29 offset:63488
    ds_read_b64_tr_b16 a[254:255], v29 offset:64512
    s_add_u32 s91, s57, 0x4000
    buffer_load_dwordx4 a[128:131], v1, s[8:11], s91 offen offset:0 sc1
    v_fma_f32 v17, v17, v58, v59
    v_mfma_f32_32x32x16_bf16 v[96:111], a[236:239], v[244:247], v[96:111]
    ds_read_b64_tr_b16 a[232:233], v29 offset:8704
    ds_read_b64_tr_b16 a[234:235], v29 offset:9728
    v_exp_f32 v16, v16
    v_rcp_f32 v19, v19
    v_mul_f32 v74, v74, v18
    v_mfma_f32_32x32x16_bf16 v[112:127], a[240:243], v[248:251], v[112:127]
    s_waitcnt lgkmcnt(4)
    ds_read_b64_tr_b16 a[236:237], v29 offset:8192
    ds_read_b64_tr_b16 a[238:239], v29 offset:9216
    s_add_u32 s92, s58, 0x4000
    buffer_load_dwordx4 a[132:135], v1, s[8:11], s92 offen offset:0 sc1
    v_mul_f32 v17, v17, v77
    v_mfma_f32_32x32x16_bf16 v[96:111], a[244:247], v[248:251], v[96:111]
    ds_read_b64_tr_b16 a[240:241], v29 offset:10752
    ds_read_b64_tr_b16 a[242:243], v29 offset:11776
    v_mul_f32 v18, v78, v78
    v_exp_f32 v17, v17
    v_fma_f32 v16, v16, v60, v60
    v_fma_f32 v18, v18, v58, v59
    v_mfma_f32_32x32x16_bf16 v[112:127], a[248:251], v[252:255], v[112:127]
    s_waitcnt lgkmcnt(4)
    ds_read_b64_tr_b16 a[244:245], v29 offset:10240
    ds_read_b64_tr_b16 a[246:247], v29 offset:11264
    buffer_load_dwordx4 a[136:139], v1, s[8:11], s91 offen offset:1024 sc1
    v_rcp_f32 v16, v16
    v_mfma_f32_32x32x16_bf16 v[96:111], a[252:255], v[252:255], v[96:111]
    ds_read_b64_tr_b16 a[248:249], v29 offset:12800
    ds_read_b64_tr_b16 a[250:251], v29 offset:13824
    v_mul_f32 v75, v75, v19
    v_mul_f32 v18, v18, v78
    v_mul_f32 v19, v79, v79
    v_cvt_pk_bf16_f32 v25, v74, v75
    v_fma_f32 v17, v17, v60, v60
    v_mfma_f32_32x32x16_bf16 v[112:127], a[232:235], v[144:147], v[112:127]
    s_waitcnt lgkmcnt(4)
    ds_read_b64_tr_b16 a[252:253], v29 offset:12288
    ds_read_b64_tr_b16 a[254:255], v29 offset:13312
    buffer_load_dwordx4 a[140:143], v1, s[8:11], s92 offen offset:1024 sc1
    v_exp_f32 v18, v18
    v_mfma_f32_32x32x16_bf16 v[96:111], a[236:239], v[144:147], v[96:111]
    ds_read_b64_tr_b16 a[232:233], v29 offset:14848
    ds_read_b64_tr_b16 a[234:235], v29 offset:15872
    v_fma_f32 v19, v19, v58, v59
    v_rcp_f32 v17, v17
    v_mul_f32 v76, v76, v16
    v_mul_f32 v19, v19, v79
    v_mfma_f32_32x32x16_bf16 v[112:127], a[240:243], v[148:151], v[112:127]
    s_waitcnt lgkmcnt(4)
    ds_read_b64_tr_b16 a[236:237], v29 offset:14336
    ds_read_b64_tr_b16 a[238:239], v29 offset:15360
    buffer_load_dwordx4 a[144:147], v1, s[8:11], s91 offen offset:2048 sc1
    v_mul_f32 v16, v80, v80
    v_fma_f32 v18, v18, v60, v60
    v_mfma_f32_32x32x16_bf16 v[96:111], a[244:247], v[148:151], v[96:111]
    ds_read_b64_tr_b16 a[240:241], v29 offset:16896
    ds_read_b64_tr_b16 a[242:243], v29 offset:17920
    v_exp_f32 v19, v19
    v_fma_f32 v16, v16, v58, v59
    v_rcp_f32 v18, v18
    v_mfma_f32_32x32x16_bf16 v[112:127], a[248:251], v[152:155], v[112:127]
    s_waitcnt lgkmcnt(4)
    ds_read_b64_tr_b16 a[244:245], v29 offset:16384
    ds_read_b64_tr_b16 a[246:247], v29 offset:17408
    buffer_load_dwordx4 a[148:151], v1, s[8:11], s92 offen offset:2048 sc1
    v_mul_f32 v77, v77, v17
    v_mul_f32 v16, v16, v80
    v_mfma_f32_32x32x16_bf16 v[96:111], a[252:255], v[152:155], v[96:111]
    ds_read_b64_tr_b16 a[248:249], v29 offset:18944
    ds_read_b64_tr_b16 a[250:251], v29 offset:19968
    v_mul_f32 v17, v81, v81
    v_cvt_pk_bf16_f32 v26, v76, v77
    v_exp_f32 v16, v16
    v_fma_f32 v19, v19, v60, v60
    v_mfma_f32_32x32x16_bf16 v[112:127], a[232:235], v[156:159], v[112:127]
    s_waitcnt lgkmcnt(4)
    ds_read_b64_tr_b16 a[252:253], v29 offset:18432
    ds_read_b64_tr_b16 a[254:255], v29 offset:19456
    buffer_load_dwordx4 a[152:155], v1, s[8:11], s91 offen offset:3072 sc1
    v_fma_f32 v17, v17, v58, v59
    v_mul_f32 v78, v78, v18
    v_mfma_f32_32x32x16_bf16 v[96:111], a[236:239], v[156:159], v[96:111]
    ds_read_b64_tr_b16 a[232:233], v29 offset:20992
    ds_read_b64_tr_b16 a[234:235], v29 offset:22016
    v_rcp_f32 v19, v19
    v_mul_f32 v17, v17, v81
    v_mul_f32 v18, v82, v82
    v_fma_f32 v16, v16, v60, v60
    v_mfma_f32_32x32x16_bf16 v[112:127], a[240:243], v[160:163], v[112:127]
    s_waitcnt lgkmcnt(4)
    ds_read_b64_tr_b16 a[236:237], v29 offset:20480
    ds_read_b64_tr_b16 a[238:239], v29 offset:21504
    buffer_load_dwordx4 a[156:159], v1, s[8:11], s92 offen offset:3072 sc1
    v_exp_f32 v17, v17
    v_mfma_f32_32x32x16_bf16 v[96:111], a[244:247], v[160:163], v[96:111]
    ds_read_b64_tr_b16 a[240:241], v29 offset:23040
    ds_read_b64_tr_b16 a[242:243], v29 offset:24064
    v_fma_f32 v18, v18, v58, v59
    v_rcp_f32 v16, v16
    v_mul_f32 v79, v79, v19
    v_mul_f32 v18, v18, v82
    v_mfma_f32_32x32x16_bf16 v[112:127], a[248:251], v[164:167], v[112:127]
    s_waitcnt lgkmcnt(4)
    ds_read_b64_tr_b16 a[244:245], v29 offset:22528
    ds_read_b64_tr_b16 a[246:247], v29 offset:23552
    s_add_u32 s91, s57, 0x5000
    buffer_load_dwordx4 a[160:163], v1, s[8:11], s91 offen offset:0 sc1
    v_mul_f32 v19, v83, v83
    v_mfma_f32_32x32x16_bf16 v[96:111], a[252:255], v[164:167], v[96:111]
    ds_read_b64_tr_b16 a[248:249], v29 offset:25088
    ds_read_b64_tr_b16 a[250:251], v29 offset:26112
    v_cvt_pk_bf16_f32 v27, v78, v79
    v_or_b32 v27, 1, v27
    v_exp_f32 v18, v18
    v_fma_f32 v17, v17, v60, v60
    v_mfma_f32_32x32x16_bf16 v[112:127], a[232:235], v[168:171], v[112:127]
    s_waitcnt lgkmcnt(4)
    ds_read_b64_tr_b16 a[252:253], v29 offset:24576
    ds_read_b64_tr_b16 a[254:255], v29 offset:25600
    s_add_u32 s92, s58, 0x5000
    buffer_load_dwordx4 a[164:167], v1, s[8:11], s92 offen offset:0 sc1
    v_fma_f32 v19, v19, v58, v59
    v_mfma_f32_32x32x16_bf16 v[96:111], a[236:239], v[168:171], v[96:111]
    ds_read_b64_tr_b16 a[232:233], v29 offset:27136
    ds_read_b64_tr_b16 a[234:235], v29 offset:28160
    buffer_store_dwordx4 v[20:23], v1, s[8:11], s60 offen offset:0 sc1
    buffer_store_dwordx4 v[24:27], v1, s[8:11], s60 offen offset:1024 sc1
    v_mul_f32 v80, v80, v16
    v_mfma_f32_32x32x16_bf16 v[112:127], a[240:243], v[172:175], v[112:127]
    s_waitcnt lgkmcnt(4)
    ds_read_b64_tr_b16 a[236:237], v29 offset:26624
    ds_read_b64_tr_b16 a[238:239], v29 offset:27648
    buffer_load_dwordx4 a[168:171], v1, s[8:11], s91 offen offset:1024 sc1
    v_rcp_f32 v17, v17
    v_mfma_f32_32x32x16_bf16 v[96:111], a[244:247], v[172:175], v[96:111]
    ds_read_b64_tr_b16 a[240:241], v29 offset:29184
    ds_read_b64_tr_b16 a[242:243], v29 offset:30208
    v_mul_f32 v19, v19, v83
    v_mul_f32 v16, v84, v84
    v_exp_f32 v19, v19
    v_fma_f32 v18, v18, v60, v60
    v_mfma_f32_32x32x16_bf16 v[112:127], a[248:251], v[176:179], v[112:127]
    s_waitcnt lgkmcnt(4)
    ds_read_b64_tr_b16 a[244:245], v29 offset:28672
    ds_read_b64_tr_b16 a[246:247], v29 offset:29696
    buffer_load_dwordx4 a[172:175], v1, s[8:11], s92 offen offset:1024 sc1
    v_fma_f32 v16, v16, v58, v59
    v_mul_f32 v81, v81, v17
    v_mfma_f32_32x32x16_bf16 v[96:111], a[252:255], v[176:179], v[96:111]
    ds_read_b64_tr_b16 a[248:249], v29 offset:31232
    ds_read_b64_tr_b16 a[250:251], v29 offset:32256
    v_rcp_f32 v18, v18
    v_mul_f32 v16, v16, v84
    v_mul_f32 v17, v85, v85
    v_cvt_pk_bf16_f32 v20, v80, v81
    v_mfma_f32_32x32x16_bf16 v[112:127], a[232:235], v[180:183], v[112:127]
    s_waitcnt lgkmcnt(4)
    ds_read_b64_tr_b16 a[252:253], v29 offset:30720
    ds_read_b64_tr_b16 a[254:255], v29 offset:31744
    buffer_load_dwordx4 a[176:179], v1, s[8:11], s91 offen offset:2048 sc1
    v_exp_f32 v16, v16
    v_mfma_f32_32x32x16_bf16 v[96:111], a[236:239], v[180:183], v[96:111]
    ds_read_b64_tr_b16 a[232:233], v29 offset:512
    ds_read_b64_tr_b16 a[234:235], v29 offset:1536
    v_fma_f32 v19, v19, v60, v60
    v_fma_f32 v17, v17, v58, v59
    v_rcp_f32 v19, v19
    v_mul_f32 v82, v82, v18
    v_mfma_f32_32x32x16_bf16 v[112:127], a[240:243], v[184:187], v[112:127]
    s_waitcnt lgkmcnt(4)
    ds_read_b64_tr_b16 a[236:237], v29 offset:0
    ds_read_b64_tr_b16 a[238:239], v29 offset:1024
    buffer_load_dwordx4 a[180:183], v1, s[8:11], s92 offen offset:2048 sc1
    v_mul_f32 v17, v17, v85
    v_mul_f32 v18, v86, v86
    v_mfma_f32_32x32x16_bf16 v[96:111], a[244:247], v[184:187], v[96:111]
    ds_read_b64_tr_b16 a[240:241], v29 offset:2560
    ds_read_b64_tr_b16 a[242:243], v29 offset:3584
    v_exp_f32 v17, v17
    v_fma_f32 v16, v16, v60, v60
    v_fma_f32 v18, v18, v58, v59
    v_mul_f32 v83, v83, v19
    v_mfma_f32_32x32x16_bf16 v[112:127], a[248:251], v[188:191], v[112:127]
    s_waitcnt lgkmcnt(4)
    ds_read_b64_tr_b16 a[244:245], v29 offset:2048
    ds_read_b64_tr_b16 a[246:247], v29 offset:3072
    buffer_load_dwordx4 a[184:187], v1, s[8:11], s91 offen offset:3072 sc1
    v_rcp_f32 v16, v16
    v_mfma_f32_32x32x16_bf16 v[96:111], a[252:255], v[188:191], v[96:111]
    ds_read_b64_tr_b16 a[248:249], v29 offset:4608
    ds_read_b64_tr_b16 a[250:251], v29 offset:5632
    buffer_load_dwordx4 v[192:195], v1, s[8:11], s51 offen offset:0 sc1
    v_mul_f32 v18, v18, v86
    v_mul_f32 v19, v87, v87
    v_cvt_pk_bf16_f32 v21, v82, v83
    v_mfma_f32_32x32x16_bf16 v[112:127], a[232:235], v[128:131], v[112:127]
    s_waitcnt lgkmcnt(4)
    ds_read_b64_tr_b16 a[252:253], v29 offset:4096
    ds_read_b64_tr_b16 a[254:255], v29 offset:5120
    buffer_load_dwordx4 v[196:199], v1, s[8:11], s51 offen offset:1024 sc1
    buffer_load_dword v9, v8, s[8:11], 0 offen offset:128 sc1
    v_mfma_f32_32x32x16_bf16 v[96:111], a[236:239], v[128:131], v[96:111]
    ds_read_b64_tr_b16 a[232:233], v29 offset:6656
    ds_read_b64_tr_b16 a[234:235], v29 offset:7680
    buffer_load_dwordx4 v[200:203], v1, s[8:11], s51 offen offset:2048 sc1
    v_exp_f32 v18, v18
    v_fma_f32 v17, v17, v60, v60
    v_mfma_f32_32x32x16_bf16 v[112:127], a[240:243], v[132:135], v[112:127]
    s_waitcnt lgkmcnt(4)
    ds_read_b64_tr_b16 a[236:237], v29 offset:6144
    ds_read_b64_tr_b16 a[238:239], v29 offset:7168
    buffer_load_dwordx4 v[204:207], v1, s[8:11], s51 offen offset:3072 sc1
    v_fma_f32 v19, v19, v58, v59
    v_mul_f32 v84, v84, v16
    v_mfma_f32_32x32x16_bf16 v[96:111], a[244:247], v[132:135], v[96:111]
    s_add_u32 s78, s51, 0x1000
    buffer_load_dwordx4 v[208:211], v1, s[8:11], s78 offen offset:0 sc1
    v_rcp_f32 v17, v17
    v_mul_f32 v19, v19, v87
    v_mul_f32 v16, v88, v88
    v_mfma_f32_32x32x16_bf16 v[112:127], a[248:251], v[136:139], v[112:127]
    s_waitcnt lgkmcnt(2)
    buffer_load_dwordx4 v[212:215], v1, s[8:11], s78 offen offset:1024 sc1
    v_exp_f32 v19, v19
    v_fma_f32 v18, v18, v60, v60
    v_fma_f32 v16, v16, v58, v59
    v_mfma_f32_32x32x16_bf16 v[96:111], a[252:255], v[136:139], v[96:111]
    buffer_load_dwordx4 v[216:219], v1, s[8:11], s78 offen offset:2048 sc1
    v_rcp_f32 v18, v18
    v_mul_f32 v85, v85, v17
    v_mul_f32 v16, v16, v88
    v_mul_f32 v17, v89, v89
    v_mfma_f32_32x32x16_bf16 v[112:127], a[232:235], v[140:143], v[112:127]
    s_waitcnt lgkmcnt(0)
    buffer_load_dwordx4 v[220:223], v1, s[8:11], s78 offen offset:3072 sc1
    v_cvt_pk_bf16_f32 v22, v84, v85
    v_exp_f32 v16, v16
    v_fma_f32 v19, v19, v60, v60
    v_mfma_f32_32x32x16_bf16 v[96:111], a[236:239], v[140:143], v[96:111]
    buffer_load_dwordx4 v[224:227], v1, s[8:11], s50 offen offset:0 sc1
    v_fma_f32 v17, v17, v58, v59
    v_rcp_f32 v19, v19
    v_mul_f32 v86, v86, v18
    v_mul_f32 v17, v17, v89
    v_mul_f32 v18, v90, v90
    v_exp_f32 v17, v17
    v_fma_f32 v16, v16, v60, v60
    v_fma_f32 v18, v18, v58, v59
    v_rcp_f32 v16, v16
    v_mul_f32 v87, v87, v19
    v_mul_f32 v18, v18, v90
    v_mul_f32 v19, v91, v91
    v_cvt_pk_bf16_f32 v23, v86, v87
    v_exp_f32 v18, v18
    v_fma_f32 v17, v17, v60, v60
    v_fma_f32 v19, v19, v58, v59
    v_rcp_f32 v17, v17
    v_mul_f32 v88, v88, v16
    v_mul_f32 v19, v19, v91
    v_mul_f32 v16, v92, v92
    v_exp_f32 v19, v19
    v_fma_f32 v18, v18, v60, v60
    v_fma_f32 v16, v16, v58, v59
    v_rcp_f32 v18, v18
    v_mul_f32 v89, v89, v17
    v_mul_f32 v16, v16, v92
    v_mul_f32 v17, v93, v93
    v_cvt_pk_bf16_f32 v24, v88, v89
    v_and_b32 v23, -2, v23
    v_exp_f32 v16, v16
    v_fma_f32 v19, v19, v60, v60
    v_fma_f32 v17, v17, v58, v59
    v_rcp_f32 v19, v19
    v_mul_f32 v90, v90, v18
    v_mul_f32 v17, v17, v93
    v_mul_f32 v18, v94, v94
    v_exp_f32 v17, v17
    v_fma_f32 v16, v16, v60, v60
    v_fma_f32 v18, v18, v58, v59
    v_rcp_f32 v16, v16
    v_mul_f32 v91, v91, v19
    v_mul_f32 v18, v18, v94
    v_mul_f32 v19, v95, v95
    v_cvt_pk_bf16_f32 v25, v90, v91
    v_exp_f32 v18, v18
    v_fma_f32 v17, v17, v60, v60
    v_fma_f32 v19, v19, v58, v59
    v_rcp_f32 v17, v17
    v_mul_f32 v92, v92, v16
    v_mul_f32 v19, v19, v95
    v_exp_f32 v19, v19
    v_fma_f32 v18, v18, v60, v60
    v_rcp_f32 v18, v18
    v_mul_f32 v93, v93, v17
    v_cvt_pk_bf16_f32 v26, v92, v93
    v_fma_f32 v19, v19, v60, v60
    v_rcp_f32 v19, v19
    v_mul_f32 v94, v94, v18
    v_mul_f32 v95, v95, v19
    v_cvt_pk_bf16_f32 v27, v94, v95
    v_and_b32 v27, -2, v27
    s_add_u32 s76, s60, 32768
    buffer_store_dwordx4 v[20:23], v1, s[8:11], s76 offen offset:0 sc1
    buffer_store_dwordx4 v[24:27], v1, s[8:11], s76 offen offset:1024 sc1
    s_waitcnt vmcnt(7)
    v_bitop3_b32 v7, v195, v199, v203 bitop3:0x80
    v_bitop3_b32 v7, v7, v207, 1 bitop3:0x2a
    v_cmp_ne_u32 vcc, 0, v7
    s_cbranch_vccnz OOL_372
RET_373:
    v_mfma_f32_32x32x16_bf16 v[80:95], a[4:7], v[192:195], 0
    buffer_load_dwordx4 v[228:231], v1, s[8:11], s50 offen offset:1024 sc1
    v_subrev_u32 v9, s69, v9
    v_subrev_u32 v9, 1, v9
    v_cmp_lt_u32 vcc, 7, v9
    v_mfma_f32_32x32x16_bf16 v[64:79], a[0:3], v[192:195], 0
    s_cbranch_vccnz OOL_375
RET_376:
    buffer_load_dwordx4 v[232:235], v1, s[8:11], s50 offen offset:2048 sc1
    v_mul_f32 v16, v96, v96
    v_fma_f32 v16, v16, v58, v59
    v_mul_f32 v16, v16, v96
    v_mul_f32 v17, v97, v97
    v_fma_f32 v17, v17, v58, v59
    v_mfma_f32_32x32x16_bf16 v[80:95], a[12:15], v[196:199], v[80:95]
    buffer_load_dwordx4 v[236:239], v1, s[8:11], s50 offen offset:3072 sc1
    v_exp_f32 v16, v16
    v_mul_f32 v17, v17, v97
    v_mul_f32 v18, v98, v98
    v_exp_f32 v17, v17
    v_fma_f32 v16, v16, v60, v60
    v_fma_f32 v18, v18, v58, v59
    v_mul_f32 v18, v18, v98
    v_mfma_f32_32x32x16_bf16 v[64:79], a[8:11], v[196:199], v[64:79]
    s_add_u32 s78, s50, 0x1000
    buffer_load_dwordx4 v[240:243], v1, s[8:11], s78 offen offset:0 sc1
    v_rcp_f32 v16, v16
    v_mul_f32 v19, v99, v99
    v_exp_f32 v18, v18
    v_fma_f32 v17, v17, v60, v60
    v_fma_f32 v19, v19, v58, v59
    v_mul_f32 v96, v96, v16
    v_mfma_f32_32x32x16_bf16 v[80:95], a[36:39], v[200:203], v[80:95]
    buffer_load_dwordx4 v[244:247], v1, s[8:11], s78 offen offset:1024 sc1
    v_rcp_f32 v17, v17
    v_mul_f32 v19, v19, v99
    v_mul_f32 v16, v100, v100
    v_exp_f32 v19, v19
    v_fma_f32 v18, v18, v60, v60
    v_fma_f32 v16, v16, v58, v59
    v_mul_f32 v97, v97, v17
    v_mfma_f32_32x32x16_bf16 v[64:79], a[32:35], v[200:203], v[64:79]
    buffer_load_dwordx4 v[248:251], v1, s[8:11], s78 offen offset:2048 sc1
    v_rcp_f32 v18, v18
    v_mul_f32 v16, v16, v100
    v_mul_f32 v17, v101, v101
    v_cvt_pk_bf16_f32 v20, v96, v97
    v_exp_f32 v16, v16
    v_fma_f32 v19, v19, v60, v60
    v_fma_f32 v17, v17, v58, v59
    v_mfma_f32_32x32x16_bf16 v[80:95], a[44:47], v[204:207], v[80:95]
    s_waitcnt vmcnt(9)
    v_bitop3_b32 v7, v211, v215, v219 bitop3:0x80
    v_bitop3_b32 v7, v7, v223, 1 bitop3:0x2a
    v_cmp_ne_u32 vcc, 0, v7
    v_rcp_f32 v19, v19
    v_mul_f32 v98, v98, v18
    v_mul_f32 v17, v17, v101
    v_mul_f32 v18, v102, v102
    v_exp_f32 v17, v17
    v_mfma_f32_32x32x16_bf16 v[64:79], a[40:43], v[204:207], v[64:79]
    s_cbranch_vccnz OOL_378
RET_379:
    buffer_load_dwordx4 v[252:255], v1, s[8:11], s78 offen offset:3072 sc1
    v_fma_f32 v16, v16, v60, v60
    v_fma_f32 v18, v18, v58, v59
    v_rcp_f32 v16, v16
    v_mul_f32 v99, v99, v19
    v_mfma_f32_32x32x16_bf16 v[80:95], a[68:71], v[208:211], v[80:95]
    buffer_load_dwordx4 a[188:191], v1, s[8:11], s92 offen offset:3072 sc1
    v_mul_f32 v18, v18, v102
    v_mul_f32 v19, v103, v103
    v_cvt_pk_bf16_f32 v21, v98, v99
    v_exp_f32 v18, v18
    v_fma_f32 v17, v17, v60, v60
    v_fma_f32 v19, v19, v58, v59
    v_rcp_f32 v17, v17
    v_mfma_f32_32x32x16_bf16 v[64:79], a[64:67], v[208:211], v[64:79]
    s_add_u32 s78, s51, 0x8000
    buffer_load_dwordx4 v[144:147], v1, s[8:11], s78 offen offset:0 sc1
    v_mul_f32 v100, v100, v16
    v_mul_f32 v19, v19, v103
    v_mul_f32 v16, v104, v104
    v_exp_f32 v19, v19
    v_fma_f32 v18, v18, v60, v60
    v_fma_f32 v16, v16, v58, v59
    v_mul_f32 v101, v101, v17
    v_mfma_f32_32x32x16_bf16 v[80:95], a[76:79], v[212:215], v[80:95]
    s_add_u32 s91, s57, 0x6000
    buffer_load_dwordx4 a[192:195], v1, s[8:11], s91 offen offset:0 sc1
    v_rcp_f32 v18, v18
    v_mul_f32 v16, v16, v104
    v_mul_f32 v17, v105, v105
    v_cvt_pk_bf16_f32 v22, v100, v101
    v_exp_f32 v16, v16
    v_fma_f32 v19, v19, v60, v60
    v_mfma_f32_32x32x16_bf16 v[64:79], a[72:75], v[212:215], v[64:79]
    buffer_load_dwordx4 v[148:151], v1, s[8:11], s78 offen offset:1024 sc1
    v_fma_f32 v17, v17, v58, v59
    v_rcp_f32 v19, v19
    v_mul_f32 v102, v102, v18
    v_mul_f32 v17, v17, v105
    v_mul_f32 v18, v106, v106
    v_exp_f32 v17, v17
    v_fma_f32 v16, v16, v60, v60
    v_mfma_f32_32x32x16_bf16 v[80:95], a[100:103], v[216:219], v[80:95]
    s_add_u32 s92, s58, 0x6000
    buffer_load_dwordx4 a[196:199], v1, s[8:11], s92 offen offset:0 sc1
    v_fma_f32 v18, v18, v58, v59
    v_rcp_f32 v16, v16
    v_mul_f32 v103, v103, v19
    v_mul_f32 v18, v18, v106
    v_mul_f32 v19, v107, v107
    v_cvt_pk_bf16_f32 v23, v102, v103
    v_fma_f32 v17, v17, v60, v60
    v_mfma_f32_32x32x16_bf16 v[64:79], a[96:99], v[216:219], v[64:79]
    buffer_load_dwordx4 v[152:155], v1, s[8:11], s78 offen offset:2048 sc1
    v_exp_f32 v18, v18
    v_fma_f32 v19, v19, v58, v59
    v_rcp_f32 v17, v17
    v_mul_f32 v104, v104, v16
    v_mul_f32 v19, v19, v107
    v_mul_f32 v16, v108, v108
    v_fma_f32 v18, v18, v60, v60
    v_mfma_f32_32x32x16_bf16 v[80:95], a[108:111], v[220:223], v[80:95]
    s_waitcnt vmcnt(10)
    v_bitop3_b32 v7, v227, v231, v235 bitop3:0x80
    v_bitop3_b32 v7, v7, v239, 1 bitop3:0x2a
    v_cmp_ne_u32 vcc, 0, v7
    v_exp_f32 v19, v19
    v_fma_f32 v16, v16, v58, v59
    v_rcp_f32 v18, v18
    v_mul_f32 v105, v105, v17
    v_mul_f32 v16, v16, v108
    v_mfma_f32_32x32x16_bf16 v[64:79], a[104:107], v[220:223], v[64:79]
    s_cbranch_vccnz OOL_381
RET_382:
    buffer_load_dwordx4 v[156:159], v1, s[8:11], s78 offen offset:3072 sc1
    v_mul_f32 v17, v109, v109
    v_cvt_pk_bf16_f32 v24, v104, v105
    v_or_b32 v23, 1, v23
    v_exp_f32 v16, v16
    v_mfma_f32_32x32x16_bf16 v[128:143], a[4:7], v[224:227], 0
    buffer_load_dwordx4 a[200:203], v1, s[8:11], s91 offen offset:1024 sc1
    v_fma_f32 v19, v19, v60, v60
    v_fma_f32 v17, v17, v58, v59
    v_rcp_f32 v19, v19
    v_mul_f32 v106, v106, v18
    v_mul_f32 v17, v17, v109
    v_mul_f32 v18, v110, v110
    v_exp_f32 v17, v17
    v_mfma_f32_32x32x16_bf16 v[32:47], a[0:3], v[224:227], v[32:47]
    s_add_u32 s78, s51, 0x9000
    buffer_load_dwordx4 v[160:163], v1, s[8:11], s78 offen offset:0 sc1
    v_fma_f32 v16, v16, v60, v60
    v_fma_f32 v18, v18, v58, v59
    v_rcp_f32 v16, v16
    v_mul_f32 v107, v107, v19
    v_mul_f32 v18, v18, v110
    v_mul_f32 v19, v111, v111
    v_cvt_pk_bf16_f32 v25, v106, v107
    v_mfma_f32_32x32x16_bf16 v[128:143], a[12:15], v[228:231], v[128:143]
    buffer_load_dwordx4 a[204:207], v1, s[8:11], s92 offen offset:1024 sc1
    v_exp_f32 v18, v18
    v_fma_f32 v17, v17, v60, v60
    v_fma_f32 v19, v19, v58, v59
    v_rcp_f32 v17, v17
    v_mul_f32 v108, v108, v16
    v_mul_f32 v19, v19, v111
    v_mul_f32 v16, v112, v112
    v_mfma_f32_32x32x16_bf16 v[32:47], a[8:11], v[228:231], v[32:47]
    buffer_load_dwordx4 v[164:167], v1, s[8:11], s78 offen offset:1024 sc1
    v_exp_f32 v19, v19
    v_fma_f32 v18, v18, v60, v60
    v_fma_f32 v16, v16, v58, v59
    v_rcp_f32 v18, v18
    v_mul_f32 v109, v109, v17
    v_mul_f32 v16, v16, v112
    v_mul_f32 v17, v113, v113
    v_mfma_f32_32x32x16_bf16 v[128:143], a[36:39], v[232:235], v[128:143]
    buffer_load_dwordx4 a[208:211], v1, s[8:11], s91 offen offset:2048 sc1
    v_cvt_pk_bf16_f32 v26, v108, v109
    v_exp_f32 v16, v16
    v_fma_f32 v19, v19, v60, v60
    v_fma_f32 v17, v17, v58, v59
    v_rcp_f32 v19, v19
    v_mul_f32 v110, v110, v18
    v_mul_f32 v17, v17, v113
    v_mfma_f32_32x32x16_bf16 v[32:47], a[32:35], v[232:235], v[32:47]
    buffer_load_dwordx4 v[168:171], v1, s[8:11], s78 offen offset:2048 sc1
    v_mul_f32 v18, v114, v114
    v_exp_f32 v17, v17
    v_fma_f32 v16, v16, v60, v60
    v_fma_f32 v18, v18, v58, v59
    v_rcp_f32 v16, v16
    v_mul_f32 v111, v111, v19
    v_mul_f32 v18, v18, v114
    v_mfma_f32_32x32x16_bf16 v[128:143], a[44:47], v[236:239], v[128:143]
    s_waitcnt vmcnt(13)
    v_bitop3_b32 v7, v243, v247, v251 bitop3:0x80
    v_bitop3_b32 v7, v7, v255, 1 bitop3:0x2a
    v_cmp_ne_u32 vcc, 0, v7
    v_mul_f32 v19, v115, v115
    v_cvt_pk_bf16_f32 v27, v110, v111
    v_or_b32 v27, 1, v27
    v_exp_f32 v18, v18
    v_fma_f32 v17, v17, v60, v60
    v_fma_f32 v19, v19, v58, v59
    v_mfma_f32_32x32x16_bf16 v[32:47], a[40:43], v[236:239], v[32:47]
    s_cbranch_vccnz OOL_384
RET_385:
    buffer_load_dwordx4 v[172:175], v1, s[8:11], s78 offen offset:3072 sc1
    buffer_store_dwordx4 v[20:23], v1, s[8:11], s61 offen offset:0 sc1
    buffer_store_dwordx4 v[24:27], v1, s[8:11], s61 offen offset:1024 sc1
    v_mul_f32 v112, v112, v16
    v_mfma_f32_32x32x16_bf16 v[128:143], a[68:71], v[240:243], v[128:143]
    buffer_load_dwordx4 a[212:215], v1, s[8:11], s92 offen offset:2048 sc1
    v_rcp_f32 v17, v17
    v_mul_f32 v19, v19, v115
    v_mul_f32 v16, v116, v116
    v_exp_f32 v19, v19
    v_fma_f32 v18, v18, v60, v60
    v_fma_f32 v16, v16, v58, v59
    v_mul_f32 v113, v113, v17
    v_mfma_f32_32x32x16_bf16 v[32:47], a[64:67], v[240:243], v[32:47]
    s_add_u32 s78, s50, 0x8000
    buffer_load_dwordx4 v[176:179], v1, s[8:11], s78 offen offset:0 sc1
    v_rcp_f32 v18, v18
    v_mul_f32 v16, v16, v116
    v_mul_f32 v17, v117, v117
    v_cvt_pk_bf16_f32 v20, v112, v113
    v_exp_f32 v16, v16
    v_fma_f32 v19, v19, v60, v60
    v_mfma_f32_32x32x16_bf16 v[128:143], a[76:79], v[244:247], v[128:143]
    buffer_load_dwordx4 a[216:219], v1, s[8:11], s91 offen offset:3072 sc1
    v_fma_f32 v17, v17, v58, v59
    v_rcp_f32 v19, v19
    v_mul_f32 v114, v114, v18
    v_mul_f32 v17, v17, v117
    v_mul_f32 v18, v118, v118
    v_exp_f32 v17, v17
    v_fma_f32 v16, v16, v60, v60
    v_mfma_f32_32x32x16_bf16 v[32:47], a[72:75], v[244:247], v[32:47]
    buffer_load_dwordx4 v[180:183], v1, s[8:11], s78 offen offset:1024 sc1
    v_fma_f32 v18, v18, v58, v59
    v_rcp_f32 v16, v16
    v_mul_f32 v115, v115, v19
    v_mul_f32 v18, v18, v118
    v_mul_f32 v19, v119, v119
    v_cvt_pk_bf16_f32 v21, v114, v115
    v_exp_f32 v18, v18
    v_mfma_f32_32x32x16_bf16 v[128:143], a[100:103], v[248:251], v[128:143]
    buffer_load_dwordx4 a[220:223], v1, s[8:11], s92 offen offset:3072 sc1
    v_fma_f32 v17, v17, v60, v60
    v_fma_f32 v19, v19, v58, v59
    v_rcp_f32 v17, v17
    v_mul_f32 v116, v116, v16
    v_mul_f32 v19, v19, v119
    v_mul_f32 v16, v120, v120
    v_exp_f32 v19, v19
    v_mfma_f32_32x32x16_bf16 v[32:47], a[96:99], v[248:251], v[32:47]
    buffer_load_dwordx4 v[184:187], v1, s[8:11], s78 offen offset:2048 sc1
    v_fma_f32 v18, v18, v60, v60
    v_fma_f32 v16, v16, v58, v59
    v_rcp_f32 v18, v18
    v_mul_f32 v117, v117, v17
    v_mul_f32 v16, v16, v120
    v_mul_f32 v17, v121, v121
    v_cvt_pk_bf16_f32 v22, v116, v117
    v_fma_f32 v19, v19, v60, v60
    v_mfma_f32_32x32x16_bf16 v[128:143], a[108:111], v[252:255], v[128:143]
    s_waitcnt vmcnt(15)
    v_bitop3_b32 v7, v147, v151, v155 bitop3:0xfe
    v_bitop3_b32 v7, v7, v159, 1 bitop3:0xa8
    v_cmp_ne_u32 vcc, 0, v7
    v_exp_f32 v16, v16
    v_fma_f32 v17, v17, v58, v59
    v_rcp_f32 v19, v19
    v_mul_f32 v118, v118, v18
    v_mul_f32 v17, v17, v121
    v_mfma_f32_32x32x16_bf16 v[32:47], a[104:107], v[252:255], v[32:47]
    s_cbranch_vccnz OOL_387
RET_388:
    buffer_load_dwordx4 v[188:191], v1, s[8:11], s78 offen offset:3072 sc1
    v_mul_f32 v18, v122, v122
    v_exp_f32 v17, v17
    v_fma_f32 v16, v16, v60, v60
    v_fma_f32 v18, v18, v58, v59
    v_mfma_f32_32x32x16_bf16 v[80:95], a[20:23], v[144:147], v[80:95]
    s_nop 0
    v_rcp_f32 v16, v16
    v_mul_f32 v119, v119, v19
    v_mul_f32 v18, v18, v122
    v_mul_f32 v19, v123, v123
    v_cvt_pk_bf16_f32 v23, v118, v119
    v_exp_f32 v18, v18
    v_fma_f32 v17, v17, v60, v60
    v_fma_f32 v19, v19, v58, v59
    v_mfma_f32_32x32x16_bf16 v[64:79], a[16:19], v[144:147], v[64:79]
    s_add_u32 s78, s50, 0x9000
    buffer_load_dwordx4 v[192:195], v1, s[8:11], s78 offen offset:0 sc1
    v_rcp_f32 v17, v17
    v_mul_f32 v120, v120, v16
    v_mul_f32 v19, v19, v123
    v_mul_f32 v16, v124, v124
    v_exp_f32 v19, v19
    v_fma_f32 v18, v18, v60, v60
    v_mfma_f32_32x32x16_bf16 v[80:95], a[28:31], v[148:151], v[80:95]
    v_fma_f32 v16, v16, v58, v59
    v_rcp_f32 v18, v18
    v_mul_f32 v121, v121, v17
    v_mul_f32 v16, v16, v124
    v_mul_f32 v17, v125, v125
    v_cvt_pk_bf16_f32 v24, v120, v121
    v_or_b32 v23, 1, v23
    v_exp_f32 v16, v16
    v_mfma_f32_32x32x16_bf16 v[64:79], a[24:27], v[148:151], v[64:79]
    buffer_load_dwordx4 v[196:199], v1, s[8:11], s78 offen offset:1024 sc1
    v_fma_f32 v19, v19, v60, v60
    v_fma_f32 v17, v17, v58, v59
    v_rcp_f32 v19, v19
    v_mul_f32 v122, v122, v18
    v_mul_f32 v17, v17, v125
    v_mul_f32 v18, v126, v126
    v_exp_f32 v17, v17
    v_mfma_f32_32x32x16_bf16 v[80:95], a[52:55], v[152:155], v[80:95]
    v_fma_f32 v16, v16, v60, v60
    v_fma_f32 v18, v18, v58, v59
    v_rcp_f32 v16, v16
    v_mul_f32 v123, v123, v19
    v_mul_f32 v18, v18, v126
    v_mul_f32 v19, v127, v127
    v_cvt_pk_bf16_f32 v25, v122, v123
    v_exp_f32 v18, v18
    v_mfma_f32_32x32x16_bf16 v[64:79], a[48:51], v[152:155], v[64:79]
    buffer_load_dwordx4 v[200:203], v1, s[8:11], s78 offen offset:2048 sc1
    v_fma_f32 v17, v17, v60, v60
    v_fma_f32 v19, v19, v58, v59
    v_rcp_f32 v17, v17
    v_mul_f32 v124, v124, v16
    v_mul_f32 v19, v19, v127
    v_exp_f32 v19, v19
    v_fma_f32 v18, v18, v60, v60
    v_mfma_f32_32x32x16_bf16 v[80:95], a[60:63], v[156:159], v[80:95]
    s_waitcnt vmcnt(12)
    v_bitop3_b32 v7, v163, v167, v171 bitop3:0xfe
    v_bitop3_b32 v7, v7, v175, 1 bitop3:0xa8
    v_cmp_ne_u32 vcc, 0, v7
    v_rcp_f32 v18, v18
    v_mul_f32 v125, v125, v17
    v_cvt_pk_bf16_f32 v26, v124, v125
    v_fma_f32 v19, v19, v60, v60
    v_rcp_f32 v19, v19
    v_mfma_f32_32x32x16_bf16 v[64:79], a[56:59], v[156:159], v[64:79]
    s_cbranch_vccnz OOL_390
RET_391:
    buffer_load_dwordx4 v[204:207], v1, s[8:11], s78 offen offset:3072 sc1
    v_mul_f32 v126, v126, v18
    v_mul_f32 v127, v127, v19
    v_cvt_pk_bf16_f32 v27, v126, v127
    v_or_b32 v27, 1, v27
    v_mfma_f32_32x32x16_bf16 v[80:95], a[84:87], v[160:163], v[80:95]
    s_add_u32 s76, s61, 6144
    buffer_store_dwordx4 v[20:23], v1, s[8:11], s76 offen offset:0 sc1
    buffer_store_dwordx4 v[24:27], v1, s[8:11], s76 offen offset:1024 sc1
    v_mfma_f32_32x32x16_bf16 v[64:79], a[80:83], v[160:163], v[64:79]
    buffer_load_dwordx4 v[208:211], v1, s[8:11], s53 offen offset:0 sc1
    v_mfma_f32_32x32x16_bf16 v[80:95], a[92:95], v[164:167], v[80:95]
    v_mfma_f32_32x32x16_bf16 v[64:79], a[88:91], v[164:167], v[64:79]
    buffer_load_dwordx4 v[212:215], v1, s[8:11], s53 offen offset:1024 sc1
    v_mfma_f32_32x32x16_bf16 v[80:95], a[116:119], v[168:171], v[80:95]
    v_mfma_f32_32x32x16_bf16 v[64:79], a[112:115], v[168:171], v[64:79]
    buffer_load_dwordx4 v[216:219], v1, s[8:11], s53 offen offset:2048 sc1
    v_mfma_f32_32x32x16_bf16 v[80:95], a[124:127], v[172:175], v[80:95]
    s_waitcnt vmcnt(9)
    v_bitop3_b32 v7, v179, v183, v187 bitop3:0xfe
    v_bitop3_b32 v7, v7, v191, 1 bitop3:0xa8
    v_cmp_ne_u32 vcc, 0, v7
    v_mfma_f32_32x32x16_bf16 v[64:79], a[120:123], v[172:175], v[64:79]
    s_cbranch_vccnz OOL_393
RET_394:
    buffer_load_dwordx4 v[220:223], v1, s[8:11], s53 offen offset:3072 sc1
    v_mfma_f32_32x32x16_bf16 v[128:143], a[20:23], v[176:179], v[128:143]
    v_mfma_f32_32x32x16_bf16 v[32:47], a[16:19], v[176:179], v[32:47]
    s_add_u32 s78, s53, 0x1000
    buffer_load_dwordx4 v[224:227], v1, s[8:11], s78 offen offset:0 sc1
    v_mfma_f32_32x32x16_bf16 v[128:143], a[28:31], v[180:183], v[128:143]
    v_mfma_f32_32x32x16_bf16 v[32:47], a[24:27], v[180:183], v[32:47]
    buffer_load_dwordx4 v[228:231], v1, s[8:11], s78 offen offset:1024 sc1
    v_mfma_f32_32x32x16_bf16 v[128:143], a[52:55], v[184:187], v[128:143]
    v_mfma_f32_32x32x16_bf16 v[32:47], a[48:51], v[184:187], v[32:47]
    buffer_load_dwordx4 v[232:235], v1, s[8:11], s52 offen offset:0 sc1
    v_mfma_f32_32x32x16_bf16 v[128:143], a[60:63], v[188:191], v[128:143]
    s_waitcnt vmcnt(9)
    v_bitop3_b32 v7, v195, v199, v203 bitop3:0xfe
    v_bitop3_b32 v7, v7, v207, 1 bitop3:0xa8
    v_cmp_ne_u32 vcc, 0, v7
    v_mfma_f32_32x32x16_bf16 v[32:47], a[56:59], v[188:191], v[32:47]
    s_cbranch_vccnz OOL_396
RET_397:
    buffer_load_dwordx4 v[236:239], v1, s[8:11], s52 offen offset:1024 sc1
    v_mfma_f32_32x32x16_bf16 v[128:143], a[84:87], v[192:195], v[128:143]
    v_mfma_f32_32x32x16_bf16 v[32:47], a[80:83], v[192:195], v[32:47]
    buffer_load_dwordx4 v[240:243], v1, s[8:11], s52 offen offset:2048 sc1
    v_mfma_f32_32x32x16_bf16 v[128:143], a[92:95], v[196:199], v[128:143]
    v_mfma_f32_32x32x16_bf16 v[32:47], a[88:91], v[196:199], v[32:47]
    buffer_load_dwordx4 v[244:247], v1, s[8:11], s52 offen offset:3072 sc1
    v_mfma_f32_32x32x16_bf16 v[128:143], a[116:119], v[200:203], v[128:143]
    v_mfma_f32_32x32x16_bf16 v[32:47], a[112:115], v[200:203], v[32:47]
    s_add_u32 s78, s52, 0x1000
    buffer_load_dwordx4 v[248:251], v1, s[8:11], s78 offen offset:0 sc1
    v_mfma_f32_32x32x16_bf16 v[128:143], a[124:127], v[204:207], v[128:143]
    s_waitcnt vmcnt(7)
    v_bitop3_b32 v7, v211, v215, v219 bitop3:0x80
    v_bitop3_b32 v7, v7, v223, 1 bitop3:0x2a
    v_cmp_ne_u32 vcc, 0, v7
    v_mfma_f32_32x32x16_bf16 v[32:47], a[120:123], v[204:207], v[32:47]
    s_cbranch_vccnz OOL_399
RET_400:
    buffer_load_dwordx4 v[252:255], v1, s[8:11], s78 offen offset:1024 sc1
    v_mfma_f32_32x32x16_bf16 v[80:95], a[132:135], v[208:211], v[80:95]
    v_mfma_f32_32x32x16_bf16 v[64:79], a[128:131], v[208:211], v[64:79]
    s_add_u32 s78, s53, 0x1800
    buffer_load_dwordx4 v[144:147], v1, s[8:11], s78 offen offset:0 sc1
    v_mfma_f32_32x32x16_bf16 v[80:95], a[140:143], v[212:215], v[80:95]
    v_mfma_f32_32x32x16_bf16 v[64:79], a[136:139], v[212:215], v[64:79]
    buffer_load_dwordx4 v[148:151], v1, s[8:11], s78 offen offset:1024 sc1
    v_mfma_f32_32x32x16_bf16 v[80:95], a[164:167], v[216:219], v[80:95]
    v_mfma_f32_32x32x16_bf16 v[64:79], a[160:163], v[216:219], v[64:79]
    buffer_load_dwordx4 v[152:155], v1, s[8:11], s78 offen offset:2048 sc1
    v_mfma_f32_32x32x16_bf16 v[80:95], a[172:175], v[220:223], v[80:95]
    s_waitcnt vmcnt(9)
    v_bitop3_b32 v7, v227, v231, 1 bitop3:0x2a
    v_cmp_ne_u32 vcc, 0, v7
    v_mfma_f32_32x32x16_bf16 v[64:79], a[168:171], v[220:223], v[64:79]
    s_cbranch_vccnz OOL_402
RET_403:
    buffer_load_dwordx4 v[156:159], v1, s[8:11], s78 offen offset:3072 sc1
    v_mfma_f32_32x32x16_bf16 v[80:95], a[196:199], v[224:227], v[80:95]
    v_mfma_f32_32x32x16_bf16 v[64:79], a[192:195], v[224:227], v[64:79]
    s_add_u32 s78, s53, 0x2800
    buffer_load_dwordx4 v[160:163], v1, s[8:11], s78 offen offset:0 sc1
    v_mfma_f32_32x32x16_bf16 v[80:95], a[204:207], v[228:231], v[80:95]
    s_waitcnt vmcnt(7)
    v_bitop3_b32 v7, v235, v239, v243 bitop3:0x80
    v_bitop3_b32 v7, v7, v247, 1 bitop3:0x2a
    v_cmp_ne_u32 vcc, 0, v7
    v_mfma_f32_32x32x16_bf16 v[64:79], a[200:203], v[228:231], v[64:79]
    s_cbranch_vccnz OOL_405
RET_406:
    buffer_load_dwordx4 v[164:167], v1, s[8:11], s78 offen offset:1024 sc1
    v_mfma_f32_32x32x16_bf16 v[128:143], a[132:135], v[232:235], v[128:143]
    v_mfma_f32_32x32x16_bf16 v[32:47], a[128:131], v[232:235], v[32:47]
    s_add_u32 s78, s52, 0x1800
    buffer_load_dwordx4 v[168:171], v1, s[8:11], s78 offen offset:0 sc1
    v_mfma_f32_32x32x16_bf16 v[128:143], a[140:143], v[236:239], v[128:143]
    v_mfma_f32_32x32x16_bf16 v[32:47], a[136:139], v[236:239], v[32:47]
    buffer_load_dwordx4 v[172:175], v1, s[8:11], s78 offen offset:1024 sc1
    v_mfma_f32_32x32x16_bf16 v[128:143], a[164:167], v[240:243], v[128:143]
    v_mfma_f32_32x32x16_bf16 v[32:47], a[160:163], v[240:243], v[32:47]
    buffer_load_dwordx4 v[176:179], v1, s[8:11], s78 offen offset:2048 sc1
    v_mfma_f32_32x32x16_bf16 v[128:143], a[172:175], v[244:247], v[128:143]
    s_waitcnt vmcnt(9)
    v_bitop3_b32 v7, v251, v255, 1 bitop3:0x2a
    v_cmp_ne_u32 vcc, 0, v7
    v_mfma_f32_32x32x16_bf16 v[32:47], a[168:171], v[244:247], v[32:47]
    s_cbranch_vccnz OOL_408
RET_409:
    buffer_load_dwordx4 v[180:183], v1, s[8:11], s78 offen offset:3072 sc1
    v_mfma_f32_32x32x16_bf16 v[128:143], a[196:199], v[248:251], v[128:143]
    v_mfma_f32_32x32x16_bf16 v[32:47], a[192:195], v[248:251], v[32:47]
    s_add_u32 s78, s52, 0x2800
    buffer_load_dwordx4 v[184:187], v1, s[8:11], s78 offen offset:0 sc1
    v_mfma_f32_32x32x16_bf16 v[128:143], a[204:207], v[252:255], v[128:143]
    s_waitcnt vmcnt(7)
    v_bitop3_b32 v7, v147, v151, v155 bitop3:0x80
    v_bitop3_b32 v7, v7, v159, 1 bitop3:0x2a
    v_cmp_ne_u32 vcc, 0, v7
    v_mfma_f32_32x32x16_bf16 v[32:47], a[200:203], v[252:255], v[32:47]
    s_cbranch_vccnz OOL_411
RET_412:
    buffer_load_dwordx4 v[188:191], v1, s[8:11], s78 offen offset:1024 sc1
    v_mfma_f32_32x32x16_bf16 v[80:95], a[148:151], v[144:147], v[80:95]
    buffer_load_dwordx4 v[192:195], v1, s[8:11], s55 offen offset:0 sc1
    v_mfma_f32_32x32x16_bf16 v[64:79], a[144:147], v[144:147], v[64:79]
    v_mfma_f32_32x32x16_bf16 v[80:95], a[156:159], v[148:151], v[80:95]
    buffer_load_dwordx4 v[196:199], v1, s[8:11], s56 offen offset:0 sc1
    v_mfma_f32_32x32x16_bf16 v[64:79], a[152:155], v[148:151], v[64:79]
    v_mfma_f32_32x32x16_bf16 v[80:95], a[180:183], v[152:155], v[80:95]
    buffer_load_dwordx4 v[200:203], v1, s[8:11], s55 offen offset:1024 sc1
    v_mfma_f32_32x32x16_bf16 v[64:79], a[176:179], v[152:155], v[64:79]
    v_mfma_f32_32x32x16_bf16 v[80:95], a[188:191], v[156:159], v[80:95]
    s_waitcnt vmcnt(9)
    v_bitop3_b32 v7, v163, v167, 1 bitop3:0x2a
    v_cmp_ne_u32 vcc, 0, v7
    v_mfma_f32_32x32x16_bf16 v[64:79], a[184:187], v[156:159], v[64:79]
    s_cbranch_vccnz OOL_414
RET_415:
    buffer_load_dwordx4 v[204:207], v1, s[8:11], s56 offen offset:1024 sc1
    v_mfma_f32_32x32x16_bf16 v[80:95], a[212:215], v[160:163], v[80:95]
    v_mfma_f32_32x32x16_bf16 v[64:79], a[208:211], v[160:163], v[64:79]
    buffer_load_dwordx4 v[208:211], v1, s[8:11], s55 offen offset:2048 sc1
    v_mfma_f32_32x32x16_bf16 v[80:95], a[220:223], v[164:167], v[80:95]
    s_waitcnt vmcnt(7)
    v_bitop3_b32 v7, v171, v175, v179 bitop3:0x80
    v_bitop3_b32 v7, v7, v183, 1 bitop3:0x2a
    v_cmp_ne_u32 vcc, 0, v7
    v_mfma_f32_32x32x16_bf16 v[64:79], a[216:219], v[164:167], v[64:79]
    s_cbranch_vccnz OOL_417
RET_418:
    buffer_load_dwordx4 v[212:215], v1, s[8:11], s56 offen offset:2048 sc1
    v_mfma_f32_32x32x16_bf16 v[128:143], a[148:151], v[168:171], v[128:143]
    s_nop 0
    v_mfma_f32_32x32x16_bf16 v[128:143], a[156:159], v[172:175], v[128:143]
    buffer_load_dwordx4 v[216:219], v1, s[8:11], s55 offen offset:3072 sc1
    v_xor_b32 v19, 6144, v2
    v_cvt_pk_bf16_f32 v80, v80, v81
    v_cvt_pk_bf16_f32 v81, v82, v83
    v_cvt_pk_bf16_f32 v82, v84, v85
    v_cvt_pk_bf16_f32 v83, v86, v87
    v_mfma_f32_32x32x16_bf16 v[128:143], a[180:183], v[176:179], v[128:143]
    ds_write_b128 v19, v[80:83] offset:16384
    v_cvt_pk_bf16_f32 v84, v88, v89
    v_cvt_pk_bf16_f32 v85, v90, v91
    v_cvt_pk_bf16_f32 v86, v92, v93
    v_mfma_f32_32x32x16_bf16 v[128:143], a[188:191], v[180:183], v[128:143]
    s_waitcnt vmcnt(7)
    v_bitop3_b32 v7, v187, v191, 1 bitop3:0x2a
    v_cmp_ne_u32 vcc, 0, v7
    v_cvt_pk_bf16_f32 v87, v94, v95
    v_xor_b32 v17, 2048, v2
    v_cvt_pk_bf16_f32 v64, v64, v65
    v_cvt_pk_bf16_f32 v65, v66, v67
    v_mfma_f32_32x32x16_bf16 v[32:47], a[144:147], v[168:171], v[32:47]
    s_cbranch_vccnz OOL_420
RET_421:
    buffer_load_dwordx4 v[220:223], v1, s[8:11], s56 offen offset:3072 sc1
    v_cvt_pk_bf16_f32 v66, v68, v69
    v_mfma_f32_32x32x16_bf16 v[128:143], a[212:215], v[184:187], v[128:143]
    ds_write_b128 v19, v[84:87] offset:17408
    v_cvt_pk_bf16_f32 v67, v70, v71
    v_cvt_pk_bf16_f32 v68, v72, v73
    v_cvt_pk_bf16_f32 v69, v74, v75
    v_mfma_f32_32x32x16_bf16 v[32:47], a[152:155], v[172:175], v[32:47]
    s_add_u32 s88, s55, 0x1000
    buffer_load_dwordx4 v[224:227], v1, s[8:11], s88 offen offset:0 sc1
    ds_write_b128 v17, v[64:67] offset:0
    v_mfma_f32_32x32x16_bf16 v[128:143], a[220:223], v[188:191], v[128:143]
    v_cvt_pk_bf16_f32 v70, v76, v77
    v_cvt_pk_bf16_f32 v71, v78, v79
    ds_write_b128 v17, v[68:71] offset:1024
    v_add_u32 v16, 161792, v1
    s_waitcnt lgkmcnt(0)
    s_barrier
    ds_read_b128 v[120:123], v16 offset:0
    ds_read_b128 v[124:127], v16 offset:1024
    ds_read_b128 v[80:83], v2 offset:0
    ds_read_b128 v[84:87], v2 offset:1024
    ds_read_b128 v[112:115], v2 offset:16384
    ds_read_b128 v[116:119], v2 offset:17408
    v_mfma_f32_32x32x16_bf16 v[32:47], a[176:179], v[176:179], v[32:47]
    s_add_u32 s89, s56, 0x1000
    buffer_load_dwordx4 v[228:231], v1, s[8:11], s89 offen offset:0 sc1
    v_mfma_f32_32x32x16_bf16 v[32:47], a[184:187], v[180:183], v[32:47]
    v_xor_b32 v18, 4096, v2
    v_cvt_pk_bf16_f32 v128, v128, v129
    v_cvt_pk_bf16_f32 v129, v130, v131
    v_cvt_pk_bf16_f32 v130, v132, v133
    v_cvt_pk_bf16_f32 v131, v134, v135
    v_cvt_pk_bf16_f32 v132, v136, v137
    v_mfma_f32_32x32x16_bf16 v[32:47], a[208:211], v[184:187], v[32:47]
    buffer_load_dwordx4 v[232:235], v1, s[8:11], s88 offen offset:1024 sc1
    ds_write_b128 v18, v[128:131] offset:8192
    v_cvt_pk_bf16_f32 v133, v138, v139
    v_mfma_f32_32x32x16_bf16 v[32:47], a[216:219], v[188:191], v[32:47]
    v_cvt_pk_bf16_f32 v134, v140, v141
    v_cvt_pk_bf16_f32 v135, v142, v143
    s_waitcnt lgkmcnt(4)
    v_mfma_f32_32x32x16_bf16 v[32:47], v[120:123], v[80:83], v[32:47]
    buffer_load_dwordx4 v[236:239], v1, s[8:11], s89 offen offset:1024 sc1
    ds_write_b128 v18, v[132:135] offset:9216
    s_waitcnt lgkmcnt(4)
    v_mfma_f32_32x32x16_bf16 v[32:47], v[124:127], v[84:87], v[32:47]
    s_waitcnt lgkmcnt(0)
    s_barrier
    ds_read_b128 v[96:99], v2 offset:8192
    ds_read_b128 v[100:103], v2 offset:9216
    v_mfma_f32_32x32x16_bf16 v[32:47], v[120:123], v[112:115], v[32:47]
    buffer_load_dwordx4 v[240:243], v1, s[8:11], s88 offen offset:2048 sc1
    v_mfma_f32_32x32x16_bf16 v[32:47], v[124:127], v[116:119], v[32:47]
    buffer_load_dwordx4 v[244:247], v1, s[8:11], s89 offen offset:2048 sc1
    buffer_load_dwordx4 v[248:251], v1, s[8:11], s88 offen offset:3072 sc1
    s_waitcnt lgkmcnt(1)
    s_nop 8
    v_dot2c_f32_bf16 v32, s65, v96
    v_dot2c_f32_bf16 v33, s66, v96
    v_dot2c_f32_bf16 v34, s65, v97
    v_dot2c_f32_bf16 v35, s66, v97
    buffer_load_dwordx4 v[252:255], v1, s[8:11], s89 offen offset:3072 sc1
    v_dot2c_f32_bf16 v36, s65, v98
    v_dot2c_f32_bf16 v37, s66, v98
    v_dot2c_f32_bf16 v38, s65, v99
    v_dot2c_f32_bf16 v39, s66, v99
    s_waitcnt lgkmcnt(0)
    v_dot2c_f32_bf16 v40, s65, v100
    v_dot2c_f32_bf16 v41, s66, v100
    v_dot2c_f32_bf16 v42, s65, v101
    v_dot2c_f32_bf16 v43, s66, v101
    v_dot2c_f32_bf16 v44, s65, v102
    v_dot2c_f32_bf16 v45, s66, v102
    v_dot2c_f32_bf16 v46, s65, v103
    v_dot2c_f32_bf16 v47, s66, v103
    s_add_u32 s77, s48, 0x1000
    s_add_u32 s76, s49, 0x1000
    v_pk_add_f32 v[18:19], v[32:33], v[34:35]
    v_pk_mul_f32 v[20:21], v[32:33], v[32:33]
    v_pk_fma_f32 v[20:21], v[34:35], v[34:35], v[20:21]
    v_pk_add_f32 v[18:19], v[18:19], v[36:37]
    v_pk_fma_f32 v[20:21], v[36:37], v[36:37], v[20:21]
    v_pk_add_f32 v[18:19], v[18:19], v[38:39]
    v_pk_fma_f32 v[20:21], v[38:39], v[38:39], v[20:21]
    v_pk_add_f32 v[18:19], v[18:19], v[40:41]
    v_pk_fma_f32 v[20:21], v[40:41], v[40:41], v[20:21]
    v_pk_add_f32 v[18:19], v[18:19], v[42:43]
    v_pk_fma_f32 v[20:21], v[42:43], v[42:43], v[20:21]
    v_pk_add_f32 v[18:19], v[18:19], v[44:45]
    v_pk_fma_f32 v[20:21], v[44:45], v[44:45], v[20:21]
    v_pk_add_f32 v[18:19], v[18:19], v[46:47]
    v_pk_fma_f32 v[20:21], v[46:47], v[46:47], v[20:21]
    v_add_f32 v18, v18, v19
    v_add_f32 v20, v20, v21
    s_nop 1
    v_permlane32_swap_b32 v18, v20
    v_add_f32 v18, v18, v20
    v_and_b32 v18, -2, v18
    buffer_store_dword v18, v1, s[8:11], s77 offen sc1
    v_add_u32 v5, v5, v14
    v_lshlrev_b32 v64, 16, v48
    v_and_b32 v65, 0xffff0000, v48
    v_lshlrev_b32 v66, 16, v49
    v_and_b32 v67, 0xffff0000, v49
    v_lshlrev_b32 v68, 16, v50
    v_and_b32 v69, 0xffff0000, v50
    v_lshlrev_b32 v70, 16, v51
    v_and_b32 v71, 0xffff0000, v51
    v_lshlrev_b32 v72, 16, v52
    v_and_b32 v73, 0xffff0000, v52
    v_lshlrev_b32 v74, 16, v53
    v_and_b32 v75, 0xffff0000, v53
    v_lshlrev_b32 v76, 16, v54
    v_and_b32 v77, 0xffff0000, v54
    v_lshlrev_b32 v78, 16, v55
    v_and_b32 v79, 0xffff0000, v55
    s_waitcnt vmcnt(0)
    buffer_load_dwordx4 v[80:83], v1, s[8:11], s76 offen offset:0 sc1
    buffer_load_dwordx4 v[84:87], v1, s[8:11], s76 offen offset:1024 sc1
    buffer_load_dwordx4 v[88:91], v1, s[8:11], s76 offen offset:2048 sc1
    buffer_load_dwordx4 v[92:95], v1, s[8:11], s76 offen offset:3072 sc1
    s_waitcnt vmcnt(0)
    v_bitop3_b32 v7, v80, v81, v82 bitop3:0xfe
    v_bitop3_b32 v7, v7, v83, v84 bitop3:0xfe
    v_bitop3_b32 v7, v7, v85, v86 bitop3:0xfe
    v_bitop3_b32 v7, v7, v87, v88 bitop3:0xfe
    v_bitop3_b32 v7, v7, v89, v90 bitop3:0xfe
    v_bitop3_b32 v7, v7, v91, v92 bitop3:0xfe
    v_bitop3_b32 v7, v7, v93, v94 bitop3:0xfe
    v_bitop3_b32 v7, v7, v95, 1 bitop3:0xa8
    v_cmp_ne_u32 vcc, 0, v7
    s_cbranch_vccnz OOL_423
RET_424:
    v_pk_add_f32 v[80:81], v[80:81], v[88:89]
    v_pk_add_f32 v[82:83], v[82:83], v[90:91]
    v_pk_add_f32 v[84:85], v[84:85], v[92:93]
    v_pk_add_f32 v[86:87], v[86:87], v[94:95]
    v_pk_add_f32 v[80:81], v[80:81], v[84:85]
    v_pk_add_f32 v[82:83], v[82:83], v[86:87]
    v_pk_add_f32 v[80:81], v[80:81], v[82:83]
    v_add_f32 v80, v80, v81
    v_mov_b32 v81, v80
    s_nop 1
    v_permlane32_swap_b32 v80, v81
    v_mul_f32 v80, 0xbb000000, v80
    v_mul_f32 v81, 0x3b000000, v81
    v_fma_f32 v81, -v80, v80, v81
    v_max_f32 v81, 0, v81
    v_add_f32 v81, 0x3727c5ac, v81
    v_rsq_f32 v82, v81
    s_nop 0
    v_mul_f32 v83, v80, v82
    v_pk_fma_f32 v[96:97], v[32:33], v[82:83], v[82:83] op_sel:[0,0,1] op_sel_hi:[1,0,1]
    v_pk_fma_f32 v[98:99], v[34:35], v[82:83], v[82:83] op_sel:[0,0,1] op_sel_hi:[1,0,1]
    v_pk_fma_f32 v[100:101], v[36:37], v[82:83], v[82:83] op_sel:[0,0,1] op_sel_hi:[1,0,1]
    v_pk_fma_f32 v[102:103], v[38:39], v[82:83], v[82:83] op_sel:[0,0,1] op_sel_hi:[1,0,1]
    v_pk_fma_f32 v[104:105], v[40:41], v[82:83], v[82:83] op_sel:[0,0,1] op_sel_hi:[1,0,1]
    v_pk_fma_f32 v[106:107], v[42:43], v[82:83], v[82:83] op_sel:[0,0,1] op_sel_hi:[1,0,1]
    v_pk_fma_f32 v[108:109], v[44:45], v[82:83], v[82:83] op_sel:[0,0,1] op_sel_hi:[1,0,1]
    v_pk_fma_f32 v[110:111], v[46:47], v[82:83], v[82:83] op_sel:[0,0,1] op_sel_hi:[1,0,1]
    v_pk_fma_f32 v[32:33], v[96:97], v[64:65], v[32:33]
    v_pk_fma_f32 v[34:35], v[98:99], v[66:67], v[34:35]
    v_pk_fma_f32 v[36:37], v[100:101], v[68:69], v[36:37]
    v_pk_fma_f32 v[38:39], v[102:103], v[70:71], v[38:39]
    v_pk_fma_f32 v[40:41], v[104:105], v[72:73], v[40:41]
    v_pk_fma_f32 v[42:43], v[106:107], v[74:75], v[42:43]
    v_pk_fma_f32 v[44:45], v[108:109], v[76:77], v[44:45]
    v_pk_fma_f32 v[46:47], v[110:111], v[78:79], v[46:47]
    v_cvt_pk_bf16_f32 v112, v32, v33
    v_cvt_pk_bf16_f32 v113, v34, v35
    v_cvt_pk_bf16_f32 v114, v36, v37
    v_cvt_pk_bf16_f32 v115, v38, v39
    v_cvt_pk_bf16_f32 v116, v40, v41
    v_cvt_pk_bf16_f32 v117, v42, v43
    v_cvt_pk_bf16_f32 v118, v44, v45
    v_cvt_pk_bf16_f32 v119, v46, v47
    v_and_b32 v115, -2, v115
    v_and_b32 v119, -2, v119
    buffer_store_dwordx4 v[112:115], v1, s[8:11], s47 offen offset:0 sc1
    buffer_store_dwordx4 v[116:119], v1, s[8:11], s47 offen offset:1024 sc1
    v_pk_add_f32 v[120:121], v[32:33], v[34:35]
    v_pk_mul_f32 v[122:123], v[32:33], v[32:33]
    v_pk_fma_f32 v[122:123], v[34:35], v[34:35], v[122:123]
    v_pk_add_f32 v[120:121], v[120:121], v[36:37]
    v_pk_fma_f32 v[122:123], v[36:37], v[36:37], v[122:123]
    v_pk_add_f32 v[120:121], v[120:121], v[38:39]
    v_pk_fma_f32 v[122:123], v[38:39], v[38:39], v[122:123]
    v_pk_add_f32 v[120:121], v[120:121], v[40:41]
    v_pk_fma_f32 v[122:123], v[40:41], v[40:41], v[122:123]
    v_pk_add_f32 v[120:121], v[120:121], v[42:43]
    v_pk_fma_f32 v[122:123], v[42:43], v[42:43], v[122:123]
    v_pk_add_f32 v[120:121], v[120:121], v[44:45]
    v_pk_fma_f32 v[122:123], v[44:45], v[44:45], v[122:123]
    v_pk_add_f32 v[120:121], v[120:121], v[46:47]
    v_pk_fma_f32 v[122:123], v[46:47], v[46:47], v[122:123]
    v_add_f32 v120, v120, v121
    v_add_f32 v122, v122, v123
    s_nop 1
    v_permlane32_swap_b32 v120, v122
    v_add_f32 v120, v120, v122
    v_or_b32 v120, 1, v120
    buffer_store_dword v120, v1, s[8:11], s48 offen sc1
    s_add_u32 s79, s51, 0x110000
    buffer_load_dwordx4 v[132:135], v1, s[8:11], s79 offen offset:0 sc1
    buffer_load_dwordx4 v[140:143], v1, s[8:11], s79 offen offset:1024 sc1
    buffer_load_dwordx4 v[148:151], v1, s[8:11], s79 offen offset:2048 sc1
    buffer_load_dwordx4 v[156:159], v1, s[8:11], s79 offen offset:3072 sc1
    s_add_u32 s79, s51, 0x111000
    buffer_load_dwordx4 v[164:167], v1, s[8:11], s79 offen offset:0 sc1
    buffer_load_dwordx4 v[172:175], v1, s[8:11], s79 offen offset:1024 sc1
    buffer_load_dwordx4 v[180:183], v1, s[8:11], s79 offen offset:2048 sc1
    buffer_load_dwordx4 v[188:191], v1, s[8:11], s79 offen offset:3072 sc1
    s_waitcnt vmcnt(6)
    v_bitop3_b32 v7, v135, v143, 1 bitop3:0xa8
    v_cmp_ne_u32 vcc, 0, v7
    s_cbranch_vccnz OOL_426
RET_427:
    v_mfma_f32_32x32x16_bf16 v[112:127], v[196:199], v[132:135], 0
    s_add_u32 s80, s50, 0x110000
    buffer_load_dwordx4 v[128:131], v1, s[8:11], s80 offen offset:0 sc1
    v_mov_b32 v30, s69
    v_add_u32 v30, 3, v30
    v_mfma_f32_32x32x16_bf16 v[80:95], v[192:195], v[132:135], 0
    s_mov_b64 exec, 1
    buffer_store_dword v30, off, s[8:11], s62 sc1
    s_mov_b64 exec, -1
    v_mfma_f32_32x32x16_bf16 v[112:127], v[204:207], v[140:143], v[112:127]
    buffer_load_dwordx4 v[136:139], v1, s[8:11], s80 offen offset:1024 sc1
    s_waitcnt vmcnt(7)
    v_bitop3_b32 v7, v151, v159, 1 bitop3:0xa8
    v_cmp_ne_u32 vcc, 0, v7
    v_mfma_f32_32x32x16_bf16 v[80:95], v[200:203], v[140:143], v[80:95]
    s_cbranch_vccnz OOL_429
RET_430:
    v_mfma_f32_32x32x16_bf16 v[112:127], v[212:215], v[148:151], v[112:127]
    buffer_load_dwordx4 v[144:147], v1, s[8:11], s80 offen offset:2048 sc1
    v_mfma_f32_32x32x16_bf16 v[80:95], v[208:211], v[148:151], v[80:95]
    v_mfma_f32_32x32x16_bf16 v[112:127], v[220:223], v[156:159], v[112:127]
    buffer_load_dwordx4 v[152:155], v1, s[8:11], s80 offen offset:3072 sc1
    s_waitcnt vmcnt(5)
    v_bitop3_b32 v7, v167, v175, v183 bitop3:0xfe
    v_bitop3_b32 v7, v7, v191, 1 bitop3:0xa8
    v_cmp_ne_u32 vcc, 0, v7
    v_mfma_f32_32x32x16_bf16 v[80:95], v[216:219], v[156:159], v[80:95]
    s_cbranch_vccnz OOL_432
RET_433:
    v_mfma_f32_32x32x16_bf16 v[112:127], v[228:231], v[164:167], v[112:127]
    s_add_u32 s80, s50, 0x111000
    buffer_load_dwordx4 v[160:163], v1, s[8:11], s80 offen offset:0 sc1
    v_mfma_f32_32x32x16_bf16 v[80:95], v[224:227], v[164:167], v[80:95]
    v_mfma_f32_32x32x16_bf16 v[112:127], v[236:239], v[172:175], v[112:127]
    buffer_load_dwordx4 v[168:171], v1, s[8:11], s80 offen offset:1024 sc1
    v_mfma_f32_32x32x16_bf16 v[80:95], v[232:235], v[172:175], v[80:95]
    v_mfma_f32_32x32x16_bf16 v[112:127], v[244:247], v[180:183], v[112:127]
    buffer_load_dwordx4 v[176:179], v1, s[8:11], s80 offen offset:2048 sc1
    v_mfma_f32_32x32x16_bf16 v[80:95], v[240:243], v[180:183], v[80:95]
    v_mfma_f32_32x32x16_bf16 v[112:127], v[252:255], v[188:191], v[112:127]
    buffer_load_dwordx4 v[184:187], v1, s[8:11], s80 offen offset:3072 sc1
    s_waitcnt vmcnt(4)
    v_bitop3_b32 v7, v131, v139, v147 bitop3:0xfe
    v_bitop3_b32 v7, v7, v155, 1 bitop3:0xa8
    v_cmp_ne_u32 vcc, 0, v7
    v_mfma_f32_32x32x16_bf16 v[80:95], v[248:251], v[188:191], v[80:95]
    s_cbranch_vccnz OOL_435
RET_436:
    buffer_load_dwordx4 v[132:135], v1, s[8:11], s49 offen offset:0 sc1
    buffer_load_dwordx4 v[140:143], v1, s[8:11], s49 offen offset:1024 sc1
    v_mfma_f32_32x32x16_bf16 v[96:111], v[196:199], v[128:131], 0
    buffer_load_dwordx4 v[148:151], v1, s[8:11], s49 offen offset:2048 sc1
    buffer_load_dwordx4 v[156:159], v1, s[8:11], s49 offen offset:3072 sc1
    buffer_load_dword v9, v8, s[8:11], 0 offen offset:0 sc1
    v_mfma_f32_32x32x16_bf16 v[96:111], v[204:207], v[136:139], v[96:111]
    v_xor_b32 v19, 6144, v2
    v_cvt_pk_bf16_f32 v112, v112, v113
    v_cvt_pk_bf16_f32 v113, v114, v115
    v_cvt_pk_bf16_f32 v114, v116, v117
    v_cvt_pk_bf16_f32 v115, v118, v119
    v_cvt_pk_bf16_f32 v116, v120, v121
    v_mfma_f32_32x32x16_bf16 v[96:111], v[212:215], v[144:147], v[96:111]
    ds_write_b128 v19, v[112:115] offset:16384
    v_cvt_pk_bf16_f32 v117, v122, v123
    v_cvt_pk_bf16_f32 v118, v124, v125
    v_cvt_pk_bf16_f32 v119, v126, v127
    v_mfma_f32_32x32x16_bf16 v[64:79], v[192:195], v[128:131], 0
    ds_write_b128 v19, v[116:119] offset:17408
    v_xor_b32 v17, 2048, v2
    v_cvt_pk_bf16_f32 v80, v80, v81
    v_cvt_pk_bf16_f32 v81, v82, v83
    v_mfma_f32_32x32x16_bf16 v[96:111], v[220:223], v[152:155], v[96:111]
    s_waitcnt vmcnt(7)
    v_bitop3_b32 v7, v163, v171, 1 bitop3:0xa8
    v_cmp_ne_u32 vcc, 0, v7
    v_cvt_pk_bf16_f32 v82, v84, v85
    v_cvt_pk_bf16_f32 v83, v86, v87
    v_cvt_pk_bf16_f32 v84, v88, v89
    v_cvt_pk_bf16_f32 v85, v90, v91
    v_mfma_f32_32x32x16_bf16 v[64:79], v[200:203], v[136:139], v[64:79]
    s_cbranch_vccnz OOL_438
RET_439:
    s_add_u32 s89, s56, 0x80000
    buffer_load_dwordx4 v[196:199], v1, s[8:11], s89 offen offset:0 sc1
    v_mfma_f32_32x32x16_bf16 v[96:111], v[228:231], v[160:163], v[96:111]
    buffer_load_dwordx4 v[204:207], v1, s[8:11], s89 offen offset:1024 sc1
    ds_write_b128 v17, v[80:83] offset:0
    v_cvt_pk_bf16_f32 v86, v92, v93
    v_mfma_f32_32x32x16_bf16 v[64:79], v[208:211], v[144:147], v[64:79]
    buffer_load_dwordx4 v[212:215], v1, s[8:11], s89 offen offset:2048 sc1
    v_cvt_pk_bf16_f32 v87, v94, v95
    v_mfma_f32_32x32x16_bf16 v[96:111], v[236:239], v[168:171], v[96:111]
    s_add_u32 s88, s55, 0x80000
    buffer_load_dwordx4 v[192:195], v1, s[8:11], s88 offen offset:0 sc1
    ds_write_b128 v17, v[84:87] offset:1024
    s_waitcnt vmcnt(9)
    v_bitop3_b32 v7, v179, v187, 1 bitop3:0xa8
    v_cmp_ne_u32 vcc, 0, v7
    v_mfma_f32_32x32x16_bf16 v[64:79], v[216:219], v[152:155], v[64:79]
    s_cbranch_vccnz OOL_441
RET_442:
    buffer_load_dwordx4 v[220:223], v1, s[8:11], s89 offen offset:3072 sc1
    v_mfma_f32_32x32x16_bf16 v[96:111], v[244:247], v[176:179], v[96:111]
    buffer_load_dwordx4 v[200:203], v1, s[8:11], s88 offen offset:1024 sc1
    v_mfma_f32_32x32x16_bf16 v[64:79], v[224:227], v[160:163], v[64:79]
    s_add_u32 s89, s56, 0x81000
    buffer_load_dwordx4 v[228:231], v1, s[8:11], s89 offen offset:0 sc1
    v_add_u32 v16, 161792, v1
    s_waitcnt lgkmcnt(0)
    s_barrier
    ds_read_b128 v[120:123], v16 offset:0
    ds_read_b128 v[124:127], v16 offset:1024
    ds_read_b128 v[80:83], v2 offset:0
    ds_read_b128 v[84:87], v2 offset:1024
    ds_read_b128 v[112:115], v2 offset:16384
    ds_read_b128 v[116:119], v2 offset:17408
    v_mfma_f32_32x32x16_bf16 v[96:111], v[252:255], v[184:187], v[96:111]
    buffer_load_dwordx4 v[208:211], v1, s[8:11], s88 offen offset:2048 sc1
    v_mfma_f32_32x32x16_bf16 v[64:79], v[232:235], v[168:171], v[64:79]
    buffer_load_dwordx4 v[236:239], v1, s[8:11], s89 offen offset:1024 sc1
    v_mfma_f32_32x32x16_bf16 v[64:79], v[240:243], v[176:179], v[64:79]
    buffer_load_dwordx4 v[216:219], v1, s[8:11], s88 offen offset:3072 sc1
    v_xor_b32 v18, 4096, v2
    s_nop 5
    v_cvt_pk_bf16_f32 v96, v96, v97
    v_cvt_pk_bf16_f32 v97, v98, v99
    v_cvt_pk_bf16_f32 v98, v100, v101
    v_mfma_f32_32x32x16_bf16 v[64:79], v[248:251], v[184:187], v[64:79]
    buffer_load_dwordx4 v[244:247], v1, s[8:11], s89 offen offset:2048 sc1
    v_cvt_pk_bf16_f32 v99, v102, v103
    v_cvt_pk_bf16_f32 v100, v104, v105
    v_cvt_pk_bf16_f32 v101, v106, v107
    v_cvt_pk_bf16_f32 v102, v108, v109
    v_cvt_pk_bf16_f32 v103, v110, v111
    s_waitcnt lgkmcnt(3)
    v_mfma_f32_32x32x16_bf16 v[64:79], v[120:123], v[80:83], v[64:79]
    s_add_u32 s88, s55, 0x81000
    buffer_load_dwordx4 v[224:227], v1, s[8:11], s88 offen offset:0 sc1
    ds_write_b128 v18, v[96:99] offset:8192
    s_waitcnt lgkmcnt(3)
    v_mfma_f32_32x32x16_bf16 v[64:79], v[124:127], v[84:87], v[64:79]
    buffer_load_dwordx4 v[252:255], v1, s[8:11], s89 offen offset:3072 sc1
    ds_write_b128 v18, v[100:103] offset:9216
    s_waitcnt lgkmcnt(3)
    v_mfma_f32_32x32x16_bf16 v[64:79], v[120:123], v[112:115], v[64:79]
    buffer_load_dwordx4 v[232:235], v1, s[8:11], s88 offen offset:1024 sc1
    s_waitcnt lgkmcnt(0)
    s_barrier
    ds_read_b128 v[96:99], v2 offset:8192
    ds_read_b128 v[100:103], v2 offset:9216
    v_mfma_f32_32x32x16_bf16 v[64:79], v[124:127], v[116:119], v[64:79]
    buffer_load_dwordx4 v[240:243], v1, s[8:11], s88 offen offset:2048 sc1
    buffer_load_dwordx4 v[248:251], v1, s[8:11], s88 offen offset:3072 sc1
    s_waitcnt vmcnt(17)
    v_bitop3_b32 v7, v132, v133, v134 bitop3:0x80
    v_bitop3_b32 v7, v7, v135, v140 bitop3:0x80
    v_bitop3_b32 v7, v7, v141, v142 bitop3:0x80
    v_bitop3_b32 v7, v7, v143, v148 bitop3:0x80
    v_bitop3_b32 v7, v7, v149, v150 bitop3:0x80
    v_bitop3_b32 v7, v7, v151, v156 bitop3:0x80
    v_bitop3_b32 v7, v7, v157, v158 bitop3:0x80
    v_bitop3_b32 v7, v7, v159, 1 bitop3:0x2a
    v_cmp_ne_u32 vcc, 0, v7
    s_cbranch_vccnz OOL_444
RET_445:
    v_pk_add_f32 v[132:133], v[132:133], v[148:149]
    v_pk_add_f32 v[134:135], v[134:135], v[150:151]
    v_pk_add_f32 v[140:141], v[140:141], v[156:157]
    v_pk_add_f32 v[142:143], v[142:143], v[158:159]
    v_pk_add_f32 v[132:133], v[132:133], v[140:141]
    v_pk_add_f32 v[134:135], v[134:135], v[142:143]
    v_pk_add_f32 v[132:133], v[132:133], v[134:135]
    v_add_f32 v132, v132, v133
    v_mov_b32 v133, v132
    s_nop 1
    v_permlane32_swap_b32 v132, v133
    v_mul_f32 v132, 0xbb000000, v132
    v_mul_f32 v133, 0x3b000000, v133
    v_fma_f32 v133, -v132, v132, v133
    v_max_f32 v133, 0, v133
    v_cvt_pk_bf16_f32 v134, v132, v132
    v_and_b32 v134, 0xffff0000, v134
    v_sub_f32 v135, v132, v134
    v_cvt_pk_bf16_f32 v12, v134, v135
    v_mov_b32 v13, v12
    s_nop 1
    v_mfma_f32_32x32x8_bf16 v[64:79], v[10:11], v[12:13], v[64:79]
    s_waitcnt vmcnt(16)
    v_subrev_u32 v9, s69, v9
    v_subrev_u32 v9, 3, v9
    v_cmp_lt_u32 vcc, 7, v9
    v_add_f32 v134, 0x3727c5ac, v133
    v_mov_b32 v140, 0x2edbe6ff
    v_rsq_f32 v56, v134
    v_fmac_f32 v140, 0x3f800054, v133
    v_mul_f32 v57, v132, v56
    v_rsq_f32 v141, v140
    s_nop 0
    v_mul_f32 v60, v140, v141
    v_mul_f32 v59, 0xc0135761, v141
    v_mul_f32 v58, v141, v141
    v_mul_f32 v141, 0xbdd2d3e8, v141
    v_mul_f32 v58, v58, v141
    v_mov_b32 v61, v60
    s_cbranch_vccnz OOL_447
RET_448:
    s_waitcnt lgkmcnt(1)
    v_dot2c_f32_bf16 v64, s65, v96
    v_dot2c_f32_bf16 v65, s66, v96
    v_dot2c_f32_bf16 v66, s65, v97
    v_dot2c_f32_bf16 v67, s66, v97
    v_dot2c_f32_bf16 v68, s65, v98
    v_dot2c_f32_bf16 v69, s66, v98
    v_dot2c_f32_bf16 v70, s65, v99
    v_dot2c_f32_bf16 v71, s66, v99
    s_waitcnt lgkmcnt(0)
    v_dot2c_f32_bf16 v72, s65, v100
    v_dot2c_f32_bf16 v73, s66, v100
    v_dot2c_f32_bf16 v74, s65, v101
    v_dot2c_f32_bf16 v75, s66, v101
    v_dot2c_f32_bf16 v76, s65, v102
    v_dot2c_f32_bf16 v77, s66, v102
    v_dot2c_f32_bf16 v78, s65, v103
    v_dot2c_f32_bf16 v79, s66, v103
    v_pk_mul_f32 v[80:81], v[64:65], v[64:65]
    v_pk_mul_f32 v[82:83], v[66:67], v[66:67]
    v_pk_mul_f32 v[84:85], v[68:69], v[68:69]
    v_pk_mul_f32 v[86:87], v[70:71], v[70:71]
    v_pk_fma_f32 v[80:81], v[80:81], v[58:59], v[58:59] op_sel:[0,0,1] op_sel_hi:[1,0,1]
    v_pk_fma_f32 v[82:83], v[82:83], v[58:59], v[58:59] op_sel:[0,0,1] op_sel_hi:[1,0,1]
    v_pk_fma_f32 v[84:85], v[84:85], v[58:59], v[58:59] op_sel:[0,0,1] op_sel_hi:[1,0,1]
    v_pk_fma_f32 v[86:87], v[86:87], v[58:59], v[58:59] op_sel:[0,0,1] op_sel_hi:[1,0,1]
    v_pk_mul_f32 v[80:81], v[80:81], v[64:65]
    v_pk_mul_f32 v[82:83], v[82:83], v[66:67]
    v_pk_mul_f32 v[84:85], v[84:85], v[68:69]
    v_pk_mul_f32 v[86:87], v[86:87], v[70:71]
    v_exp_f32 v80, v80
    v_exp_f32 v81, v81
    v_exp_f32 v82, v82
    v_exp_f32 v83, v83
    v_exp_f32 v84, v84
    v_exp_f32 v85, v85
    v_exp_f32 v86, v86
    v_exp_f32 v87, v87
    v_pk_fma_f32 v[80:81], v[80:81], v[60:61], v[60:61]
    v_pk_fma_f32 v[82:83], v[82:83], v[60:61], v[60:61]
    v_pk_fma_f32 v[84:85], v[84:85], v[60:61], v[60:61]
    v_pk_fma_f32 v[86:87], v[86:87], v[60:61], v[60:61]
    v_rcp_f32 v80, v80
    v_rcp_f32 v81, v81
    v_rcp_f32 v82, v82
    v_rcp_f32 v83, v83
    v_rcp_f32 v84, v84
    v_rcp_f32 v85, v85
    v_rcp_f32 v86, v86
    v_rcp_f32 v87, v87
    v_pk_mul_f32 v[64:65], v[64:65], v[80:81]
    v_pk_mul_f32 v[66:67], v[66:67], v[82:83]
    v_pk_mul_f32 v[68:69], v[68:69], v[84:85]
    v_pk_mul_f32 v[70:71], v[70:71], v[86:87]
    v_pk_mul_f32 v[80:81], v[72:73], v[72:73]
    v_pk_mul_f32 v[82:83], v[74:75], v[74:75]
    v_pk_mul_f32 v[84:85], v[76:77], v[76:77]
    v_pk_mul_f32 v[86:87], v[78:79], v[78:79]
    v_pk_fma_f32 v[80:81], v[80:81], v[58:59], v[58:59] op_sel:[0,0,1] op_sel_hi:[1,0,1]
    v_pk_fma_f32 v[82:83], v[82:83], v[58:59], v[58:59] op_sel:[0,0,1] op_sel_hi:[1,0,1]
    v_pk_fma_f32 v[84:85], v[84:85], v[58:59], v[58:59] op_sel:[0,0,1] op_sel_hi:[1,0,1]
    v_pk_fma_f32 v[86:87], v[86:87], v[58:59], v[58:59] op_sel:[0,0,1] op_sel_hi:[1,0,1]
    v_pk_mul_f32 v[80:81], v[80:81], v[72:73]
    v_pk_mul_f32 v[82:83], v[82:83], v[74:75]
    v_pk_mul_f32 v[84:85], v[84:85], v[76:77]
    v_pk_mul_f32 v[86:87], v[86:87], v[78:79]
    v_exp_f32 v80, v80
    v_exp_f32 v81, v81
    v_exp_f32 v82, v82
    v_exp_f32 v83, v83
    v_exp_f32 v84, v84
    v_exp_f32 v85, v85
    v_exp_f32 v86, v86
    v_exp_f32 v87, v87
    v_pk_fma_f32 v[80:81], v[80:81], v[60:61], v[60:61]
    v_pk_fma_f32 v[82:83], v[82:83], v[60:61], v[60:61]
    v_pk_fma_f32 v[84:85], v[84:85], v[60:61], v[60:61]
    v_pk_fma_f32 v[86:87], v[86:87], v[60:61], v[60:61]
    v_rcp_f32 v80, v80
    v_rcp_f32 v81, v81
    v_rcp_f32 v82, v82
    v_rcp_f32 v83, v83
    v_rcp_f32 v84, v84
    v_rcp_f32 v85, v85
    v_rcp_f32 v86, v86
    v_rcp_f32 v87, v87
    v_pk_mul_f32 v[72:73], v[72:73], v[80:81]
    v_pk_mul_f32 v[74:75], v[74:75], v[82:83]
    v_pk_mul_f32 v[76:77], v[76:77], v[84:85]
    v_pk_mul_f32 v[78:79], v[78:79], v[86:87]
    v_cvt_pk_bf16_f32 v112, v64, v65
    v_cvt_pk_bf16_f32 v113, v66, v67
    v_cvt_pk_bf16_f32 v114, v68, v69
    v_cvt_pk_bf16_f32 v115, v70, v71
    v_cvt_pk_bf16_f32 v116, v72, v73
    v_cvt_pk_bf16_f32 v117, v74, v75
    v_cvt_pk_bf16_f32 v118, v76, v77
    v_cvt_pk_bf16_f32 v119, v78, v79
    v_or_b32 v115, 1, v115
    v_or_b32 v119, 1, v119
    buffer_store_dwordx4 v[112:115], v3, s[8:11], s54 offen offset:0 sc1
    buffer_store_dwordx4 v[116:119], v3, s[8:11], s54 offen offset:1024 sc1
    buffer_store_dwordx4 v[112:115], v4, s[8:11], s68 offen offset:128 sc1
    buffer_store_dwordx4 v[116:119], v4, s[8:11], s68 offen offset:1152 sc1
    s_cmp_eq_u32 s64, 2
    s_cbranch_scc1 OOL_450
RET_451:
    v_pk_fma_f32 v[64:65], v[32:33], v[56:57], v[56:57] op_sel:[0,0,1] op_sel_hi:[1,0,1]
    v_pk_fma_f32 v[66:67], v[34:35], v[56:57], v[56:57] op_sel:[0,0,1] op_sel_hi:[1,0,1]
    v_pk_fma_f32 v[68:69], v[36:37], v[56:57], v[56:57] op_sel:[0,0,1] op_sel_hi:[1,0,1]
    v_pk_fma_f32 v[70:71], v[38:39], v[56:57], v[56:57] op_sel:[0,0,1] op_sel_hi:[1,0,1]
    v_pk_fma_f32 v[72:73], v[40:41], v[56:57], v[56:57] op_sel:[0,0,1] op_sel_hi:[1,0,1]
    v_pk_fma_f32 v[74:75], v[42:43], v[56:57], v[56:57] op_sel:[0,0,1] op_sel_hi:[1,0,1]
    v_pk_fma_f32 v[76:77], v[44:45], v[56:57], v[56:57] op_sel:[0,0,1] op_sel_hi:[1,0,1]
    v_pk_fma_f32 v[78:79], v[46:47], v[56:57], v[56:57] op_sel:[0,0,1] op_sel_hi:[1,0,1]
    s_add_u32 s79, s51, 0x8000
    buffer_load_dwordx4 v[132:135], v1, s[8:11], s79 offen offset:0 sc1
    buffer_load_dwordx4 v[140:143], v1, s[8:11], s79 offen offset:1024 sc1
    buffer_load_dwordx4 v[148:151], v1, s[8:11], s79 offen offset:2048 sc1
    buffer_load_dwordx4 v[156:159], v1, s[8:11], s79 offen offset:3072 sc1
    s_add_u32 s79, s51, 0x9000
    buffer_load_dwordx4 v[164:167], v1, s[8:11], s79 offen offset:0 sc1
    buffer_load_dwordx4 v[172:175], v1, s[8:11], s79 offen offset:1024 sc1
    buffer_load_dwordx4 v[180:183], v1, s[8:11], s79 offen offset:2048 sc1
    buffer_load_dwordx4 v[188:191], v1, s[8:11], s79 offen offset:3072 sc1
    s_waitcnt vmcnt(6)
    v_bitop3_b32 v7, v135, v143, 1 bitop3:0x2a
    v_cmp_ne_u32 vcc, 0, v7
    s_cbranch_vccnz OOL_453
RET_454:
    v_mfma_f32_32x32x16_bf16 v[112:127], v[196:199], v[132:135], 0
    s_add_u32 s80, s50, 0x8000
    buffer_load_dwordx4 v[128:131], v5, s[8:11], s80 offen offset:0 sc1
    v_mfma_f32_32x32x16_bf16 v[80:95], v[192:195], v[132:135], 0
    v_mfma_f32_32x32x16_bf16 v[112:127], v[204:207], v[140:143], v[112:127]
    buffer_load_dwordx4 v[136:139], v5, s[8:11], s80 offen offset:1024 sc1
    s_waitcnt vmcnt(6)
    v_bitop3_b32 v7, v151, v159, 1 bitop3:0x2a
    v_cmp_ne_u32 vcc, 0, v7
    v_mfma_f32_32x32x16_bf16 v[80:95], v[200:203], v[140:143], v[80:95]
    s_cbranch_vccnz OOL_456
RET_457:
    v_mfma_f32_32x32x16_bf16 v[112:127], v[212:215], v[148:151], v[112:127]
    buffer_load_dwordx4 v[144:147], v5, s[8:11], s80 offen offset:2048 sc1
    v_mfma_f32_32x32x16_bf16 v[80:95], v[208:211], v[148:151], v[80:95]
    v_mfma_f32_32x32x16_bf16 v[112:127], v[220:223], v[156:159], v[112:127]
    buffer_load_dwordx4 v[152:155], v5, s[8:11], s80 offen offset:3072 sc1
    s_waitcnt vmcnt(6)
    v_bitop3_b32 v7, v167, v175, 1 bitop3:0x2a
    v_cmp_ne_u32 vcc, 0, v7
    v_mfma_f32_32x32x16_bf16 v[80:95], v[216:219], v[156:159], v[80:95]
    s_cbranch_vccnz OOL_459
RET_460:
    v_mfma_f32_32x32x16_bf16 v[112:127], v[228:231], v[164:167], v[112:127]
    s_add_u32 s80, s50, 0x9000
    buffer_load_dwordx4 v[160:163], v5, s[8:11], s80 offen offset:0 sc1
    v_mfma_f32_32x32x16_bf16 v[80:95], v[224:227], v[164:167], v[80:95]
    v_mfma_f32_32x32x16_bf16 v[112:127], v[236:239], v[172:175], v[112:127]
    buffer_load_dwordx4 v[168:171], v5, s[8:11], s80 offen offset:1024 sc1
    s_waitcnt vmcnt(6)
    v_bitop3_b32 v7, v183, v191, 1 bitop3:0x2a
    v_cmp_ne_u32 vcc, 0, v7
    v_mfma_f32_32x32x16_bf16 v[80:95], v[232:235], v[172:175], v[80:95]
    s_cbranch_vccnz OOL_462
RET_463:
    v_mfma_f32_32x32x16_bf16 v[112:127], v[244:247], v[180:183], v[112:127]
    buffer_load_dwordx4 v[176:179], v5, s[8:11], s80 offen offset:2048 sc1
    v_mfma_f32_32x32x16_bf16 v[80:95], v[240:243], v[180:183], v[80:95]
    v_mfma_f32_32x32x16_bf16 v[112:127], v[252:255], v[188:191], v[112:127]
    buffer_load_dwordx4 v[184:187], v5, s[8:11], s80 offen offset:3072 sc1
    s_waitcnt vmcnt(4)
    v_bitop3_b32 v7, v131, v139, v147 bitop3:0x80
    v_bitop3_b32 v7, v7, v155, 1 bitop3:0x2a
    v_cmp_ne_u32 vcc, 0, v7
    v_mfma_f32_32x32x16_bf16 v[80:95], v[248:251], v[188:191], v[80:95]
    s_cbranch_vccnz OOL_465
RET_466:
    v_mfma_f32_32x32x16_bf16 v[96:111], v[196:199], v[128:131], 0
    v_mfma_f32_32x32x16_bf16 v[96:111], v[204:207], v[136:139], v[96:111]
    v_xor_b32 v19, 6144, v2
    s_nop 1
    v_cvt_pk_bf16_f32 v112, v112, v113
    v_cvt_pk_bf16_f32 v113, v114, v115
    v_cvt_pk_bf16_f32 v114, v116, v117
    v_cvt_pk_bf16_f32 v115, v118, v119
    v_mfma_f32_32x32x16_bf16 v[96:111], v[212:215], v[144:147], v[96:111]
    ds_write_b128 v19, v[112:115] offset:16384
    v_cvt_pk_bf16_f32 v116, v120, v121
    v_cvt_pk_bf16_f32 v117, v122, v123
    v_cvt_pk_bf16_f32 v118, v124, v125
    v_mfma_f32_32x32x16_bf16 v[96:111], v[220:223], v[152:155], v[96:111]
    s_waitcnt vmcnt(2)
    v_bitop3_b32 v7, v163, v171, 1 bitop3:0x2a
    v_cmp_ne_u32 vcc, 0, v7
    v_cvt_pk_bf16_f32 v119, v126, v127
    v_xor_b32 v17, 2048, v2
    v_cvt_pk_bf16_f32 v80, v80, v81
    v_cvt_pk_bf16_f32 v81, v82, v83
    v_mfma_f32_32x32x16_bf16 v[64:79], v[192:195], v[128:131], v[64:79]
    s_cbranch_vccnz OOL_468
RET_469:
    v_cvt_pk_bf16_f32 v82, v84, v85
    v_cvt_pk_bf16_f32 v83, v86, v87
    v_cvt_pk_bf16_f32 v84, v88, v89
    v_mfma_f32_32x32x16_bf16 v[96:111], v[228:231], v[160:163], v[96:111]
    ds_write_b128 v19, v[116:119] offset:17408
    v_cvt_pk_bf16_f32 v85, v90, v91
    v_cvt_pk_bf16_f32 v86, v92, v93
    v_cvt_pk_bf16_f32 v87, v94, v95
    v_mfma_f32_32x32x16_bf16 v[64:79], v[200:203], v[136:139], v[64:79]
    ds_write_b128 v17, v[80:83] offset:0
    v_mfma_f32_32x32x16_bf16 v[96:111], v[236:239], v[168:171], v[96:111]
    ds_write_b128 v17, v[84:87] offset:1024
    s_waitcnt vmcnt(0)
    v_bitop3_b32 v7, v179, v187, 1 bitop3:0x2a
    v_cmp_ne_u32 vcc, 0, v7
    v_mfma_f32_32x32x16_bf16 v[64:79], v[208:211], v[144:147], v[64:79]
    s_cbranch_vccnz OOL_471
RET_472:
    v_mfma_f32_32x32x16_bf16 v[96:111], v[244:247], v[176:179], v[96:111]
    v_mfma_f32_32x32x16_bf16 v[64:79], v[216:219], v[152:155], v[64:79]
    v_add_u32 v16, 161792, v1
    s_waitcnt lgkmcnt(0)
    s_barrier
    ds_read_b128 v[120:123], v16 offset:0
    ds_read_b128 v[124:127], v16 offset:1024
    ds_read_b128 v[80:83], v2 offset:0
    ds_read_b128 v[84:87], v2 offset:1024
    ds_read_b128 v[112:115], v2 offset:16384
    ds_read_b128 v[116:119], v2 offset:17408
    v_mfma_f32_32x32x16_bf16 v[96:111], v[252:255], v[184:187], v[96:111]
    v_mfma_f32_32x32x16_bf16 v[64:79], v[224:227], v[160:163], v[64:79]
    v_mfma_f32_32x32x16_bf16 v[64:79], v[232:235], v[168:171], v[64:79]
    v_xor_b32 v18, 4096, v2
    s_nop 8
    v_cvt_pk_bf16_f32 v96, v96, v97
    v_cvt_pk_bf16_f32 v97, v98, v99
    v_cvt_pk_bf16_f32 v98, v100, v101
    v_cvt_pk_bf16_f32 v99, v102, v103
    v_mfma_f32_32x32x16_bf16 v[64:79], v[240:243], v[176:179], v[64:79]
    ds_write_b128 v18, v[96:99] offset:8192
    v_cvt_pk_bf16_f32 v100, v104, v105
    v_cvt_pk_bf16_f32 v101, v106, v107
    v_cvt_pk_bf16_f32 v102, v108, v109
    v_mfma_f32_32x32x16_bf16 v[64:79], v[248:251], v[184:187], v[64:79]
    v_cvt_pk_bf16_f32 v103, v110, v111
    s_waitcnt lgkmcnt(4)
    v_mfma_f32_32x32x16_bf16 v[64:79], v[120:123], v[80:83], v[64:79]
    ds_write_b128 v18, v[100:103] offset:9216
    s_waitcnt lgkmcnt(4)
    v_mfma_f32_32x32x16_bf16 v[64:79], v[124:127], v[84:87], v[64:79]
    s_waitcnt lgkmcnt(0)
    s_barrier
    ds_read_b128 v[96:99], v2 offset:8192
    ds_read_b128 v[100:103], v2 offset:9216
    v_mfma_f32_32x32x16_bf16 v[64:79], v[120:123], v[112:115], v[64:79]
    v_mfma_f32_32x32x16_bf16 v[64:79], v[124:127], v[116:119], v[64:79]
    s_waitcnt lgkmcnt(1)
    s_nop 10
    v_dot2c_f32_bf16 v64, s65, v96
    v_dot2c_f32_bf16 v65, s66, v96
    v_dot2c_f32_bf16 v66, s65, v97
    v_dot2c_f32_bf16 v67, s66, v97
    v_dot2c_f32_bf16 v68, s65, v98
    v_dot2c_f32_bf16 v69, s66, v98
    v_dot2c_f32_bf16 v70, s65, v99
    v_dot2c_f32_bf16 v71, s66, v99
    s_waitcnt lgkmcnt(0)
    v_dot2c_f32_bf16 v72, s65, v100
    v_dot2c_f32_bf16 v73, s66, v100
    v_dot2c_f32_bf16 v74, s65, v101
    v_dot2c_f32_bf16 v75, s66, v101
    v_dot2c_f32_bf16 v76, s65, v102
    v_dot2c_f32_bf16 v77, s66, v102
    v_dot2c_f32_bf16 v78, s65, v103
    v_dot2c_f32_bf16 v79, s66, v103
    v_cvt_pk_bf16_f32 v112, v64, v65
    v_cvt_pk_bf16_f32 v113, v66, v67
    v_cvt_pk_bf16_f32 v114, v68, v69
    v_cvt_pk_bf16_f32 v115, v70, v71
    v_cvt_pk_bf16_f32 v116, v72, v73
    v_cvt_pk_bf16_f32 v117, v74, v75
    v_cvt_pk_bf16_f32 v118, v76, v77
    v_cvt_pk_bf16_f32 v119, v78, v79
    v_or_b32 v115, 1, v115
    v_or_b32 v119, 1, v119
    buffer_store_dwordx4 v[112:115], v1, s[8:11], s47 offen offset:0 sc1
    buffer_store_dwordx4 v[116:119], v1, s[8:11], s47 offen offset:1024 sc1
    v_pk_add_f32 v[120:121], v[64:65], v[66:67]
    v_pk_mul_f32 v[122:123], v[64:65], v[64:65]
    v_pk_fma_f32 v[122:123], v[66:67], v[66:67], v[122:123]
    v_pk_add_f32 v[120:121], v[120:121], v[68:69]
    v_pk_fma_f32 v[122:123], v[68:69], v[68:69], v[122:123]
    v_pk_add_f32 v[120:121], v[120:121], v[70:71]
    v_pk_fma_f32 v[122:123], v[70:71], v[70:71], v[122:123]
    v_pk_add_f32 v[120:121], v[120:121], v[72:73]
    v_pk_fma_f32 v[122:123], v[72:73], v[72:73], v[122:123]
    v_pk_add_f32 v[120:121], v[120:121], v[74:75]
    v_pk_fma_f32 v[122:123], v[74:75], v[74:75], v[122:123]
    v_pk_add_f32 v[120:121], v[120:121], v[76:77]
    v_pk_fma_f32 v[122:123], v[76:77], v[76:77], v[122:123]
    v_pk_add_f32 v[120:121], v[120:121], v[78:79]
    v_pk_fma_f32 v[122:123], v[78:79], v[78:79], v[122:123]
    v_add_f32 v120, v120, v121
    v_add_f32 v122, v122, v123
    s_nop 1
    v_permlane32_swap_b32 v120, v122
    v_add_f32 v120, v120, v122
    v_and_b32 v120, -2, v120
    buffer_store_dword v120, v1, s[8:11], s48 offen sc1
    v_pk_add_f32 v[32:33], v[32:33], v[64:65]
    v_pk_add_f32 v[34:35], v[34:35], v[66:67]
    v_pk_add_f32 v[36:37], v[36:37], v[68:69]
    v_pk_add_f32 v[38:39], v[38:39], v[70:71]
    v_pk_add_f32 v[40:41], v[40:41], v[72:73]
    v_pk_add_f32 v[42:43], v[42:43], v[74:75]
    v_pk_add_f32 v[44:45], v[44:45], v[76:77]
    v_pk_add_f32 v[46:47], v[46:47], v[78:79]
    v_add_u32 v29, 65536, v15
    buffer_load_dwordx4 v[128:131], v1, s[8:11], s59 offen offset:0 sc1
    buffer_load_dwordx4 v[132:135], v1, s[8:11], s59 offen offset:1024 sc1
    buffer_load_dwordx4 v[136:139], v1, s[8:11], s59 offen offset:2048 sc1
    buffer_load_dwordx4 v[140:143], v1, s[8:11], s59 offen offset:3072 sc1
    s_add_u32 s79, s59, 0x1000
    buffer_load_dwordx4 v[144:147], v1, s[8:11], s79 offen offset:0 sc1
    buffer_load_dwordx4 v[148:151], v1, s[8:11], s79 offen offset:1024 sc1
    buffer_load_dwordx4 v[152:155], v1, s[8:11], s79 offen offset:2048 sc1
    buffer_load_dwordx4 v[156:159], v1, s[8:11], s79 offen offset:3072 sc1
    s_add_u32 s79, s59, 0x2000
    buffer_load_dwordx4 v[160:163], v1, s[8:11], s79 offen offset:0 sc1
    buffer_load_dwordx4 v[164:167], v1, s[8:11], s79 offen offset:1024 sc1
    buffer_load_dwordx4 v[168:171], v1, s[8:11], s79 offen offset:2048 sc1
    buffer_load_dwordx4 v[172:175], v1, s[8:11], s79 offen offset:3072 sc1
    ds_read_b64_tr_b16 a[232:233], v15 offset:0
    ds_read_b64_tr_b16 a[234:235], v15 offset:1024
    ds_read_b64_tr_b16 a[236:237], v15 offset:512
    ds_read_b64_tr_b16 a[238:239], v15 offset:1536
    ds_read_b64_tr_b16 a[240:241], v15 offset:2048
    ds_read_b64_tr_b16 a[242:243], v15 offset:3072
    ds_read_b64_tr_b16 a[244:245], v15 offset:2560
    ds_read_b64_tr_b16 a[246:247], v15 offset:3584
    ds_read_b64_tr_b16 a[248:249], v15 offset:4096
    ds_read_b64_tr_b16 a[250:251], v15 offset:5120
    s_add_u32 s77, s59, 0xfff0c000
    v_and_b32 v52, 4, v0
    v_lshl_add_u32 v52, v52, 8, v1
    s_waitcnt vmcnt(10)
    v_bitop3_b32 v7, v131, v135, 1 bitop3:0x2a
    v_cmp_ne_u32 vcc, 0, v7
    s_cbranch_vccnz OOL_474
RET_475:
    s_waitcnt lgkmcnt(8)
    v_mfma_f32_32x32x16_bf16 v[64:79], a[232:235], v[128:131], 0
    s_waitcnt lgkmcnt(4)
    ds_read_b64_tr_b16 a[252:253], v15 offset:4608
    ds_read_b64_tr_b16 a[254:255], v15 offset:5632
    s_add_u32 s79, s59, 0x3000
    buffer_load_dwordx4 v[176:179], v1, s[8:11], s79 offen offset:0 sc1
    v_mfma_f32_32x32x16_bf16 v[80:95], a[236:239], v[128:131], 0
    ds_read_b64_tr_b16 a[232:233], v15 offset:6144
    ds_read_b64_tr_b16 a[234:235], v15 offset:7168
    v_mfma_f32_32x32x16_bf16 v[64:79], a[240:243], v[132:135], v[64:79]
    s_waitcnt lgkmcnt(4)
    ds_read_b64_tr_b16 a[236:237], v15 offset:6656
    ds_read_b64_tr_b16 a[238:239], v15 offset:7680
    buffer_load_dwordx4 v[180:183], v1, s[8:11], s79 offen offset:1024 sc1
    s_waitcnt vmcnt(10)
    v_bitop3_b32 v7, v139, v143, 1 bitop3:0x2a
    v_cmp_ne_u32 vcc, 0, v7
    v_mfma_f32_32x32x16_bf16 v[80:95], a[244:247], v[132:135], v[80:95]
    s_cbranch_vccnz OOL_477
RET_478:
    ds_read_b64_tr_b16 a[240:241], v15 offset:8192
    ds_read_b64_tr_b16 a[242:243], v15 offset:9216
    v_mfma_f32_32x32x16_bf16 v[64:79], a[248:251], v[136:139], v[64:79]
    s_waitcnt lgkmcnt(4)
    ds_read_b64_tr_b16 a[244:245], v15 offset:8704
    ds_read_b64_tr_b16 a[246:247], v15 offset:9728
    buffer_load_dwordx4 v[184:187], v1, s[8:11], s79 offen offset:2048 sc1
    v_mfma_f32_32x32x16_bf16 v[80:95], a[252:255], v[136:139], v[80:95]
    ds_read_b64_tr_b16 a[248:249], v15 offset:10240
    ds_read_b64_tr_b16 a[250:251], v15 offset:11264
    v_mfma_f32_32x32x16_bf16 v[64:79], a[232:235], v[140:143], v[64:79]
    s_waitcnt lgkmcnt(4)
    ds_read_b64_tr_b16 a[252:253], v15 offset:10752
    ds_read_b64_tr_b16 a[254:255], v15 offset:11776
    buffer_load_dwordx4 v[188:191], v1, s[8:11], s79 offen offset:3072 sc1
    s_waitcnt vmcnt(8)
    v_bitop3_b32 v7, v147, v151, v155 bitop3:0x80
    v_bitop3_b32 v7, v7, v159, 1 bitop3:0x2a
    v_cmp_ne_u32 vcc, 0, v7
    v_mfma_f32_32x32x16_bf16 v[80:95], a[236:239], v[140:143], v[80:95]
    s_cbranch_vccnz OOL_480
RET_481:
    ds_read_b64_tr_b16 a[232:233], v15 offset:12288
    ds_read_b64_tr_b16 a[234:235], v15 offset:13312
    v_mfma_f32_32x32x16_bf16 v[64:79], a[240:243], v[144:147], v[64:79]
    s_waitcnt lgkmcnt(4)
    ds_read_b64_tr_b16 a[236:237], v15 offset:12800
    ds_read_b64_tr_b16 a[238:239], v15 offset:13824
    s_add_u32 s79, s59, 0x4000
    buffer_load_dwordx4 v[192:195], v1, s[8:11], s79 offen offset:0 sc1
    v_mfma_f32_32x32x16_bf16 v[80:95], a[244:247], v[144:147], v[80:95]
    ds_read_b64_tr_b16 a[240:241], v15 offset:14336
    ds_read_b64_tr_b16 a[242:243], v15 offset:15360
    v_mfma_f32_32x32x16_bf16 v[64:79], a[248:251], v[148:151], v[64:79]
    s_waitcnt lgkmcnt(4)
    ds_read_b64_tr_b16 a[244:245], v15 offset:14848
    ds_read_b64_tr_b16 a[246:247], v15 offset:15872
    buffer_load_dwordx4 v[196:199], v1, s[8:11], s79 offen offset:1024 sc1
    v_mfma_f32_32x32x16_bf16 v[80:95], a[252:255], v[148:151], v[80:95]
    ds_read_b64_tr_b16 a[248:249], v15 offset:16384
    ds_read_b64_tr_b16 a[250:251], v15 offset:17408
    v_mfma_f32_32x32x16_bf16 v[64:79], a[232:235], v[152:155], v[64:79]
    s_waitcnt lgkmcnt(4)
    ds_read_b64_tr_b16 a[252:253], v15 offset:16896
    ds_read_b64_tr_b16 a[254:255], v15 offset:17920
    buffer_load_dwordx4 v[200:203], v1, s[8:11], s79 offen offset:2048 sc1
    v_mfma_f32_32x32x16_bf16 v[80:95], a[236:239], v[152:155], v[80:95]
    ds_read_b64_tr_b16 a[232:233], v15 offset:18432
    ds_read_b64_tr_b16 a[234:235], v15 offset:19456
    v_mfma_f32_32x32x16_bf16 v[64:79], a[240:243], v[156:159], v[64:79]
    s_waitcnt lgkmcnt(4)
    ds_read_b64_tr_b16 a[236:237], v15 offset:18944
    ds_read_b64_tr_b16 a[238:239], v15 offset:19968
    buffer_load_dwordx4 v[204:207], v1, s[8:11], s79 offen offset:3072 sc1
    s_waitcnt vmcnt(8)
    v_bitop3_b32 v7, v163, v167, v171 bitop3:0x80
    v_bitop3_b32 v7, v7, v175, 1 bitop3:0x2a
    v_cmp_ne_u32 vcc, 0, v7
    v_mfma_f32_32x32x16_bf16 v[80:95], a[244:247], v[156:159], v[80:95]
    s_cbranch_vccnz OOL_483
RET_484:
    ds_read_b64_tr_b16 a[240:241], v15 offset:20480
    ds_read_b64_tr_b16 a[242:243], v15 offset:21504
    v_mfma_f32_32x32x16_bf16 v[64:79], a[248:251], v[160:163], v[64:79]
    s_waitcnt lgkmcnt(4)
    ds_read_b64_tr_b16 a[244:245], v15 offset:20992
    ds_read_b64_tr_b16 a[246:247], v15 offset:22016
    s_add_u32 s79, s59, 0x5000
    buffer_load_dwordx4 v[208:211], v1, s[8:11], s79 offen offset:0 sc1
    v_mfma_f32_32x32x16_bf16 v[80:95], a[252:255], v[160:163], v[80:95]
    ds_read_b64_tr_b16 a[248:249], v15 offset:22528
    ds_read_b64_tr_b16 a[250:251], v15 offset:23552
    v_mfma_f32_32x32x16_bf16 v[64:79], a[232:235], v[164:167], v[64:79]
    s_waitcnt lgkmcnt(4)
    ds_read_b64_tr_b16 a[252:253], v15 offset:23040
    ds_read_b64_tr_b16 a[254:255], v15 offset:24064
    buffer_load_dwordx4 v[212:215], v1, s[8:11], s79 offen offset:1024 sc1
    v_mfma_f32_32x32x16_bf16 v[80:95], a[236:239], v[164:167], v[80:95]
    ds_read_b64_tr_b16 a[232:233], v15 offset:24576
    ds_read_b64_tr_b16 a[234:235], v15 offset:25600
    v_mfma_f32_32x32x16_bf16 v[64:79], a[240:243], v[168:171], v[64:79]
    s_waitcnt lgkmcnt(4)
    ds_read_b64_tr_b16 a[236:237], v15 offset:25088
    ds_read_b64_tr_b16 a[238:239], v15 offset:26112
    buffer_load_dwordx4 v[216:219], v1, s[8:11], s79 offen offset:2048 sc1
    v_mfma_f32_32x32x16_bf16 v[80:95], a[244:247], v[168:171], v[80:95]
    ds_read_b64_tr_b16 a[240:241], v15 offset:26624
    ds_read_b64_tr_b16 a[242:243], v15 offset:27648
    v_mfma_f32_32x32x16_bf16 v[64:79], a[248:251], v[172:175], v[64:79]
    s_waitcnt lgkmcnt(4)
    ds_read_b64_tr_b16 a[244:245], v15 offset:27136
    ds_read_b64_tr_b16 a[246:247], v15 offset:28160
    buffer_load_dwordx4 v[220:223], v1, s[8:11], s79 offen offset:3072 sc1
    s_waitcnt vmcnt(8)
    v_bitop3_b32 v7, v179, v183, v187 bitop3:0x80
    v_bitop3_b32 v7, v7, v191, 1 bitop3:0x2a
    v_cmp_ne_u32 vcc, 0, v7
    v_mfma_f32_32x32x16_bf16 v[80:95], a[252:255], v[172:175], v[80:95]
    s_cbranch_vccnz OOL_486
RET_487:
    ds_read_b64_tr_b16 a[248:249], v15 offset:28672
    ds_read_b64_tr_b16 a[250:251], v15 offset:29696
    v_mfma_f32_32x32x16_bf16 v[64:79], a[232:235], v[176:179], v[64:79]
    s_waitcnt lgkmcnt(4)
    ds_read_b64_tr_b16 a[252:253], v15 offset:29184
    ds_read_b64_tr_b16 a[254:255], v15 offset:30208
    s_add_u32 s79, s59, 0x6000
    buffer_load_dwordx4 v[224:227], v1, s[8:11], s79 offen offset:0 sc1
    v_mfma_f32_32x32x16_bf16 v[80:95], a[236:239], v[176:179], v[80:95]
    ds_read_b64_tr_b16 a[232:233], v15 offset:30720
    ds_read_b64_tr_b16 a[234:235], v15 offset:31744
    v_mfma_f32_32x32x16_bf16 v[64:79], a[240:243], v[180:183], v[64:79]
    s_waitcnt lgkmcnt(4)
    ds_read_b64_tr_b16 a[236:237], v15 offset:31232
    ds_read_b64_tr_b16 a[238:239], v15 offset:32256
    buffer_load_dwordx4 v[228:231], v1, s[8:11], s79 offen offset:1024 sc1
    v_mfma_f32_32x32x16_bf16 v[80:95], a[244:247], v[180:183], v[80:95]
    ds_read_b64_tr_b16 a[240:241], v15 offset:32768
    ds_read_b64_tr_b16 a[242:243], v15 offset:33792
    v_mfma_f32_32x32x16_bf16 v[64:79], a[248:251], v[184:187], v[64:79]
    s_waitcnt lgkmcnt(4)
    ds_read_b64_tr_b16 a[244:245], v15 offset:33280
    ds_read_b64_tr_b16 a[246:247], v15 offset:34304
    buffer_load_dwordx4 v[232:235], v1, s[8:11], s79 offen offset:2048 sc1
    v_mfma_f32_32x32x16_bf16 v[80:95], a[252:255], v[184:187], v[80:95]
    ds_read_b64_tr_b16 a[248:249], v15 offset:34816
    ds_read_b64_tr_b16 a[250:251], v15 offset:35840
    v_mfma_f32_32x32x16_bf16 v[64:79], a[232:235], v[188:191], v[64:79]
    s_waitcnt lgkmcnt(4)
    ds_read_b64_tr_b16 a[252:253], v15 offset:35328
    ds_read_b64_tr_b16 a[254:255], v15 offset:36352
    buffer_load_dwordx4 v[236:239], v1, s[8:11], s79 offen offset:3072 sc1
    s_waitcnt vmcnt(8)
    v_bitop3_b32 v7, v195, v199, v203 bitop3:0x80
    v_bitop3_b32 v7, v7, v207, 1 bitop3:0x2a
    v_cmp_ne_u32 vcc, 0, v7
    v_mfma_f32_32x32x16_bf16 v[80:95], a[236:239], v[188:191], v[80:95]
    s_cbranch_vccnz OOL_489
RET_490:
    ds_read_b64_tr_b16 a[232:233], v15 offset:36864
    ds_read_b64_tr_b16 a[234:235], v15 offset:37888
    v_mfma_f32_32x32x16_bf16 v[64:79], a[240:243], v[192:195], v[64:79]
    s_waitcnt lgkmcnt(4)
    ds_read_b64_tr_b16 a[236:237], v15 offset:37376
    ds_read_b64_tr_b16 a[238:239], v15 offset:38400
    s_add_u32 s79, s59, 0x7000
    buffer_load_dwordx4 v[240:243], v1, s[8:11], s79 offen offset:0 sc1
    v_mfma_f32_32x32x16_bf16 v[80:95], a[244:247], v[192:195], v[80:95]
    ds_read_b64_tr_b16 a[240:241], v15 offset:38912
    ds_read_b64_tr_b16 a[242:243], v15 offset:39936
    v_mfma_f32_32x32x16_bf16 v[64:79], a[248:251], v[196:199], v[64:79]
    s_waitcnt lgkmcnt(4)
    ds_read_b64_tr_b16 a[244:245], v15 offset:39424
    ds_read_b64_tr_b16 a[246:247], v15 offset:40448
    buffer_load_dwordx4 v[244:247], v1, s[8:11], s79 offen offset:1024 sc1
    v_mfma_f32_32x32x16_bf16 v[80:95], a[252:255], v[196:199], v[80:95]
    ds_read_b64_tr_b16 a[248:249], v15 offset:40960
    ds_read_b64_tr_b16 a[250:251], v15 offset:41984
    v_mfma_f32_32x32x16_bf16 v[64:79], a[232:235], v[200:203], v[64:79]
    s_waitcnt lgkmcnt(4)
    ds_read_b64_tr_b16 a[252:253], v15 offset:41472
    ds_read_b64_tr_b16 a[254:255], v15 offset:42496
    buffer_load_dwordx4 v[248:251], v1, s[8:11], s79 offen offset:2048 sc1
    v_mfma_f32_32x32x16_bf16 v[80:95], a[236:239], v[200:203], v[80:95]
    ds_read_b64_tr_b16 a[232:233], v15 offset:43008
    ds_read_b64_tr_b16 a[234:235], v15 offset:44032
    v_mfma_f32_32x32x16_bf16 v[64:79], a[240:243], v[204:207], v[64:79]
    s_waitcnt lgkmcnt(4)
    ds_read_b64_tr_b16 a[236:237], v15 offset:43520
    ds_read_b64_tr_b16 a[238:239], v15 offset:44544
    buffer_load_dwordx4 v[252:255], v1, s[8:11], s79 offen offset:3072 sc1
    s_waitcnt vmcnt(8)
    v_bitop3_b32 v7, v211, v215, v219 bitop3:0x80
    v_bitop3_b32 v7, v7, v223, 1 bitop3:0x2a
    v_cmp_ne_u32 vcc, 0, v7
    v_mfma_f32_32x32x16_bf16 v[80:95], a[244:247], v[204:207], v[80:95]
    s_cbranch_vccnz OOL_492
RET_493:
    ds_read_b64_tr_b16 a[240:241], v15 offset:45056
    ds_read_b64_tr_b16 a[242:243], v15 offset:46080
    v_mfma_f32_32x32x16_bf16 v[64:79], a[248:251], v[208:211], v[64:79]
    s_waitcnt lgkmcnt(4)
    ds_read_b64_tr_b16 a[244:245], v15 offset:45568
    ds_read_b64_tr_b16 a[246:247], v15 offset:46592
    v_mfma_f32_32x32x16_bf16 v[80:95], a[252:255], v[208:211], v[80:95]
    ds_read_b64_tr_b16 a[248:249], v15 offset:47104
    ds_read_b64_tr_b16 a[250:251], v15 offset:48128
    buffer_load_dwordx4 v[112:115], v1, s[8:11], s77 offen offset:0 sc1
    buffer_load_dwordx4 v[116:119], v1, s[8:11], s77 offen offset:1024 sc1
    buffer_load_dwordx4 v[120:123], v1, s[8:11], s77 offen offset:2048 sc1
    buffer_load_dwordx4 v[124:127], v1, s[8:11], s77 offen offset:3072 sc1
    v_mfma_f32_32x32x16_bf16 v[64:79], a[232:235], v[212:215], v[64:79]
    s_waitcnt lgkmcnt(4)
    ds_read_b64_tr_b16 a[252:253], v15 offset:47616
    ds_read_b64_tr_b16 a[254:255], v15 offset:48640
    v_mfma_f32_32x32x16_bf16 v[80:95], a[236:239], v[212:215], v[80:95]
    ds_read_b64_tr_b16 a[232:233], v15 offset:49152
    ds_read_b64_tr_b16 a[234:235], v15 offset:50176
    v_mfma_f32_32x32x16_bf16 v[64:79], a[240:243], v[216:219], v[64:79]
    s_waitcnt lgkmcnt(4)
    ds_read_b64_tr_b16 a[236:237], v15 offset:49664
    ds_read_b64_tr_b16 a[238:239], v15 offset:50688
    v_mfma_f32_32x32x16_bf16 v[80:95], a[244:247], v[216:219], v[80:95]
    ds_read_b64_tr_b16 a[240:241], v15 offset:51200
    ds_read_b64_tr_b16 a[242:243], v15 offset:52224
    v_mfma_f32_32x32x16_bf16 v[64:79], a[248:251], v[220:223], v[64:79]
    s_waitcnt lgkmcnt(4)
    ds_read_b64_tr_b16 a[244:245], v15 offset:51712
    ds_read_b64_tr_b16 a[246:247], v15 offset:52736
    s_waitcnt vmcnt(8)
    v_bitop3_b32 v7, v227, v231, v235 bitop3:0x80
    v_bitop3_b32 v7, v7, v239, 1 bitop3:0x2a
    v_cmp_ne_u32 vcc, 0, v7
    v_mfma_f32_32x32x16_bf16 v[80:95], a[252:255], v[220:223], v[80:95]
    s_cbranch_vccnz OOL_495
RET_496:
    ds_read_b64_tr_b16 a[248:249], v15 offset:53248
    ds_read_b64_tr_b16 a[250:251], v15 offset:54272
    v_mfma_f32_32x32x16_bf16 v[64:79], a[232:235], v[224:227], v[64:79]
    s_waitcnt lgkmcnt(4)
    ds_read_b64_tr_b16 a[252:253], v15 offset:53760
    ds_read_b64_tr_b16 a[254:255], v15 offset:54784
    v_mfma_f32_32x32x16_bf16 v[80:95], a[236:239], v[224:227], v[80:95]
    ds_read_b64_tr_b16 a[232:233], v15 offset:55296
    ds_read_b64_tr_b16 a[234:235], v15 offset:56320
    v_mfma_f32_32x32x16_bf16 v[64:79], a[240:243], v[228:231], v[64:79]
    s_waitcnt lgkmcnt(4)
    ds_read_b64_tr_b16 a[236:237], v15 offset:55808
    ds_read_b64_tr_b16 a[238:239], v15 offset:56832
    v_mfma_f32_32x32x16_bf16 v[80:95], a[244:247], v[228:231], v[80:95]
    ds_read_b64_tr_b16 a[240:241], v15 offset:57344
    ds_read_b64_tr_b16 a[242:243], v15 offset:58368
    v_mfma_f32_32x32x16_bf16 v[64:79], a[248:251], v[232:235], v[64:79]
    s_waitcnt lgkmcnt(4)
    ds_read_b64_tr_b16 a[244:245], v15 offset:57856
    ds_read_b64_tr_b16 a[246:247], v15 offset:58880
    s_waitcnt vmcnt(0)
    v_bitop3_b32 v7, v112, v113, v114 bitop3:0xfe
    v_bitop3_b32 v7, v7, v115, v116 bitop3:0xfe
    v_bitop3_b32 v7, v7, v117, v118 bitop3:0xfe
    v_bitop3_b32 v7, v7, v119, v120 bitop3:0xfe
    v_bitop3_b32 v7, v7, v121, v122 bitop3:0xfe
    v_bitop3_b32 v7, v7, v123, v124 bitop3:0xfe
    v_bitop3_b32 v7, v7, v125, v126 bitop3:0xfe
    v_bitop3_b32 v7, v7, v127, 1 bitop3:0xa8
    v_cmp_ne_u32 vcc, 0, v7
    v_mfma_f32_32x32x16_bf16 v[80:95], a[252:255], v[232:235], v[80:95]
    s_cbranch_vccnz OOL_498
RET_499:
    ds_read_b64_tr_b16 a[248:249], v15 offset:59392
    ds_read_b64_tr_b16 a[250:251], v15 offset:60416
    v_add_f32 v112, v112, v120
    v_mfma_f32_32x32x16_bf16 v[64:79], a[232:235], v[236:239], v[64:79]
    s_waitcnt lgkmcnt(4)
    ds_read_b64_tr_b16 a[252:253], v15 offset:61440
    ds_read_b64_tr_b16 a[254:255], v15 offset:62464
    v_bitop3_b32 v7, v243, v247, v251 bitop3:0x80
    v_bitop3_b32 v7, v7, v255, 1 bitop3:0x2a
    v_cmp_ne_u32 vcc, 0, v7
    v_add_f32 v113, v113, v121
    v_mfma_f32_32x32x16_bf16 v[80:95], a[236:239], v[236:239], v[80:95]
    s_cbranch_vccnz OOL_501
RET_502:
    ds_read_b64_tr_b16 a[232:233], v15 offset:63488
    ds_read_b64_tr_b16 a[234:235], v15 offset:64512
    v_add_f32 v114, v114, v122
    v_mfma_f32_32x32x16_bf16 v[64:79], a[240:243], v[240:243], v[64:79]
    s_waitcnt lgkmcnt(4)
    ds_read_b64_tr_b16 a[236:237], v15 offset:59904
    ds_read_b64_tr_b16 a[238:239], v15 offset:60928
    v_add_f32 v115, v115, v123
    v_add_f32 v116, v116, v124
    v_add_f32 v117, v117, v125
    v_add_f32 v118, v118, v126
    v_mfma_f32_32x32x16_bf16 v[80:95], a[244:247], v[240:243], v[80:95]
    ds_read_b64_tr_b16 a[240:241], v15 offset:61952
    ds_read_b64_tr_b16 a[242:243], v15 offset:62976
    v_add_f32 v119, v119, v127
    v_add_f32 v112, v112, v116
    v_add_f32 v113, v113, v117
    v_add_f32 v114, v114, v118
    v_add_f32 v115, v115, v119
    v_mfma_f32_32x32x16_bf16 v[64:79], a[248:251], v[244:247], v[64:79]
    s_waitcnt lgkmcnt(4)
    ds_read_b64_tr_b16 a[244:245], v15 offset:64000
    ds_read_b64_tr_b16 a[246:247], v15 offset:65024
    v_add_f32 v112, v112, v114
    v_add_f32 v113, v113, v115
    v_add_f32 v112, v112, v113
    v_mov_b32 v113, v112
    v_mfma_f32_32x32x16_bf16 v[64:79], a[252:255], v[248:251], v[64:79]
    ds_read_b64_tr_b16 a[248:249], v29 offset:33280
    ds_read_b64_tr_b16 a[250:251], v29 offset:34304
    v_permlane32_swap_b32 v112, v113
    v_mul_f32 v112, 0xbb000000, v112
    v_mul_f32 v113, 0x3b000000, v113
    v_fma_f32 v113, -v112, v112, v113
    v_max_f32 v113, 0, v113
    v_mfma_f32_32x32x16_bf16 v[64:79], a[232:235], v[252:255], v[64:79]
    s_waitcnt lgkmcnt(4)
    ds_read_b64_tr_b16 a[252:253], v29 offset:32768
    ds_read_b64_tr_b16 a[254:255], v29 offset:33792
    v_cvt_pk_bf16_f32 v114, v112, v112
    v_and_b32 v114, 0xffff0000, v114
    v_sub_f32 v115, v112, v114
    v_cvt_pk_bf16_f32 v12, v114, v115
    v_mov_b32 v13, v12
    v_add_f32 v116, 0x3727c5ac, v113
    v_rsq_f32 v117, v116
    s_nop 0
    v_mul_f32 v60, v116, v117
    v_mul_f32 v59, 0xc0135761, v117
    v_mul_f32 v58, v117, v117
    v_mul_f32 v117, 0xbdd2d3e8, v117
    v_mul_f32 v58, v58, v117
    v_mov_b32 v61, v60
    v_mfma_f32_32x32x8_bf16 v[64:79], a[224:225], v[12:13], v[64:79]
    v_mov_b32 v30, s69
    v_add_u32 v30, 2, v30
    v_mfma_f32_32x32x16_bf16 v[80:95], a[236:239], v[244:247], v[80:95]
    ds_read_b64_tr_b16 a[232:233], v29 offset:35328
    ds_read_b64_tr_b16 a[234:235], v29 offset:36352
    s_mov_b64 exec, 1
    buffer_store_dword v30, off, s[8:11], s63 sc1
    s_mov_b64 exec, -1
    v_mfma_f32_32x32x16_bf16 v[80:95], a[240:243], v[248:251], v[80:95]
    s_waitcnt lgkmcnt(4)
    ds_read_b64_tr_b16 a[236:237], v29 offset:34816
    ds_read_b64_tr_b16 a[238:239], v29 offset:35840
    v_mul_f32 v16, v64, v64
    v_fma_f32 v16, v16, v58, v59
    v_mul_f32 v16, v16, v64
    v_mul_f32 v17, v65, v65
    v_fma_f32 v17, v17, v58, v59
    v_mfma_f32_32x32x16_bf16 v[80:95], a[244:247], v[252:255], v[80:95]
    ds_read_b64_tr_b16 a[240:241], v29 offset:37376
    ds_read_b64_tr_b16 a[242:243], v29 offset:38400
    v_exp_f32 v16, v16
    v_mul_f32 v17, v17, v65
    v_mul_f32 v18, v66, v66
    v_exp_f32 v17, v17
    v_mfma_f32_32x32x8_bf16 v[80:95], a[226:227], v[12:13], v[80:95]
    v_fma_f32 v16, v16, v60, v60
    v_fma_f32 v18, v18, v58, v59
    v_rcp_f32 v16, v16
    v_mul_f32 v18, v18, v66
    v_mul_f32 v19, v67, v67
    v_fma_f32 v17, v17, v60, v60
    v_mfma_f32_32x32x8_bf16 v[96:111], a[228:229], v[12:13], 0
    v_exp_f32 v18, v18
    v_fma_f32 v19, v19, v58, v59
    v_rcp_f32 v17, v17
    v_mul_f32 v64, v64, v16
    v_mul_f32 v19, v19, v67
    v_mfma_f32_32x32x8_bf16 v[112:127], a[230:231], v[12:13], 0
    v_mul_f32 v16, v68, v68
    v_exp_f32 v19, v19
    v_fma_f32 v18, v18, v60, v60
    v_fma_f32 v16, v16, v58, v59
    v_rcp_f32 v18, v18
    v_mfma_f32_32x32x16_bf16 v[112:127], a[248:251], v[192:195], v[112:127]
    s_waitcnt lgkmcnt(4)
    ds_read_b64_tr_b16 a[244:245], v29 offset:36864
    ds_read_b64_tr_b16 a[246:247], v29 offset:37888
    v_mul_f32 v65, v65, v17
    v_mul_f32 v16, v16, v68
    v_mul_f32 v17, v69, v69
    v_cvt_pk_bf16_f32 v20, v64, v65
    v_fma_f32 v19, v19, v60, v60
    v_mfma_f32_32x32x16_bf16 v[96:111], a[252:255], v[192:195], v[96:111]
    ds_read_b64_tr_b16 a[248:249], v29 offset:39424
    ds_read_b64_tr_b16 a[250:251], v29 offset:40448
    v_exp_f32 v16, v16
    v_fma_f32 v17, v17, v58, v59
    v_rcp_f32 v19, v19
    v_mul_f32 v66, v66, v18
    v_mfma_f32_32x32x16_bf16 v[112:127], a[232:235], v[196:199], v[112:127]
    s_waitcnt lgkmcnt(4)
    ds_read_b64_tr_b16 a[252:253], v29 offset:38912
    ds_read_b64_tr_b16 a[254:255], v29 offset:39936
    v_mul_f32 v17, v17, v69
    v_mul_f32 v18, v70, v70
    v_exp_f32 v17, v17
    v_fma_f32 v16, v16, v60, v60
    v_mfma_f32_32x32x16_bf16 v[96:111], a[236:239], v[196:199], v[96:111]
    ds_read_b64_tr_b16 a[232:233], v29 offset:41472
    ds_read_b64_tr_b16 a[234:235], v29 offset:42496
    v_fma_f32 v18, v18, v58, v59
    v_rcp_f32 v16, v16
    v_mul_f32 v67, v67, v19
    v_mul_f32 v18, v18, v70
    v_mul_f32 v19, v71, v71
    v_mfma_f32_32x32x16_bf16 v[112:127], a[240:243], v[200:203], v[112:127]
    s_waitcnt lgkmcnt(4)
    ds_read_b64_tr_b16 a[236:237], v29 offset:40960
    ds_read_b64_tr_b16 a[238:239], v29 offset:41984
    v_cvt_pk_bf16_f32 v21, v66, v67
    v_exp_f32 v18, v18
    v_fma_f32 v17, v17, v60, v60
    v_fma_f32 v19, v19, v58, v59
    v_mfma_f32_32x32x16_bf16 v[96:111], a[244:247], v[200:203], v[96:111]
    ds_read_b64_tr_b16 a[240:241], v29 offset:43520
    ds_read_b64_tr_b16 a[242:243], v29 offset:44544
    v_rcp_f32 v17, v17
    v_mul_f32 v68, v68, v16
    v_mul_f32 v19, v19, v71
    v_mul_f32 v16, v72, v72
    v_fma_f32 v18, v18, v60, v60
    v_mfma_f32_32x32x16_bf16 v[112:127], a[248:251], v[204:207], v[112:127]
    s_waitcnt lgkmcnt(4)
    ds_read_b64_tr_b16 a[244:245], v29 offset:43008
    ds_read_b64_tr_b16 a[246:247], v29 offset:44032
    v_exp_f32 v19, v19
    v_fma_f32 v16, v16, v58, v59
    v_rcp_f32 v18, v18
    v_mfma_f32_32x32x16_bf16 v[96:111], a[252:255], v[204:207], v[96:111]
    ds_read_b64_tr_b16 a[248:249], v29 offset:45568
    ds_read_b64_tr_b16 a[250:251], v29 offset:46592
    v_mul_f32 v69, v69, v17
    v_mul_f32 v16, v16, v72
    v_mul_f32 v17, v73, v73
    v_cvt_pk_bf16_f32 v22, v68, v69
    v_exp_f32 v16, v16
    v_mfma_f32_32x32x16_bf16 v[112:127], a[232:235], v[208:211], v[112:127]
    s_waitcnt lgkmcnt(4)
    ds_read_b64_tr_b16 a[252:253], v29 offset:45056
    ds_read_b64_tr_b16 a[254:255], v29 offset:46080
    v_fma_f32 v19, v19, v60, v60
    v_fma_f32 v17, v17, v58, v59
    v_rcp_f32 v19, v19
    v_mul_f32 v70, v70, v18
    v_mfma_f32_32x32x16_bf16 v[96:111], a[236:239], v[208:211], v[96:111]
    ds_read_b64_tr_b16 a[232:233], v29 offset:47616
    ds_read_b64_tr_b16 a[234:235], v29 offset:48640
    v_mul_f32 v17, v17, v73
    v_mul_f32 v18, v74, v74
    v_exp_f32 v17, v17
    v_fma_f32 v16, v16, v60, v60
    v_fma_f32 v18, v18, v58, v59
    v_mfma_f32_32x32x16_bf16 v[112:127], a[240:243], v[212:215], v[112:127]
    s_waitcnt lgkmcnt(4)
    ds_read_b64_tr_b16 a[236:237], v29 offset:47104
    ds_read_b64_tr_b16 a[238:239], v29 offset:48128
    v_rcp_f32 v16, v16
    v_mul_f32 v71, v71, v19
    v_mul_f32 v18, v18, v74
    v_mul_f32 v19, v75, v75
    v_mfma_f32_32x32x16_bf16 v[96:111], a[244:247], v[212:215], v[96:111]
    ds_read_b64_tr_b16 a[240:241], v29 offset:49664
    ds_read_b64_tr_b16 a[242:243], v29 offset:50688
    v_cvt_pk_bf16_f32 v23, v70, v71
    v_exp_f32 v18, v18
    v_fma_f32 v17, v17, v60, v60
    v_fma_f32 v19, v19, v58, v59
    v_mul_f32 v72, v72, v16
    v_mfma_f32_32x32x16_bf16 v[112:127], a[248:251], v[216:219], v[112:127]
    s_waitcnt lgkmcnt(4)
    ds_read_b64_tr_b16 a[244:245], v29 offset:49152
    ds_read_b64_tr_b16 a[246:247], v29 offset:50176
    v_rcp_f32 v17, v17
    v_mul_f32 v19, v19, v75
    v_mul_f32 v16, v76, v76
    v_fma_f32 v18, v18, v60, v60
    v_mfma_f32_32x32x16_bf16 v[96:111], a[252:255], v[216:219], v[96:111]
    ds_read_b64_tr_b16 a[248:249], v29 offset:51712
    ds_read_b64_tr_b16 a[250:251], v29 offset:52736
    v_exp_f32 v19, v19
    v_fma_f32 v16, v16, v58, v59
    v_rcp_f32 v18, v18
    v_mul_f32 v73, v73, v17
    v_mfma_f32_32x32x16_bf16 v[112:127], a[232:235], v[220:223], v[112:127]
    s_waitcnt lgkmcnt(4)
    ds_read_b64_tr_b16 a[252:253], v29 offset:51200
    ds_read_b64_tr_b16 a[254:255], v29 offset:52224
    v_mul_f32 v16, v16, v76
    v_mul_f32 v17, v77, v77
    v_cvt_pk_bf16_f32 v24, v72, v73
    v_and_b32 v23, -2, v23
    v_fma_f32 v19, v19, v60, v60
    v_mfma_f32_32x32x16_bf16 v[96:111], a[236:239], v[220:223], v[96:111]
    ds_read_b64_tr_b16 a[232:233], v29 offset:53760
    ds_read_b64_tr_b16 a[234:235], v29 offset:54784
    v_exp_f32 v16, v16
    v_fma_f32 v17, v17, v58, v59
    v_rcp_f32 v19, v19
    v_mul_f32 v74, v74, v18
    v_mfma_f32_32x32x16_bf16 v[112:127], a[240:243], v[224:227], v[112:127]
    s_waitcnt lgkmcnt(4)
    ds_read_b64_tr_b16 a[236:237], v29 offset:53248
    ds_read_b64_tr_b16 a[238:239], v29 offset:54272
    v_mul_f32 v17, v17, v77
    v_mul_f32 v18, v78, v78
    v_exp_f32 v17, v17
    v_fma_f32 v16, v16, v60, v60
    v_mfma_f32_32x32x16_bf16 v[96:111], a[244:247], v[224:227], v[96:111]
    ds_read_b64_tr_b16 a[240:241], v29 offset:55808
    ds_read_b64_tr_b16 a[242:243], v29 offset:56832
    v_fma_f32 v18, v18, v58, v59
    v_rcp_f32 v16, v16
    v_mul_f32 v75, v75, v19
    v_mul_f32 v18, v18, v78
    v_mul_f32 v19, v79, v79
    v_mfma_f32_32x32x16_bf16 v[112:127], a[248:251], v[228:231], v[112:127]
    s_waitcnt lgkmcnt(4)
    ds_read_b64_tr_b16 a[244:245], v29 offset:55296
    ds_read_b64_tr_b16 a[246:247], v29 offset:56320
    v_cvt_pk_bf16_f32 v25, v74, v75
    v_exp_f32 v18, v18
    v_fma_f32 v17, v17, v60, v60
    v_fma_f32 v19, v19, v58, v59
    v_mfma_f32_32x32x16_bf16 v[96:111], a[252:255], v[228:231], v[96:111]
    ds_read_b64_tr_b16 a[248:249], v29 offset:57856
    ds_read_b64_tr_b16 a[250:251], v29 offset:58880
    v_rcp_f32 v17, v17
    v_mul_f32 v76, v76, v16
    v_mul_f32 v19, v19, v79
    v_mul_f32 v16, v80, v80
    v_fma_f32 v18, v18, v60, v60
    v_mfma_f32_32x32x16_bf16 v[112:127], a[232:235], v[232:235], v[112:127]
    s_waitcnt lgkmcnt(4)
    ds_read_b64_tr_b16 a[252:253], v29 offset:57344
    ds_read_b64_tr_b16 a[254:255], v29 offset:58368
    v_exp_f32 v19, v19
    v_fma_f32 v16, v16, v58, v59
    v_rcp_f32 v18, v18
    v_mfma_f32_32x32x16_bf16 v[96:111], a[236:239], v[232:235], v[96:111]
    ds_read_b64_tr_b16 a[232:233], v29 offset:59904
    ds_read_b64_tr_b16 a[234:235], v29 offset:60928
    v_mul_f32 v77, v77, v17
    v_mul_f32 v16, v16, v80
    v_mul_f32 v17, v81, v81
    v_cvt_pk_bf16_f32 v26, v76, v77
    v_exp_f32 v16, v16
    v_mfma_f32_32x32x16_bf16 v[112:127], a[240:243], v[236:239], v[112:127]
    s_waitcnt lgkmcnt(4)
    ds_read_b64_tr_b16 a[236:237], v29 offset:59392
    ds_read_b64_tr_b16 a[238:239], v29 offset:60416
    v_fma_f32 v19, v19, v60, v60
    v_fma_f32 v17, v17, v58, v59
    v_rcp_f32 v19, v19
    v_mul_f32 v78, v78, v18
    v_mfma_f32_32x32x16_bf16 v[96:111], a[244:247], v[236:239], v[96:111]
    ds_read_b64_tr_b16 a[240:241], v29 offset:61952
    ds_read_b64_tr_b16 a[242:243], v29 offset:62976
    v_mul_f32 v17, v17, v81
    v_mul_f32 v18, v82, v82
    v_exp_f32 v17, v17
    v_fma_f32 v16, v16, v60, v60
    v_fma_f32 v18, v18, v58, v59
    v_mfma_f32_32x32x16_bf16 v[112:127], a[248:251], v[240:243], v[112:127]
    s_waitcnt lgkmcnt(4)
    ds_read_b64_tr_b16 a[244:245], v29 offset:61440
    ds_read_b64_tr_b16 a[246:247], v29 offset:62464
    v_rcp_f32 v16, v16
    v_mul_f32 v79, v79, v19
    v_mul_f32 v18, v18, v82
    v_mul_f32 v19, v83, v83
    v_mfma_f32_32x32x16_bf16 v[96:111], a[252:255], v[240:243], v[96:111]
    ds_read_b64_tr_b16 a[248:249], v29 offset:64000
    ds_read_b64_tr_b16 a[250:251], v29 offset:65024
    v_cvt_pk_bf16_f32 v27, v78, v79
    v_and_b32 v27, -2, v27
    v_exp_f32 v18, v18
    v_fma_f32 v17, v17, v60, v60
    v_fma_f32 v19, v19, v58, v59
    v_mfma_f32_32x32x16_bf16 v[112:127], a[232:235], v[244:247], v[112:127]
    s_waitcnt lgkmcnt(4)
    ds_read_b64_tr_b16 a[252:253], v29 offset:63488
    ds_read_b64_tr_b16 a[254:255], v29 offset:64512
    buffer_store_dwordx4 v[20:23], v1, s[8:11], s60 offen offset:0 sc1
    buffer_store_dwordx4 v[24:27], v1, s[8:11], s60 offen offset:1024 sc1
    v_mul_f32 v80, v80, v16
    v_mfma_f32_32x32x16_bf16 v[96:111], a[236:239], v[244:247], v[96:111]
    ds_read_b64_tr_b16 a[232:233], v29 offset:8704
    ds_read_b64_tr_b16 a[234:235], v29 offset:9728
    v_rcp_f32 v17, v17
    v_mul_f32 v19, v19, v83
    v_mul_f32 v16, v84, v84
    v_exp_f32 v19, v19
    v_mfma_f32_32x32x16_bf16 v[112:127], a[240:243], v[248:251], v[112:127]
    s_waitcnt lgkmcnt(4)
    ds_read_b64_tr_b16 a[236:237], v29 offset:8192
    ds_read_b64_tr_b16 a[238:239], v29 offset:9216
    v_fma_f32 v18, v18, v60, v60
    v_fma_f32 v16, v16, v58, v59
    v_rcp_f32 v18, v18
    v_mul_f32 v81, v81, v17
    v_mfma_f32_32x32x16_bf16 v[96:111], a[244:247], v[248:251], v[96:111]
    ds_read_b64_tr_b16 a[240:241], v29 offset:10752
    ds_read_b64_tr_b16 a[242:243], v29 offset:11776
    v_mul_f32 v16, v16, v84
    v_mul_f32 v17, v85, v85
    v_cvt_pk_bf16_f32 v20, v80, v81
    v_exp_f32 v16, v16
    v_fma_f32 v19, v19, v60, v60
    v_mfma_f32_32x32x16_bf16 v[112:127], a[248:251], v[252:255], v[112:127]
    s_waitcnt lgkmcnt(4)
    ds_read_b64_tr_b16 a[244:245], v29 offset:10240
    ds_read_b64_tr_b16 a[246:247], v29 offset:11264
    v_fma_f32 v17, v17, v58, v59
    v_rcp_f32 v19, v19
    v_mul_f32 v82, v82, v18
    v_mul_f32 v17, v17, v85
    v_mfma_f32_32x32x16_bf16 v[96:111], a[252:255], v[252:255], v[96:111]
    ds_read_b64_tr_b16 a[248:249], v29 offset:12800
    ds_read_b64_tr_b16 a[250:251], v29 offset:13824
    v_mul_f32 v18, v86, v86
    v_exp_f32 v17, v17
    v_fma_f32 v16, v16, v60, v60
    v_fma_f32 v18, v18, v58, v59
    v_mul_f32 v83, v83, v19
    v_mfma_f32_32x32x16_bf16 v[112:127], a[232:235], v[144:147], v[112:127]
    s_waitcnt lgkmcnt(4)
    ds_read_b64_tr_b16 a[252:253], v29 offset:12288
    ds_read_b64_tr_b16 a[254:255], v29 offset:13312
    v_rcp_f32 v16, v16
    v_mul_f32 v18, v18, v86
    v_mul_f32 v19, v87, v87
    v_cvt_pk_bf16_f32 v21, v82, v83
    v_mfma_f32_32x32x16_bf16 v[96:111], a[236:239], v[144:147], v[96:111]
    ds_read_b64_tr_b16 a[232:233], v29 offset:14848
    ds_read_b64_tr_b16 a[234:235], v29 offset:15872
    v_exp_f32 v18, v18
    v_fma_f32 v17, v17, v60, v60
    v_fma_f32 v19, v19, v58, v59
    v_rcp_f32 v17, v17
    v_mfma_f32_32x32x16_bf16 v[112:127], a[240:243], v[148:151], v[112:127]
    s_waitcnt lgkmcnt(4)
    ds_read_b64_tr_b16 a[236:237], v29 offset:14336
    ds_read_b64_tr_b16 a[238:239], v29 offset:15360
    v_mul_f32 v84, v84, v16
    v_mul_f32 v19, v19, v87
    v_mul_f32 v16, v88, v88
    v_exp_f32 v19, v19
    v_mfma_f32_32x32x16_bf16 v[96:111], a[244:247], v[148:151], v[96:111]
    ds_read_b64_tr_b16 a[240:241], v29 offset:16896
    ds_read_b64_tr_b16 a[242:243], v29 offset:17920
    v_fma_f32 v18, v18, v60, v60
    v_fma_f32 v16, v16, v58, v59
    v_rcp_f32 v18, v18
    v_mul_f32 v85, v85, v17
    v_mul_f32 v16, v16, v88
    v_mfma_f32_32x32x16_bf16 v[112:127], a[248:251], v[152:155], v[112:127]
    s_waitcnt lgkmcnt(4)
    ds_read_b64_tr_b16 a[244:245], v29 offset:16384
    ds_read_b64_tr_b16 a[246:247], v29 offset:17408
    buffer_load_dwordx4 v[192:195], v1, s[8:11], s51 offen offset:0 sc1
    v_mul_f32 v17, v89, v89
    v_cvt_pk_bf16_f32 v22, v84, v85
    v_fma_f32 v19, v19, v60, v60
    v_mfma_f32_32x32x16_bf16 v[96:111], a[252:255], v[152:155], v[96:111]
    ds_read_b64_tr_b16 a[248:249], v29 offset:18944
    ds_read_b64_tr_b16 a[250:251], v29 offset:19968
    buffer_load_dwordx4 v[196:199], v1, s[8:11], s51 offen offset:1024 sc1
    v_exp_f32 v16, v16
    v_fma_f32 v17, v17, v58, v59
    v_mul_f32 v86, v86, v18
    v_mfma_f32_32x32x16_bf16 v[112:127], a[232:235], v[156:159], v[112:127]
    s_waitcnt lgkmcnt(4)
    ds_read_b64_tr_b16 a[252:253], v29 offset:18432
    ds_read_b64_tr_b16 a[254:255], v29 offset:19456
    buffer_load_dwordx4 v[200:203], v1, s[8:11], s51 offen offset:2048 sc1
    v_rcp_f32 v19, v19
    v_mul_f32 v17, v17, v89
    v_mfma_f32_32x32x16_bf16 v[96:111], a[236:239], v[156:159], v[96:111]
    ds_read_b64_tr_b16 a[232:233], v29 offset:20992
    ds_read_b64_tr_b16 a[234:235], v29 offset:22016
    buffer_load_dwordx4 v[204:207], v1, s[8:11], s51 offen offset:3072 sc1
    v_mul_f32 v18, v90, v90
    v_exp_f32 v17, v17
    v_fma_f32 v16, v16, v60, v60
    v_mfma_f32_32x32x16_bf16 v[112:127], a[240:243], v[160:163], v[112:127]
    s_waitcnt lgkmcnt(4)
    ds_read_b64_tr_b16 a[236:237], v29 offset:20480
    ds_read_b64_tr_b16 a[238:239], v29 offset:21504
    s_add_u32 s78, s51, 0x1000
    buffer_load_dwordx4 v[208:211], v1, s[8:11], s78 offen offset:0 sc1
    v_fma_f32 v18, v18, v58, v59
    v_mul_f32 v87, v87, v19
    v_mfma_f32_32x32x16_bf16 v[96:111], a[244:247], v[160:163], v[96:111]
    ds_read_b64_tr_b16 a[240:241], v29 offset:23040
    ds_read_b64_tr_b16 a[242:243], v29 offset:24064
    buffer_load_dwordx4 v[212:215], v1, s[8:11], s78 offen offset:1024 sc1
    v_rcp_f32 v16, v16
    v_mul_f32 v18, v18, v90
    v_mul_f32 v19, v91, v91
    v_mfma_f32_32x32x16_bf16 v[112:127], a[248:251], v[164:167], v[112:127]
    s_waitcnt lgkmcnt(4)
    ds_read_b64_tr_b16 a[244:245], v29 offset:22528
    ds_read_b64_tr_b16 a[246:247], v29 offset:23552
    buffer_load_dwordx4 v[216:219], v1, s[8:11], s78 offen offset:2048 sc1
    v_cvt_pk_bf16_f32 v23, v86, v87
    v_exp_f32 v18, v18
    v_mfma_f32_32x32x16_bf16 v[96:111], a[252:255], v[164:167], v[96:111]
    ds_read_b64_tr_b16 a[248:249], v29 offset:25088
    ds_read_b64_tr_b16 a[250:251], v29 offset:26112
    buffer_load_dwordx4 v[220:223], v1, s[8:11], s78 offen offset:3072 sc1
    v_fma_f32 v17, v17, v60, v60
    v_fma_f32 v19, v19, v58, v59
    v_rcp_f32 v17, v17
    v_mfma_f32_32x32x16_bf16 v[112:127], a[232:235], v[168:171], v[112:127]
    s_waitcnt lgkmcnt(4)
    ds_read_b64_tr_b16 a[252:253], v29 offset:24576
    ds_read_b64_tr_b16 a[254:255], v29 offset:25600
    buffer_load_dwordx4 v[224:227], v1, s[8:11], s50 offen offset:0 sc1
    v_mul_f32 v88, v88, v16
    v_mul_f32 v19, v19, v91
    v_mul_f32 v16, v92, v92
    v_mfma_f32_32x32x16_bf16 v[96:111], a[236:239], v[168:171], v[96:111]
    ds_read_b64_tr_b16 a[232:233], v29 offset:27136
    ds_read_b64_tr_b16 a[234:235], v29 offset:28160
    buffer_load_dwordx4 v[228:231], v1, s[8:11], s50 offen offset:1024 sc1
    v_exp_f32 v19, v19
    v_fma_f32 v18, v18, v60, v60
    v_fma_f32 v16, v16, v58, v59
    v_mfma_f32_32x32x16_bf16 v[112:127], a[240:243], v[172:175], v[112:127]
    s_waitcnt lgkmcnt(4)
    ds_read_b64_tr_b16 a[236:237], v29 offset:26624
    ds_read_b64_tr_b16 a[238:239], v29 offset:27648
    buffer_load_dwordx4 v[232:235], v1, s[8:11], s50 offen offset:2048 sc1
    v_rcp_f32 v18, v18
    v_mul_f32 v89, v89, v17
    v_mfma_f32_32x32x16_bf16 v[96:111], a[244:247], v[172:175], v[96:111]
    ds_read_b64_tr_b16 a[240:241], v29 offset:29184
    ds_read_b64_tr_b16 a[242:243], v29 offset:30208
    buffer_load_dwordx4 v[236:239], v1, s[8:11], s50 offen offset:3072 sc1
    v_mul_f32 v16, v16, v92
    v_mul_f32 v17, v93, v93
    v_cvt_pk_bf16_f32 v24, v88, v89
    v_and_b32 v23, -2, v23
    v_mfma_f32_32x32x16_bf16 v[112:127], a[248:251], v[176:179], v[112:127]
    s_waitcnt lgkmcnt(4)
    ds_read_b64_tr_b16 a[244:245], v29 offset:28672
    ds_read_b64_tr_b16 a[246:247], v29 offset:29696
    v_exp_f32 v16, v16
    v_fma_f32 v19, v19, v60, v60
    v_fma_f32 v17, v17, v58, v59
    v_mul_f32 v90, v90, v18
    v_mfma_f32_32x32x16_bf16 v[96:111], a[252:255], v[176:179], v[96:111]
    ds_read_b64_tr_b16 a[248:249], v29 offset:31232
    ds_read_b64_tr_b16 a[250:251], v29 offset:32256
    v_rcp_f32 v19, v19
    v_mul_f32 v17, v17, v93
    v_mul_f32 v18, v94, v94
    v_exp_f32 v17, v17
    v_mfma_f32_32x32x16_bf16 v[112:127], a[232:235], v[180:183], v[112:127]
    s_waitcnt lgkmcnt(4)
    ds_read_b64_tr_b16 a[252:253], v29 offset:30720
    ds_read_b64_tr_b16 a[254:255], v29 offset:31744
    v_fma_f32 v16, v16, v60, v60
    v_fma_f32 v18, v18, v58, v59
    v_rcp_f32 v16, v16
    v_mul_f32 v91, v91, v19
    v_mfma_f32_32x32x16_bf16 v[96:111], a[236:239], v[180:183], v[96:111]
    ds_read_b64_tr_b16 a[232:233], v29 offset:512
    ds_read_b64_tr_b16 a[234:235], v29 offset:1536
    v_mul_f32 v18, v18, v94
    v_mul_f32 v19, v95, v95
    v_cvt_pk_bf16_f32 v25, v90, v91
    v_exp_f32 v18, v18
    v_fma_f32 v17, v17, v60, v60
    v_mfma_f32_32x32x16_bf16 v[112:127], a[240:243], v[184:187], v[112:127]
    s_waitcnt lgkmcnt(4)
    ds_read_b64_tr_b16 a[236:237], v29 offset:0
    ds_read_b64_tr_b16 a[238:239], v29 offset:1024
    v_fma_f32 v19, v19, v58, v59
    v_rcp_f32 v17, v17
    v_mul_f32 v92, v92, v16
    v_mul_f32 v19, v19, v95
    v_mfma_f32_32x32x16_bf16 v[96:111], a[244:247], v[184:187], v[96:111]
    ds_read_b64_tr_b16 a[240:241], v29 offset:2560
    ds_read_b64_tr_b16 a[242:243], v29 offset:3584
    v_exp_f32 v19, v19
    v_fma_f32 v18, v18, v60, v60
    v_rcp_f32 v18, v18
    v_mul_f32 v93, v93, v17
    v_mfma_f32_32x32x16_bf16 v[112:127], a[248:251], v[188:191], v[112:127]
    s_waitcnt lgkmcnt(4)
    ds_read_b64_tr_b16 a[244:245], v29 offset:2048
    ds_read_b64_tr_b16 a[246:247], v29 offset:3072
    v_cvt_pk_bf16_f32 v26, v92, v93
    v_fma_f32 v19, v19, v60, v60
    v_rcp_f32 v19, v19
    v_mul_f32 v94, v94, v18
    v_mfma_f32_32x32x16_bf16 v[96:111], a[252:255], v[188:191], v[96:111]
    ds_read_b64_tr_b16 a[248:249], v29 offset:4608
    ds_read_b64_tr_b16 a[250:251], v29 offset:5632
    v_mul_f32 v95, v95, v19
    v_cvt_pk_bf16_f32 v27, v94, v95
    v_and_b32 v27, -2, v27
    v_mfma_f32_32x32x16_bf16 v[112:127], a[232:235], v[128:131], v[112:127]
    s_waitcnt lgkmcnt(4)
    ds_read_b64_tr_b16 a[252:253], v29 offset:4096
    ds_read_b64_tr_b16 a[254:255], v29 offset:5120
    buffer_load_dword v9, v8, s[8:11], 0 offen offset:128 sc1
    v_mfma_f32_32x32x16_bf16 v[96:111], a[236:239], v[128:131], v[96:111]
    ds_read_b64_tr_b16 a[232:233], v29 offset:6656
    ds_read_b64_tr_b16 a[234:235], v29 offset:7680
    s_add_u32 s76, s60, 32768
    buffer_store_dwordx4 v[20:23], v1, s[8:11], s76 offen offset:0 sc1
    buffer_store_dwordx4 v[24:27], v1, s[8:11], s76 offen offset:1024 sc1
    v_mfma_f32_32x32x16_bf16 v[112:127], a[240:243], v[132:135], v[112:127]
    s_waitcnt lgkmcnt(4)
    ds_read_b64_tr_b16 a[236:237], v29 offset:6144
    ds_read_b64_tr_b16 a[238:239], v29 offset:7168
    v_mfma_f32_32x32x16_bf16 v[96:111], a[244:247], v[132:135], v[96:111]
    v_mfma_f32_32x32x16_bf16 v[112:127], a[248:251], v[136:139], v[112:127]
    s_waitcnt lgkmcnt(2)
    v_mfma_f32_32x32x16_bf16 v[96:111], a[252:255], v[136:139], v[96:111]
    v_mfma_f32_32x32x16_bf16 v[112:127], a[232:235], v[140:143], v[112:127]
    s_waitcnt lgkmcnt(0)
    v_mfma_f32_32x32x16_bf16 v[96:111], a[236:239], v[140:143], v[96:111]
    s_add_u32 s78, s50, 0x1000
    buffer_load_dwordx4 v[240:243], v1, s[8:11], s78 offen offset:0 sc1
    s_waitcnt vmcnt(12)
    v_bitop3_b32 v7, v195, v199, v203 bitop3:0xfe
    v_bitop3_b32 v7, v7, v207, 1 bitop3:0xa8
    v_cmp_ne_u32 vcc, 0, v7
    s_cbranch_vccnz OOL_504
RET_505:
    v_mfma_f32_32x32x16_bf16 v[80:95], a[4:7], v[192:195], 0
    buffer_load_dwordx4 v[244:247], v1, s[8:11], s78 offen offset:1024 sc1
    s_waitcnt vmcnt(4)
    v_subrev_u32 v9, s69, v9
    v_subrev_u32 v9, 2, v9
    v_cmp_lt_u32 vcc, 7, v9
    v_mfma_f32_32x32x16_bf16 v[64:79], a[0:3], v[192:195], 0
    s_cbranch_vccnz OOL_507
RET_508:
    buffer_load_dwordx4 v[248:251], v1, s[8:11], s78 offen offset:2048 sc1
    v_mul_f32 v16, v96, v96
    v_fma_f32 v16, v16, v58, v59
    v_mul_f32 v16, v16, v96
    v_mul_f32 v17, v97, v97
    v_fma_f32 v17, v17, v58, v59
    v_mfma_f32_32x32x16_bf16 v[80:95], a[12:15], v[196:199], v[80:95]
    v_exp_f32 v16, v16
    v_mul_f32 v17, v17, v97
    v_mul_f32 v18, v98, v98
    v_exp_f32 v17, v17
    v_fma_f32 v16, v16, v60, v60
    v_fma_f32 v18, v18, v58, v59
    v_rcp_f32 v16, v16
    v_mfma_f32_32x32x16_bf16 v[64:79], a[8:11], v[196:199], v[64:79]
    buffer_load_dwordx4 v[252:255], v1, s[8:11], s78 offen offset:3072 sc1
    v_mul_f32 v18, v18, v98
    v_mul_f32 v19, v99, v99
    v_exp_f32 v18, v18
    v_fma_f32 v17, v17, v60, v60
    v_fma_f32 v19, v19, v58, v59
    v_rcp_f32 v17, v17
    v_mul_f32 v96, v96, v16
    v_mfma_f32_32x32x16_bf16 v[80:95], a[36:39], v[200:203], v[80:95]
    v_mul_f32 v19, v19, v99
    v_mul_f32 v16, v100, v100
    v_exp_f32 v19, v19
    v_fma_f32 v18, v18, v60, v60
    v_fma_f32 v16, v16, v58, v59
    v_rcp_f32 v18, v18
    v_mul_f32 v97, v97, v17
    v_mul_f32 v16, v16, v100
    v_mfma_f32_32x32x16_bf16 v[64:79], a[32:35], v[200:203], v[64:79]
    s_add_u32 s78, s51, 0x8000
    buffer_load_dwordx4 v[144:147], v1, s[8:11], s78 offen offset:0 sc1
    v_mul_f32 v17, v101, v101
    v_cvt_pk_bf16_f32 v20, v96, v97
    v_exp_f32 v16, v16
    v_fma_f32 v19, v19, v60, v60
    v_fma_f32 v17, v17, v58, v59
    v_rcp_f32 v19, v19
    v_mfma_f32_32x32x16_bf16 v[80:95], a[44:47], v[204:207], v[80:95]
    v_bitop3_b32 v7, v211, v215, v219 bitop3:0xfe
    v_bitop3_b32 v7, v7, v223, 1 bitop3:0xa8
    v_cmp_ne_u32 vcc, 0, v7
    v_mul_f32 v98, v98, v18
    v_mul_f32 v17, v17, v101
    v_mul_f32 v18, v102, v102
    v_exp_f32 v17, v17
    v_fma_f32 v16, v16, v60, v60
    v_fma_f32 v18, v18, v58, v59
    v_mfma_f32_32x32x16_bf16 v[64:79], a[40:43], v[204:207], v[64:79]
    s_cbranch_vccnz OOL_510
RET_511:
    buffer_load_dwordx4 v[148:151], v1, s[8:11], s78 offen offset:1024 sc1
    v_rcp_f32 v16, v16
    v_mul_f32 v99, v99, v19
    v_mul_f32 v18, v18, v102
    v_mul_f32 v19, v103, v103
    v_mfma_f32_32x32x16_bf16 v[80:95], a[68:71], v[208:211], v[80:95]
    v_cvt_pk_bf16_f32 v21, v98, v99
    v_exp_f32 v18, v18
    v_fma_f32 v17, v17, v60, v60
    v_fma_f32 v19, v19, v58, v59
    v_rcp_f32 v17, v17
    v_mul_f32 v100, v100, v16
    v_mul_f32 v19, v19, v103
    v_mul_f32 v16, v104, v104
    v_mfma_f32_32x32x16_bf16 v[64:79], a[64:67], v[208:211], v[64:79]
    buffer_load_dwordx4 v[152:155], v1, s[8:11], s78 offen offset:2048 sc1
    v_exp_f32 v19, v19
    v_fma_f32 v18, v18, v60, v60
    v_fma_f32 v16, v16, v58, v59
    v_rcp_f32 v18, v18
    v_mul_f32 v101, v101, v17
    v_mul_f32 v16, v16, v104
    v_mul_f32 v17, v105, v105
    v_mfma_f32_32x32x16_bf16 v[80:95], a[76:79], v[212:215], v[80:95]
    v_cvt_pk_bf16_f32 v22, v100, v101
    v_exp_f32 v16, v16
    v_fma_f32 v19, v19, v60, v60
    v_fma_f32 v17, v17, v58, v59
    v_rcp_f32 v19, v19
    v_mul_f32 v102, v102, v18
    v_mul_f32 v17, v17, v105
    v_mul_f32 v18, v106, v106
    v_mfma_f32_32x32x16_bf16 v[64:79], a[72:75], v[212:215], v[64:79]
    buffer_load_dwordx4 v[156:159], v1, s[8:11], s78 offen offset:3072 sc1
    v_exp_f32 v17, v17
    v_fma_f32 v16, v16, v60, v60
    v_fma_f32 v18, v18, v58, v59
    v_rcp_f32 v16, v16
    v_mul_f32 v103, v103, v19
    v_mul_f32 v18, v18, v106
    v_mul_f32 v19, v107, v107
    v_mfma_f32_32x32x16_bf16 v[80:95], a[100:103], v[216:219], v[80:95]
    v_cvt_pk_bf16_f32 v23, v102, v103
    v_exp_f32 v18, v18
    v_fma_f32 v17, v17, v60, v60
    v_fma_f32 v19, v19, v58, v59
    v_rcp_f32 v17, v17
    v_mul_f32 v104, v104, v16
    v_mul_f32 v19, v19, v107
    v_mul_f32 v16, v108, v108
    v_mfma_f32_32x32x16_bf16 v[64:79], a[96:99], v[216:219], v[64:79]
    s_add_u32 s78, s51, 0x9000
    buffer_load_dwordx4 v[160:163], v1, s[8:11], s78 offen offset:0 sc1
    v_exp_f32 v19, v19
    v_fma_f32 v18, v18, v60, v60
    v_fma_f32 v16, v16, v58, v59
    v_rcp_f32 v18, v18
    v_mul_f32 v105, v105, v17
    v_mul_f32 v16, v16, v108
    v_mfma_f32_32x32x16_bf16 v[80:95], a[108:111], v[220:223], v[80:95]
    v_bitop3_b32 v7, v227, v231, v235 bitop3:0xfe
    v_bitop3_b32 v7, v7, v239, 1 bitop3:0xa8
    v_cmp_ne_u32 vcc, 0, v7
    v_mul_f32 v17, v109, v109
    v_cvt_pk_bf16_f32 v24, v104, v105
    v_and_b32 v23, -2, v23
    v_exp_f32 v16, v16
    v_fma_f32 v19, v19, v60, v60
    v_fma_f32 v17, v17, v58, v59
    v_mfma_f32_32x32x16_bf16 v[64:79], a[104:107], v[220:223], v[64:79]
    s_cbranch_vccnz OOL_513
RET_514:
    buffer_load_dwordx4 v[164:167], v1, s[8:11], s78 offen offset:1024 sc1
    v_rcp_f32 v19, v19
    v_mul_f32 v106, v106, v18
    v_mul_f32 v17, v17, v109
    v_mul_f32 v18, v110, v110
    v_mfma_f32_32x32x16_bf16 v[128:143], a[4:7], v[224:227], 0
    v_exp_f32 v17, v17
    v_fma_f32 v16, v16, v60, v60
    v_fma_f32 v18, v18, v58, v59
    v_rcp_f32 v16, v16
    v_mul_f32 v107, v107, v19
    v_mul_f32 v18, v18, v110
    v_mul_f32 v19, v111, v111
    v_cvt_pk_bf16_f32 v25, v106, v107
    v_mfma_f32_32x32x16_bf16 v[32:47], a[0:3], v[224:227], v[32:47]
    buffer_load_dwordx4 v[168:171], v1, s[8:11], s78 offen offset:2048 sc1
    v_exp_f32 v18, v18
    v_fma_f32 v17, v17, v60, v60
    v_fma_f32 v19, v19, v58, v59
    v_rcp_f32 v17, v17
    v_mul_f32 v108, v108, v16
    v_mul_f32 v19, v19, v111
    v_mul_f32 v16, v112, v112
    v_mfma_f32_32x32x16_bf16 v[128:143], a[12:15], v[228:231], v[128:143]
    v_exp_f32 v19, v19
    v_fma_f32 v18, v18, v60, v60
    v_fma_f32 v16, v16, v58, v59
    v_rcp_f32 v18, v18
    v_mul_f32 v109, v109, v17
    v_mul_f32 v16, v16, v112
    v_mul_f32 v17, v113, v113
    v_cvt_pk_bf16_f32 v26, v108, v109
    v_mfma_f32_32x32x16_bf16 v[32:47], a[8:11], v[228:231], v[32:47]
    buffer_load_dwordx4 v[172:175], v1, s[8:11], s78 offen offset:3072 sc1
    v_exp_f32 v16, v16
    v_fma_f32 v19, v19, v60, v60
    v_fma_f32 v17, v17, v58, v59
    v_rcp_f32 v19, v19
    v_mul_f32 v110, v110, v18
    v_mul_f32 v17, v17, v113
    v_mul_f32 v18, v114, v114
    v_mfma_f32_32x32x16_bf16 v[128:143], a[36:39], v[232:235], v[128:143]
    v_exp_f32 v17, v17
    v_fma_f32 v16, v16, v60, v60
    v_fma_f32 v18, v18, v58, v59
    v_rcp_f32 v16, v16
    v_mul_f32 v111, v111, v19
    v_mul_f32 v18, v18, v114
    v_mul_f32 v19, v115, v115
    v_cvt_pk_bf16_f32 v27, v110, v111
    v_mfma_f32_32x32x16_bf16 v[32:47], a[32:35], v[232:235], v[32:47]
    s_add_u32 s78, s50, 0x8000
    buffer_load_dwordx4 v[176:179], v1, s[8:11], s78 offen offset:0 sc1
    v_and_b32 v27, -2, v27
    v_exp_f32 v18, v18
    v_fma_f32 v17, v17, v60, v60
    v_fma_f32 v19, v19, v58, v59
    v_rcp_f32 v17, v17
    v_mul_f32 v112, v112, v16
    v_mfma_f32_32x32x16_bf16 v[128:143], a[44:47], v[236:239], v[128:143]
    buffer_store_dwordx4 v[20:23], v1, s[8:11], s61 offen offset:0 sc1
    buffer_store_dwordx4 v[24:27], v1, s[8:11], s61 offen offset:1024 sc1
    s_waitcnt vmcnt(11)
    v_bitop3_b32 v7, v243, v247, v251 bitop3:0xfe
    v_bitop3_b32 v7, v7, v255, 1 bitop3:0xa8
    v_cmp_ne_u32 vcc, 0, v7
    v_mul_f32 v19, v19, v115
    v_mul_f32 v16, v116, v116
    v_fma_f32 v18, v18, v60, v60
    v_mfma_f32_32x32x16_bf16 v[32:47], a[40:43], v[236:239], v[32:47]
    s_cbranch_vccnz OOL_516
RET_517:
    buffer_load_dwordx4 v[180:183], v1, s[8:11], s78 offen offset:1024 sc1
    v_exp_f32 v19, v19
    v_fma_f32 v16, v16, v58, v59
    v_rcp_f32 v18, v18
    v_mfma_f32_32x32x16_bf16 v[128:143], a[68:71], v[240:243], v[128:143]
    v_mul_f32 v113, v113, v17
    v_mul_f32 v16, v16, v116
    v_mul_f32 v17, v117, v117
    v_cvt_pk_bf16_f32 v20, v112, v113
    v_exp_f32 v16, v16
    v_fma_f32 v19, v19, v60, v60
    v_fma_f32 v17, v17, v58, v59
    v_rcp_f32 v19, v19
    v_mfma_f32_32x32x16_bf16 v[32:47], a[64:67], v[240:243], v[32:47]
    buffer_load_dwordx4 v[184:187], v1, s[8:11], s78 offen offset:2048 sc1
    v_mul_f32 v114, v114, v18
    v_mul_f32 v17, v17, v117
    v_mul_f32 v18, v118, v118
    v_exp_f32 v17, v17
    v_fma_f32 v16, v16, v60, v60
    v_fma_f32 v18, v18, v58, v59
    v_rcp_f32 v16, v16
    v_mfma_f32_32x32x16_bf16 v[128:143], a[76:79], v[244:247], v[128:143]
    v_mul_f32 v115, v115, v19
    v_mul_f32 v18, v18, v118
    v_mul_f32 v19, v119, v119
    v_cvt_pk_bf16_f32 v21, v114, v115
    v_exp_f32 v18, v18
    v_fma_f32 v17, v17, v60, v60
    v_fma_f32 v19, v19, v58, v59
    v_rcp_f32 v17, v17
    v_mfma_f32_32x32x16_bf16 v[32:47], a[72:75], v[244:247], v[32:47]
    buffer_load_dwordx4 v[188:191], v1, s[8:11], s78 offen offset:3072 sc1
    v_mul_f32 v116, v116, v16
    v_mul_f32 v19, v19, v119
    v_mul_f32 v16, v120, v120
    v_exp_f32 v19, v19
    v_fma_f32 v18, v18, v60, v60
    v_fma_f32 v16, v16, v58, v59
    v_rcp_f32 v18, v18
    v_mfma_f32_32x32x16_bf16 v[128:143], a[100:103], v[248:251], v[128:143]
    v_mul_f32 v117, v117, v17
    v_mul_f32 v16, v16, v120
    v_mul_f32 v17, v121, v121
    v_cvt_pk_bf16_f32 v22, v116, v117
    v_exp_f32 v16, v16
    v_fma_f32 v19, v19, v60, v60
    v_fma_f32 v17, v17, v58, v59
    v_rcp_f32 v19, v19
    v_mfma_f32_32x32x16_bf16 v[32:47], a[96:99], v[248:251], v[32:47]
    s_add_u32 s78, s50, 0x9000
    buffer_load_dwordx4 v[192:195], v1, s[8:11], s78 offen offset:0 sc1
    v_mul_f32 v118, v118, v18
    v_mul_f32 v17, v17, v121
    v_mul_f32 v18, v122, v122
    v_exp_f32 v17, v17
    v_fma_f32 v16, v16, v60, v60
    v_fma_f32 v18, v18, v58, v59
    v_mul_f32 v119, v119, v19
    v_mfma_f32_32x32x16_bf16 v[128:143], a[108:111], v[252:255], v[128:143]
    s_waitcnt vmcnt(11)
    v_bitop3_b32 v7, v147, v151, v155 bitop3:0xfe
    v_bitop3_b32 v7, v7, v159, 1 bitop3:0xa8
    v_cmp_ne_u32 vcc, 0, v7
    v_rcp_f32 v16, v16
    v_mul_f32 v18, v18, v122
    v_mul_f32 v19, v123, v123
    v_cvt_pk_bf16_f32 v23, v118, v119
    v_exp_f32 v18, v18
    v_mfma_f32_32x32x16_bf16 v[32:47], a[104:107], v[252:255], v[32:47]
    s_cbranch_vccnz OOL_519
RET_520:
    buffer_load_dwordx4 v[196:199], v1, s[8:11], s78 offen offset:1024 sc1
    v_fma_f32 v17, v17, v60, v60
    v_fma_f32 v19, v19, v58, v59
    v_rcp_f32 v17, v17
    v_mul_f32 v120, v120, v16
    v_mfma_f32_32x32x16_bf16 v[80:95], a[20:23], v[144:147], v[80:95]
    v_mul_f32 v19, v19, v123
    v_mul_f32 v16, v124, v124
    v_exp_f32 v19, v19
    v_fma_f32 v18, v18, v60, v60
    v_fma_f32 v16, v16, v58, v59
    v_rcp_f32 v18, v18
    v_mul_f32 v121, v121, v17
    v_mul_f32 v16, v16, v124
    v_mfma_f32_32x32x16_bf16 v[64:79], a[16:19], v[144:147], v[64:79]
    buffer_load_dwordx4 v[200:203], v1, s[8:11], s78 offen offset:2048 sc1
    v_mul_f32 v17, v125, v125
    v_cvt_pk_bf16_f32 v24, v120, v121
    v_and_b32 v23, -2, v23
    v_exp_f32 v16, v16
    v_fma_f32 v19, v19, v60, v60
    v_fma_f32 v17, v17, v58, v59
    v_rcp_f32 v19, v19
    v_mfma_f32_32x32x16_bf16 v[80:95], a[28:31], v[148:151], v[80:95]
    v_mul_f32 v122, v122, v18
    v_mul_f32 v17, v17, v125
    v_mul_f32 v18, v126, v126
    v_exp_f32 v17, v17
    v_fma_f32 v16, v16, v60, v60
    v_fma_f32 v18, v18, v58, v59
    v_rcp_f32 v16, v16
    v_mul_f32 v123, v123, v19
    v_mfma_f32_32x32x16_bf16 v[64:79], a[24:27], v[148:151], v[64:79]
    buffer_load_dwordx4 v[204:207], v1, s[8:11], s78 offen offset:3072 sc1
    v_mul_f32 v18, v18, v126
    v_mul_f32 v19, v127, v127
    v_cvt_pk_bf16_f32 v25, v122, v123
    v_exp_f32 v18, v18
    v_fma_f32 v17, v17, v60, v60
    v_fma_f32 v19, v19, v58, v59
    v_rcp_f32 v17, v17
    v_mfma_f32_32x32x16_bf16 v[80:95], a[52:55], v[152:155], v[80:95]
    v_mul_f32 v124, v124, v16
    v_mul_f32 v19, v19, v127
    v_exp_f32 v19, v19
    v_fma_f32 v18, v18, v60, v60
    v_rcp_f32 v18, v18
    v_mul_f32 v125, v125, v17
    v_cvt_pk_bf16_f32 v26, v124, v125
    v_fma_f32 v19, v19, v60, v60
    v_mfma_f32_32x32x16_bf16 v[64:79], a[48:51], v[152:155], v[64:79]
    buffer_load_dwordx4 v[208:211], v1, s[8:11], s53 offen offset:0 sc1
    v_rcp_f32 v19, v19
    v_mul_f32 v126, v126, v18
    v_mul_f32 v127, v127, v19
    v_cvt_pk_bf16_f32 v27, v126, v127
    v_and_b32 v27, -2, v27
    v_mfma_f32_32x32x16_bf16 v[80:95], a[60:63], v[156:159], v[80:95]
    s_add_u32 s76, s61, 6144
    buffer_store_dwordx4 v[20:23], v1, s[8:11], s76 offen offset:0 sc1
    buffer_store_dwordx4 v[24:27], v1, s[8:11], s76 offen offset:1024 sc1
    s_waitcnt vmcnt(13)
    v_bitop3_b32 v7, v163, v167, v171 bitop3:0xfe
    v_bitop3_b32 v7, v7, v175, 1 bitop3:0xa8
    v_cmp_ne_u32 vcc, 0, v7
    v_mfma_f32_32x32x16_bf16 v[64:79], a[56:59], v[156:159], v[64:79]
    s_cbranch_vccnz OOL_522
RET_523:
    buffer_load_dwordx4 v[212:215], v1, s[8:11], s53 offen offset:1024 sc1
    v_mfma_f32_32x32x16_bf16 v[80:95], a[84:87], v[160:163], v[80:95]
    v_mfma_f32_32x32x16_bf16 v[64:79], a[80:83], v[160:163], v[64:79]
    buffer_load_dwordx4 v[216:219], v1, s[8:11], s53 offen offset:2048 sc1
    v_mfma_f32_32x32x16_bf16 v[80:95], a[92:95], v[164:167], v[80:95]
    v_mfma_f32_32x32x16_bf16 v[64:79], a[88:91], v[164:167], v[64:79]
    buffer_load_dwordx4 v[220:223], v1, s[8:11], s53 offen offset:3072 sc1
    v_mfma_f32_32x32x16_bf16 v[80:95], a[116:119], v[168:171], v[80:95]
    v_mfma_f32_32x32x16_bf16 v[64:79], a[112:115], v[168:171], v[64:79]
    s_add_u32 s78, s53, 0x1000
    buffer_load_dwordx4 v[224:227], v1, s[8:11], s78 offen offset:0 sc1
    v_mfma_f32_32x32x16_bf16 v[80:95], a[124:127], v[172:175], v[80:95]
    s_waitcnt vmcnt(11)
    v_bitop3_b32 v7, v179, v183, v187 bitop3:0xfe
    v_bitop3_b32 v7, v7, v191, 1 bitop3:0xa8
    v_cmp_ne_u32 vcc, 0, v7
    v_mfma_f32_32x32x16_bf16 v[64:79], a[120:123], v[172:175], v[64:79]
    s_cbranch_vccnz OOL_525
RET_526:
    buffer_load_dwordx4 v[228:231], v1, s[8:11], s78 offen offset:1024 sc1
    v_mfma_f32_32x32x16_bf16 v[128:143], a[20:23], v[176:179], v[128:143]
    v_mfma_f32_32x32x16_bf16 v[32:47], a[16:19], v[176:179], v[32:47]
    buffer_load_dwordx4 v[232:235], v1, s[8:11], s52 offen offset:0 sc1
    v_mfma_f32_32x32x16_bf16 v[128:143], a[28:31], v[180:183], v[128:143]
    v_mfma_f32_32x32x16_bf16 v[32:47], a[24:27], v[180:183], v[32:47]
    buffer_load_dwordx4 v[236:239], v1, s[8:11], s52 offen offset:1024 sc1
    v_mfma_f32_32x32x16_bf16 v[128:143], a[52:55], v[184:187], v[128:143]
    v_mfma_f32_32x32x16_bf16 v[32:47], a[48:51], v[184:187], v[32:47]
    buffer_load_dwordx4 v[240:243], v1, s[8:11], s52 offen offset:2048 sc1
    v_mfma_f32_32x32x16_bf16 v[128:143], a[60:63], v[188:191], v[128:143]
    s_waitcnt vmcnt(11)
    v_bitop3_b32 v7, v195, v199, v203 bitop3:0xfe
    v_bitop3_b32 v7, v7, v207, 1 bitop3:0xa8
    v_cmp_ne_u32 vcc, 0, v7
    v_mfma_f32_32x32x16_bf16 v[32:47], a[56:59], v[188:191], v[32:47]
    s_cbranch_vccnz OOL_528
RET_529:
    buffer_load_dwordx4 v[244:247], v1, s[8:11], s52 offen offset:3072 sc1
    v_mfma_f32_32x32x16_bf16 v[128:143], a[84:87], v[192:195], v[128:143]
    v_mfma_f32_32x32x16_bf16 v[32:47], a[80:83], v[192:195], v[32:47]
    s_add_u32 s78, s52, 0x1000
    buffer_load_dwordx4 v[248:251], v1, s[8:11], s78 offen offset:0 sc1
    v_mfma_f32_32x32x16_bf16 v[128:143], a[92:95], v[196:199], v[128:143]
    v_mfma_f32_32x32x16_bf16 v[32:47], a[88:91], v[196:199], v[32:47]
    buffer_load_dwordx4 v[252:255], v1, s[8:11], s78 offen offset:1024 sc1
    v_mfma_f32_32x32x16_bf16 v[128:143], a[116:119], v[200:203], v[128:143]
    v_mfma_f32_32x32x16_bf16 v[32:47], a[112:115], v[200:203], v[32:47]
    s_add_u32 s78, s53, 0x1800
    buffer_load_dwordx4 v[144:147], v1, s[8:11], s78 offen offset:0 sc1
    v_mfma_f32_32x32x16_bf16 v[128:143], a[124:127], v[204:207], v[128:143]
    s_waitcnt vmcnt(9)
    v_bitop3_b32 v7, v211, v215, v219 bitop3:0xfe
    v_bitop3_b32 v7, v7, v223, 1 bitop3:0xa8
    v_cmp_ne_u32 vcc, 0, v7
    v_mfma_f32_32x32x16_bf16 v[32:47], a[120:123], v[204:207], v[32:47]
    s_cbranch_vccnz OOL_531
RET_532:
    buffer_load_dwordx4 v[148:151], v1, s[8:11], s78 offen offset:1024 sc1
    v_mfma_f32_32x32x16_bf16 v[80:95], a[132:135], v[208:211], v[80:95]
    v_mfma_f32_32x32x16_bf16 v[64:79], a[128:131], v[208:211], v[64:79]
    buffer_load_dwordx4 v[152:155], v1, s[8:11], s78 offen offset:2048 sc1
    v_mfma_f32_32x32x16_bf16 v[80:95], a[140:143], v[212:215], v[80:95]
    v_mfma_f32_32x32x16_bf16 v[64:79], a[136:139], v[212:215], v[64:79]
    buffer_load_dwordx4 v[156:159], v1, s[8:11], s78 offen offset:3072 sc1
    v_mfma_f32_32x32x16_bf16 v[80:95], a[164:167], v[216:219], v[80:95]
    v_mfma_f32_32x32x16_bf16 v[64:79], a[160:163], v[216:219], v[64:79]
    s_add_u32 s78, s53, 0x2800
    buffer_load_dwordx4 v[160:163], v1, s[8:11], s78 offen offset:0 sc1
    v_mfma_f32_32x32x16_bf16 v[80:95], a[172:175], v[220:223], v[80:95]
    s_waitcnt vmcnt(11)
    v_bitop3_b32 v7, v227, v231, 1 bitop3:0xa8
    v_cmp_ne_u32 vcc, 0, v7
    v_mfma_f32_32x32x16_bf16 v[64:79], a[168:171], v[220:223], v[64:79]
    s_cbranch_vccnz OOL_534
RET_535:
    buffer_load_dwordx4 v[164:167], v1, s[8:11], s78 offen offset:1024 sc1
    v_mfma_f32_32x32x16_bf16 v[80:95], a[196:199], v[224:227], v[80:95]
    v_mfma_f32_32x32x16_bf16 v[64:79], a[192:195], v[224:227], v[64:79]
    s_add_u32 s78, s52, 0x1800
    buffer_load_dwordx4 v[168:171], v1, s[8:11], s78 offen offset:0 sc1
    v_mfma_f32_32x32x16_bf16 v[80:95], a[204:207], v[228:231], v[80:95]
    s_waitcnt vmcnt(9)
    v_bitop3_b32 v7, v235, v239, v243 bitop3:0xfe
    v_bitop3_b32 v7, v7, v247, 1 bitop3:0xa8
    v_cmp_ne_u32 vcc, 0, v7
    v_mfma_f32_32x32x16_bf16 v[64:79], a[200:203], v[228:231], v[64:79]
    s_cbranch_vccnz OOL_537
RET_538:
    buffer_load_dwordx4 v[172:175], v1, s[8:11], s78 offen offset:1024 sc1
    v_mfma_f32_32x32x16_bf16 v[128:143], a[132:135], v[232:235], v[128:143]
    v_mfma_f32_32x32x16_bf16 v[32:47], a[128:131], v[232:235], v[32:47]
    buffer_load_dwordx4 v[176:179], v1, s[8:11], s78 offen offset:2048 sc1
    v_mfma_f32_32x32x16_bf16 v[128:143], a[140:143], v[236:239], v[128:143]
    v_mfma_f32_32x32x16_bf16 v[32:47], a[136:139], v[236:239], v[32:47]
    buffer_load_dwordx4 v[180:183], v1, s[8:11], s78 offen offset:3072 sc1
    v_mfma_f32_32x32x16_bf16 v[128:143], a[164:167], v[240:243], v[128:143]
    v_mfma_f32_32x32x16_bf16 v[32:47], a[160:163], v[240:243], v[32:47]
    s_add_u32 s78, s52, 0x2800
    buffer_load_dwordx4 v[184:187], v1, s[8:11], s78 offen offset:0 sc1
    v_mfma_f32_32x32x16_bf16 v[128:143], a[172:175], v[244:247], v[128:143]
    s_waitcnt vmcnt(11)
    v_bitop3_b32 v7, v251, v255, 1 bitop3:0xa8
    v_cmp_ne_u32 vcc, 0, v7
    v_mfma_f32_32x32x16_bf16 v[32:47], a[168:171], v[244:247], v[32:47]
    s_cbranch_vccnz OOL_540
RET_541:
    buffer_load_dwordx4 v[188:191], v1, s[8:11], s78 offen offset:1024 sc1
    v_mfma_f32_32x32x16_bf16 v[128:143], a[196:199], v[248:251], v[128:143]
    v_mfma_f32_32x32x16_bf16 v[32:47], a[192:195], v[248:251], v[32:47]
    v_mfma_f32_32x32x16_bf16 v[128:143], a[204:207], v[252:255], v[128:143]
    s_waitcnt vmcnt(8)
    v_bitop3_b32 v7, v147, v151, v155 bitop3:0xfe
    v_bitop3_b32 v7, v7, v159, 1 bitop3:0xa8
    v_cmp_ne_u32 vcc, 0, v7
    v_mfma_f32_32x32x16_bf16 v[32:47], a[200:203], v[252:255], v[32:47]
    s_cbranch_vccnz OOL_543
RET_544:
    v_mfma_f32_32x32x16_bf16 v[80:95], a[148:151], v[144:147], v[80:95]
    v_mfma_f32_32x32x16_bf16 v[64:79], a[144:147], v[144:147], v[64:79]
    v_mfma_f32_32x32x16_bf16 v[80:95], a[156:159], v[148:151], v[80:95]
    v_mfma_f32_32x32x16_bf16 v[64:79], a[152:155], v[148:151], v[64:79]
    v_mfma_f32_32x32x16_bf16 v[80:95], a[180:183], v[152:155], v[80:95]
    v_mfma_f32_32x32x16_bf16 v[64:79], a[176:179], v[152:155], v[64:79]
    v_mfma_f32_32x32x16_bf16 v[80:95], a[188:191], v[156:159], v[80:95]
    s_waitcnt vmcnt(6)
    v_bitop3_b32 v7, v163, v167, 1 bitop3:0xa8
    v_cmp_ne_u32 vcc, 0, v7
    v_mfma_f32_32x32x16_bf16 v[64:79], a[184:187], v[156:159], v[64:79]
    s_cbranch_vccnz OOL_546
RET_547:
    v_mfma_f32_32x32x16_bf16 v[80:95], a[212:215], v[160:163], v[80:95]
    v_mfma_f32_32x32x16_bf16 v[64:79], a[208:211], v[160:163], v[64:79]
    v_mfma_f32_32x32x16_bf16 v[80:95], a[220:223], v[164:167], v[80:95]
    s_waitcnt vmcnt(2)
    v_bitop3_b32 v7, v171, v175, v179 bitop3:0xfe
    v_bitop3_b32 v7, v7, v183, 1 bitop3:0xa8
    v_cmp_ne_u32 vcc, 0, v7
    v_mfma_f32_32x32x16_bf16 v[64:79], a[216:219], v[164:167], v[64:79]
    s_cbranch_vccnz OOL_549
RET_550:
    v_mfma_f32_32x32x16_bf16 v[128:143], a[148:151], v[168:171], v[128:143]
    v_mfma_f32_32x32x16_bf16 v[128:143], a[156:159], v[172:175], v[128:143]
    v_xor_b32 v19, 6144, v2
    s_nop 2
    v_cvt_pk_bf16_f32 v80, v80, v81
    v_cvt_pk_bf16_f32 v81, v82, v83
    v_cvt_pk_bf16_f32 v82, v84, v85
    v_cvt_pk_bf16_f32 v83, v86, v87
    v_mfma_f32_32x32x16_bf16 v[128:143], a[180:183], v[176:179], v[128:143]
    ds_write_b128 v19, v[80:83] offset:16384
    v_cvt_pk_bf16_f32 v84, v88, v89
    v_cvt_pk_bf16_f32 v85, v90, v91
    v_cvt_pk_bf16_f32 v86, v92, v93
    v_mfma_f32_32x32x16_bf16 v[32:47], a[144:147], v[168:171], v[32:47]
    v_cvt_pk_bf16_f32 v87, v94, v95
    v_xor_b32 v17, 2048, v2
    v_cvt_pk_bf16_f32 v64, v64, v65
    v_cvt_pk_bf16_f32 v65, v66, v67
    v_cvt_pk_bf16_f32 v66, v68, v69
    v_cvt_pk_bf16_f32 v67, v70, v71
    v_mfma_f32_32x32x16_bf16 v[128:143], a[188:191], v[180:183], v[128:143]
    ds_write_b128 v19, v[84:87] offset:17408
    s_waitcnt vmcnt(0)
    v_bitop3_b32 v7, v187, v191, 1 bitop3:0xa8
    v_cmp_ne_u32 vcc, 0, v7
    v_mfma_f32_32x32x16_bf16 v[32:47], a[152:155], v[172:175], v[32:47]
    s_cbranch_vccnz OOL_552
RET_553:
    v_cvt_pk_bf16_f32 v68, v72, v73
    v_cvt_pk_bf16_f32 v69, v74, v75
    v_cvt_pk_bf16_f32 v70, v76, v77
    v_mfma_f32_32x32x16_bf16 v[128:143], a[212:215], v[184:187], v[128:143]
    ds_write_b128 v17, v[64:67] offset:0
    v_cvt_pk_bf16_f32 v71, v78, v79
    v_mfma_f32_32x32x16_bf16 v[32:47], a[176:179], v[176:179], v[32:47]
    ds_write_b128 v17, v[68:71] offset:1024
    v_mfma_f32_32x32x16_bf16 v[128:143], a[220:223], v[188:191], v[128:143]
    v_add_u32 v16, 161792, v1
    s_waitcnt lgkmcnt(0)
    s_barrier
    ds_read_b128 v[120:123], v16 offset:0
    ds_read_b128 v[124:127], v16 offset:1024
    ds_read_b128 v[80:83], v2 offset:0
    ds_read_b128 v[84:87], v2 offset:1024
    ds_read_b128 v[112:115], v2 offset:16384
    ds_read_b128 v[116:119], v2 offset:17408
    v_mfma_f32_32x32x16_bf16 v[32:47], a[184:187], v[180:183], v[32:47]
    v_mfma_f32_32x32x16_bf16 v[32:47], a[208:211], v[184:187], v[32:47]
    v_xor_b32 v18, 4096, v2
    v_cvt_pk_bf16_f32 v128, v128, v129
    v_cvt_pk_bf16_f32 v129, v130, v131
    v_cvt_pk_bf16_f32 v130, v132, v133
    v_cvt_pk_bf16_f32 v131, v134, v135
    v_cvt_pk_bf16_f32 v132, v136, v137
    v_mfma_f32_32x32x16_bf16 v[32:47], a[216:219], v[188:191], v[32:47]
    ds_write_b128 v18, v[128:131] offset:8192
    v_cvt_pk_bf16_f32 v133, v138, v139
    v_cvt_pk_bf16_f32 v134, v140, v141
    v_cvt_pk_bf16_f32 v135, v142, v143
    s_waitcnt lgkmcnt(4)
    v_mfma_f32_32x32x16_bf16 v[32:47], v[120:123], v[80:83], v[32:47]
    ds_write_b128 v18, v[132:135] offset:9216
    s_waitcnt lgkmcnt(4)
    v_mfma_f32_32x32x16_bf16 v[32:47], v[124:127], v[84:87], v[32:47]
    s_waitcnt lgkmcnt(0)
    s_barrier
    ds_read_b128 v[96:99], v2 offset:8192
    ds_read_b128 v[100:103], v2 offset:9216
    v_mfma_f32_32x32x16_bf16 v[32:47], v[120:123], v[112:115], v[32:47]
    v_mfma_f32_32x32x16_bf16 v[32:47], v[124:127], v[116:119], v[32:47]
    s_waitcnt lgkmcnt(1)
    s_nop 10
    v_dot2c_f32_bf16 v32, s65, v96
    v_dot2c_f32_bf16 v33, s66, v96
    v_dot2c_f32_bf16 v34, s65, v97
    v_dot2c_f32_bf16 v35, s66, v97
    v_dot2c_f32_bf16 v36, s65, v98
    v_dot2c_f32_bf16 v37, s66, v98
    v_dot2c_f32_bf16 v38, s65, v99
    v_dot2c_f32_bf16 v39, s66, v99
    s_waitcnt lgkmcnt(0)
    v_dot2c_f32_bf16 v40, s65, v100
    v_dot2c_f32_bf16 v41, s66, v100
    v_dot2c_f32_bf16 v42, s65, v101
    v_dot2c_f32_bf16 v43, s66, v101
    v_dot2c_f32_bf16 v44, s65, v102
    v_dot2c_f32_bf16 v45, s66, v102
    v_dot2c_f32_bf16 v46, s65, v103
    v_dot2c_f32_bf16 v47, s66, v103
    v_cvt_pk_bf16_f32 v112, v32, v33
    v_cvt_pk_bf16_f32 v113, v34, v35
    v_cvt_pk_bf16_f32 v114, v36, v37
    v_cvt_pk_bf16_f32 v115, v38, v39
    v_cvt_pk_bf16_f32 v116, v40, v41
    v_cvt_pk_bf16_f32 v117, v42, v43
    v_cvt_pk_bf16_f32 v118, v44, v45
    v_cvt_pk_bf16_f32 v119, v46, v47
    v_and_b32 v16, 31, v0
    v_lshlrev_b32 v16, 10, v16
    v_lshrrev_b32 v17, 5, v0
    v_lshl_add_u32 v16, v17, 4, v16
    s_lshr_b32 s76, s67, 3
    s_bfe_u32 s77, s46, 0x30011
    s_lshl_b32 s77, s77, 15
    s_add_u32 s76, s76, s77
    s_lshl_b32 s77, s70, 6
    s_add_u32 s76, s76, s77
    v_permlane32_swap_b32 v112, v114
    v_permlane32_swap_b32 v113, v115
    buffer_store_dwordx4 v[112:115], v16, s[12:15], s76 offen offset:0
    v_permlane32_swap_b32 v116, v118
    v_permlane32_swap_b32 v117, v119
    buffer_store_dwordx4 v[116:119], v16, s[12:15], s76 offen offset:32
    s_or_b32 s76, s2, s44
    s_mov_b32 s77, 0x1130000
    v_mov_b32 v18, s69
    s_cmp_eq_u32 s76, 0
    s_cbranch_scc1 OOL_554
RET_555:
    s_nop 2
L_end2:
    s_endpgm
OOL_283:
    s_nop 3
CHK_282:
    buffer_load_dwordx4 v[136:139], v64, s[8:11], s7 offen sc1
    buffer_load_dwordx4 v[140:143], v64, s[8:11], s85 offen sc1
    buffer_load_dwordx4 v[144:147], v64, s[8:11], s5 offen sc1
    s_sub_u32 s45, s45, 1
    s_nop 0
    s_cbranch_scc1 L_end2
    s_waitcnt vmcnt(0)
    v_xor_b32 v116, s69, v139
    v_bitop3_b32 v116, v116, v143, s69 bitop3:0xf6
    v_bitop3_b32 v116, v116, v146, s69 bitop3:0xf6
    v_cmp_ne_u32 vcc, 0, v116
    s_nop 4
    s_cbranch_vccnz CHK_282
    s_nop 0
    s_branch RET_284
OOL_288:
    s_nop 3
CHK_287:
    buffer_load_dword v9, v6, s[8:11], 0 offen offset:0 sc1
    s_sub_u32 s45, s45, 1
    s_nop 0
    s_cbranch_scc1 L_end2
    s_waitcnt vmcnt(0)
    v_subrev_u32 v9, s69, v9
    v_subrev_u32 v9, 1, v9
    v_cmp_lt_u32 vcc, 7, v9
    s_nop 4
    s_cbranch_vccnz CHK_287
    s_nop 0
    s_branch RET_289
OOL_291:
    s_nop 3
CHK_290:
    buffer_load_dwordx4 v[80:83], v1, s[8:11], s76 offen offset:0 sc1
    buffer_load_dwordx4 v[84:87], v1, s[8:11], s76 offen offset:1024 sc1
    buffer_load_dwordx4 v[88:91], v1, s[8:11], s76 offen offset:2048 sc1
    buffer_load_dwordx4 v[92:95], v1, s[8:11], s76 offen offset:3072 sc1
    s_sub_u32 s45, s45, 1
    s_nop 0
    s_cbranch_scc1 L_end2
    s_waitcnt vmcnt(0)
    v_bitop3_b32 v7, v80, v81, v82 bitop3:0x80
    v_bitop3_b32 v7, v7, v83, v84 bitop3:0x80
    v_bitop3_b32 v7, v7, v85, v86 bitop3:0x80
    v_bitop3_b32 v7, v7, v87, v88 bitop3:0x80
    v_bitop3_b32 v7, v7, v89, v90 bitop3:0x80
    v_bitop3_b32 v7, v7, v91, v92 bitop3:0x80
    v_bitop3_b32 v7, v7, v93, v94 bitop3:0x80
    v_bitop3_b32 v7, v7, v95, 1 bitop3:0x2a
    v_cmp_ne_u32 vcc, 0, v7
    s_nop 4
    s_cbranch_vccnz CHK_290
    s_nop 0
    s_branch RET_292
OOL_294:
    s_nop 3
CHK_293:
    buffer_load_dwordx2 v[160:161], v123, s[8:11], s46 offen offset:0 sc1
    buffer_load_dwordx2 v[162:163], v123, s[8:11], s46 offen offset:256 sc1
    buffer_load_dwordx2 v[164:165], v123, s[8:11], s46 offen offset:1024 sc1
    buffer_load_dwordx2 v[166:167], v123, s[8:11], s46 offen offset:1280 sc1
    buffer_load_dwordx2 v[168:169], v123, s[8:11], s78 offen offset:0 sc1
    buffer_load_dwordx2 v[170:171], v123, s[8:11], s78 offen offset:256 sc1
    buffer_load_dwordx2 v[172:173], v123, s[8:11], s78 offen offset:1024 sc1
    buffer_load_dwordx2 v[174:175], v123, s[8:11], s78 offen offset:1280 sc1
    s_sub_u32 s45, s45, 1
    s_nop 0
    s_cbranch_scc1 L_end2
    s_waitcnt vmcnt(0)
    v_xor_b32 v7, s69, v161
    v_bitop3_b32 v7, v7, v163, s69 bitop3:0xf6
    v_bitop3_b32 v7, v7, v165, s69 bitop3:0xf6
    v_bitop3_b32 v7, v7, v167, s69 bitop3:0xf6
    v_bitop3_b32 v7, v7, v169, s69 bitop3:0xf6
    v_bitop3_b32 v7, v7, v171, s69 bitop3:0xf6
    v_bitop3_b32 v7, v7, v173, s69 bitop3:0xf6
    v_bitop3_b32 v7, v7, v175, s69 bitop3:0xf6
    v_cmp_ne_u32 vcc, 0, v7
    s_nop 4
    s_cbranch_vccnz CHK_293
    s_nop 0
    s_branch RET_295
OOL_297:
    s_nop 7
CHK_296:
    s_add_u32 s79, s51, 0x110000
    buffer_load_dwordx4 v[132:135], v1, s[8:11], s79 offen offset:0 sc1
    buffer_load_dwordx4 v[140:143], v1, s[8:11], s79 offen offset:1024 sc1
    buffer_load_dwordx4 v[148:151], v1, s[8:11], s79 offen offset:2048 sc1
    buffer_load_dwordx4 v[156:159], v1, s[8:11], s79 offen offset:3072 sc1
    s_add_u32 s79, s51, 0x111000
    buffer_load_dwordx4 v[164:167], v1, s[8:11], s79 offen offset:0 sc1
    buffer_load_dwordx4 v[172:175], v1, s[8:11], s79 offen offset:1024 sc1
    buffer_load_dwordx4 v[180:183], v1, s[8:11], s79 offen offset:2048 sc1
    buffer_load_dwordx4 v[188:191], v1, s[8:11], s79 offen offset:3072 sc1
    s_sub_u32 s45, s45, 1
    s_nop 0
    s_cbranch_scc1 L_end2
    s_waitcnt vmcnt(6)
    v_bitop3_b32 v7, v135, v143, 1 bitop3:0x2a
    v_cmp_ne_u32 vcc, 0, v7
    s_nop 4
    s_cbranch_vccnz CHK_296
    s_nop 0
    s_branch RET_298
OOL_300:
    s_nop 10
CHK_299:
    s_add_u32 s79, s51, 0x110000
    buffer_load_dwordx4 v[148:151], v1, s[8:11], s79 offen offset:2048 sc1
    buffer_load_dwordx4 v[156:159], v1, s[8:11], s79 offen offset:3072 sc1
    s_add_u32 s79, s51, 0x111000
    buffer_load_dwordx4 v[164:167], v1, s[8:11], s79 offen offset:0 sc1
    buffer_load_dwordx4 v[172:175], v1, s[8:11], s79 offen offset:1024 sc1
    buffer_load_dwordx4 v[180:183], v1, s[8:11], s79 offen offset:2048 sc1
    buffer_load_dwordx4 v[188:191], v1, s[8:11], s79 offen offset:3072 sc1
    s_add_u32 s80, s50, 0x110000
    buffer_load_dwordx4 v[128:131], v1, s[8:11], s80 offen offset:0 sc1
    buffer_load_dword v62, off, s[8:11], s62
    buffer_load_dwordx4 v[136:139], v1, s[8:11], s80 offen offset:1024 sc1
    s_sub_u32 s45, s45, 1
    s_nop 0
    s_cbranch_scc1 L_end2
    s_waitcnt vmcnt(7)
    v_bitop3_b32 v7, v151, v159, 1 bitop3:0x2a
    v_cmp_ne_u32 vcc, 0, v7
    s_nop 4
    s_cbranch_vccnz CHK_299
    s_nop 0
    s_branch RET_301
OOL_303:
    s_nop 10
CHK_302:
    s_add_u32 s79, s51, 0x111000
    buffer_load_dwordx4 v[164:167], v1, s[8:11], s79 offen offset:0 sc1
    buffer_load_dwordx4 v[172:175], v1, s[8:11], s79 offen offset:1024 sc1
    buffer_load_dwordx4 v[180:183], v1, s[8:11], s79 offen offset:2048 sc1
    buffer_load_dwordx4 v[188:191], v1, s[8:11], s79 offen offset:3072 sc1
    s_add_u32 s80, s50, 0x110000
    buffer_load_dwordx4 v[128:131], v1, s[8:11], s80 offen offset:0 sc1
    buffer_load_dword v62, off, s[8:11], s62
    buffer_load_dwordx4 v[136:139], v1, s[8:11], s80 offen offset:1024 sc1
    buffer_load_dwordx4 v[144:147], v1, s[8:11], s80 offen offset:2048 sc1
    buffer_load_dwordx4 v[152:155], v1, s[8:11], s80 offen offset:3072 sc1
    s_sub_u32 s45, s45, 1
    s_nop 0
    s_cbranch_scc1 L_end2
    s_waitcnt vmcnt(5)
    v_bitop3_b32 v7, v167, v175, v183 bitop3:0x80
    v_bitop3_b32 v7, v7, v191, 1 bitop3:0x2a
    v_cmp_ne_u32 vcc, 0, v7
    s_nop 4
    s_cbranch_vccnz CHK_302
    s_nop 0
    s_branch RET_304
OOL_306:
    s_nop 10
CHK_305:
    s_add_u32 s80, s50, 0x110000
    buffer_load_dwordx4 v[128:131], v1, s[8:11], s80 offen offset:0 sc1
    buffer_load_dword v62, off, s[8:11], s62
    buffer_load_dwordx4 v[136:139], v1, s[8:11], s80 offen offset:1024 sc1
    buffer_load_dwordx4 v[144:147], v1, s[8:11], s80 offen offset:2048 sc1
    buffer_load_dwordx4 v[152:155], v1, s[8:11], s80 offen offset:3072 sc1
    s_add_u32 s80, s50, 0x111000
    buffer_load_dwordx4 v[160:163], v1, s[8:11], s80 offen offset:0 sc1
    buffer_load_dwordx4 v[168:171], v1, s[8:11], s80 offen offset:1024 sc1
    buffer_load_dwordx4 v[176:179], v1, s[8:11], s80 offen offset:2048 sc1
    buffer_load_dwordx4 v[184:187], v1, s[8:11], s80 offen offset:3072 sc1
    s_sub_u32 s45, s45, 1
    s_nop 0
    s_cbranch_scc1 L_end2
    s_waitcnt vmcnt(4)
    v_bitop3_b32 v7, v131, v139, v147 bitop3:0x80
    v_bitop3_b32 v7, v7, v155, 1 bitop3:0x2a
    v_cmp_ne_u32 vcc, 0, v7
    s_nop 4
    s_cbranch_vccnz CHK_305
    s_nop 0
    s_branch RET_307
OOL_309:
    s_nop 10
CHK_308:
    s_add_u32 s80, s50, 0x111000
    buffer_load_dwordx4 v[160:163], v1, s[8:11], s80 offen offset:0 sc1
    buffer_load_dwordx4 v[168:171], v1, s[8:11], s80 offen offset:1024 sc1
    buffer_load_dwordx4 v[176:179], v1, s[8:11], s80 offen offset:2048 sc1
    buffer_load_dwordx4 v[184:187], v1, s[8:11], s80 offen offset:3072 sc1
    buffer_load_dword v62, off, s[8:11], s62
    buffer_load_dword v62, off, s[8:11], s62
    buffer_load_dword v62, off, s[8:11], s62
    buffer_load_dword v62, off, s[8:11], s62
    buffer_load_dword v62, off, s[8:11], s62
    buffer_load_dword v62, off, s[8:11], s62
    buffer_load_dword v62, off, s[8:11], s62
    buffer_load_dword v62, off, s[8:11], s62
    s_sub_u32 s45, s45, 1
    s_nop 0
    s_cbranch_scc1 L_end2
    s_waitcnt vmcnt(10)
    v_bitop3_b32 v7, v163, v171, 1 bitop3:0x2a
    v_cmp_ne_u32 vcc, 0, v7
    s_nop 4
    s_cbranch_vccnz CHK_308
    s_nop 0
    s_branch RET_310
OOL_312:
    s_nop 10
CHK_311:
    s_add_u32 s80, s50, 0x111000
    buffer_load_dwordx4 v[176:179], v1, s[8:11], s80 offen offset:2048 sc1
    buffer_load_dwordx4 v[184:187], v1, s[8:11], s80 offen offset:3072 sc1
    buffer_load_dword v62, off, s[8:11], s62
    buffer_load_dword v62, off, s[8:11], s62
    buffer_load_dword v62, off, s[8:11], s62
    buffer_load_dword v62, off, s[8:11], s62
    buffer_load_dword v62, off, s[8:11], s62
    buffer_load_dword v62, off, s[8:11], s62
    buffer_load_dword v62, off, s[8:11], s62
    buffer_load_dword v62, off, s[8:11], s62
    buffer_load_dword v62, off, s[8:11], s62
    buffer_load_dword v62, off, s[8:11], s62
    buffer_load_dword v62, off, s[8:11], s62
    buffer_load_dword v62, off, s[8:11], s62
    s_sub_u32 s45, s45, 1
    s_nop 0
    s_cbranch_scc1 L_end2
    s_waitcnt vmcnt(12)
    v_bitop3_b32 v7, v179, v187, 1 bitop3:0x2a
    v_cmp_ne_u32 vcc, 0, v7
    s_nop 4
    s_cbranch_vccnz CHK_311
    s_nop 0
    s_branch RET_313
OOL_315:
    s_nop 3
CHK_314:
    buffer_load_dwordx4 v[132:135], v1, s[8:11], s49 offen offset:0 sc1
    buffer_load_dwordx4 v[140:143], v1, s[8:11], s49 offen offset:1024 sc1
    buffer_load_dwordx4 v[148:151], v1, s[8:11], s49 offen offset:2048 sc1
    buffer_load_dwordx4 v[156:159], v1, s[8:11], s49 offen offset:3072 sc1
    s_sub_u32 s45, s45, 1
    s_nop 0
    s_cbranch_scc1 L_end2
    s_waitcnt vmcnt(0)
    v_bitop3_b32 v7, v132, v133, v134 bitop3:0x80
    v_bitop3_b32 v7, v7, v135, v140 bitop3:0x80
    v_bitop3_b32 v7, v7, v141, v142 bitop3:0x80
    v_bitop3_b32 v7, v7, v143, v148 bitop3:0x80
    v_bitop3_b32 v7, v7, v149, v150 bitop3:0x80
    v_bitop3_b32 v7, v7, v151, v156 bitop3:0x80
    v_bitop3_b32 v7, v7, v157, v158 bitop3:0x80
    v_bitop3_b32 v7, v7, v159, 1 bitop3:0x2a
    v_cmp_ne_u32 vcc, 0, v7
    s_nop 4
    s_cbranch_vccnz CHK_314
    s_nop 0
    s_branch RET_316
OOL_318:
    s_nop 3
CHK_317:
    buffer_load_dword v9, v8, s[8:11], 0 offen offset:0 sc1
    s_sub_u32 s45, s45, 1
    s_nop 0
    s_cbranch_scc1 L_end2
    s_waitcnt vmcnt(0)
    v_subrev_u32 v9, s69, v9
    v_subrev_u32 v9, 2, v9
    v_cmp_lt_u32 vcc, 7, v9
    s_nop 4
    s_cbranch_vccnz CHK_317
    s_nop 0
    s_branch RET_319
OOL_321:
    s_add_u32 s76, s46, 0x8000
    buffer_store_dwordx4 v[112:115], v4, s[8:11], s76 offen offset:0 sc1
    buffer_store_dwordx4 v[116:119], v4, s[8:11], s76 offen offset:1024 sc1
    s_nop 1
    s_branch RET_322
OOL_324:
    s_nop 3
CHK_323:
    s_add_u32 s79, s51, 0x8000
    buffer_load_dwordx4 v[132:135], v1, s[8:11], s79 offen offset:0 sc1
    buffer_load_dwordx4 v[140:143], v1, s[8:11], s79 offen offset:1024 sc1
    buffer_load_dwordx4 v[148:151], v1, s[8:11], s79 offen offset:2048 sc1
    buffer_load_dwordx4 v[156:159], v1, s[8:11], s79 offen offset:3072 sc1
    s_add_u32 s79, s51, 0x9000
    buffer_load_dwordx4 v[164:167], v1, s[8:11], s79 offen offset:0 sc1
    buffer_load_dwordx4 v[172:175], v1, s[8:11], s79 offen offset:1024 sc1
    buffer_load_dwordx4 v[180:183], v1, s[8:11], s79 offen offset:2048 sc1
    buffer_load_dwordx4 v[188:191], v1, s[8:11], s79 offen offset:3072 sc1
    s_sub_u32 s45, s45, 1
    s_nop 0
    s_cbranch_scc1 L_end2
    s_waitcnt vmcnt(6)
    v_bitop3_b32 v7, v135, v143, 1 bitop3:0x2a
    v_cmp_ne_u32 vcc, 0, v7
    s_nop 4
    s_cbranch_vccnz CHK_323
    s_nop 0
    s_branch RET_325
OOL_327:
    s_nop 10
CHK_326:
    s_add_u32 s79, s51, 0x8000
    buffer_load_dwordx4 v[148:151], v1, s[8:11], s79 offen offset:2048 sc1
    buffer_load_dwordx4 v[156:159], v1, s[8:11], s79 offen offset:3072 sc1
    s_add_u32 s79, s51, 0x9000
    buffer_load_dwordx4 v[164:167], v1, s[8:11], s79 offen offset:0 sc1
    buffer_load_dwordx4 v[172:175], v1, s[8:11], s79 offen offset:1024 sc1
    buffer_load_dwordx4 v[180:183], v1, s[8:11], s79 offen offset:2048 sc1
    buffer_load_dwordx4 v[188:191], v1, s[8:11], s79 offen offset:3072 sc1
    s_add_u32 s80, s50, 0x8000
    buffer_load_dwordx4 v[128:131], v5, s[8:11], s80 offen offset:0 sc1
    buffer_load_dwordx4 v[136:139], v5, s[8:11], s80 offen offset:1024 sc1
    s_sub_u32 s45, s45, 1
    s_nop 0
    s_cbranch_scc1 L_end2
    s_waitcnt vmcnt(6)
    v_bitop3_b32 v7, v151, v159, 1 bitop3:0x2a
    v_cmp_ne_u32 vcc, 0, v7
    s_nop 4
    s_cbranch_vccnz CHK_326
    s_nop 0
    s_branch RET_328
OOL_330:
    s_nop 10
CHK_329:
    s_add_u32 s79, s51, 0x9000
    buffer_load_dwordx4 v[164:167], v1, s[8:11], s79 offen offset:0 sc1
    buffer_load_dwordx4 v[172:175], v1, s[8:11], s79 offen offset:1024 sc1
    buffer_load_dwordx4 v[180:183], v1, s[8:11], s79 offen offset:2048 sc1
    buffer_load_dwordx4 v[188:191], v1, s[8:11], s79 offen offset:3072 sc1
    s_add_u32 s80, s50, 0x8000
    buffer_load_dwordx4 v[128:131], v5, s[8:11], s80 offen offset:0 sc1
    buffer_load_dwordx4 v[136:139], v5, s[8:11], s80 offen offset:1024 sc1
    buffer_load_dwordx4 v[144:147], v5, s[8:11], s80 offen offset:2048 sc1
    buffer_load_dwordx4 v[152:155], v5, s[8:11], s80 offen offset:3072 sc1
    s_sub_u32 s45, s45, 1
    s_nop 0
    s_cbranch_scc1 L_end2
    s_waitcnt vmcnt(4)
    v_bitop3_b32 v7, v167, v175, v183 bitop3:0x80
    v_bitop3_b32 v7, v7, v191, 1 bitop3:0x2a
    v_cmp_ne_u32 vcc, 0, v7
    s_nop 4
    s_cbranch_vccnz CHK_329
    s_nop 0
    s_branch RET_331
OOL_333:
    s_nop 10
CHK_332:
    s_add_u32 s80, s50, 0x8000
    buffer_load_dwordx4 v[128:131], v5, s[8:11], s80 offen offset:0 sc1
    buffer_load_dwordx4 v[136:139], v5, s[8:11], s80 offen offset:1024 sc1
    buffer_load_dwordx4 v[144:147], v5, s[8:11], s80 offen offset:2048 sc1
    buffer_load_dwordx4 v[152:155], v5, s[8:11], s80 offen offset:3072 sc1
    s_add_u32 s80, s50, 0x9000
    buffer_load_dwordx4 v[160:163], v5, s[8:11], s80 offen offset:0 sc1
    buffer_load_dwordx4 v[168:171], v5, s[8:11], s80 offen offset:1024 sc1
    buffer_load_dwordx4 v[176:179], v5, s[8:11], s80 offen offset:2048 sc1
    buffer_load_dwordx4 v[184:187], v5, s[8:11], s80 offen offset:3072 sc1
    s_sub_u32 s45, s45, 1
    s_nop 0
    s_cbranch_scc1 L_end2
    s_waitcnt vmcnt(4)
    v_bitop3_b32 v7, v131, v139, v147 bitop3:0x80
    v_bitop3_b32 v7, v7, v155, 1 bitop3:0x2a
    v_cmp_ne_u32 vcc, 0, v7
    s_nop 4
    s_cbranch_vccnz CHK_332
    s_nop 0
    s_branch RET_334
OOL_336:
    s_nop 10
CHK_335:
    s_add_u32 s80, s50, 0x9000
    buffer_load_dwordx4 v[160:163], v5, s[8:11], s80 offen offset:0 sc1
    buffer_load_dwordx4 v[168:171], v5, s[8:11], s80 offen offset:1024 sc1
    buffer_load_dwordx4 v[176:179], v5, s[8:11], s80 offen offset:2048 sc1
    buffer_load_dwordx4 v[184:187], v5, s[8:11], s80 offen offset:3072 sc1
    buffer_load_dword v62, off, s[8:11], s62
    buffer_load_dword v62, off, s[8:11], s62
    buffer_load_dword v62, off, s[8:11], s62
    buffer_load_dword v62, off, s[8:11], s62
    buffer_load_dword v62, off, s[8:11], s62
    s_sub_u32 s45, s45, 1
    s_nop 0
    s_cbranch_scc1 L_end2
    s_waitcnt vmcnt(7)
    v_bitop3_b32 v7, v163, v171, 1 bitop3:0x2a
    v_cmp_ne_u32 vcc, 0, v7
    s_nop 4
    s_cbranch_vccnz CHK_335
    s_nop 0
    s_branch RET_337
OOL_339:
    s_nop 10
CHK_338:
    s_add_u32 s80, s50, 0x9000
    buffer_load_dwordx4 v[176:179], v5, s[8:11], s80 offen offset:2048 sc1
    buffer_load_dwordx4 v[184:187], v5, s[8:11], s80 offen offset:3072 sc1
    buffer_load_dword v62, off, s[8:11], s62
    buffer_load_dword v62, off, s[8:11], s62
    buffer_load_dword v62, off, s[8:11], s62
    buffer_load_dword v62, off, s[8:11], s62
    buffer_load_dword v62, off, s[8:11], s62
    buffer_load_dword v62, off, s[8:11], s62
    buffer_load_dword v62, off, s[8:11], s62
    buffer_load_dword v62, off, s[8:11], s62
    buffer_load_dword v62, off, s[8:11], s62
    s_sub_u32 s45, s45, 1
    s_nop 0
    s_cbranch_scc1 L_end2
    s_waitcnt vmcnt(9)
    v_bitop3_b32 v7, v179, v187, 1 bitop3:0x2a
    v_cmp_ne_u32 vcc, 0, v7
    s_nop 4
    s_cbranch_vccnz CHK_338
    s_nop 0
    s_branch RET_340
OOL_342:
    s_nop 3
CHK_341:
    buffer_load_dwordx4 v[128:131], v1, s[8:11], s59 offen offset:0 sc1
    buffer_load_dwordx4 v[132:135], v1, s[8:11], s59 offen offset:1024 sc1
    buffer_load_dwordx4 v[136:139], v1, s[8:11], s59 offen offset:2048 sc1
    buffer_load_dwordx4 v[140:143], v1, s[8:11], s59 offen offset:3072 sc1
    s_add_u32 s79, s59, 0x1000
    buffer_load_dwordx4 v[144:147], v1, s[8:11], s79 offen offset:0 sc1
    buffer_load_dwordx4 v[148:151], v1, s[8:11], s79 offen offset:1024 sc1
    buffer_load_dwordx4 v[152:155], v1, s[8:11], s79 offen offset:2048 sc1
    buffer_load_dwordx4 v[156:159], v1, s[8:11], s79 offen offset:3072 sc1
    s_add_u32 s79, s59, 0x2000
    buffer_load_dwordx4 v[160:163], v1, s[8:11], s79 offen offset:0 sc1
    buffer_load_dwordx4 v[164:167], v1, s[8:11], s79 offen offset:1024 sc1
    buffer_load_dwordx4 v[168:171], v1, s[8:11], s79 offen offset:2048 sc1
    buffer_load_dwordx4 v[172:175], v1, s[8:11], s79 offen offset:3072 sc1
    s_sub_u32 s45, s45, 1
    s_nop 0
    s_cbranch_scc1 L_end2
    s_waitcnt vmcnt(10)
    v_bitop3_b32 v7, v131, v135, 1 bitop3:0xa8
    v_cmp_ne_u32 vcc, 0, v7
    s_nop 4
    s_cbranch_vccnz CHK_341
    s_nop 0
    s_branch RET_343
OOL_345:
    s_nop 10
CHK_344:
    buffer_load_dwordx4 v[136:139], v1, s[8:11], s59 offen offset:2048 sc1
    buffer_load_dwordx4 v[140:143], v1, s[8:11], s59 offen offset:3072 sc1
    s_add_u32 s79, s59, 0x1000
    buffer_load_dwordx4 v[144:147], v1, s[8:11], s79 offen offset:0 sc1
    buffer_load_dwordx4 v[148:151], v1, s[8:11], s79 offen offset:1024 sc1
    buffer_load_dwordx4 v[152:155], v1, s[8:11], s79 offen offset:2048 sc1
    buffer_load_dwordx4 v[156:159], v1, s[8:11], s79 offen offset:3072 sc1
    s_add_u32 s79, s59, 0x2000
    buffer_load_dwordx4 v[160:163], v1, s[8:11], s79 offen offset:0 sc1
    buffer_load_dwordx4 v[164:167], v1, s[8:11], s79 offen offset:1024 sc1
    buffer_load_dwordx4 v[168:171], v1, s[8:11], s79 offen offset:2048 sc1
    buffer_load_dwordx4 v[172:175], v1, s[8:11], s79 offen offset:3072 sc1
    s_add_u32 s79, s59, 0x3000
    buffer_load_dwordx4 v[176:179], v1, s[8:11], s79 offen offset:0 sc1
    buffer_load_dwordx4 v[180:183], v1, s[8:11], s79 offen offset:1024 sc1
    s_sub_u32 s45, s45, 1
    s_nop 0
    s_cbranch_scc1 L_end2
    s_waitcnt vmcnt(10)
    v_bitop3_b32 v7, v139, v143, 1 bitop3:0xa8
    v_cmp_ne_u32 vcc, 0, v7
    s_nop 4
    s_cbranch_vccnz CHK_344
    s_nop 0
    s_branch RET_346
OOL_348:
    s_nop 10
CHK_347:
    s_add_u32 s79, s59, 0x1000
    buffer_load_dwordx4 v[144:147], v1, s[8:11], s79 offen offset:0 sc1
    buffer_load_dwordx4 v[148:151], v1, s[8:11], s79 offen offset:1024 sc1
    buffer_load_dwordx4 v[152:155], v1, s[8:11], s79 offen offset:2048 sc1
    buffer_load_dwordx4 v[156:159], v1, s[8:11], s79 offen offset:3072 sc1
    s_add_u32 s79, s59, 0x2000
    buffer_load_dwordx4 v[160:163], v1, s[8:11], s79 offen offset:0 sc1
    buffer_load_dwordx4 v[164:167], v1, s[8:11], s79 offen offset:1024 sc1
    buffer_load_dwordx4 v[168:171], v1, s[8:11], s79 offen offset:2048 sc1
    buffer_load_dwordx4 v[172:175], v1, s[8:11], s79 offen offset:3072 sc1
    s_add_u32 s79, s59, 0x3000
    buffer_load_dwordx4 v[176:179], v1, s[8:11], s79 offen offset:0 sc1
    buffer_load_dwordx4 v[180:183], v1, s[8:11], s79 offen offset:1024 sc1
    buffer_load_dwordx4 v[184:187], v1, s[8:11], s79 offen offset:2048 sc1
    buffer_load_dwordx4 v[188:191], v1, s[8:11], s79 offen offset:3072 sc1
    s_sub_u32 s45, s45, 1
    s_nop 0
    s_cbranch_scc1 L_end2
    s_waitcnt vmcnt(8)
    v_bitop3_b32 v7, v147, v151, v155 bitop3:0xfe
    v_bitop3_b32 v7, v7, v159, 1 bitop3:0xa8
    v_cmp_ne_u32 vcc, 0, v7
    s_nop 4
    s_cbranch_vccnz CHK_347
    s_nop 0
    s_branch RET_349
OOL_351:
    s_nop 10
CHK_350:
    s_add_u32 s79, s59, 0x2000
    buffer_load_dwordx4 v[160:163], v1, s[8:11], s79 offen offset:0 sc1
    buffer_load_dwordx4 v[164:167], v1, s[8:11], s79 offen offset:1024 sc1
    buffer_load_dwordx4 v[168:171], v1, s[8:11], s79 offen offset:2048 sc1
    buffer_load_dwordx4 v[172:175], v1, s[8:11], s79 offen offset:3072 sc1
    s_add_u32 s79, s59, 0x3000
    buffer_load_dwordx4 v[176:179], v1, s[8:11], s79 offen offset:0 sc1
    buffer_load_dwordx4 v[180:183], v1, s[8:11], s79 offen offset:1024 sc1
    buffer_load_dwordx4 v[184:187], v1, s[8:11], s79 offen offset:2048 sc1
    buffer_load_dwordx4 v[188:191], v1, s[8:11], s79 offen offset:3072 sc1
    s_add_u32 s79, s59, 0x4000
    buffer_load_dwordx4 v[192:195], v1, s[8:11], s79 offen offset:0 sc1
    buffer_load_dwordx4 v[196:199], v1, s[8:11], s79 offen offset:1024 sc1
    buffer_load_dwordx4 v[200:203], v1, s[8:11], s79 offen offset:2048 sc1
    buffer_load_dwordx4 v[204:207], v1, s[8:11], s79 offen offset:3072 sc1
    s_sub_u32 s45, s45, 1
    s_nop 0
    s_cbranch_scc1 L_end2
    s_waitcnt vmcnt(8)
    v_bitop3_b32 v7, v163, v167, v171 bitop3:0xfe
    v_bitop3_b32 v7, v7, v175, 1 bitop3:0xa8
    v_cmp_ne_u32 vcc, 0, v7
    s_nop 4
    s_cbranch_vccnz CHK_350
    s_nop 0
    s_branch RET_352
OOL_354:
    s_nop 10
CHK_353:
    s_add_u32 s79, s59, 0x3000
    buffer_load_dwordx4 v[176:179], v1, s[8:11], s79 offen offset:0 sc1
    buffer_load_dwordx4 v[180:183], v1, s[8:11], s79 offen offset:1024 sc1
    buffer_load_dwordx4 v[184:187], v1, s[8:11], s79 offen offset:2048 sc1
    buffer_load_dwordx4 v[188:191], v1, s[8:11], s79 offen offset:3072 sc1
    s_add_u32 s79, s59, 0x4000
    buffer_load_dwordx4 v[192:195], v1, s[8:11], s79 offen offset:0 sc1
    buffer_load_dwordx4 v[196:199], v1, s[8:11], s79 offen offset:1024 sc1
    buffer_load_dwordx4 v[200:203], v1, s[8:11], s79 offen offset:2048 sc1
    buffer_load_dwordx4 v[204:207], v1, s[8:11], s79 offen offset:3072 sc1
    s_add_u32 s79, s59, 0x5000
    buffer_load_dwordx4 v[208:211], v1, s[8:11], s79 offen offset:0 sc1
    buffer_load_dwordx4 v[212:215], v1, s[8:11], s79 offen offset:1024 sc1
    buffer_load_dwordx4 v[216:219], v1, s[8:11], s79 offen offset:2048 sc1
    buffer_load_dwordx4 v[220:223], v1, s[8:11], s79 offen offset:3072 sc1
    s_sub_u32 s45, s45, 1
    s_nop 0
    s_cbranch_scc1 L_end2
    s_waitcnt vmcnt(8)
    v_bitop3_b32 v7, v179, v183, v187 bitop3:0xfe
    v_bitop3_b32 v7, v7, v191, 1 bitop3:0xa8
    v_cmp_ne_u32 vcc, 0, v7
    s_nop 4
    s_cbranch_vccnz CHK_353
    s_nop 0
    s_branch RET_355
OOL_357:
    s_nop 10
CHK_356:
    s_add_u32 s79, s59, 0x4000
    buffer_load_dwordx4 v[192:195], v1, s[8:11], s79 offen offset:0 sc1
    buffer_load_dwordx4 v[196:199], v1, s[8:11], s79 offen offset:1024 sc1
    buffer_load_dwordx4 v[200:203], v1, s[8:11], s79 offen offset:2048 sc1
    buffer_load_dwordx4 v[204:207], v1, s[8:11], s79 offen offset:3072 sc1
    s_add_u32 s79, s59, 0x5000
    buffer_load_dwordx4 v[208:211], v1, s[8:11], s79 offen offset:0 sc1
    buffer_load_dwordx4 v[212:215], v1, s[8:11], s79 offen offset:1024 sc1
    buffer_load_dwordx4 v[216:219], v1, s[8:11], s79 offen offset:2048 sc1
    buffer_load_dwordx4 v[220:223], v1, s[8:11], s79 offen offset:3072 sc1
    s_add_u32 s79, s59, 0x6000
    buffer_load_dwordx4 v[224:227], v1, s[8:11], s79 offen offset:0 sc1
    buffer_load_dwordx4 v[228:231], v1, s[8:11], s79 offen offset:1024 sc1
    buffer_load_dwordx4 v[232:235], v1, s[8:11], s79 offen offset:2048 sc1
    buffer_load_dwordx4 v[236:239], v1, s[8:11], s79 offen offset:3072 sc1
    s_sub_u32 s45, s45, 1
    s_nop 0
    s_cbranch_scc1 L_end2
    s_waitcnt vmcnt(8)
    v_bitop3_b32 v7, v195, v199, v203 bitop3:0xfe
    v_bitop3_b32 v7, v7, v207, 1 bitop3:0xa8
    v_cmp_ne_u32 vcc, 0, v7
    s_nop 4
    s_cbranch_vccnz CHK_356
    s_nop 0
    s_branch RET_358
OOL_360:
    s_nop 10
CHK_359:
    s_add_u32 s79, s59, 0x5000
    buffer_load_dwordx4 v[208:211], v1, s[8:11], s79 offen offset:0 sc1
    buffer_load_dwordx4 v[212:215], v1, s[8:11], s79 offen offset:1024 sc1
    buffer_load_dwordx4 v[216:219], v1, s[8:11], s79 offen offset:2048 sc1
    buffer_load_dwordx4 v[220:223], v1, s[8:11], s79 offen offset:3072 sc1
    s_add_u32 s79, s59, 0x6000
    buffer_load_dwordx4 v[224:227], v1, s[8:11], s79 offen offset:0 sc1
    buffer_load_dwordx4 v[228:231], v1, s[8:11], s79 offen offset:1024 sc1
    buffer_load_dwordx4 v[232:235], v1, s[8:11], s79 offen offset:2048 sc1
    buffer_load_dwordx4 v[236:239], v1, s[8:11], s79 offen offset:3072 sc1
    s_add_u32 s79, s59, 0x7000
    buffer_load_dwordx4 v[240:243], v1, s[8:11], s79 offen offset:0 sc1
    buffer_load_dwordx4 v[244:247], v1, s[8:11], s79 offen offset:1024 sc1
    buffer_load_dwordx4 v[248:251], v1, s[8:11], s79 offen offset:2048 sc1
    buffer_load_dwordx4 v[252:255], v1, s[8:11], s79 offen offset:3072 sc1
    s_sub_u32 s45, s45, 1
    s_nop 0
    s_cbranch_scc1 L_end2
    s_waitcnt vmcnt(8)
    v_bitop3_b32 v7, v211, v215, v219 bitop3:0xfe
    v_bitop3_b32 v7, v7, v223, 1 bitop3:0xa8
    v_cmp_ne_u32 vcc, 0, v7
    s_nop 4
    s_cbranch_vccnz CHK_359
    s_nop 0
    s_branch RET_361
OOL_363:
    s_nop 10
CHK_362:
    s_add_u32 s79, s59, 0x6000
    buffer_load_dwordx4 v[224:227], v1, s[8:11], s79 offen offset:0 sc1
    buffer_load_dwordx4 v[228:231], v1, s[8:11], s79 offen offset:1024 sc1
    buffer_load_dwordx4 v[232:235], v1, s[8:11], s79 offen offset:2048 sc1
    buffer_load_dwordx4 v[236:239], v1, s[8:11], s79 offen offset:3072 sc1
    s_add_u32 s79, s59, 0x7000
    buffer_load_dwordx4 v[240:243], v1, s[8:11], s79 offen offset:0 sc1
    buffer_load_dwordx4 v[244:247], v1, s[8:11], s79 offen offset:1024 sc1
    buffer_load_dwordx4 v[248:251], v1, s[8:11], s79 offen offset:2048 sc1
    buffer_load_dwordx4 v[252:255], v1, s[8:11], s79 offen offset:3072 sc1
    buffer_load_dword v62, off, s[8:11], s62
    buffer_load_dword v62, off, s[8:11], s62
    buffer_load_dword v62, off, s[8:11], s62
    buffer_load_dword v62, off, s[8:11], s62
    buffer_load_dword v62, off, s[8:11], s62
    buffer_load_dword v62, off, s[8:11], s62
    buffer_load_dword v62, off, s[8:11], s62
    s_sub_u32 s45, s45, 1
    s_nop 0
    s_cbranch_scc1 L_end2
    s_waitcnt vmcnt(11)
    v_bitop3_b32 v7, v227, v231, v235 bitop3:0xfe
    v_bitop3_b32 v7, v7, v239, 1 bitop3:0xa8
    v_cmp_ne_u32 vcc, 0, v7
    s_nop 4
    s_cbranch_vccnz CHK_362
    s_nop 0
    s_branch RET_364
OOL_366:
    s_nop 10
CHK_365:
    buffer_load_dwordx4 v[112:115], v1, s[8:11], s77 offen offset:0 sc1
    buffer_load_dwordx4 v[116:119], v1, s[8:11], s77 offen offset:1024 sc1
    buffer_load_dwordx4 v[120:123], v1, s[8:11], s77 offen offset:2048 sc1
    buffer_load_dwordx4 v[124:127], v1, s[8:11], s77 offen offset:3072 sc1
    s_sub_u32 s45, s45, 1
    s_nop 0
    s_cbranch_scc1 L_end2
    s_waitcnt vmcnt(0)
    v_bitop3_b32 v7, v112, v113, v114 bitop3:0xfe
    v_bitop3_b32 v7, v7, v115, v116 bitop3:0xfe
    v_bitop3_b32 v7, v7, v117, v118 bitop3:0xfe
    v_bitop3_b32 v7, v7, v119, v120 bitop3:0xfe
    v_bitop3_b32 v7, v7, v121, v122 bitop3:0xfe
    v_bitop3_b32 v7, v7, v123, v124 bitop3:0xfe
    v_bitop3_b32 v7, v7, v125, v126 bitop3:0xfe
    v_bitop3_b32 v7, v7, v127, 1 bitop3:0xa8
    v_cmp_ne_u32 vcc, 0, v7
    s_nop 4
    s_cbranch_vccnz CHK_365
    s_nop 0
    s_branch RET_367
OOL_369:
    s_nop 10
CHK_368:
    s_add_u32 s79, s59, 0x7000
    buffer_load_dwordx4 v[240:243], v1, s[8:11], s79 offen offset:0 sc1
    buffer_load_dwordx4 v[244:247], v1, s[8:11], s79 offen offset:1024 sc1
    buffer_load_dwordx4 v[248:251], v1, s[8:11], s79 offen offset:2048 sc1
    buffer_load_dwordx4 v[252:255], v1, s[8:11], s79 offen offset:3072 sc1
    buffer_load_dword v62, off, s[8:11], s62
    buffer_load_dword v62, off, s[8:11], s62
    buffer_load_dword v62, off, s[8:11], s62
    buffer_load_dword v62, off, s[8:11], s62
    buffer_load_dword v62, off, s[8:11], s62
    buffer_load_dword v62, off, s[8:11], s62
    buffer_load_dword v62, off, s[8:11], s62
    buffer_load_dword v62, off, s[8:11], s62
    buffer_load_dword v62, off, s[8:11], s62
    buffer_load_dword v62, off, s[8:11], s62
    buffer_load_dword v62, off, s[8:11], s62
    s_sub_u32 s45, s45, 1
    s_nop 0
    s_cbranch_scc1 L_end2
    s_waitcnt vmcnt(11)
    v_bitop3_b32 v7, v243, v247, v251 bitop3:0xfe
    v_bitop3_b32 v7, v7, v255, 1 bitop3:0xa8
    v_cmp_ne_u32 vcc, 0, v7
    s_nop 4
    s_cbranch_vccnz CHK_368
    s_nop 0
    s_branch RET_370
OOL_372:
    s_nop 3
CHK_371:
    buffer_load_dwordx4 v[192:195], v1, s[8:11], s51 offen offset:0 sc1
    buffer_load_dwordx4 v[196:199], v1, s[8:11], s51 offen offset:1024 sc1
    buffer_load_dword v62, off, s[8:11], s62
    buffer_load_dwordx4 v[200:203], v1, s[8:11], s51 offen offset:2048 sc1
    buffer_load_dwordx4 v[204:207], v1, s[8:11], s51 offen offset:3072 sc1
    s_add_u32 s78, s51, 0x1000
    buffer_load_dwordx4 v[208:211], v1, s[8:11], s78 offen offset:0 sc1
    buffer_load_dwordx4 v[212:215], v1, s[8:11], s78 offen offset:1024 sc1
    buffer_load_dwordx4 v[216:219], v1, s[8:11], s78 offen offset:2048 sc1
    buffer_load_dwordx4 v[220:223], v1, s[8:11], s78 offen offset:3072 sc1
    buffer_load_dwordx4 v[224:227], v1, s[8:11], s50 offen offset:0 sc1
    buffer_load_dword v62, off, s[8:11], s62
    buffer_load_dword v62, off, s[8:11], s62
    s_sub_u32 s45, s45, 1
    s_nop 0
    s_cbranch_scc1 L_end2
    s_waitcnt vmcnt(7)
    v_bitop3_b32 v7, v195, v199, v203 bitop3:0x80
    v_bitop3_b32 v7, v7, v207, 1 bitop3:0x2a
    v_cmp_ne_u32 vcc, 0, v7
    s_nop 4
    s_cbranch_vccnz CHK_371
    s_nop 0
    s_branch RET_373
OOL_375:
    s_nop 10
CHK_374:
    buffer_load_dword v9, v8, s[8:11], 0 offen offset:128 sc1
    s_sub_u32 s45, s45, 1
    s_nop 0
    s_cbranch_scc1 L_end2
    s_waitcnt vmcnt(0)
    v_subrev_u32 v9, s69, v9
    v_subrev_u32 v9, 1, v9
    v_cmp_lt_u32 vcc, 7, v9
    s_nop 4
    s_cbranch_vccnz CHK_374
    s_nop 0
    s_branch RET_376
OOL_378:
    s_nop 10
CHK_377:
    s_add_u32 s78, s51, 0x1000
    buffer_load_dwordx4 v[208:211], v1, s[8:11], s78 offen offset:0 sc1
    buffer_load_dwordx4 v[212:215], v1, s[8:11], s78 offen offset:1024 sc1
    buffer_load_dwordx4 v[216:219], v1, s[8:11], s78 offen offset:2048 sc1
    buffer_load_dwordx4 v[220:223], v1, s[8:11], s78 offen offset:3072 sc1
    buffer_load_dwordx4 v[224:227], v1, s[8:11], s50 offen offset:0 sc1
    buffer_load_dword v62, off, s[8:11], s62
    buffer_load_dword v62, off, s[8:11], s62
    buffer_load_dwordx4 v[228:231], v1, s[8:11], s50 offen offset:1024 sc1
    buffer_load_dwordx4 v[232:235], v1, s[8:11], s50 offen offset:2048 sc1
    buffer_load_dwordx4 v[236:239], v1, s[8:11], s50 offen offset:3072 sc1
    s_add_u32 s78, s50, 0x1000
    buffer_load_dwordx4 v[240:243], v1, s[8:11], s78 offen offset:0 sc1
    buffer_load_dwordx4 v[244:247], v1, s[8:11], s78 offen offset:1024 sc1
    buffer_load_dwordx4 v[248:251], v1, s[8:11], s78 offen offset:2048 sc1
    s_sub_u32 s45, s45, 1
    s_nop 0
    s_cbranch_scc1 L_end2
    s_waitcnt vmcnt(9)
    v_bitop3_b32 v7, v211, v215, v219 bitop3:0x80
    v_bitop3_b32 v7, v7, v223, 1 bitop3:0x2a
    v_cmp_ne_u32 vcc, 0, v7
    s_nop 4
    s_cbranch_vccnz CHK_377
    s_nop 0
    s_branch RET_379
OOL_381:
    s_nop 10
CHK_380:
    buffer_load_dwordx4 v[224:227], v1, s[8:11], s50 offen offset:0 sc1
    buffer_load_dword v62, off, s[8:11], s62
    buffer_load_dword v62, off, s[8:11], s62
    buffer_load_dwordx4 v[228:231], v1, s[8:11], s50 offen offset:1024 sc1
    buffer_load_dwordx4 v[232:235], v1, s[8:11], s50 offen offset:2048 sc1
    buffer_load_dwordx4 v[236:239], v1, s[8:11], s50 offen offset:3072 sc1
    s_add_u32 s78, s50, 0x1000
    buffer_load_dwordx4 v[240:243], v1, s[8:11], s78 offen offset:0 sc1
    buffer_load_dwordx4 v[244:247], v1, s[8:11], s78 offen offset:1024 sc1
    buffer_load_dwordx4 v[248:251], v1, s[8:11], s78 offen offset:2048 sc1
    buffer_load_dwordx4 v[252:255], v1, s[8:11], s78 offen offset:3072 sc1
    buffer_load_dword v62, off, s[8:11], s62
    s_add_u32 s78, s51, 0x8000
    buffer_load_dwordx4 v[144:147], v1, s[8:11], s78 offen offset:0 sc1
    buffer_load_dword v62, off, s[8:11], s62
    buffer_load_dwordx4 v[148:151], v1, s[8:11], s78 offen offset:1024 sc1
    buffer_load_dword v62, off, s[8:11], s62
    buffer_load_dwordx4 v[152:155], v1, s[8:11], s78 offen offset:2048 sc1
    s_sub_u32 s45, s45, 1
    s_nop 0
    s_cbranch_scc1 L_end2
    s_waitcnt vmcnt(10)
    v_bitop3_b32 v7, v227, v231, v235 bitop3:0x80
    v_bitop3_b32 v7, v7, v239, 1 bitop3:0x2a
    v_cmp_ne_u32 vcc, 0, v7
    s_nop 4
    s_cbranch_vccnz CHK_380
    s_nop 0
    s_branch RET_382
OOL_384:
    s_nop 10
CHK_383:
    s_add_u32 s78, s50, 0x1000
    buffer_load_dwordx4 v[240:243], v1, s[8:11], s78 offen offset:0 sc1
    buffer_load_dwordx4 v[244:247], v1, s[8:11], s78 offen offset:1024 sc1
    buffer_load_dwordx4 v[248:251], v1, s[8:11], s78 offen offset:2048 sc1
    buffer_load_dwordx4 v[252:255], v1, s[8:11], s78 offen offset:3072 sc1
    buffer_load_dword v62, off, s[8:11], s62
    s_add_u32 s78, s51, 0x8000
    buffer_load_dwordx4 v[144:147], v1, s[8:11], s78 offen offset:0 sc1
    buffer_load_dword v62, off, s[8:11], s62
    buffer_load_dwordx4 v[148:151], v1, s[8:11], s78 offen offset:1024 sc1
    buffer_load_dword v62, off, s[8:11], s62
    buffer_load_dwordx4 v[152:155], v1, s[8:11], s78 offen offset:2048 sc1
    buffer_load_dwordx4 v[156:159], v1, s[8:11], s78 offen offset:3072 sc1
    buffer_load_dword v62, off, s[8:11], s62
    s_add_u32 s78, s51, 0x9000
    buffer_load_dwordx4 v[160:163], v1, s[8:11], s78 offen offset:0 sc1
    buffer_load_dword v62, off, s[8:11], s62
    buffer_load_dwordx4 v[164:167], v1, s[8:11], s78 offen offset:1024 sc1
    buffer_load_dword v62, off, s[8:11], s62
    buffer_load_dwordx4 v[168:171], v1, s[8:11], s78 offen offset:2048 sc1
    s_sub_u32 s45, s45, 1
    s_nop 0
    s_cbranch_scc1 L_end2
    s_waitcnt vmcnt(13)
    v_bitop3_b32 v7, v243, v247, v251 bitop3:0x80
    v_bitop3_b32 v7, v7, v255, 1 bitop3:0x2a
    v_cmp_ne_u32 vcc, 0, v7
    s_nop 4
    s_cbranch_vccnz CHK_383
    s_nop 0
    s_branch RET_385
OOL_387:
    s_nop 10
CHK_386:
    s_add_u32 s78, s51, 0x8000
    buffer_load_dwordx4 v[144:147], v1, s[8:11], s78 offen offset:0 sc1
    buffer_load_dword v62, off, s[8:11], s62
    buffer_load_dwordx4 v[148:151], v1, s[8:11], s78 offen offset:1024 sc1
    buffer_load_dword v62, off, s[8:11], s62
    buffer_load_dwordx4 v[152:155], v1, s[8:11], s78 offen offset:2048 sc1
    buffer_load_dwordx4 v[156:159], v1, s[8:11], s78 offen offset:3072 sc1
    buffer_load_dword v62, off, s[8:11], s62
    s_add_u32 s78, s51, 0x9000
    buffer_load_dwordx4 v[160:163], v1, s[8:11], s78 offen offset:0 sc1
    buffer_load_dword v62, off, s[8:11], s62
    buffer_load_dwordx4 v[164:167], v1, s[8:11], s78 offen offset:1024 sc1
    buffer_load_dword v62, off, s[8:11], s62
    buffer_load_dwordx4 v[168:171], v1, s[8:11], s78 offen offset:2048 sc1
    buffer_load_dwordx4 v[172:175], v1, s[8:11], s78 offen offset:3072 sc1
    buffer_load_dword v62, off, s[8:11], s62
    buffer_load_dword v62, off, s[8:11], s62
    buffer_load_dword v62, off, s[8:11], s62
    s_add_u32 s78, s50, 0x8000
    buffer_load_dwordx4 v[176:179], v1, s[8:11], s78 offen offset:0 sc1
    buffer_load_dword v62, off, s[8:11], s62
    buffer_load_dwordx4 v[180:183], v1, s[8:11], s78 offen offset:1024 sc1
    buffer_load_dword v62, off, s[8:11], s62
    buffer_load_dwordx4 v[184:187], v1, s[8:11], s78 offen offset:2048 sc1
    s_sub_u32 s45, s45, 1
    s_nop 0
    s_cbranch_scc1 L_end2
    s_waitcnt vmcnt(15)
    v_bitop3_b32 v7, v147, v151, v155 bitop3:0xfe
    v_bitop3_b32 v7, v7, v159, 1 bitop3:0xa8
    v_cmp_ne_u32 vcc, 0, v7
    s_nop 4
    s_cbranch_vccnz CHK_386
    s_nop 0
    s_branch RET_388
OOL_390:
    s_nop 10
CHK_389:
    s_add_u32 s78, s51, 0x9000
    buffer_load_dwordx4 v[160:163], v1, s[8:11], s78 offen offset:0 sc1
    buffer_load_dword v62, off, s[8:11], s62
    buffer_load_dwordx4 v[164:167], v1, s[8:11], s78 offen offset:1024 sc1
    buffer_load_dword v62, off, s[8:11], s62
    buffer_load_dwordx4 v[168:171], v1, s[8:11], s78 offen offset:2048 sc1
    buffer_load_dwordx4 v[172:175], v1, s[8:11], s78 offen offset:3072 sc1
    buffer_load_dword v62, off, s[8:11], s62
    buffer_load_dword v62, off, s[8:11], s62
    buffer_load_dword v62, off, s[8:11], s62
    s_add_u32 s78, s50, 0x8000
    buffer_load_dwordx4 v[176:179], v1, s[8:11], s78 offen offset:0 sc1
    buffer_load_dword v62, off, s[8:11], s62
    buffer_load_dwordx4 v[180:183], v1, s[8:11], s78 offen offset:1024 sc1
    buffer_load_dword v62, off, s[8:11], s62
    buffer_load_dwordx4 v[184:187], v1, s[8:11], s78 offen offset:2048 sc1
    buffer_load_dwordx4 v[188:191], v1, s[8:11], s78 offen offset:3072 sc1
    s_add_u32 s78, s50, 0x9000
    buffer_load_dwordx4 v[192:195], v1, s[8:11], s78 offen offset:0 sc1
    buffer_load_dwordx4 v[196:199], v1, s[8:11], s78 offen offset:1024 sc1
    buffer_load_dwordx4 v[200:203], v1, s[8:11], s78 offen offset:2048 sc1
    s_sub_u32 s45, s45, 1
    s_nop 0
    s_cbranch_scc1 L_end2
    s_waitcnt vmcnt(12)
    v_bitop3_b32 v7, v163, v167, v171 bitop3:0xfe
    v_bitop3_b32 v7, v7, v175, 1 bitop3:0xa8
    v_cmp_ne_u32 vcc, 0, v7
    s_nop 4
    s_cbranch_vccnz CHK_389
    s_nop 0
    s_branch RET_391
OOL_393:
    s_nop 10
CHK_392:
    s_add_u32 s78, s50, 0x8000
    buffer_load_dwordx4 v[176:179], v1, s[8:11], s78 offen offset:0 sc1
    buffer_load_dword v62, off, s[8:11], s62
    buffer_load_dwordx4 v[180:183], v1, s[8:11], s78 offen offset:1024 sc1
    buffer_load_dword v62, off, s[8:11], s62
    buffer_load_dwordx4 v[184:187], v1, s[8:11], s78 offen offset:2048 sc1
    buffer_load_dwordx4 v[188:191], v1, s[8:11], s78 offen offset:3072 sc1
    s_add_u32 s78, s50, 0x9000
    buffer_load_dwordx4 v[192:195], v1, s[8:11], s78 offen offset:0 sc1
    buffer_load_dwordx4 v[196:199], v1, s[8:11], s78 offen offset:1024 sc1
    buffer_load_dwordx4 v[200:203], v1, s[8:11], s78 offen offset:2048 sc1
    buffer_load_dwordx4 v[204:207], v1, s[8:11], s78 offen offset:3072 sc1
    buffer_load_dword v62, off, s[8:11], s62
    buffer_load_dword v62, off, s[8:11], s62
    buffer_load_dwordx4 v[208:211], v1, s[8:11], s53 offen offset:0 sc1
    buffer_load_dwordx4 v[212:215], v1, s[8:11], s53 offen offset:1024 sc1
    buffer_load_dwordx4 v[216:219], v1, s[8:11], s53 offen offset:2048 sc1
    s_sub_u32 s45, s45, 1
    s_nop 0
    s_cbranch_scc1 L_end2
    s_waitcnt vmcnt(9)
    v_bitop3_b32 v7, v179, v183, v187 bitop3:0xfe
    v_bitop3_b32 v7, v7, v191, 1 bitop3:0xa8
    v_cmp_ne_u32 vcc, 0, v7
    s_nop 4
    s_cbranch_vccnz CHK_392
    s_nop 0
    s_branch RET_394
OOL_396:
    s_nop 10
CHK_395:
    s_add_u32 s78, s50, 0x9000
    buffer_load_dwordx4 v[192:195], v1, s[8:11], s78 offen offset:0 sc1
    buffer_load_dwordx4 v[196:199], v1, s[8:11], s78 offen offset:1024 sc1
    buffer_load_dwordx4 v[200:203], v1, s[8:11], s78 offen offset:2048 sc1
    buffer_load_dwordx4 v[204:207], v1, s[8:11], s78 offen offset:3072 sc1
    buffer_load_dword v62, off, s[8:11], s62
    buffer_load_dword v62, off, s[8:11], s62
    buffer_load_dwordx4 v[208:211], v1, s[8:11], s53 offen offset:0 sc1
    buffer_load_dwordx4 v[212:215], v1, s[8:11], s53 offen offset:1024 sc1
    buffer_load_dwordx4 v[216:219], v1, s[8:11], s53 offen offset:2048 sc1
    buffer_load_dwordx4 v[220:223], v1, s[8:11], s53 offen offset:3072 sc1
    s_add_u32 s78, s53, 0x1000
    buffer_load_dwordx4 v[224:227], v1, s[8:11], s78 offen offset:0 sc1
    buffer_load_dwordx4 v[228:231], v1, s[8:11], s78 offen offset:1024 sc1
    buffer_load_dwordx4 v[232:235], v1, s[8:11], s52 offen offset:0 sc1
    s_sub_u32 s45, s45, 1
    s_nop 0
    s_cbranch_scc1 L_end2
    s_waitcnt vmcnt(9)
    v_bitop3_b32 v7, v195, v199, v203 bitop3:0xfe
    v_bitop3_b32 v7, v7, v207, 1 bitop3:0xa8
    v_cmp_ne_u32 vcc, 0, v7
    s_nop 4
    s_cbranch_vccnz CHK_395
    s_nop 0
    s_branch RET_397
OOL_399:
    s_nop 10
CHK_398:
    buffer_load_dwordx4 v[208:211], v1, s[8:11], s53 offen offset:0 sc1
    buffer_load_dwordx4 v[212:215], v1, s[8:11], s53 offen offset:1024 sc1
    buffer_load_dwordx4 v[216:219], v1, s[8:11], s53 offen offset:2048 sc1
    buffer_load_dwordx4 v[220:223], v1, s[8:11], s53 offen offset:3072 sc1
    s_add_u32 s78, s53, 0x1000
    buffer_load_dwordx4 v[224:227], v1, s[8:11], s78 offen offset:0 sc1
    buffer_load_dwordx4 v[228:231], v1, s[8:11], s78 offen offset:1024 sc1
    buffer_load_dwordx4 v[232:235], v1, s[8:11], s52 offen offset:0 sc1
    buffer_load_dwordx4 v[236:239], v1, s[8:11], s52 offen offset:1024 sc1
    buffer_load_dwordx4 v[240:243], v1, s[8:11], s52 offen offset:2048 sc1
    buffer_load_dwordx4 v[244:247], v1, s[8:11], s52 offen offset:3072 sc1
    s_add_u32 s78, s52, 0x1000
    buffer_load_dwordx4 v[248:251], v1, s[8:11], s78 offen offset:0 sc1
    s_sub_u32 s45, s45, 1
    s_nop 0
    s_cbranch_scc1 L_end2
    s_waitcnt vmcnt(7)
    v_bitop3_b32 v7, v211, v215, v219 bitop3:0x80
    v_bitop3_b32 v7, v7, v223, 1 bitop3:0x2a
    v_cmp_ne_u32 vcc, 0, v7
    s_nop 4
    s_cbranch_vccnz CHK_398
    s_nop 0
    s_branch RET_400
OOL_402:
    s_nop 10
CHK_401:
    s_add_u32 s78, s53, 0x1000
    buffer_load_dwordx4 v[224:227], v1, s[8:11], s78 offen offset:0 sc1
    buffer_load_dwordx4 v[228:231], v1, s[8:11], s78 offen offset:1024 sc1
    buffer_load_dwordx4 v[232:235], v1, s[8:11], s52 offen offset:0 sc1
    buffer_load_dwordx4 v[236:239], v1, s[8:11], s52 offen offset:1024 sc1
    buffer_load_dwordx4 v[240:243], v1, s[8:11], s52 offen offset:2048 sc1
    buffer_load_dwordx4 v[244:247], v1, s[8:11], s52 offen offset:3072 sc1
    s_add_u32 s78, s52, 0x1000
    buffer_load_dwordx4 v[248:251], v1, s[8:11], s78 offen offset:0 sc1
    buffer_load_dwordx4 v[252:255], v1, s[8:11], s78 offen offset:1024 sc1
    s_add_u32 s78, s53, 0x1800
    buffer_load_dwordx4 v[144:147], v1, s[8:11], s78 offen offset:0 sc1
    buffer_load_dwordx4 v[148:151], v1, s[8:11], s78 offen offset:1024 sc1
    buffer_load_dwordx4 v[152:155], v1, s[8:11], s78 offen offset:2048 sc1
    s_sub_u32 s45, s45, 1
    s_nop 0
    s_cbranch_scc1 L_end2
    s_waitcnt vmcnt(9)
    v_bitop3_b32 v7, v227, v231, 1 bitop3:0x2a
    v_cmp_ne_u32 vcc, 0, v7
    s_nop 4
    s_cbranch_vccnz CHK_401
    s_nop 0
    s_branch RET_403
OOL_405:
    s_nop 10
CHK_404:
    buffer_load_dwordx4 v[232:235], v1, s[8:11], s52 offen offset:0 sc1
    buffer_load_dwordx4 v[236:239], v1, s[8:11], s52 offen offset:1024 sc1
    buffer_load_dwordx4 v[240:243], v1, s[8:11], s52 offen offset:2048 sc1
    buffer_load_dwordx4 v[244:247], v1, s[8:11], s52 offen offset:3072 sc1
    s_add_u32 s78, s52, 0x1000
    buffer_load_dwordx4 v[248:251], v1, s[8:11], s78 offen offset:0 sc1
    buffer_load_dwordx4 v[252:255], v1, s[8:11], s78 offen offset:1024 sc1
    s_add_u32 s78, s53, 0x1800
    buffer_load_dwordx4 v[144:147], v1, s[8:11], s78 offen offset:0 sc1
    buffer_load_dwordx4 v[148:151], v1, s[8:11], s78 offen offset:1024 sc1
    buffer_load_dwordx4 v[152:155], v1, s[8:11], s78 offen offset:2048 sc1
    buffer_load_dwordx4 v[156:159], v1, s[8:11], s78 offen offset:3072 sc1
    s_add_u32 s78, s53, 0x2800
    buffer_load_dwordx4 v[160:163], v1, s[8:11], s78 offen offset:0 sc1
    s_sub_u32 s45, s45, 1
    s_nop 0
    s_cbranch_scc1 L_end2
    s_waitcnt vmcnt(7)
    v_bitop3_b32 v7, v235, v239, v243 bitop3:0x80
    v_bitop3_b32 v7, v7, v247, 1 bitop3:0x2a
    v_cmp_ne_u32 vcc, 0, v7
    s_nop 4
    s_cbranch_vccnz CHK_404
    s_nop 0
    s_branch RET_406
OOL_408:
    s_nop 10
CHK_407:
    s_add_u32 s78, s52, 0x1000
    buffer_load_dwordx4 v[248:251], v1, s[8:11], s78 offen offset:0 sc1
    buffer_load_dwordx4 v[252:255], v1, s[8:11], s78 offen offset:1024 sc1
    s_add_u32 s78, s53, 0x1800
    buffer_load_dwordx4 v[144:147], v1, s[8:11], s78 offen offset:0 sc1
    buffer_load_dwordx4 v[148:151], v1, s[8:11], s78 offen offset:1024 sc1
    buffer_load_dwordx4 v[152:155], v1, s[8:11], s78 offen offset:2048 sc1
    buffer_load_dwordx4 v[156:159], v1, s[8:11], s78 offen offset:3072 sc1
    s_add_u32 s78, s53, 0x2800
    buffer_load_dwordx4 v[160:163], v1, s[8:11], s78 offen offset:0 sc1
    buffer_load_dwordx4 v[164:167], v1, s[8:11], s78 offen offset:1024 sc1
    s_add_u32 s78, s52, 0x1800
    buffer_load_dwordx4 v[168:171], v1, s[8:11], s78 offen offset:0 sc1
    buffer_load_dwordx4 v[172:175], v1, s[8:11], s78 offen offset:1024 sc1
    buffer_load_dwordx4 v[176:179], v1, s[8:11], s78 offen offset:2048 sc1
    s_sub_u32 s45, s45, 1
    s_nop 0
    s_cbranch_scc1 L_end2
    s_waitcnt vmcnt(9)
    v_bitop3_b32 v7, v251, v255, 1 bitop3:0x2a
    v_cmp_ne_u32 vcc, 0, v7
    s_nop 4
    s_cbranch_vccnz CHK_407
    s_nop 0
    s_branch RET_409
OOL_411:
    s_nop 10
CHK_410:
    s_add_u32 s78, s53, 0x1800
    buffer_load_dwordx4 v[144:147], v1, s[8:11], s78 offen offset:0 sc1
    buffer_load_dwordx4 v[148:151], v1, s[8:11], s78 offen offset:1024 sc1
    buffer_load_dwordx4 v[152:155], v1, s[8:11], s78 offen offset:2048 sc1
    buffer_load_dwordx4 v[156:159], v1, s[8:11], s78 offen offset:3072 sc1
    s_add_u32 s78, s53, 0x2800
    buffer_load_dwordx4 v[160:163], v1, s[8:11], s78 offen offset:0 sc1
    buffer_load_dwordx4 v[164:167], v1, s[8:11], s78 offen offset:1024 sc1
    s_add_u32 s78, s52, 0x1800
    buffer_load_dwordx4 v[168:171], v1, s[8:11], s78 offen offset:0 sc1
    buffer_load_dwordx4 v[172:175], v1, s[8:11], s78 offen offset:1024 sc1
    buffer_load_dwordx4 v[176:179], v1, s[8:11], s78 offen offset:2048 sc1
    buffer_load_dwordx4 v[180:183], v1, s[8:11], s78 offen offset:3072 sc1
    s_add_u32 s78, s52, 0x2800
    buffer_load_dwordx4 v[184:187], v1, s[8:11], s78 offen offset:0 sc1
    s_sub_u32 s45, s45, 1
    s_nop 0
    s_cbranch_scc1 L_end2
    s_waitcnt vmcnt(7)
    v_bitop3_b32 v7, v147, v151, v155 bitop3:0x80
    v_bitop3_b32 v7, v7, v159, 1 bitop3:0x2a
    v_cmp_ne_u32 vcc, 0, v7
    s_nop 4
    s_cbranch_vccnz CHK_410
    s_nop 0
    s_branch RET_412
OOL_414:
    s_nop 10
CHK_413:
    s_add_u32 s78, s53, 0x2800
    buffer_load_dwordx4 v[160:163], v1, s[8:11], s78 offen offset:0 sc1
    buffer_load_dwordx4 v[164:167], v1, s[8:11], s78 offen offset:1024 sc1
    s_add_u32 s78, s52, 0x1800
    buffer_load_dwordx4 v[168:171], v1, s[8:11], s78 offen offset:0 sc1
    buffer_load_dwordx4 v[172:175], v1, s[8:11], s78 offen offset:1024 sc1
    buffer_load_dwordx4 v[176:179], v1, s[8:11], s78 offen offset:2048 sc1
    buffer_load_dwordx4 v[180:183], v1, s[8:11], s78 offen offset:3072 sc1
    s_add_u32 s78, s52, 0x2800
    buffer_load_dwordx4 v[184:187], v1, s[8:11], s78 offen offset:0 sc1
    buffer_load_dwordx4 v[188:191], v1, s[8:11], s78 offen offset:1024 sc1
    buffer_load_dword v62, off, s[8:11], s62
    buffer_load_dword v62, off, s[8:11], s62
    buffer_load_dword v62, off, s[8:11], s62
    s_sub_u32 s45, s45, 1
    s_nop 0
    s_cbranch_scc1 L_end2
    s_waitcnt vmcnt(9)
    v_bitop3_b32 v7, v163, v167, 1 bitop3:0x2a
    v_cmp_ne_u32 vcc, 0, v7
    s_nop 4
    s_cbranch_vccnz CHK_413
    s_nop 0
    s_branch RET_415
OOL_417:
    s_nop 10
CHK_416:
    s_add_u32 s78, s52, 0x1800
    buffer_load_dwordx4 v[168:171], v1, s[8:11], s78 offen offset:0 sc1
    buffer_load_dwordx4 v[172:175], v1, s[8:11], s78 offen offset:1024 sc1
    buffer_load_dwordx4 v[176:179], v1, s[8:11], s78 offen offset:2048 sc1
    buffer_load_dwordx4 v[180:183], v1, s[8:11], s78 offen offset:3072 sc1
    s_add_u32 s78, s52, 0x2800
    buffer_load_dwordx4 v[184:187], v1, s[8:11], s78 offen offset:0 sc1
    buffer_load_dwordx4 v[188:191], v1, s[8:11], s78 offen offset:1024 sc1
    buffer_load_dword v62, off, s[8:11], s62
    buffer_load_dword v62, off, s[8:11], s62
    buffer_load_dword v62, off, s[8:11], s62
    buffer_load_dword v62, off, s[8:11], s62
    buffer_load_dword v62, off, s[8:11], s62
    s_sub_u32 s45, s45, 1
    s_nop 0
    s_cbranch_scc1 L_end2
    s_waitcnt vmcnt(7)
    v_bitop3_b32 v7, v171, v175, v179 bitop3:0x80
    v_bitop3_b32 v7, v7, v183, 1 bitop3:0x2a
    v_cmp_ne_u32 vcc, 0, v7
    s_nop 4
    s_cbranch_vccnz CHK_416
    s_nop 0
    s_branch RET_418
OOL_420:
    s_nop 10
CHK_419:
    s_add_u32 s78, s52, 0x2800
    buffer_load_dwordx4 v[184:187], v1, s[8:11], s78 offen offset:0 sc1
    buffer_load_dwordx4 v[188:191], v1, s[8:11], s78 offen offset:1024 sc1
    buffer_load_dword v62, off, s[8:11], s62
    buffer_load_dword v62, off, s[8:11], s62
    buffer_load_dword v62, off, s[8:11], s62
    buffer_load_dword v62, off, s[8:11], s62
    buffer_load_dword v62, off, s[8:11], s62
    buffer_load_dword v62, off, s[8:11], s62
    buffer_load_dword v62, off, s[8:11], s62
    s_sub_u32 s45, s45, 1
    s_nop 0
    s_cbranch_scc1 L_end2
    s_waitcnt vmcnt(7)
    v_bitop3_b32 v7, v187, v191, 1 bitop3:0x2a
    v_cmp_ne_u32 vcc, 0, v7
    s_nop 4
    s_cbranch_vccnz CHK_419
    s_nop 0
    s_branch RET_421
OOL_423:
    s_nop 3
CHK_422:
    buffer_load_dwordx4 v[80:83], v1, s[8:11], s76 offen offset:0 sc1
    buffer_load_dwordx4 v[84:87], v1, s[8:11], s76 offen offset:1024 sc1
    buffer_load_dwordx4 v[88:91], v1, s[8:11], s76 offen offset:2048 sc1
    buffer_load_dwordx4 v[92:95], v1, s[8:11], s76 offen offset:3072 sc1
    s_sub_u32 s45, s45, 1
    s_nop 0
    s_cbranch_scc1 L_end2
    s_waitcnt vmcnt(0)
    v_bitop3_b32 v7, v80, v81, v82 bitop3:0xfe
    v_bitop3_b32 v7, v7, v83, v84 bitop3:0xfe
    v_bitop3_b32 v7, v7, v85, v86 bitop3:0xfe
    v_bitop3_b32 v7, v7, v87, v88 bitop3:0xfe
    v_bitop3_b32 v7, v7, v89, v90 bitop3:0xfe
    v_bitop3_b32 v7, v7, v91, v92 bitop3:0xfe
    v_bitop3_b32 v7, v7, v93, v94 bitop3:0xfe
    v_bitop3_b32 v7, v7, v95, 1 bitop3:0xa8
    v_cmp_ne_u32 vcc, 0, v7
    s_nop 4
    s_cbranch_vccnz CHK_422
    s_nop 0
    s_branch RET_424
OOL_426:
    s_nop 3
CHK_425:
    s_add_u32 s79, s51, 0x110000
    buffer_load_dwordx4 v[132:135], v1, s[8:11], s79 offen offset:0 sc1
    buffer_load_dwordx4 v[140:143], v1, s[8:11], s79 offen offset:1024 sc1
    buffer_load_dwordx4 v[148:151], v1, s[8:11], s79 offen offset:2048 sc1
    buffer_load_dwordx4 v[156:159], v1, s[8:11], s79 offen offset:3072 sc1
    s_add_u32 s79, s51, 0x111000
    buffer_load_dwordx4 v[164:167], v1, s[8:11], s79 offen offset:0 sc1
    buffer_load_dwordx4 v[172:175], v1, s[8:11], s79 offen offset:1024 sc1
    buffer_load_dwordx4 v[180:183], v1, s[8:11], s79 offen offset:2048 sc1
    buffer_load_dwordx4 v[188:191], v1, s[8:11], s79 offen offset:3072 sc1
    s_sub_u32 s45, s45, 1
    s_nop 0
    s_cbranch_scc1 L_end2
    s_waitcnt vmcnt(6)
    v_bitop3_b32 v7, v135, v143, 1 bitop3:0xa8
    v_cmp_ne_u32 vcc, 0, v7
    s_nop 4
    s_cbranch_vccnz CHK_425
    s_nop 0
    s_branch RET_427
OOL_429:
    s_nop 10
CHK_428:
    s_add_u32 s79, s51, 0x110000
    buffer_load_dwordx4 v[148:151], v1, s[8:11], s79 offen offset:2048 sc1
    buffer_load_dwordx4 v[156:159], v1, s[8:11], s79 offen offset:3072 sc1
    s_add_u32 s79, s51, 0x111000
    buffer_load_dwordx4 v[164:167], v1, s[8:11], s79 offen offset:0 sc1
    buffer_load_dwordx4 v[172:175], v1, s[8:11], s79 offen offset:1024 sc1
    buffer_load_dwordx4 v[180:183], v1, s[8:11], s79 offen offset:2048 sc1
    buffer_load_dwordx4 v[188:191], v1, s[8:11], s79 offen offset:3072 sc1
    s_add_u32 s80, s50, 0x110000
    buffer_load_dwordx4 v[128:131], v1, s[8:11], s80 offen offset:0 sc1
    buffer_load_dword v62, off, s[8:11], s62
    buffer_load_dwordx4 v[136:139], v1, s[8:11], s80 offen offset:1024 sc1
    s_sub_u32 s45, s45, 1
    s_nop 0
    s_cbranch_scc1 L_end2
    s_waitcnt vmcnt(7)
    v_bitop3_b32 v7, v151, v159, 1 bitop3:0xa8
    v_cmp_ne_u32 vcc, 0, v7
    s_nop 4
    s_cbranch_vccnz CHK_428
    s_nop 0
    s_branch RET_430
OOL_432:
    s_nop 10
CHK_431:
    s_add_u32 s79, s51, 0x111000
    buffer_load_dwordx4 v[164:167], v1, s[8:11], s79 offen offset:0 sc1
    buffer_load_dwordx4 v[172:175], v1, s[8:11], s79 offen offset:1024 sc1
    buffer_load_dwordx4 v[180:183], v1, s[8:11], s79 offen offset:2048 sc1
    buffer_load_dwordx4 v[188:191], v1, s[8:11], s79 offen offset:3072 sc1
    s_add_u32 s80, s50, 0x110000
    buffer_load_dwordx4 v[128:131], v1, s[8:11], s80 offen offset:0 sc1
    buffer_load_dword v62, off, s[8:11], s62
    buffer_load_dwordx4 v[136:139], v1, s[8:11], s80 offen offset:1024 sc1
    buffer_load_dwordx4 v[144:147], v1, s[8:11], s80 offen offset:2048 sc1
    buffer_load_dwordx4 v[152:155], v1, s[8:11], s80 offen offset:3072 sc1
    s_sub_u32 s45, s45, 1
    s_nop 0
    s_cbranch_scc1 L_end2
    s_waitcnt vmcnt(5)
    v_bitop3_b32 v7, v167, v175, v183 bitop3:0xfe
    v_bitop3_b32 v7, v7, v191, 1 bitop3:0xa8
    v_cmp_ne_u32 vcc, 0, v7
    s_nop 4
    s_cbranch_vccnz CHK_431
    s_nop 0
    s_branch RET_433
OOL_435:
    s_nop 10
CHK_434:
    s_add_u32 s80, s50, 0x110000
    buffer_load_dwordx4 v[128:131], v1, s[8:11], s80 offen offset:0 sc1
    buffer_load_dword v62, off, s[8:11], s62
    buffer_load_dwordx4 v[136:139], v1, s[8:11], s80 offen offset:1024 sc1
    buffer_load_dwordx4 v[144:147], v1, s[8:11], s80 offen offset:2048 sc1
    buffer_load_dwordx4 v[152:155], v1, s[8:11], s80 offen offset:3072 sc1
    s_add_u32 s80, s50, 0x111000
    buffer_load_dwordx4 v[160:163], v1, s[8:11], s80 offen offset:0 sc1
    buffer_load_dwordx4 v[168:171], v1, s[8:11], s80 offen offset:1024 sc1
    buffer_load_dwordx4 v[176:179], v1, s[8:11], s80 offen offset:2048 sc1
    buffer_load_dwordx4 v[184:187], v1, s[8:11], s80 offen offset:3072 sc1
    s_sub_u32 s45, s45, 1
    s_nop 0
    s_cbranch_scc1 L_end2
    s_waitcnt vmcnt(4)
    v_bitop3_b32 v7, v131, v139, v147 bitop3:0xfe
    v_bitop3_b32 v7, v7, v155, 1 bitop3:0xa8
    v_cmp_ne_u32 vcc, 0, v7
    s_nop 4
    s_cbranch_vccnz CHK_434
    s_nop 0
    s_branch RET_436
OOL_438:
    s_nop 10
CHK_437:
    s_add_u32 s80, s50, 0x111000
    buffer_load_dwordx4 v[160:163], v1, s[8:11], s80 offen offset:0 sc1
    buffer_load_dwordx4 v[168:171], v1, s[8:11], s80 offen offset:1024 sc1
    buffer_load_dwordx4 v[176:179], v1, s[8:11], s80 offen offset:2048 sc1
    buffer_load_dwordx4 v[184:187], v1, s[8:11], s80 offen offset:3072 sc1
    buffer_load_dword v62, off, s[8:11], s62
    buffer_load_dword v62, off, s[8:11], s62
    buffer_load_dword v62, off, s[8:11], s62
    buffer_load_dword v62, off, s[8:11], s62
    buffer_load_dword v62, off, s[8:11], s62
    s_sub_u32 s45, s45, 1
    s_nop 0
    s_cbranch_scc1 L_end2
    s_waitcnt vmcnt(7)
    v_bitop3_b32 v7, v163, v171, 1 bitop3:0xa8
    v_cmp_ne_u32 vcc, 0, v7
    s_nop 4
    s_cbranch_vccnz CHK_437
    s_nop 0
    s_branch RET_439
OOL_441:
    s_nop 10
CHK_440:
    s_add_u32 s80, s50, 0x111000
    buffer_load_dwordx4 v[176:179], v1, s[8:11], s80 offen offset:2048 sc1
    buffer_load_dwordx4 v[184:187], v1, s[8:11], s80 offen offset:3072 sc1
    buffer_load_dword v62, off, s[8:11], s62
    buffer_load_dword v62, off, s[8:11], s62
    buffer_load_dword v62, off, s[8:11], s62
    buffer_load_dword v62, off, s[8:11], s62
    buffer_load_dword v62, off, s[8:11], s62
    buffer_load_dword v62, off, s[8:11], s62
    buffer_load_dword v62, off, s[8:11], s62
    buffer_load_dword v62, off, s[8:11], s62
    buffer_load_dword v62, off, s[8:11], s62
    s_sub_u32 s45, s45, 1
    s_nop 0
    s_cbranch_scc1 L_end2
    s_waitcnt vmcnt(9)
    v_bitop3_b32 v7, v179, v187, 1 bitop3:0xa8
    v_cmp_ne_u32 vcc, 0, v7
    s_nop 4
    s_cbranch_vccnz CHK_440
    s_nop 0
    s_branch RET_442
OOL_444:
    s_nop 3
CHK_443:
    buffer_load_dwordx4 v[132:135], v1, s[8:11], s49 offen offset:0 sc1
    buffer_load_dwordx4 v[140:143], v1, s[8:11], s49 offen offset:1024 sc1
    buffer_load_dwordx4 v[148:151], v1, s[8:11], s49 offen offset:2048 sc1
    buffer_load_dwordx4 v[156:159], v1, s[8:11], s49 offen offset:3072 sc1
    s_sub_u32 s45, s45, 1
    s_nop 0
    s_cbranch_scc1 L_end2
    s_waitcnt vmcnt(0)
    v_bitop3_b32 v7, v132, v133, v134 bitop3:0x80
    v_bitop3_b32 v7, v7, v135, v140 bitop3:0x80
    v_bitop3_b32 v7, v7, v141, v142 bitop3:0x80
    v_bitop3_b32 v7, v7, v143, v148 bitop3:0x80
    v_bitop3_b32 v7, v7, v149, v150 bitop3:0x80
    v_bitop3_b32 v7, v7, v151, v156 bitop3:0x80
    v_bitop3_b32 v7, v7, v157, v158 bitop3:0x80
    v_bitop3_b32 v7, v7, v159, 1 bitop3:0x2a
    v_cmp_ne_u32 vcc, 0, v7
    s_nop 4
    s_cbranch_vccnz CHK_443
    s_nop 0
    s_branch RET_445
OOL_447:
    s_nop 3
CHK_446:
    buffer_load_dword v9, v8, s[8:11], 0 offen offset:0 sc1
    s_sub_u32 s45, s45, 1
    s_nop 0
    s_cbranch_scc1 L_end2
    s_waitcnt vmcnt(0)
    v_subrev_u32 v9, s69, v9
    v_subrev_u32 v9, 3, v9
    v_cmp_lt_u32 vcc, 7, v9
    s_nop 4
    s_cbranch_vccnz CHK_446
    s_nop 0
    s_branch RET_448
OOL_450:
    s_add_u32 s76, s46, 0x8000
    buffer_store_dwordx4 v[112:115], v4, s[8:11], s76 offen offset:0 sc1
    buffer_store_dwordx4 v[116:119], v4, s[8:11], s76 offen offset:1024 sc1
    s_nop 1
    s_branch RET_451
OOL_453:
    s_nop 3
CHK_452:
    s_add_u32 s79, s51, 0x8000
    buffer_load_dwordx4 v[132:135], v1, s[8:11], s79 offen offset:0 sc1
    buffer_load_dwordx4 v[140:143], v1, s[8:11], s79 offen offset:1024 sc1
    buffer_load_dwordx4 v[148:151], v1, s[8:11], s79 offen offset:2048 sc1
    buffer_load_dwordx4 v[156:159], v1, s[8:11], s79 offen offset:3072 sc1
    s_add_u32 s79, s51, 0x9000
    buffer_load_dwordx4 v[164:167], v1, s[8:11], s79 offen offset:0 sc1
    buffer_load_dwordx4 v[172:175], v1, s[8:11], s79 offen offset:1024 sc1
    buffer_load_dwordx4 v[180:183], v1, s[8:11], s79 offen offset:2048 sc1
    buffer_load_dwordx4 v[188:191], v1, s[8:11], s79 offen offset:3072 sc1
    s_sub_u32 s45, s45, 1
    s_nop 0
    s_cbranch_scc1 L_end2
    s_waitcnt vmcnt(6)
    v_bitop3_b32 v7, v135, v143, 1 bitop3:0x2a
    v_cmp_ne_u32 vcc, 0, v7
    s_nop 4
    s_cbranch_vccnz CHK_452
    s_nop 0
    s_branch RET_454
OOL_456:
    s_nop 10
CHK_455:
    s_add_u32 s79, s51, 0x8000
    buffer_load_dwordx4 v[148:151], v1, s[8:11], s79 offen offset:2048 sc1
    buffer_load_dwordx4 v[156:159], v1, s[8:11], s79 offen offset:3072 sc1
    s_add_u32 s79, s51, 0x9000
    buffer_load_dwordx4 v[164:167], v1, s[8:11], s79 offen offset:0 sc1
    buffer_load_dwordx4 v[172:175], v1, s[8:11], s79 offen offset:1024 sc1
    buffer_load_dwordx4 v[180:183], v1, s[8:11], s79 offen offset:2048 sc1
    buffer_load_dwordx4 v[188:191], v1, s[8:11], s79 offen offset:3072 sc1
    s_add_u32 s80, s50, 0x8000
    buffer_load_dwordx4 v[128:131], v5, s[8:11], s80 offen offset:0 sc1
    buffer_load_dwordx4 v[136:139], v5, s[8:11], s80 offen offset:1024 sc1
    s_sub_u32 s45, s45, 1
    s_nop 0
    s_cbranch_scc1 L_end2
    s_waitcnt vmcnt(6)
    v_bitop3_b32 v7, v151, v159, 1 bitop3:0x2a
    v_cmp_ne_u32 vcc, 0, v7
    s_nop 4
    s_cbranch_vccnz CHK_455
    s_nop 0
    s_branch RET_457
OOL_459:
    s_nop 10
CHK_458:
    s_add_u32 s79, s51, 0x9000
    buffer_load_dwordx4 v[164:167], v1, s[8:11], s79 offen offset:0 sc1
    buffer_load_dwordx4 v[172:175], v1, s[8:11], s79 offen offset:1024 sc1
    buffer_load_dwordx4 v[180:183], v1, s[8:11], s79 offen offset:2048 sc1
    buffer_load_dwordx4 v[188:191], v1, s[8:11], s79 offen offset:3072 sc1
    s_add_u32 s80, s50, 0x8000
    buffer_load_dwordx4 v[128:131], v5, s[8:11], s80 offen offset:0 sc1
    buffer_load_dwordx4 v[136:139], v5, s[8:11], s80 offen offset:1024 sc1
    buffer_load_dwordx4 v[144:147], v5, s[8:11], s80 offen offset:2048 sc1
    buffer_load_dwordx4 v[152:155], v5, s[8:11], s80 offen offset:3072 sc1
    s_sub_u32 s45, s45, 1
    s_nop 0
    s_cbranch_scc1 L_end2
    s_waitcnt vmcnt(6)
    v_bitop3_b32 v7, v167, v175, 1 bitop3:0x2a
    v_cmp_ne_u32 vcc, 0, v7
    s_nop 4
    s_cbranch_vccnz CHK_458
    s_nop 0
    s_branch RET_460
OOL_462:
    s_nop 10
CHK_461:
    s_add_u32 s79, s51, 0x9000
    buffer_load_dwordx4 v[180:183], v1, s[8:11], s79 offen offset:2048 sc1
    buffer_load_dwordx4 v[188:191], v1, s[8:11], s79 offen offset:3072 sc1
    s_add_u32 s80, s50, 0x8000
    buffer_load_dwordx4 v[128:131], v5, s[8:11], s80 offen offset:0 sc1
    buffer_load_dwordx4 v[136:139], v5, s[8:11], s80 offen offset:1024 sc1
    buffer_load_dwordx4 v[144:147], v5, s[8:11], s80 offen offset:2048 sc1
    buffer_load_dwordx4 v[152:155], v5, s[8:11], s80 offen offset:3072 sc1
    s_add_u32 s80, s50, 0x9000
    buffer_load_dwordx4 v[160:163], v5, s[8:11], s80 offen offset:0 sc1
    buffer_load_dwordx4 v[168:171], v5, s[8:11], s80 offen offset:1024 sc1
    s_sub_u32 s45, s45, 1
    s_nop 0
    s_cbranch_scc1 L_end2
    s_waitcnt vmcnt(6)
    v_bitop3_b32 v7, v183, v191, 1 bitop3:0x2a
    v_cmp_ne_u32 vcc, 0, v7
    s_nop 4
    s_cbranch_vccnz CHK_461
    s_nop 0
    s_branch RET_463
OOL_465:
    s_nop 10
CHK_464:
    s_add_u32 s80, s50, 0x8000
    buffer_load_dwordx4 v[128:131], v5, s[8:11], s80 offen offset:0 sc1
    buffer_load_dwordx4 v[136:139], v5, s[8:11], s80 offen offset:1024 sc1
    buffer_load_dwordx4 v[144:147], v5, s[8:11], s80 offen offset:2048 sc1
    buffer_load_dwordx4 v[152:155], v5, s[8:11], s80 offen offset:3072 sc1
    s_add_u32 s80, s50, 0x9000
    buffer_load_dwordx4 v[160:163], v5, s[8:11], s80 offen offset:0 sc1
    buffer_load_dwordx4 v[168:171], v5, s[8:11], s80 offen offset:1024 sc1
    buffer_load_dwordx4 v[176:179], v5, s[8:11], s80 offen offset:2048 sc1
    buffer_load_dwordx4 v[184:187], v5, s[8:11], s80 offen offset:3072 sc1
    s_sub_u32 s45, s45, 1
    s_nop 0
    s_cbranch_scc1 L_end2
    s_waitcnt vmcnt(4)
    v_bitop3_b32 v7, v131, v139, v147 bitop3:0x80
    v_bitop3_b32 v7, v7, v155, 1 bitop3:0x2a
    v_cmp_ne_u32 vcc, 0, v7
    s_nop 4
    s_cbranch_vccnz CHK_464
    s_nop 0
    s_branch RET_466
OOL_468:
    s_nop 10
CHK_467:
    s_add_u32 s80, s50, 0x9000
    buffer_load_dwordx4 v[160:163], v5, s[8:11], s80 offen offset:0 sc1
    buffer_load_dwordx4 v[168:171], v5, s[8:11], s80 offen offset:1024 sc1
    buffer_load_dwordx4 v[176:179], v5, s[8:11], s80 offen offset:2048 sc1
    buffer_load_dwordx4 v[184:187], v5, s[8:11], s80 offen offset:3072 sc1
    s_sub_u32 s45, s45, 1
    s_nop 0
    s_cbranch_scc1 L_end2
    s_waitcnt vmcnt(2)
    v_bitop3_b32 v7, v163, v171, 1 bitop3:0x2a
    v_cmp_ne_u32 vcc, 0, v7
    s_nop 4
    s_cbranch_vccnz CHK_467
    s_nop 0
    s_branch RET_469
OOL_471:
    s_nop 10
CHK_470:
    s_add_u32 s80, s50, 0x9000
    buffer_load_dwordx4 v[176:179], v5, s[8:11], s80 offen offset:2048 sc1
    buffer_load_dwordx4 v[184:187], v5, s[8:11], s80 offen offset:3072 sc1
    s_sub_u32 s45, s45, 1
    s_nop 0
    s_cbranch_scc1 L_end2
    s_waitcnt vmcnt(0)
    v_bitop3_b32 v7, v179, v187, 1 bitop3:0x2a
    v_cmp_ne_u32 vcc, 0, v7
    s_nop 4
    s_cbranch_vccnz CHK_470
    s_nop 0
    s_branch RET_472
OOL_474:
    s_nop 3
CHK_473:
    buffer_load_dwordx4 v[128:131], v1, s[8:11], s59 offen offset:0 sc1
    buffer_load_dwordx4 v[132:135], v1, s[8:11], s59 offen offset:1024 sc1
    buffer_load_dwordx4 v[136:139], v1, s[8:11], s59 offen offset:2048 sc1
    buffer_load_dwordx4 v[140:143], v1, s[8:11], s59 offen offset:3072 sc1
    s_add_u32 s79, s59, 0x1000
    buffer_load_dwordx4 v[144:147], v1, s[8:11], s79 offen offset:0 sc1
    buffer_load_dwordx4 v[148:151], v1, s[8:11], s79 offen offset:1024 sc1
    buffer_load_dwordx4 v[152:155], v1, s[8:11], s79 offen offset:2048 sc1
    buffer_load_dwordx4 v[156:159], v1, s[8:11], s79 offen offset:3072 sc1
    s_add_u32 s79, s59, 0x2000
    buffer_load_dwordx4 v[160:163], v1, s[8:11], s79 offen offset:0 sc1
    buffer_load_dwordx4 v[164:167], v1, s[8:11], s79 offen offset:1024 sc1
    buffer_load_dwordx4 v[168:171], v1, s[8:11], s79 offen offset:2048 sc1
    buffer_load_dwordx4 v[172:175], v1, s[8:11], s79 offen offset:3072 sc1
    s_sub_u32 s45, s45, 1
    s_nop 0
    s_cbranch_scc1 L_end2
    s_waitcnt vmcnt(10)
    v_bitop3_b32 v7, v131, v135, 1 bitop3:0x2a
    v_cmp_ne_u32 vcc, 0, v7
    s_nop 4
    s_cbranch_vccnz CHK_473
    s_nop 0
    s_branch RET_475
OOL_477:
    s_nop 10
CHK_476:
    buffer_load_dwordx4 v[136:139], v1, s[8:11], s59 offen offset:2048 sc1
    buffer_load_dwordx4 v[140:143], v1, s[8:11], s59 offen offset:3072 sc1
    s_add_u32 s79, s59, 0x1000
    buffer_load_dwordx4 v[144:147], v1, s[8:11], s79 offen offset:0 sc1
    buffer_load_dwordx4 v[148:151], v1, s[8:11], s79 offen offset:1024 sc1
    buffer_load_dwordx4 v[152:155], v1, s[8:11], s79 offen offset:2048 sc1
    buffer_load_dwordx4 v[156:159], v1, s[8:11], s79 offen offset:3072 sc1
    s_add_u32 s79, s59, 0x2000
    buffer_load_dwordx4 v[160:163], v1, s[8:11], s79 offen offset:0 sc1
    buffer_load_dwordx4 v[164:167], v1, s[8:11], s79 offen offset:1024 sc1
    buffer_load_dwordx4 v[168:171], v1, s[8:11], s79 offen offset:2048 sc1
    buffer_load_dwordx4 v[172:175], v1, s[8:11], s79 offen offset:3072 sc1
    s_add_u32 s79, s59, 0x3000
    buffer_load_dwordx4 v[176:179], v1, s[8:11], s79 offen offset:0 sc1
    buffer_load_dwordx4 v[180:183], v1, s[8:11], s79 offen offset:1024 sc1
    s_sub_u32 s45, s45, 1
    s_nop 0
    s_cbranch_scc1 L_end2
    s_waitcnt vmcnt(10)
    v_bitop3_b32 v7, v139, v143, 1 bitop3:0x2a
    v_cmp_ne_u32 vcc, 0, v7
    s_nop 4
    s_cbranch_vccnz CHK_476
    s_nop 0
    s_branch RET_478
OOL_480:
    s_nop 10
CHK_479:
    s_add_u32 s79, s59, 0x1000
    buffer_load_dwordx4 v[144:147], v1, s[8:11], s79 offen offset:0 sc1
    buffer_load_dwordx4 v[148:151], v1, s[8:11], s79 offen offset:1024 sc1
    buffer_load_dwordx4 v[152:155], v1, s[8:11], s79 offen offset:2048 sc1
    buffer_load_dwordx4 v[156:159], v1, s[8:11], s79 offen offset:3072 sc1
    s_add_u32 s79, s59, 0x2000
    buffer_load_dwordx4 v[160:163], v1, s[8:11], s79 offen offset:0 sc1
    buffer_load_dwordx4 v[164:167], v1, s[8:11], s79 offen offset:1024 sc1
    buffer_load_dwordx4 v[168:171], v1, s[8:11], s79 offen offset:2048 sc1
    buffer_load_dwordx4 v[172:175], v1, s[8:11], s79 offen offset:3072 sc1
    s_add_u32 s79, s59, 0x3000
    buffer_load_dwordx4 v[176:179], v1, s[8:11], s79 offen offset:0 sc1
    buffer_load_dwordx4 v[180:183], v1, s[8:11], s79 offen offset:1024 sc1
    buffer_load_dwordx4 v[184:187], v1, s[8:11], s79 offen offset:2048 sc1
    buffer_load_dwordx4 v[188:191], v1, s[8:11], s79 offen offset:3072 sc1
    s_sub_u32 s45, s45, 1
    s_nop 0
    s_cbranch_scc1 L_end2
    s_waitcnt vmcnt(8)
    v_bitop3_b32 v7, v147, v151, v155 bitop3:0x80
    v_bitop3_b32 v7, v7, v159, 1 bitop3:0x2a
    v_cmp_ne_u32 vcc, 0, v7
    s_nop 4
    s_cbranch_vccnz CHK_479
    s_nop 0
    s_branch RET_481
OOL_483:
    s_nop 10
CHK_482:
    s_add_u32 s79, s59, 0x2000
    buffer_load_dwordx4 v[160:163], v1, s[8:11], s79 offen offset:0 sc1
    buffer_load_dwordx4 v[164:167], v1, s[8:11], s79 offen offset:1024 sc1
    buffer_load_dwordx4 v[168:171], v1, s[8:11], s79 offen offset:2048 sc1
    buffer_load_dwordx4 v[172:175], v1, s[8:11], s79 offen offset:3072 sc1
    s_add_u32 s79, s59, 0x3000
    buffer_load_dwordx4 v[176:179], v1, s[8:11], s79 offen offset:0 sc1
    buffer_load_dwordx4 v[180:183], v1, s[8:11], s79 offen offset:1024 sc1
    buffer_load_dwordx4 v[184:187], v1, s[8:11], s79 offen offset:2048 sc1
    buffer_load_dwordx4 v[188:191], v1, s[8:11], s79 offen offset:3072 sc1
    s_add_u32 s79, s59, 0x4000
    buffer_load_dwordx4 v[192:195], v1, s[8:11], s79 offen offset:0 sc1
    buffer_load_dwordx4 v[196:199], v1, s[8:11], s79 offen offset:1024 sc1
    buffer_load_dwordx4 v[200:203], v1, s[8:11], s79 offen offset:2048 sc1
    buffer_load_dwordx4 v[204:207], v1, s[8:11], s79 offen offset:3072 sc1
    s_sub_u32 s45, s45, 1
    s_nop 0
    s_cbranch_scc1 L_end2
    s_waitcnt vmcnt(8)
    v_bitop3_b32 v7, v163, v167, v171 bitop3:0x80
    v_bitop3_b32 v7, v7, v175, 1 bitop3:0x2a
    v_cmp_ne_u32 vcc, 0, v7
    s_nop 4
    s_cbranch_vccnz CHK_482
    s_nop 0
    s_branch RET_484
OOL_486:
    s_nop 10
CHK_485:
    s_add_u32 s79, s59, 0x3000
    buffer_load_dwordx4 v[176:179], v1, s[8:11], s79 offen offset:0 sc1
    buffer_load_dwordx4 v[180:183], v1, s[8:11], s79 offen offset:1024 sc1
    buffer_load_dwordx4 v[184:187], v1, s[8:11], s79 offen offset:2048 sc1
    buffer_load_dwordx4 v[188:191], v1, s[8:11], s79 offen offset:3072 sc1
    s_add_u32 s79, s59, 0x4000
    buffer_load_dwordx4 v[192:195], v1, s[8:11], s79 offen offset:0 sc1
    buffer_load_dwordx4 v[196:199], v1, s[8:11], s79 offen offset:1024 sc1
    buffer_load_dwordx4 v[200:203], v1, s[8:11], s79 offen offset:2048 sc1
    buffer_load_dwordx4 v[204:207], v1, s[8:11], s79 offen offset:3072 sc1
    s_add_u32 s79, s59, 0x5000
    buffer_load_dwordx4 v[208:211], v1, s[8:11], s79 offen offset:0 sc1
    buffer_load_dwordx4 v[212:215], v1, s[8:11], s79 offen offset:1024 sc1
    buffer_load_dwordx4 v[216:219], v1, s[8:11], s79 offen offset:2048 sc1
    buffer_load_dwordx4 v[220:223], v1, s[8:11], s79 offen offset:3072 sc1
    s_sub_u32 s45, s45, 1
    s_nop 0
    s_cbranch_scc1 L_end2
    s_waitcnt vmcnt(8)
    v_bitop3_b32 v7, v179, v183, v187 bitop3:0x80
    v_bitop3_b32 v7, v7, v191, 1 bitop3:0x2a
    v_cmp_ne_u32 vcc, 0, v7
    s_nop 4
    s_cbranch_vccnz CHK_485
    s_nop 0
    s_branch RET_487
OOL_489:
    s_nop 10
CHK_488:
    s_add_u32 s79, s59, 0x4000
    buffer_load_dwordx4 v[192:195], v1, s[8:11], s79 offen offset:0 sc1
    buffer_load_dwordx4 v[196:199], v1, s[8:11], s79 offen offset:1024 sc1
    buffer_load_dwordx4 v[200:203], v1, s[8:11], s79 offen offset:2048 sc1
    buffer_load_dwordx4 v[204:207], v1, s[8:11], s79 offen offset:3072 sc1
    s_add_u32 s79, s59, 0x5000
    buffer_load_dwordx4 v[208:211], v1, s[8:11], s79 offen offset:0 sc1
    buffer_load_dwordx4 v[212:215], v1, s[8:11], s79 offen offset:1024 sc1
    buffer_load_dwordx4 v[216:219], v1, s[8:11], s79 offen offset:2048 sc1
    buffer_load_dwordx4 v[220:223], v1, s[8:11], s79 offen offset:3072 sc1
    s_add_u32 s79, s59, 0x6000
    buffer_load_dwordx4 v[224:227], v1, s[8:11], s79 offen offset:0 sc1
    buffer_load_dwordx4 v[228:231], v1, s[8:11], s79 offen offset:1024 sc1
    buffer_load_dwordx4 v[232:235], v1, s[8:11], s79 offen offset:2048 sc1
    buffer_load_dwordx4 v[236:239], v1, s[8:11], s79 offen offset:3072 sc1
    s_sub_u32 s45, s45, 1
    s_nop 0
    s_cbranch_scc1 L_end2
    s_waitcnt vmcnt(8)
    v_bitop3_b32 v7, v195, v199, v203 bitop3:0x80
    v_bitop3_b32 v7, v7, v207, 1 bitop3:0x2a
    v_cmp_ne_u32 vcc, 0, v7
    s_nop 4
    s_cbranch_vccnz CHK_488
    s_nop 0
    s_branch RET_490
OOL_492:
    s_nop 10
CHK_491:
    s_add_u32 s79, s59, 0x5000
    buffer_load_dwordx4 v[208:211], v1, s[8:11], s79 offen offset:0 sc1
    buffer_load_dwordx4 v[212:215], v1, s[8:11], s79 offen offset:1024 sc1
    buffer_load_dwordx4 v[216:219], v1, s[8:11], s79 offen offset:2048 sc1
    buffer_load_dwordx4 v[220:223], v1, s[8:11], s79 offen offset:3072 sc1
    s_add_u32 s79, s59, 0x6000
    buffer_load_dwordx4 v[224:227], v1, s[8:11], s79 offen offset:0 sc1
    buffer_load_dwordx4 v[228:231], v1, s[8:11], s79 offen offset:1024 sc1
    buffer_load_dwordx4 v[232:235], v1, s[8:11], s79 offen offset:2048 sc1
    buffer_load_dwordx4 v[236:239], v1, s[8:11], s79 offen offset:3072 sc1
    s_add_u32 s79, s59, 0x7000
    buffer_load_dwordx4 v[240:243], v1, s[8:11], s79 offen offset:0 sc1
    buffer_load_dwordx4 v[244:247], v1, s[8:11], s79 offen offset:1024 sc1
    buffer_load_dwordx4 v[248:251], v1, s[8:11], s79 offen offset:2048 sc1
    buffer_load_dwordx4 v[252:255], v1, s[8:11], s79 offen offset:3072 sc1
    s_sub_u32 s45, s45, 1
    s_nop 0
    s_cbranch_scc1 L_end2
    s_waitcnt vmcnt(8)
    v_bitop3_b32 v7, v211, v215, v219 bitop3:0x80
    v_bitop3_b32 v7, v7, v223, 1 bitop3:0x2a
    v_cmp_ne_u32 vcc, 0, v7
    s_nop 4
    s_cbranch_vccnz CHK_491
    s_nop 0
    s_branch RET_493
OOL_495:
    s_nop 10
CHK_494:
    s_add_u32 s79, s59, 0x6000
    buffer_load_dwordx4 v[224:227], v1, s[8:11], s79 offen offset:0 sc1
    buffer_load_dwordx4 v[228:231], v1, s[8:11], s79 offen offset:1024 sc1
    buffer_load_dwordx4 v[232:235], v1, s[8:11], s79 offen offset:2048 sc1
    buffer_load_dwordx4 v[236:239], v1, s[8:11], s79 offen offset:3072 sc1
    s_add_u32 s79, s59, 0x7000
    buffer_load_dwordx4 v[240:243], v1, s[8:11], s79 offen offset:0 sc1
    buffer_load_dwordx4 v[244:247], v1, s[8:11], s79 offen offset:1024 sc1
    buffer_load_dwordx4 v[248:251], v1, s[8:11], s79 offen offset:2048 sc1
    buffer_load_dwordx4 v[252:255], v1, s[8:11], s79 offen offset:3072 sc1
    buffer_load_dword v62, off, s[8:11], s62
    buffer_load_dword v62, off, s[8:11], s62
    buffer_load_dword v62, off, s[8:11], s62
    buffer_load_dword v62, off, s[8:11], s62
    s_sub_u32 s45, s45, 1
    s_nop 0
    s_cbranch_scc1 L_end2
    s_waitcnt vmcnt(8)
    v_bitop3_b32 v7, v227, v231, v235 bitop3:0x80
    v_bitop3_b32 v7, v7, v239, 1 bitop3:0x2a
    v_cmp_ne_u32 vcc, 0, v7
    s_nop 4
    s_cbranch_vccnz CHK_494
    s_nop 0
    s_branch RET_496
OOL_498:
    s_nop 10
CHK_497:
    buffer_load_dwordx4 v[112:115], v1, s[8:11], s77 offen offset:0 sc1
    buffer_load_dwordx4 v[116:119], v1, s[8:11], s77 offen offset:1024 sc1
    buffer_load_dwordx4 v[120:123], v1, s[8:11], s77 offen offset:2048 sc1
    buffer_load_dwordx4 v[124:127], v1, s[8:11], s77 offen offset:3072 sc1
    s_sub_u32 s45, s45, 1
    s_nop 0
    s_cbranch_scc1 L_end2
    s_waitcnt vmcnt(0)
    v_bitop3_b32 v7, v112, v113, v114 bitop3:0xfe
    v_bitop3_b32 v7, v7, v115, v116 bitop3:0xfe
    v_bitop3_b32 v7, v7, v117, v118 bitop3:0xfe
    v_bitop3_b32 v7, v7, v119, v120 bitop3:0xfe
    v_bitop3_b32 v7, v7, v121, v122 bitop3:0xfe
    v_bitop3_b32 v7, v7, v123, v124 bitop3:0xfe
    v_bitop3_b32 v7, v7, v125, v126 bitop3:0xfe
    v_bitop3_b32 v7, v7, v127, 1 bitop3:0xa8
    v_cmp_ne_u32 vcc, 0, v7
    s_nop 4
    s_cbranch_vccnz CHK_497
    s_nop 0
    s_branch RET_499
OOL_501:
    s_nop 10
CHK_500:
    s_add_u32 s79, s59, 0x7000
    buffer_load_dwordx4 v[240:243], v1, s[8:11], s79 offen offset:0 sc1
    buffer_load_dwordx4 v[244:247], v1, s[8:11], s79 offen offset:1024 sc1
    buffer_load_dwordx4 v[248:251], v1, s[8:11], s79 offen offset:2048 sc1
    buffer_load_dwordx4 v[252:255], v1, s[8:11], s79 offen offset:3072 sc1
    buffer_load_dword v62, off, s[8:11], s62
    buffer_load_dword v62, off, s[8:11], s62
    buffer_load_dword v62, off, s[8:11], s62
    buffer_load_dword v62, off, s[8:11], s62
    s_sub_u32 s45, s45, 1
    s_nop 0
    s_cbranch_scc1 L_end2
    s_waitcnt vmcnt(4)
    v_bitop3_b32 v7, v243, v247, v251 bitop3:0x80
    v_bitop3_b32 v7, v7, v255, 1 bitop3:0x2a
    v_cmp_ne_u32 vcc, 0, v7
    s_nop 4
    s_cbranch_vccnz CHK_500
    s_nop 0
    s_branch RET_502
OOL_504:
    s_nop 4
CHK_503:
    buffer_load_dwordx4 v[192:195], v1, s[8:11], s51 offen offset:0 sc1
    buffer_load_dwordx4 v[196:199], v1, s[8:11], s51 offen offset:1024 sc1
    buffer_load_dwordx4 v[200:203], v1, s[8:11], s51 offen offset:2048 sc1
    buffer_load_dwordx4 v[204:207], v1, s[8:11], s51 offen offset:3072 sc1
    s_add_u32 s78, s51, 0x1000
    buffer_load_dwordx4 v[208:211], v1, s[8:11], s78 offen offset:0 sc1
    buffer_load_dwordx4 v[212:215], v1, s[8:11], s78 offen offset:1024 sc1
    buffer_load_dwordx4 v[216:219], v1, s[8:11], s78 offen offset:2048 sc1
    buffer_load_dwordx4 v[220:223], v1, s[8:11], s78 offen offset:3072 sc1
    buffer_load_dwordx4 v[224:227], v1, s[8:11], s50 offen offset:0 sc1
    buffer_load_dwordx4 v[228:231], v1, s[8:11], s50 offen offset:1024 sc1
    buffer_load_dwordx4 v[232:235], v1, s[8:11], s50 offen offset:2048 sc1
    buffer_load_dwordx4 v[236:239], v1, s[8:11], s50 offen offset:3072 sc1
    buffer_load_dword v62, off, s[8:11], s62
    buffer_load_dword v62, off, s[8:11], s62
    buffer_load_dword v62, off, s[8:11], s62
    s_add_u32 s78, s50, 0x1000
    buffer_load_dwordx4 v[240:243], v1, s[8:11], s78 offen offset:0 sc1
    s_sub_u32 s45, s45, 1
    s_nop 0
    s_cbranch_scc1 L_end2
    s_waitcnt vmcnt(12)
    v_bitop3_b32 v7, v195, v199, v203 bitop3:0xfe
    v_bitop3_b32 v7, v7, v207, 1 bitop3:0xa8
    v_cmp_ne_u32 vcc, 0, v7
    s_nop 4
    s_cbranch_vccnz CHK_503
    s_nop 0
    s_branch RET_505
OOL_507:
    s_nop 10
CHK_506:
    buffer_load_dword v9, v8, s[8:11], 0 offen offset:128 sc1
    s_sub_u32 s45, s45, 1
    s_nop 0
    s_cbranch_scc1 L_end2
    s_waitcnt vmcnt(0)
    v_subrev_u32 v9, s69, v9
    v_subrev_u32 v9, 2, v9
    v_cmp_lt_u32 vcc, 7, v9
    s_nop 4
    s_cbranch_vccnz CHK_506
    s_nop 0
    s_branch RET_508
OOL_510:
    s_nop 10
CHK_509:
    s_add_u32 s78, s51, 0x1000
    buffer_load_dwordx4 v[208:211], v1, s[8:11], s78 offen offset:0 sc1
    buffer_load_dwordx4 v[212:215], v1, s[8:11], s78 offen offset:1024 sc1
    buffer_load_dwordx4 v[216:219], v1, s[8:11], s78 offen offset:2048 sc1
    buffer_load_dwordx4 v[220:223], v1, s[8:11], s78 offen offset:3072 sc1
    buffer_load_dwordx4 v[224:227], v1, s[8:11], s50 offen offset:0 sc1
    buffer_load_dwordx4 v[228:231], v1, s[8:11], s50 offen offset:1024 sc1
    buffer_load_dwordx4 v[232:235], v1, s[8:11], s50 offen offset:2048 sc1
    buffer_load_dwordx4 v[236:239], v1, s[8:11], s50 offen offset:3072 sc1
    buffer_load_dword v62, off, s[8:11], s62
    buffer_load_dword v62, off, s[8:11], s62
    buffer_load_dword v62, off, s[8:11], s62
    s_add_u32 s78, s50, 0x1000
    buffer_load_dwordx4 v[240:243], v1, s[8:11], s78 offen offset:0 sc1
    buffer_load_dwordx4 v[244:247], v1, s[8:11], s78 offen offset:1024 sc1
    buffer_load_dwordx4 v[248:251], v1, s[8:11], s78 offen offset:2048 sc1
    buffer_load_dwordx4 v[252:255], v1, s[8:11], s78 offen offset:3072 sc1
    s_add_u32 s78, s51, 0x8000
    buffer_load_dwordx4 v[144:147], v1, s[8:11], s78 offen offset:0 sc1
    s_sub_u32 s45, s45, 1
    s_nop 0
    s_cbranch_scc1 L_end2
    s_waitcnt vmcnt(12)
    v_bitop3_b32 v7, v211, v215, v219 bitop3:0xfe
    v_bitop3_b32 v7, v7, v223, 1 bitop3:0xa8
    v_cmp_ne_u32 vcc, 0, v7
    s_nop 4
    s_cbranch_vccnz CHK_509
    s_nop 0
    s_branch RET_511
OOL_513:
    s_nop 10
CHK_512:
    buffer_load_dwordx4 v[224:227], v1, s[8:11], s50 offen offset:0 sc1
    buffer_load_dwordx4 v[228:231], v1, s[8:11], s50 offen offset:1024 sc1
    buffer_load_dwordx4 v[232:235], v1, s[8:11], s50 offen offset:2048 sc1
    buffer_load_dwordx4 v[236:239], v1, s[8:11], s50 offen offset:3072 sc1
    buffer_load_dword v62, off, s[8:11], s62
    buffer_load_dword v62, off, s[8:11], s62
    buffer_load_dword v62, off, s[8:11], s62
    s_add_u32 s78, s50, 0x1000
    buffer_load_dwordx4 v[240:243], v1, s[8:11], s78 offen offset:0 sc1
    buffer_load_dwordx4 v[244:247], v1, s[8:11], s78 offen offset:1024 sc1
    buffer_load_dwordx4 v[248:251], v1, s[8:11], s78 offen offset:2048 sc1
    buffer_load_dwordx4 v[252:255], v1, s[8:11], s78 offen offset:3072 sc1
    s_add_u32 s78, s51, 0x8000
    buffer_load_dwordx4 v[144:147], v1, s[8:11], s78 offen offset:0 sc1
    buffer_load_dwordx4 v[148:151], v1, s[8:11], s78 offen offset:1024 sc1
    buffer_load_dwordx4 v[152:155], v1, s[8:11], s78 offen offset:2048 sc1
    buffer_load_dwordx4 v[156:159], v1, s[8:11], s78 offen offset:3072 sc1
    s_add_u32 s78, s51, 0x9000
    buffer_load_dwordx4 v[160:163], v1, s[8:11], s78 offen offset:0 sc1
    s_sub_u32 s45, s45, 1
    s_nop 0
    s_cbranch_scc1 L_end2
    s_waitcnt vmcnt(12)
    v_bitop3_b32 v7, v227, v231, v235 bitop3:0xfe
    v_bitop3_b32 v7, v7, v239, 1 bitop3:0xa8
    v_cmp_ne_u32 vcc, 0, v7
    s_nop 4
    s_cbranch_vccnz CHK_512
    s_nop 0
    s_branch RET_514
OOL_516:
    s_nop 10
CHK_515:
    s_add_u32 s78, s50, 0x1000
    buffer_load_dwordx4 v[240:243], v1, s[8:11], s78 offen offset:0 sc1
    buffer_load_dwordx4 v[244:247], v1, s[8:11], s78 offen offset:1024 sc1
    buffer_load_dwordx4 v[248:251], v1, s[8:11], s78 offen offset:2048 sc1
    buffer_load_dwordx4 v[252:255], v1, s[8:11], s78 offen offset:3072 sc1
    s_add_u32 s78, s51, 0x8000
    buffer_load_dwordx4 v[144:147], v1, s[8:11], s78 offen offset:0 sc1
    buffer_load_dwordx4 v[148:151], v1, s[8:11], s78 offen offset:1024 sc1
    buffer_load_dwordx4 v[152:155], v1, s[8:11], s78 offen offset:2048 sc1
    buffer_load_dwordx4 v[156:159], v1, s[8:11], s78 offen offset:3072 sc1
    s_add_u32 s78, s51, 0x9000
    buffer_load_dwordx4 v[160:163], v1, s[8:11], s78 offen offset:0 sc1
    buffer_load_dwordx4 v[164:167], v1, s[8:11], s78 offen offset:1024 sc1
    buffer_load_dwordx4 v[168:171], v1, s[8:11], s78 offen offset:2048 sc1
    buffer_load_dwordx4 v[172:175], v1, s[8:11], s78 offen offset:3072 sc1
    s_add_u32 s78, s50, 0x8000
    buffer_load_dwordx4 v[176:179], v1, s[8:11], s78 offen offset:0 sc1
    buffer_load_dword v62, off, s[8:11], s62
    buffer_load_dword v62, off, s[8:11], s62
    s_sub_u32 s45, s45, 1
    s_nop 0
    s_cbranch_scc1 L_end2
    s_waitcnt vmcnt(11)
    v_bitop3_b32 v7, v243, v247, v251 bitop3:0xfe
    v_bitop3_b32 v7, v7, v255, 1 bitop3:0xa8
    v_cmp_ne_u32 vcc, 0, v7
    s_nop 4
    s_cbranch_vccnz CHK_515
    s_nop 0
    s_branch RET_517
OOL_519:
    s_nop 10
CHK_518:
    s_add_u32 s78, s51, 0x8000
    buffer_load_dwordx4 v[144:147], v1, s[8:11], s78 offen offset:0 sc1
    buffer_load_dwordx4 v[148:151], v1, s[8:11], s78 offen offset:1024 sc1
    buffer_load_dwordx4 v[152:155], v1, s[8:11], s78 offen offset:2048 sc1
    buffer_load_dwordx4 v[156:159], v1, s[8:11], s78 offen offset:3072 sc1
    s_add_u32 s78, s51, 0x9000
    buffer_load_dwordx4 v[160:163], v1, s[8:11], s78 offen offset:0 sc1
    buffer_load_dwordx4 v[164:167], v1, s[8:11], s78 offen offset:1024 sc1
    buffer_load_dwordx4 v[168:171], v1, s[8:11], s78 offen offset:2048 sc1
    buffer_load_dwordx4 v[172:175], v1, s[8:11], s78 offen offset:3072 sc1
    s_add_u32 s78, s50, 0x8000
    buffer_load_dwordx4 v[176:179], v1, s[8:11], s78 offen offset:0 sc1
    buffer_load_dword v62, off, s[8:11], s62
    buffer_load_dword v62, off, s[8:11], s62
    buffer_load_dwordx4 v[180:183], v1, s[8:11], s78 offen offset:1024 sc1
    buffer_load_dwordx4 v[184:187], v1, s[8:11], s78 offen offset:2048 sc1
    buffer_load_dwordx4 v[188:191], v1, s[8:11], s78 offen offset:3072 sc1
    s_add_u32 s78, s50, 0x9000
    buffer_load_dwordx4 v[192:195], v1, s[8:11], s78 offen offset:0 sc1
    s_sub_u32 s45, s45, 1
    s_nop 0
    s_cbranch_scc1 L_end2
    s_waitcnt vmcnt(11)
    v_bitop3_b32 v7, v147, v151, v155 bitop3:0xfe
    v_bitop3_b32 v7, v7, v159, 1 bitop3:0xa8
    v_cmp_ne_u32 vcc, 0, v7
    s_nop 4
    s_cbranch_vccnz CHK_518
    s_nop 0
    s_branch RET_520
OOL_522:
    s_nop 10
CHK_521:
    s_add_u32 s78, s51, 0x9000
    buffer_load_dwordx4 v[160:163], v1, s[8:11], s78 offen offset:0 sc1
    buffer_load_dwordx4 v[164:167], v1, s[8:11], s78 offen offset:1024 sc1
    buffer_load_dwordx4 v[168:171], v1, s[8:11], s78 offen offset:2048 sc1
    buffer_load_dwordx4 v[172:175], v1, s[8:11], s78 offen offset:3072 sc1
    s_add_u32 s78, s50, 0x8000
    buffer_load_dwordx4 v[176:179], v1, s[8:11], s78 offen offset:0 sc1
    buffer_load_dword v62, off, s[8:11], s62
    buffer_load_dword v62, off, s[8:11], s62
    buffer_load_dwordx4 v[180:183], v1, s[8:11], s78 offen offset:1024 sc1
    buffer_load_dwordx4 v[184:187], v1, s[8:11], s78 offen offset:2048 sc1
    buffer_load_dwordx4 v[188:191], v1, s[8:11], s78 offen offset:3072 sc1
    s_add_u32 s78, s50, 0x9000
    buffer_load_dwordx4 v[192:195], v1, s[8:11], s78 offen offset:0 sc1
    buffer_load_dwordx4 v[196:199], v1, s[8:11], s78 offen offset:1024 sc1
    buffer_load_dwordx4 v[200:203], v1, s[8:11], s78 offen offset:2048 sc1
    buffer_load_dwordx4 v[204:207], v1, s[8:11], s78 offen offset:3072 sc1
    buffer_load_dwordx4 v[208:211], v1, s[8:11], s53 offen offset:0 sc1
    buffer_load_dword v62, off, s[8:11], s62
    buffer_load_dword v62, off, s[8:11], s62
    s_sub_u32 s45, s45, 1
    s_nop 0
    s_cbranch_scc1 L_end2
    s_waitcnt vmcnt(13)
    v_bitop3_b32 v7, v163, v167, v171 bitop3:0xfe
    v_bitop3_b32 v7, v7, v175, 1 bitop3:0xa8
    v_cmp_ne_u32 vcc, 0, v7
    s_nop 4
    s_cbranch_vccnz CHK_521
    s_nop 0
    s_branch RET_523
OOL_525:
    s_nop 10
CHK_524:
    s_add_u32 s78, s50, 0x8000
    buffer_load_dwordx4 v[176:179], v1, s[8:11], s78 offen offset:0 sc1
    buffer_load_dword v62, off, s[8:11], s62
    buffer_load_dword v62, off, s[8:11], s62
    buffer_load_dwordx4 v[180:183], v1, s[8:11], s78 offen offset:1024 sc1
    buffer_load_dwordx4 v[184:187], v1, s[8:11], s78 offen offset:2048 sc1
    buffer_load_dwordx4 v[188:191], v1, s[8:11], s78 offen offset:3072 sc1
    s_add_u32 s78, s50, 0x9000
    buffer_load_dwordx4 v[192:195], v1, s[8:11], s78 offen offset:0 sc1
    buffer_load_dwordx4 v[196:199], v1, s[8:11], s78 offen offset:1024 sc1
    buffer_load_dwordx4 v[200:203], v1, s[8:11], s78 offen offset:2048 sc1
    buffer_load_dwordx4 v[204:207], v1, s[8:11], s78 offen offset:3072 sc1
    buffer_load_dwordx4 v[208:211], v1, s[8:11], s53 offen offset:0 sc1
    buffer_load_dword v62, off, s[8:11], s62
    buffer_load_dword v62, off, s[8:11], s62
    buffer_load_dwordx4 v[212:215], v1, s[8:11], s53 offen offset:1024 sc1
    buffer_load_dwordx4 v[216:219], v1, s[8:11], s53 offen offset:2048 sc1
    buffer_load_dwordx4 v[220:223], v1, s[8:11], s53 offen offset:3072 sc1
    s_add_u32 s78, s53, 0x1000
    buffer_load_dwordx4 v[224:227], v1, s[8:11], s78 offen offset:0 sc1
    s_sub_u32 s45, s45, 1
    s_nop 0
    s_cbranch_scc1 L_end2
    s_waitcnt vmcnt(11)
    v_bitop3_b32 v7, v179, v183, v187 bitop3:0xfe
    v_bitop3_b32 v7, v7, v191, 1 bitop3:0xa8
    v_cmp_ne_u32 vcc, 0, v7
    s_nop 4
    s_cbranch_vccnz CHK_524
    s_nop 0
    s_branch RET_526
OOL_528:
    s_nop 10
CHK_527:
    s_add_u32 s78, s50, 0x9000
    buffer_load_dwordx4 v[192:195], v1, s[8:11], s78 offen offset:0 sc1
    buffer_load_dwordx4 v[196:199], v1, s[8:11], s78 offen offset:1024 sc1
    buffer_load_dwordx4 v[200:203], v1, s[8:11], s78 offen offset:2048 sc1
    buffer_load_dwordx4 v[204:207], v1, s[8:11], s78 offen offset:3072 sc1
    buffer_load_dwordx4 v[208:211], v1, s[8:11], s53 offen offset:0 sc1
    buffer_load_dword v62, off, s[8:11], s62
    buffer_load_dword v62, off, s[8:11], s62
    buffer_load_dwordx4 v[212:215], v1, s[8:11], s53 offen offset:1024 sc1
    buffer_load_dwordx4 v[216:219], v1, s[8:11], s53 offen offset:2048 sc1
    buffer_load_dwordx4 v[220:223], v1, s[8:11], s53 offen offset:3072 sc1
    s_add_u32 s78, s53, 0x1000
    buffer_load_dwordx4 v[224:227], v1, s[8:11], s78 offen offset:0 sc1
    buffer_load_dwordx4 v[228:231], v1, s[8:11], s78 offen offset:1024 sc1
    buffer_load_dwordx4 v[232:235], v1, s[8:11], s52 offen offset:0 sc1
    buffer_load_dwordx4 v[236:239], v1, s[8:11], s52 offen offset:1024 sc1
    buffer_load_dwordx4 v[240:243], v1, s[8:11], s52 offen offset:2048 sc1
    s_sub_u32 s45, s45, 1
    s_nop 0
    s_cbranch_scc1 L_end2
    s_waitcnt vmcnt(11)
    v_bitop3_b32 v7, v195, v199, v203 bitop3:0xfe
    v_bitop3_b32 v7, v7, v207, 1 bitop3:0xa8
    v_cmp_ne_u32 vcc, 0, v7
    s_nop 4
    s_cbranch_vccnz CHK_527
    s_nop 0
    s_branch RET_529
OOL_531:
    s_nop 10
CHK_530:
    buffer_load_dwordx4 v[208:211], v1, s[8:11], s53 offen offset:0 sc1
    buffer_load_dword v62, off, s[8:11], s62
    buffer_load_dword v62, off, s[8:11], s62
    buffer_load_dwordx4 v[212:215], v1, s[8:11], s53 offen offset:1024 sc1
    buffer_load_dwordx4 v[216:219], v1, s[8:11], s53 offen offset:2048 sc1
    buffer_load_dwordx4 v[220:223], v1, s[8:11], s53 offen offset:3072 sc1
    s_add_u32 s78, s53, 0x1000
    buffer_load_dwordx4 v[224:227], v1, s[8:11], s78 offen offset:0 sc1
    buffer_load_dwordx4 v[228:231], v1, s[8:11], s78 offen offset:1024 sc1
    buffer_load_dwordx4 v[232:235], v1, s[8:11], s52 offen offset:0 sc1
    buffer_load_dwordx4 v[236:239], v1, s[8:11], s52 offen offset:1024 sc1
    buffer_load_dwordx4 v[240:243], v1, s[8:11], s52 offen offset:2048 sc1
    buffer_load_dwordx4 v[244:247], v1, s[8:11], s52 offen offset:3072 sc1
    s_add_u32 s78, s52, 0x1000
    buffer_load_dwordx4 v[248:251], v1, s[8:11], s78 offen offset:0 sc1
    buffer_load_dwordx4 v[252:255], v1, s[8:11], s78 offen offset:1024 sc1
    s_add_u32 s78, s53, 0x1800
    buffer_load_dwordx4 v[144:147], v1, s[8:11], s78 offen offset:0 sc1
    s_sub_u32 s45, s45, 1
    s_nop 0
    s_cbranch_scc1 L_end2
    s_waitcnt vmcnt(9)
    v_bitop3_b32 v7, v211, v215, v219 bitop3:0xfe
    v_bitop3_b32 v7, v7, v223, 1 bitop3:0xa8
    v_cmp_ne_u32 vcc, 0, v7
    s_nop 4
    s_cbranch_vccnz CHK_530
    s_nop 0
    s_branch RET_532
OOL_534:
    s_nop 10
CHK_533:
    s_add_u32 s78, s53, 0x1000
    buffer_load_dwordx4 v[224:227], v1, s[8:11], s78 offen offset:0 sc1
    buffer_load_dwordx4 v[228:231], v1, s[8:11], s78 offen offset:1024 sc1
    buffer_load_dwordx4 v[232:235], v1, s[8:11], s52 offen offset:0 sc1
    buffer_load_dwordx4 v[236:239], v1, s[8:11], s52 offen offset:1024 sc1
    buffer_load_dwordx4 v[240:243], v1, s[8:11], s52 offen offset:2048 sc1
    buffer_load_dwordx4 v[244:247], v1, s[8:11], s52 offen offset:3072 sc1
    s_add_u32 s78, s52, 0x1000
    buffer_load_dwordx4 v[248:251], v1, s[8:11], s78 offen offset:0 sc1
    buffer_load_dwordx4 v[252:255], v1, s[8:11], s78 offen offset:1024 sc1
    s_add_u32 s78, s53, 0x1800
    buffer_load_dwordx4 v[144:147], v1, s[8:11], s78 offen offset:0 sc1
    buffer_load_dwordx4 v[148:151], v1, s[8:11], s78 offen offset:1024 sc1
    buffer_load_dwordx4 v[152:155], v1, s[8:11], s78 offen offset:2048 sc1
    buffer_load_dwordx4 v[156:159], v1, s[8:11], s78 offen offset:3072 sc1
    s_add_u32 s78, s53, 0x2800
    buffer_load_dwordx4 v[160:163], v1, s[8:11], s78 offen offset:0 sc1
    s_sub_u32 s45, s45, 1
    s_nop 0
    s_cbranch_scc1 L_end2
    s_waitcnt vmcnt(11)
    v_bitop3_b32 v7, v227, v231, 1 bitop3:0xa8
    v_cmp_ne_u32 vcc, 0, v7
    s_nop 4
    s_cbranch_vccnz CHK_533
    s_nop 0
    s_branch RET_535
OOL_537:
    s_nop 10
CHK_536:
    buffer_load_dwordx4 v[232:235], v1, s[8:11], s52 offen offset:0 sc1
    buffer_load_dwordx4 v[236:239], v1, s[8:11], s52 offen offset:1024 sc1
    buffer_load_dwordx4 v[240:243], v1, s[8:11], s52 offen offset:2048 sc1
    buffer_load_dwordx4 v[244:247], v1, s[8:11], s52 offen offset:3072 sc1
    s_add_u32 s78, s52, 0x1000
    buffer_load_dwordx4 v[248:251], v1, s[8:11], s78 offen offset:0 sc1
    buffer_load_dwordx4 v[252:255], v1, s[8:11], s78 offen offset:1024 sc1
    s_add_u32 s78, s53, 0x1800
    buffer_load_dwordx4 v[144:147], v1, s[8:11], s78 offen offset:0 sc1
    buffer_load_dwordx4 v[148:151], v1, s[8:11], s78 offen offset:1024 sc1
    buffer_load_dwordx4 v[152:155], v1, s[8:11], s78 offen offset:2048 sc1
    buffer_load_dwordx4 v[156:159], v1, s[8:11], s78 offen offset:3072 sc1
    s_add_u32 s78, s53, 0x2800
    buffer_load_dwordx4 v[160:163], v1, s[8:11], s78 offen offset:0 sc1
    buffer_load_dwordx4 v[164:167], v1, s[8:11], s78 offen offset:1024 sc1
    s_add_u32 s78, s52, 0x1800
    buffer_load_dwordx4 v[168:171], v1, s[8:11], s78 offen offset:0 sc1
    s_sub_u32 s45, s45, 1
    s_nop 0
    s_cbranch_scc1 L_end2
    s_waitcnt vmcnt(9)
    v_bitop3_b32 v7, v235, v239, v243 bitop3:0xfe
    v_bitop3_b32 v7, v7, v247, 1 bitop3:0xa8
    v_cmp_ne_u32 vcc, 0, v7
    s_nop 4
    s_cbranch_vccnz CHK_536
    s_nop 0
    s_branch RET_538
OOL_540:
    s_nop 10
CHK_539:
    s_add_u32 s78, s52, 0x1000
    buffer_load_dwordx4 v[248:251], v1, s[8:11], s78 offen offset:0 sc1
    buffer_load_dwordx4 v[252:255], v1, s[8:11], s78 offen offset:1024 sc1
    s_add_u32 s78, s53, 0x1800
    buffer_load_dwordx4 v[144:147], v1, s[8:11], s78 offen offset:0 sc1
    buffer_load_dwordx4 v[148:151], v1, s[8:11], s78 offen offset:1024 sc1
    buffer_load_dwordx4 v[152:155], v1, s[8:11], s78 offen offset:2048 sc1
    buffer_load_dwordx4 v[156:159], v1, s[8:11], s78 offen offset:3072 sc1
    s_add_u32 s78, s53, 0x2800
    buffer_load_dwordx4 v[160:163], v1, s[8:11], s78 offen offset:0 sc1
    buffer_load_dwordx4 v[164:167], v1, s[8:11], s78 offen offset:1024 sc1
    s_add_u32 s78, s52, 0x1800
    buffer_load_dwordx4 v[168:171], v1, s[8:11], s78 offen offset:0 sc1
    buffer_load_dwordx4 v[172:175], v1, s[8:11], s78 offen offset:1024 sc1
    buffer_load_dwordx4 v[176:179], v1, s[8:11], s78 offen offset:2048 sc1
    buffer_load_dwordx4 v[180:183], v1, s[8:11], s78 offen offset:3072 sc1
    s_add_u32 s78, s52, 0x2800
    buffer_load_dwordx4 v[184:187], v1, s[8:11], s78 offen offset:0 sc1
    s_sub_u32 s45, s45, 1
    s_nop 0
    s_cbranch_scc1 L_end2
    s_waitcnt vmcnt(11)
    v_bitop3_b32 v7, v251, v255, 1 bitop3:0xa8
    v_cmp_ne_u32 vcc, 0, v7
    s_nop 4
    s_cbranch_vccnz CHK_539
    s_nop 0
    s_branch RET_541
OOL_543:
    s_nop 10
CHK_542:
    s_add_u32 s78, s53, 0x1800
    buffer_load_dwordx4 v[144:147], v1, s[8:11], s78 offen offset:0 sc1
    buffer_load_dwordx4 v[148:151], v1, s[8:11], s78 offen offset:1024 sc1
    buffer_load_dwordx4 v[152:155], v1, s[8:11], s78 offen offset:2048 sc1
    buffer_load_dwordx4 v[156:159], v1, s[8:11], s78 offen offset:3072 sc1
    s_add_u32 s78, s53, 0x2800
    buffer_load_dwordx4 v[160:163], v1, s[8:11], s78 offen offset:0 sc1
    buffer_load_dwordx4 v[164:167], v1, s[8:11], s78 offen offset:1024 sc1
    s_add_u32 s78, s52, 0x1800
    buffer_load_dwordx4 v[168:171], v1, s[8:11], s78 offen offset:0 sc1
    buffer_load_dwordx4 v[172:175], v1, s[8:11], s78 offen offset:1024 sc1
    buffer_load_dwordx4 v[176:179], v1, s[8:11], s78 offen offset:2048 sc1
    buffer_load_dwordx4 v[180:183], v1, s[8:11], s78 offen offset:3072 sc1
    s_add_u32 s78, s52, 0x2800
    buffer_load_dwordx4 v[184:187], v1, s[8:11], s78 offen offset:0 sc1
    buffer_load_dwordx4 v[188:191], v1, s[8:11], s78 offen offset:1024 sc1
    s_sub_u32 s45, s45, 1
    s_nop 0
    s_cbranch_scc1 L_end2
    s_waitcnt vmcnt(8)
    v_bitop3_b32 v7, v147, v151, v155 bitop3:0xfe
    v_bitop3_b32 v7, v7, v159, 1 bitop3:0xa8
    v_cmp_ne_u32 vcc, 0, v7
    s_nop 4
    s_cbranch_vccnz CHK_542
    s_nop 0
    s_branch RET_544
OOL_546:
    s_nop 10
CHK_545:
    s_add_u32 s78, s53, 0x2800
    buffer_load_dwordx4 v[160:163], v1, s[8:11], s78 offen offset:0 sc1
    buffer_load_dwordx4 v[164:167], v1, s[8:11], s78 offen offset:1024 sc1
    s_add_u32 s78, s52, 0x1800
    buffer_load_dwordx4 v[168:171], v1, s[8:11], s78 offen offset:0 sc1
    buffer_load_dwordx4 v[172:175], v1, s[8:11], s78 offen offset:1024 sc1
    buffer_load_dwordx4 v[176:179], v1, s[8:11], s78 offen offset:2048 sc1
    buffer_load_dwordx4 v[180:183], v1, s[8:11], s78 offen offset:3072 sc1
    s_add_u32 s78, s52, 0x2800
    buffer_load_dwordx4 v[184:187], v1, s[8:11], s78 offen offset:0 sc1
    buffer_load_dwordx4 v[188:191], v1, s[8:11], s78 offen offset:1024 sc1
    s_sub_u32 s45, s45, 1
    s_nop 0
    s_cbranch_scc1 L_end2
    s_waitcnt vmcnt(6)
    v_bitop3_b32 v7, v163, v167, 1 bitop3:0xa8
    v_cmp_ne_u32 vcc, 0, v7
    s_nop 4
    s_cbranch_vccnz CHK_545
    s_nop 0
    s_branch RET_547
OOL_549:
    s_nop 10
CHK_548:
    s_add_u32 s78, s52, 0x1800
    buffer_load_dwordx4 v[168:171], v1, s[8:11], s78 offen offset:0 sc1
    buffer_load_dwordx4 v[172:175], v1, s[8:11], s78 offen offset:1024 sc1
    buffer_load_dwordx4 v[176:179], v1, s[8:11], s78 offen offset:2048 sc1
    buffer_load_dwordx4 v[180:183], v1, s[8:11], s78 offen offset:3072 sc1
    s_add_u32 s78, s52, 0x2800
    buffer_load_dwordx4 v[184:187], v1, s[8:11], s78 offen offset:0 sc1
    buffer_load_dwordx4 v[188:191], v1, s[8:11], s78 offen offset:1024 sc1
    s_sub_u32 s45, s45, 1
    s_nop 0
    s_cbranch_scc1 L_end2
    s_waitcnt vmcnt(2)
    v_bitop3_b32 v7, v171, v175, v179 bitop3:0xfe
    v_bitop3_b32 v7, v7, v183, 1 bitop3:0xa8
    v_cmp_ne_u32 vcc, 0, v7
    s_nop 4
    s_cbranch_vccnz CHK_548
    s_nop 0
    s_branch RET_550
OOL_552:
    s_nop 10
CHK_551:
    s_add_u32 s78, s52, 0x2800
    buffer_load_dwordx4 v[184:187], v1, s[8:11], s78 offen offset:0 sc1
    buffer_load_dwordx4 v[188:191], v1, s[8:11], s78 offen offset:1024 sc1
    s_sub_u32 s45, s45, 1
    s_nop 0
    s_cbranch_scc1 L_end2
    s_waitcnt vmcnt(0)
    v_bitop3_b32 v7, v187, v191, 1 bitop3:0xa8
    v_cmp_ne_u32 vcc, 0, v7
    s_nop 4
    s_cbranch_vccnz CHK_551
    s_nop 0
    s_branch RET_553
OOL_554:
    s_mov_b64 exec, 1
    buffer_store_dword v18, off, s[8:11], s77 sc1
    s_mov_b64 exec, -1
    s_nop 0
    s_branch RET_555
.section .rodata,"a"
.p2align 6
.amdhsa_kernel interleave_layers__ssm_conv_h3__mixer_s_mlp__prompt_kernel
  .amdhsa_next_free_vgpr 512
  .amdhsa_next_free_sgpr 102
  .amdhsa_accum_offset 256
  .amdhsa_group_segment_fixed_size 0
  .amdhsa_kernarg_size 112
  .amdhsa_user_sgpr_count 2
  .amdhsa_user_sgpr_kernarg_segment_ptr 1
  .amdhsa_system_sgpr_workgroup_id_x 1
.end_amdhsa_kernel
```
